```python
import torch

def _softmax(x, axis=-1):
    return torch.softmax(x, dim=axis)
def _gelu(x):
    return torch.nn.functional.gelu(x, approximate="tanh")
def _silu(x):
    return torch.nn.functional.silu(x)
def _sigmoid(x):
    return torch.sigmoid(x)
def _layernorm(x, axis=-1, eps=1e-5):
    m = x.mean(dim=axis, keepdim=True)
    v = x.var(dim=axis, keepdim=True, unbiased=False)
    return (x - m) / torch.sqrt(v + eps)
def _scatter_add(tgt, idx, src, axis=0):
    return tgt.clone().index_add_(axis, idx, src)
def _segment_sum(src, seg, n):
    out = torch.zeros((n,) + src.shape[1:], dtype=src.dtype)
    return out.index_add_(0, seg, src)
def _pad(x, pw):
    flat = tuple(v for pair in reversed(pw) for v in pair)
    return torch.nn.functional.pad(x, flat)

kernel_name = 'parallel_sum__linear_attn_block__glu_gated_swiglu__prompt'

def setup_inputs():

    _w = (lambda a: (lambda t: t.to(torch.bfloat16) if t.is_floating_point() else t)(torch.as_tensor(a)))
    def _A_setup():
        B, S, D = 1, 2048, 576
        return {
            "x": _w((lambda *s: torch.randn(*s, dtype=torch.bfloat16) * 0.05)(B, S, D)),
            "wqkv": _w((lambda *s: torch.randn(*s, dtype=torch.bfloat16) * 0.05)(D, 3 * D)),
            "wo": _w((lambda *s: torch.randn(*s, dtype=torch.bfloat16) * 0.05)(D, D)),
        }
    _A_in = _A_setup()

    def _B_setup():
        B, S, D, F = 1, 2048, 576, 4608
        return {
            "x": _w((lambda *s: torch.randn(*s, dtype=torch.bfloat16) * 0.05)(B, S, D)),
            "w1": _w((lambda *s: torch.randn(*s, dtype=torch.bfloat16) * 0.2)(D, F) * (2.0 / D) ** 0.5),
            "w3": _w((lambda *s: torch.randn(*s, dtype=torch.bfloat16) * 0.2)(D, F) * (2.0 / D) ** 0.5),
            "w2": _w((lambda *s: torch.randn(*s, dtype=torch.bfloat16) * 0.2)(F, D) * (2.0 / F) ** 0.5),
        }
    _B_in = _B_setup()

    return {
        "A_x": _A_in["x"],
        "A_wqkv": _A_in["wqkv"],
        "A_wo": _A_in["wo"],
        "B_x": _B_in["x"],
        "B_w1": _B_in["w1"],
        "B_w3": _B_in["w3"],
        "B_w2": _B_in["w2"],
    }

def reference(A_x, A_wqkv, A_wo, B_x, B_w1, B_w3, B_w2):
    def _A_ref(x, wqkv, wo):
        B, S, D = x.shape
        H = 32; Dh = D // H
        qkv = (lambda x, *d: x.permute(*d))((x @ wqkv).reshape(B, S, 3, H, Dh), 2, 0, 3, 1, 4)
        q, k, v = qkv[0], qkv[1], qkv[2]
        phi = lambda t: torch.where(t > 0, t + 1, torch.exp(t)) + 1e-6
        pq, pk = phi(q), phi(k)
        kv = torch.einsum("bhsd,bhse->bhde", pk, v)
        z = torch.einsum("bhsd->bhd", pk)
        num = torch.einsum("bhqd,bhde->bhqe", pq, kv)
        den = torch.einsum("bhqd,bhd->bhq", pq, z)[..., None] + 1e-6
        o = num / den
        return (lambda x, *d: x.permute(*d))(o, 0, 2, 1, 3).reshape(B, S, D) @ wo

    def _B_ref(x, w1, w3, w2):
        gate = torch.einsum("bsd,df->bsf", x, w1)
        up = torch.einsum("bsd,df->bsf", x, w3)
        h = _silu(gate) * up
        out = torch.einsum("bsf,fd->bsd", h, w2)
        return out

    x = A_x
    xn = _layernorm(x, axis=-1)
    return x + _A_ref(xn, A_wqkv, A_wo) + _B_ref(xn, B_w1, B_w3, B_w2)
```

```asm
; @launch grid=(256,1,1) block=(256,1,1) lds=163840
.amdgcn_target "amdgcn-amd-amdhsa--gfx950"
.text
.globl parallel_sum__linear_attn_block__glu_gated_swiglu__prompt_kernel
.p2align 8
.type parallel_sum__linear_attn_block__glu_gated_swiglu__prompt_kernel,@function
parallel_sum__linear_attn_block__glu_gated_swiglu__prompt_kernel:
    s_cmp_ge_u32 s2, 256
    s_cbranch_scc1 L_end
    s_load_dwordx16 s[4:19], s[0:1], 0
    s_load_dwordx4 s[20:23], s[0:1], 64
    s_getpc_b64 s[60:61]
Lpc_1:
    s_sub_u32 s40, s60, Lpc_1-parallel_sum__linear_attn_block__glu_gated_swiglu__prompt_kernel
    s_subb_u32 s41, s61, 0
    s_and_b32 s41, s41, 0xffff
    s_mov_b32 s42, L_code_end-parallel_sum__linear_attn_block__glu_gated_swiglu__prompt_kernel
    s_mov_b32 s43, 0x20000
    s_lshr_b32 s52, s2, 4
    s_lshl_b32 s52, s52, 12
    s_bitcmp1_b32 s2, 3
    s_cselect_b32 s49, (L_attn-parallel_sum__linear_attn_block__glu_gated_swiglu__prompt_kernel)&0xffffff80, 0
    s_add_u32 s52, s52, s49
    v_lshlrev_b32 v63, 4, v0
    buffer_load_dword v62, v63, s[40:43], s52 offen
    v_and_b32 v174, 63, v0
    v_lshrrev_b32 v1, 6, v0
    v_cmp_eq_u32 vcc, 0xc0, v0
    v_readfirstlane_b32 s48, v1
    v_mov_b32 v1, 0x7f000000
    s_lshr_b32 s78, s2, 6
    v_cndmask_b32 v216, v1, v174, vcc
    v_and_b32 v1, 31, v0
    v_lshlrev_b32 v217, 2, v1
    s_and_b32 s51, s2, 7
    s_bfe_u32 s50, s2, 0x30003
    s_mul_i32 s81, s78, 0
    s_add_u32 s81, s81, s50
    s_cmp_ge_u32 s81, 9
    s_cselect_b32 s52, 9, 0
    s_sub_u32 s81, s81, s52
    s_lshl_b32 s52, s50, 14
    s_lshl_b32 s49, s48, 12
    s_add_u32 s52, s52, s49
    v_lshl_add_u32 v175, v174, 4, s52
    s_lshl_b32 s80, s50, 10
    s_add_u32 s80, s80, 0x80000
    s_lshl_b32 s52, s2, 2
    s_add_u32 s52, s52, s48
    v_lshrrev_b32 v40, 5, v174
    v_lshl_add_u32 v40, s52, 1, v40
    v_mul_u32_u24 v41, 1152, v40
    v_and_b32 v42, 31, v174
    v_lshl_add_u32 v43, v42, 4, v41
    v_cmp_gt_u32 vcc, 8, v42
    v_mov_b32 v45, 0x7f000000
    v_lshlrev_b32 v40, 4, v40
    v_cndmask_b32 v44, v45, v43, vcc
    v_cmp_eq_u32 vcc, 0, v42
    s_mov_b32 s38, 0x240000
    s_mov_b32 s39, 0x20000
    s_waitcnt lgkmcnt(0)
    s_mov_b32 s36, s4
    s_and_b32 s37, s5, 0xffff
    buffer_load_dwordx4 v[0:3], v43, s[36:39], 0 offen
    buffer_load_dwordx4 v[4:7], v43, s[36:39], 0 offen offset:512
    buffer_load_dwordx4 v[8:11], v44, s[36:39], 0 offen offset:1024
    v_cndmask_b32 v40, v45, v40, vcc
    s_add_u32 s60, s22, 0x80000
    s_addc_u32 s61, s23, 0
    s_load_dword s79, s[60:61], 0
    s_mov_b32 s24, s22
    s_and_b32 s25, s23, 0xffff
    s_mov_b32 s26, 0x10000000
    s_mov_b32 s27, 0x20000
    s_cmp_eq_u32 s78, 3
    s_cbranch_scc1 L_attn
    v_lshrrev_b32 v64, 3, v174
    v_lshrrev_b32 v65, 1, v64
    v_xor_b32 v65, v65, v174
    v_and_b32 v65, 7, v65
    s_lshl_b32 s52, s50, 8
    s_lshl_b32 s49, s48, 6
    s_add_u32 s52, s52, s49
    v_add_u32 v64, s52, v64
    v_mul_u32_u24 v64, 1152, v64
    v_lshl_add_u32 v176, v65, 4, v64
    v_xor_b32 v177, 64, v176
    v_add_u32 v178, 16384, v176
    v_add_u32 v179, 24576, v177
    v_add_u32 v177, 8192, v177
    s_mul_i32 s34, s48, 24576
    s_add_u32 s34, s34, 65536
    s_lshl_b32 s32, s81, 7
    s_add_u32 m0, s34, 0
    s_add_u32 s54, s32, 0
    buffer_load_dwordx4 v176, s[36:39], s54 offen offset:0 lds
    buffer_load_dwordx4 v177, s[36:39], s54 offen offset:1024 lds
    buffer_load_dwordx4 v178, s[36:39], s54 offen offset:2048 lds
    buffer_load_dwordx4 v179, s[36:39], s54 offen offset:3072 lds
    s_add_u32 m0, s34, 4096
    s_add_u32 s54, s32, 36864
    buffer_load_dwordx4 v176, s[36:39], s54 offen offset:0 lds
    buffer_load_dwordx4 v177, s[36:39], s54 offen offset:1024 lds
    buffer_load_dwordx4 v178, s[36:39], s54 offen offset:2048 lds
    buffer_load_dwordx4 v179, s[36:39], s54 offen offset:3072 lds
    s_add_u32 s32, s32, 128
    s_cmp_ge_u32 s32, 1152
    s_cmov_b32 s32, 0
    s_cmp_ge_u32 s48, 2
    s_cselect_b32 s28, s14, s12
    s_cselect_b32 s29, s15, s13
    s_and_b32 s29, s29, 0xffff
    s_mov_b32 s30, 5308416
    s_mov_b32 s31, 0x20000
    s_mul_i32 s70, s51, 3
    s_add_u32 s70, s70, s78
    v_lshrrev_b32 v64, 3, v174
    v_and_b32 v65, 6, v64
    v_xor_b32 v65, v65, v174
    v_and_b32 v65, 7, v65
    v_and_b32 v172, 4, v64
    v_add_u32 v64, v64, v172
    v_mul_u32_u24 v64, 9216, v64
    v_lshl_add_u32 v172, v65, 4, v64
    s_mul_i32 s52, s70, 384
    s_and_b32 s49, s48, 1
    s_mul_i32 s49, s49, 36864
    s_add_u32 s52, s52, s49
    v_add_u32 v172, s52, v172
    v_add_u32 v173, 146432, v172
    s_lshl_b32 s53, s48, 11
    s_mul_i32 s33, s81, 589824
    s_add_u32 m0, s53, 0
    s_add_u32 s55, s33, 0
    buffer_load_dwordx4 v172, s[28:31], s55 offen lds
    buffer_load_dwordx4 v173, s[28:31], s55 offen offset:1024 lds
    s_add_u32 m0, s53, 8192
    s_add_u32 s55, s33, 294912
    buffer_load_dwordx4 v172, s[28:31], s55 offen lds
    buffer_load_dwordx4 v173, s[28:31], s55 offen offset:1024 lds
    s_add_u32 s4, s33, 589824
    s_cmp_ge_u32 s4, 5308416
    s_cmov_b32 s4, 0
    v_and_b32 v64, 15, v174
    v_lshrrev_b32 v65, 1, v64
    v_lshrrev_b32 v66, 4, v174
    v_xor_b32 v65, v65, v66
    v_lshlrev_b32 v64, 7, v64
    v_lshl_add_u32 v64, v65, 4, v64
    v_add_u32 v180, s34, v64
    v_xor_b32 v181, 64, v180
    v_lshrrev_b32 v64, 4, v174
    v_bfe_u32 v65, v174, 2, 3
    v_and_b32 v66, 3, v174
    v_lshrrev_b32 v64, 1, v64
    v_lshlrev_b32 v64, 10, v64
    v_lshl_add_u32 v64, v65, 7, v64
    v_lshl_add_u32 v64, v66, 3, v64
    v_lshrrev_b32 v65, 1, v65
    v_xor_b32 v66, 0, v65
    v_lshl_add_u32 v160, v66, 5, v64
    v_add_u32 v164, 0x10000, v160
    v_add_u32 v168, 0x20000, v160
    v_xor_b32 v66, 1, v65
    v_lshl_add_u32 v161, v66, 5, v64
    v_add_u32 v165, 0x10000, v161
    v_add_u32 v169, 0x20000, v161
    v_xor_b32 v66, 2, v65
    v_lshl_add_u32 v162, v66, 5, v64
    v_add_u32 v166, 0x10000, v162
    v_add_u32 v170, 0x20000, v162
    v_xor_b32 v66, 3, v65
    v_lshl_add_u32 v163, v66, 5, v64
    v_add_u32 v167, 0x10000, v163
    v_add_u32 v171, 0x20000, v163
    v_xor_b32 v66, s48, v65
    v_lshl_add_u32 v220, v66, 5, v64
    s_mov_b32 s68, s78
    s_mov_b32 s40, s16
    s_and_b32 s41, s17, 0xffff
    s_mov_b32 s42, 0x510000
    s_mov_b32 s43, 0x20000
    s_mov_b32 s44, s8
    s_and_b32 s45, s9, 0xffff
    s_mov_b32 s46, 0xa2000
    s_mov_b32 s47, 0x20000
    s_lshl_b32 s66, s48, 11
    s_lshr_b32 s60, s48, 1
    s_lshr_b32 s67, s51, 1
    s_mul_i32 s56, s60, 4128
    s_and_b32 s52, s67, 1
    s_lshl_b32 s52, s52, 6
    s_add_u32 s56, s56, s52
    s_lshr_b32 s74, s67, 1
    s_lshl_b32 s74, s74, 7
    s_and_b32 s49, s51, 6
    s_add_u32 s49, s49, s60
    s_mul_i32 s62, s49, 2359296
    s_add_u32 s62, s62, 2359296
    s_mul_i32 s63, s49, 663552
    s_mul_i32 s64, s49, 262144
    s_add_u32 s64, s64, 21233664
    s_mul_i32 s65, s49, 82944
    s_mul_i32 s57, s70, 786432
    s_add_u32 s57, s57, 2359296
    s_lshl_b32 s52, s51, 7
    s_add_u32 s69, s52, s80
    s_lshl2_add_u32 s69, s78, s69
    s_lshl_b32 s52, s49, 7
    s_add_u32 s71, s52, s80
    s_mul_i32 s82, s70, 12288
    s_add_u32 s82, s82, 65536
    s_lshl_b32 s83, s70, 7
    s_add_u32 s83, s83, 0x83000
    v_mov_b32 v191, 0x3f803f80
    v_mov_b32 v190, 0x3f803f80
    v_mov_b32 v189, 0x3f803f80
    v_mov_b32 v188, 0x3f803f80
    v_and_b32 v192, 15, v174
    v_lshlrev_b32 v192, 4, v192
    v_lshrrev_b32 v193, 4, v174
    v_lshlrev_b32 v222, 4, v174
    v_lshl_add_u32 v221, v193, 10, v192
    s_lshr_b32 s52, s48, 1
    s_lshl_b32 s52, s52, 11
    s_and_b32 s60, s48, 1
    s_lshl_b32 s60, s60, 3
    s_add_u32 s52, s52, s60
    s_lshr_b32 s60, s50, 1
    s_lshl_b32 s60, s60, 8
    s_add_u32 s52, s52, s60
    s_and_b32 s60, s50, 1
    s_lshl2_add_u32 s52, s60, s52
    v_add_u32 v221, s52, v221
    v_cmp_gt_u32 vcc, 32, v174
    v_mov_b32 v192, 0x7f000000
    s_nop 0
    v_cndmask_b32 v221, v192, v221, vcc
    s_cmp_eq_u32 s50, 7
    s_cselect_b32 s35, 0x3f803f80, 0
    v_mov_b32 v236, s35
    v_mov_b32 v237, s35
    v_mov_b32 v238, s35
    v_mov_b32 v239, s35
    v_cndmask_b32 v184, 0, v188, vcc
    v_xor_b32 v232, v184, v188
    v_cndmask_b32 v185, 0, v188, vcc
    v_xor_b32 v233, v185, v188
    v_cndmask_b32 v186, 0, v188, vcc
    v_xor_b32 v234, v186, v188
    v_cndmask_b32 v187, 0, v188, vcc
    v_xor_b32 v235, v187, v188
    s_add_u32 s61, s68, s50
    s_mul_i32 s60, s61, 43
    s_lshr_b32 s60, s60, 7
    s_mul_i32 s60, s60, 3
    s_sub_u32 s61, s61, s60
    s_add_u32 s52, s61, 0
    s_cmp_ge_u32 s52, 3
    s_cselect_b32 s60, 3, 0
    s_sub_u32 s52, s52, s60
    s_mul_i32 s60, s52, 221184
    s_add_u32 s14, s63, s60
    s_mul_i32 s60, s52, 786432
    s_add_u32 s12, s62, s60
    s_add_u32 s52, s61, 1
    s_cmp_ge_u32 s52, 3
    s_cselect_b32 s60, 3, 0
    s_sub_u32 s52, s52, s60
    s_mul_i32 s60, s52, 221184
    s_add_u32 s15, s63, s60
    s_mul_i32 s60, s52, 786432
    s_add_u32 s13, s62, s60
    s_add_u32 s52, s61, 2
    s_cmp_ge_u32 s52, 3
    s_cselect_b32 s60, 3, 0
    s_sub_u32 s52, s52, s60
    s_mul_i32 s60, s52, 221184
    s_add_u32 s3, s63, s60
    s_mul_i32 s60, s52, 786432
    s_add_u32 s62, s62, s60
    s_mov_b32 s49, 0x3f803f80
    s_waitcnt lgkmcnt(0)
    s_add_u32 s79, s79, 1
    v_mov_b32 v218, s79
    v_mov_b32 v17, s79
    v_mov_b32 v19, s79
    s_waitcnt vmcnt(12)
    v_dot2_f32_bf16 v12, v0, s49, 0
    v_dot2_f32_bf16 v13, v0, v0, 0
    v_dot2_f32_bf16 v12, v1, s49, v12
    v_dot2_f32_bf16 v13, v1, v1, v13
    v_dot2_f32_bf16 v12, v2, s49, v12
    v_dot2_f32_bf16 v13, v2, v2, v13
    v_dot2_f32_bf16 v12, v3, s49, v12
    v_dot2_f32_bf16 v13, v3, v3, v13
    v_dot2_f32_bf16 v12, v4, s49, v12
    v_dot2_f32_bf16 v13, v4, v4, v13
    v_dot2_f32_bf16 v12, v5, s49, v12
    v_dot2_f32_bf16 v13, v5, v5, v13
    v_dot2_f32_bf16 v12, v6, s49, v12
    v_dot2_f32_bf16 v13, v6, v6, v13
    v_dot2_f32_bf16 v12, v7, s49, v12
    v_dot2_f32_bf16 v13, v7, v7, v13
    v_dot2_f32_bf16 v12, v8, s49, v12
    v_dot2_f32_bf16 v13, v8, v8, v13
    v_dot2_f32_bf16 v12, v9, s49, v12
    v_dot2_f32_bf16 v13, v9, v9, v13
    v_dot2_f32_bf16 v12, v10, s49, v12
    v_dot2_f32_bf16 v13, v10, v10, v13
    v_dot2_f32_bf16 v12, v11, s49, v12
    v_dot2_f32_bf16 v13, v11, v11, v13
    s_mov_b32 s49, 0
    s_nop 1
    v_add_f32_dpp v12, v12, v12 row_ror:1 row_mask:0xf bank_mask:0xf
    v_add_f32_dpp v13, v13, v13 row_ror:1 row_mask:0xf bank_mask:0xf
    s_nop 0
    v_add_f32_dpp v12, v12, v12 row_ror:2 row_mask:0xf bank_mask:0xf
    v_add_f32_dpp v13, v13, v13 row_ror:2 row_mask:0xf bank_mask:0xf
    s_nop 0
    v_add_f32_dpp v12, v12, v12 row_ror:4 row_mask:0xf bank_mask:0xf
    v_add_f32_dpp v13, v13, v13 row_ror:4 row_mask:0xf bank_mask:0xf
    s_nop 0
    v_add_f32_dpp v12, v12, v12 row_ror:8 row_mask:0xf bank_mask:0xf
    v_add_f32_dpp v13, v13, v13 row_ror:8 row_mask:0xf bank_mask:0xf
    s_nop 0
    v_mov_b32 v14, v12
    v_mov_b32 v15, v13
    s_nop 1
    v_permlane16_swap_b32 v12, v14
    v_permlane16_swap_b32 v13, v15
    s_nop 0
    v_add_f32 v12, v12, v14
    v_add_f32 v13, v13, v15
    v_mul_f32 v12, 0x3ae38e39, v12
    v_mul_f32 v13, 0x3ae38e39, v13
    v_fma_f32 v13, -v12, v12, v13
    v_max_f32 v13, 0, v13
    v_cvt_pk_bf16_f32 v13, v13, v13
    v_cvt_pk_bf16_f32 v16, -v12, -v12
    v_and_b32 v13, 0xffff0000, v13
    v_add_f32 v13, 0x3727c5ac, v13
    v_cvt_pk_bf16_f32 v13, v13, v13
    v_and_b32 v13, 0xffff0000, v13
    v_sqrt_f32 v13, v13
    s_nop 0
    v_cvt_pk_bf16_f32 v13, v13, v13
    v_and_b32 v18, 0xffff0000, v13
    buffer_store_dwordx4 v[16:19], v40, s[24:27], s49 offen sc0 sc1
    s_waitcnt vmcnt(5)
    ds_read_b128 a[0:3], v180 offset:0
    ds_read_b128 a[4:7], v180 offset:2048
    ds_read_b128 a[8:11], v180 offset:4096
    ds_read_b128 a[12:15], v180 offset:6144
    ds_read_b128 a[16:19], v181 offset:0
    ds_read_b128 a[20:23], v181 offset:2048
    ds_read_b128 a[24:27], v181 offset:4096
    ds_read_b128 a[28:31], v181 offset:6144
    s_waitcnt vmcnt(1)
    s_barrier
    ds_read_b64_tr_b16 v[128:129], v160 offset:0
    ds_read_b64_tr_b16 v[130:131], v160 offset:2048
    ds_read_b64_tr_b16 v[132:133], v160 offset:8192
    ds_read_b64_tr_b16 v[134:135], v160 offset:10240
    ds_read_b64_tr_b16 v[136:137], v160 offset:4096
    ds_read_b64_tr_b16 v[138:139], v160 offset:6144
    ds_read_b64_tr_b16 v[140:141], v160 offset:12288
    ds_read_b64_tr_b16 v[142:143], v160 offset:14336
    s_waitcnt lgkmcnt(8)
    s_waitcnt lgkmcnt(4)
    v_mfma_f32_16x16x32_bf16 v[0:3], v[128:131], a[0:3], 0
    s_add_u32 m0, s34, 8192
    ds_read_b64_tr_b16 v[144:145], v162 offset:0
    s_add_u32 s54, s32, 0
    v_mfma_f32_16x16x32_bf16 v[0:3], v[132:135], a[16:19], v[0:3]
    buffer_load_dwordx4 v176, s[36:39], s54 offen offset:0 lds
    v_mfma_f32_16x16x32_bf16 v[4:7], v[128:131], a[4:7], 0
    ds_read_b64_tr_b16 v[146:147], v162 offset:2048
    v_mfma_f32_16x16x32_bf16 v[4:7], v[132:135], a[20:23], v[4:7]
    buffer_load_dwordx4 v177, s[36:39], s54 offen offset:1024 lds
    v_mfma_f32_16x16x32_bf16 v[8:11], v[128:131], a[8:11], 0
    ds_read_b64_tr_b16 v[148:149], v162 offset:8192
    v_mfma_f32_16x16x32_bf16 v[8:11], v[132:135], a[24:27], v[8:11]
    buffer_load_dwordx4 v178, s[36:39], s54 offen offset:2048 lds
    v_mfma_f32_16x16x32_bf16 v[12:15], v[128:131], a[12:15], 0
    ds_read_b64_tr_b16 v[150:151], v162 offset:10240
    v_mfma_f32_16x16x32_bf16 v[12:15], v[132:135], a[28:31], v[12:15]
    s_waitcnt lgkmcnt(4)
    buffer_load_dwordx4 v179, s[36:39], s54 offen offset:3072 lds
    v_mfma_f32_16x16x32_bf16 v[32:35], v[136:139], a[0:3], 0
    s_add_u32 m0, s34, 12288
    ds_read_b64_tr_b16 v[152:153], v162 offset:4096
    s_add_u32 s54, s32, 36864
    v_mfma_f32_16x16x32_bf16 v[32:35], v[140:143], a[16:19], v[32:35]
    buffer_load_dwordx4 v176, s[36:39], s54 offen offset:0 lds
    v_mfma_f32_16x16x32_bf16 v[36:39], v[136:139], a[4:7], 0
    ds_read_b64_tr_b16 v[154:155], v162 offset:6144
    v_mfma_f32_16x16x32_bf16 v[36:39], v[140:143], a[20:23], v[36:39]
    buffer_load_dwordx4 v177, s[36:39], s54 offen offset:1024 lds
    v_mfma_f32_16x16x32_bf16 v[40:43], v[136:139], a[8:11], 0
    ds_read_b64_tr_b16 v[156:157], v162 offset:12288
    v_mfma_f32_16x16x32_bf16 v[40:43], v[140:143], a[24:27], v[40:43]
    buffer_load_dwordx4 v178, s[36:39], s54 offen offset:2048 lds
    v_mfma_f32_16x16x32_bf16 v[44:47], v[136:139], a[12:15], 0
    ds_read_b64_tr_b16 v[158:159], v162 offset:14336
    v_mfma_f32_16x16x32_bf16 v[44:47], v[140:143], a[28:31], v[44:47]
    s_waitcnt lgkmcnt(4)
    buffer_load_dwordx4 v179, s[36:39], s54 offen offset:3072 lds
    v_mfma_f32_16x16x32_bf16 v[64:67], v[144:147], a[0:3], 0
    s_add_u32 s32, s32, 128
    ds_read_b64_tr_b16 v[128:129], v161 offset:0
    v_mfma_f32_16x16x32_bf16 v[64:67], v[148:151], a[16:19], v[64:67]
    s_cmp_ge_u32 s32, 1152
    s_cmov_b32 s32, 0
    s_add_u32 m0, s53, 16384
    v_mfma_f32_16x16x32_bf16 v[68:71], v[144:147], a[4:7], 0
    s_add_u32 s55, s4, 0
    ds_read_b64_tr_b16 v[130:131], v161 offset:2048
    v_mfma_f32_16x16x32_bf16 v[68:71], v[148:151], a[20:23], v[68:71]
    buffer_load_dwordx4 v172, s[28:31], s55 offen lds
    v_mfma_f32_16x16x32_bf16 v[72:75], v[144:147], a[8:11], 0
    ds_read_b64_tr_b16 v[132:133], v161 offset:8192
    v_mfma_f32_16x16x32_bf16 v[72:75], v[148:151], a[24:27], v[72:75]
    buffer_load_dwordx4 v173, s[28:31], s55 offen offset:1024 lds
    v_mfma_f32_16x16x32_bf16 v[76:79], v[144:147], a[12:15], 0
    s_add_u32 m0, s53, 24576
    ds_read_b64_tr_b16 v[134:135], v161 offset:10240
    s_add_u32 s55, s4, 294912
    v_mfma_f32_16x16x32_bf16 v[76:79], v[148:151], a[28:31], v[76:79]
    s_waitcnt lgkmcnt(4)
    buffer_load_dwordx4 v172, s[28:31], s55 offen lds
    v_mfma_f32_16x16x32_bf16 v[96:99], v[152:155], a[0:3], 0
    ds_read_b64_tr_b16 v[136:137], v161 offset:4096
    v_mfma_f32_16x16x32_bf16 v[96:99], v[156:159], a[16:19], v[96:99]
    buffer_load_dwordx4 v173, s[28:31], s55 offen offset:1024 lds
    v_mfma_f32_16x16x32_bf16 v[100:103], v[152:155], a[4:7], 0
    s_add_u32 s5, s4, 589824
    ds_read_b64_tr_b16 v[138:139], v161 offset:6144
    v_mfma_f32_16x16x32_bf16 v[100:103], v[156:159], a[20:23], v[100:103]
    s_cmp_ge_u32 s5, 5308416
    s_cmov_b32 s5, 0
    s_add_u32 m0, s34, 16384
    v_mfma_f32_16x16x32_bf16 v[104:107], v[152:155], a[8:11], 0
    s_add_u32 s54, s32, 0
    ds_read_b64_tr_b16 v[140:141], v161 offset:12288
    v_mfma_f32_16x16x32_bf16 v[104:107], v[156:159], a[24:27], v[104:107]
    buffer_load_dwordx4 v176, s[36:39], s54 offen offset:0 lds
    v_mfma_f32_16x16x32_bf16 v[108:111], v[152:155], a[12:15], 0
    ds_read_b64_tr_b16 v[142:143], v161 offset:14336
    v_mfma_f32_16x16x32_bf16 v[108:111], v[156:159], a[28:31], v[108:111]
    s_waitcnt lgkmcnt(4)
    buffer_load_dwordx4 v177, s[36:39], s54 offen offset:1024 lds
    v_mfma_f32_16x16x32_bf16 v[16:19], v[128:131], a[0:3], 0
    s_waitcnt vmcnt(6)
    ds_read_b64_tr_b16 v[144:145], v163 offset:0
    v_mfma_f32_16x16x32_bf16 v[16:19], v[132:135], a[16:19], v[16:19]
    buffer_load_dwordx4 v178, s[36:39], s54 offen offset:2048 lds
    v_mfma_f32_16x16x32_bf16 v[20:23], v[128:131], a[4:7], 0
    ds_read_b64_tr_b16 v[146:147], v163 offset:2048
    v_mfma_f32_16x16x32_bf16 v[20:23], v[132:135], a[20:23], v[20:23]
    buffer_load_dwordx4 v179, s[36:39], s54 offen offset:3072 lds
    v_mfma_f32_16x16x32_bf16 v[24:27], v[128:131], a[8:11], 0
    s_add_u32 m0, s34, 20480
    ds_read_b64_tr_b16 v[148:149], v163 offset:8192
    s_add_u32 s54, s32, 36864
    v_mfma_f32_16x16x32_bf16 v[24:27], v[132:135], a[24:27], v[24:27]
    buffer_load_dwordx4 v176, s[36:39], s54 offen offset:0 lds
    v_mfma_f32_16x16x32_bf16 v[28:31], v[128:131], a[12:15], 0
    ds_read_b64_tr_b16 v[150:151], v163 offset:10240
    v_mfma_f32_16x16x32_bf16 v[28:31], v[132:135], a[28:31], v[28:31]
    s_waitcnt lgkmcnt(4)
    buffer_load_dwordx4 v177, s[36:39], s54 offen offset:1024 lds
    v_mfma_f32_16x16x32_bf16 v[48:51], v[136:139], a[0:3], 0
    ds_read_b64_tr_b16 v[152:153], v163 offset:4096
    v_mfma_f32_16x16x32_bf16 v[48:51], v[140:143], a[16:19], v[48:51]
    buffer_load_dwordx4 v178, s[36:39], s54 offen offset:2048 lds
    v_mfma_f32_16x16x32_bf16 v[52:55], v[136:139], a[4:7], 0
    ds_read_b64_tr_b16 v[154:155], v163 offset:6144
    v_mfma_f32_16x16x32_bf16 v[52:55], v[140:143], a[20:23], v[52:55]
    buffer_load_dwordx4 v179, s[36:39], s54 offen offset:3072 lds
    v_mfma_f32_16x16x32_bf16 v[56:59], v[136:139], a[8:11], 0
    s_add_u32 s32, s32, 128
    ds_read_b64_tr_b16 v[156:157], v163 offset:12288
    v_mfma_f32_16x16x32_bf16 v[56:59], v[140:143], a[24:27], v[56:59]
    s_cmp_ge_u32 s32, 1152
    s_cmov_b32 s32, 0
    ds_read_b128 a[32:35], v180 offset:8192
    v_mfma_f32_16x16x32_bf16 v[60:63], v[136:139], a[12:15], 0
    s_add_u32 m0, s53, 32768
    ds_read_b64_tr_b16 v[158:159], v163 offset:14336
    s_add_u32 s55, s5, 0
    v_mfma_f32_16x16x32_bf16 v[60:63], v[140:143], a[28:31], v[60:63]
    s_waitcnt lgkmcnt(5)
    buffer_load_dwordx4 v172, s[28:31], s55 offen lds
    v_mfma_f32_16x16x32_bf16 v[80:83], v[144:147], a[0:3], 0
    s_waitcnt vmcnt(9)
    s_barrier
    v_mfma_f32_16x16x32_bf16 v[80:83], v[148:151], a[16:19], v[80:83]
    ds_read_b64_tr_b16 v[128:129], v160 offset:16384
    v_mfma_f32_16x16x32_bf16 v[84:87], v[144:147], a[4:7], 0
    ds_read_b64_tr_b16 v[130:131], v160 offset:18432
    v_mfma_f32_16x16x32_bf16 v[84:87], v[148:151], a[20:23], v[84:87]
    buffer_load_dwordx4 v173, s[28:31], s55 offen offset:1024 lds
    v_mfma_f32_16x16x32_bf16 v[88:91], v[144:147], a[8:11], 0
    s_add_u32 m0, s53, 40960
    ds_read_b64_tr_b16 v[132:133], v160 offset:24576
    s_add_u32 s55, s5, 294912
    v_mfma_f32_16x16x32_bf16 v[88:91], v[148:151], a[24:27], v[88:91]
    buffer_load_dwordx4 v172, s[28:31], s55 offen lds
    v_mfma_f32_16x16x32_bf16 v[92:95], v[144:147], a[12:15], 0
    ds_read_b64_tr_b16 v[134:135], v160 offset:26624
    v_mfma_f32_16x16x32_bf16 v[92:95], v[148:151], a[28:31], v[92:95]
    s_waitcnt lgkmcnt(4)
    ds_read_b128 a[36:39], v180 offset:10240
    v_mfma_f32_16x16x32_bf16 v[112:115], v[152:155], a[0:3], 0
    ds_read_b64_tr_b16 v[136:137], v220 offset:0
    v_mfma_f32_16x16x32_bf16 v[112:115], v[156:159], a[16:19], v[112:115]
    buffer_load_dwordx4 v173, s[28:31], s55 offen offset:1024 lds
    v_mfma_f32_16x16x32_bf16 v[116:119], v[152:155], a[4:7], 0
    s_add_u32 s6, s5, 589824
    ds_read_b64_tr_b16 v[138:139], v220 offset:2048
    v_mfma_f32_16x16x32_bf16 v[116:119], v[156:159], a[20:23], v[116:119]
    s_cmp_ge_u32 s6, 5308416
    s_cmov_b32 s6, 0
    ds_read_b128 a[40:43], v180 offset:12288
    v_mfma_f32_16x16x32_bf16 v[120:123], v[152:155], a[8:11], 0
    ds_read_b64_tr_b16 v[140:141], v220 offset:4096
    s_add_u32 m0, s34, 0
    v_mfma_f32_16x16x32_bf16 v[120:123], v[156:159], a[24:27], v[120:123]
    s_add_u32 s54, s32, 0
    ds_read_b128 a[44:47], v180 offset:14336
    v_mfma_f32_16x16x32_bf16 v[124:127], v[152:155], a[12:15], 0
    ds_read_b64_tr_b16 v[142:143], v220 offset:6144
    v_mfma_f32_16x16x32_bf16 v[124:127], v[156:159], a[28:31], v[124:127]
    s_waitcnt lgkmcnt(7)
    buffer_load_dwordx4 v176, s[36:39], s54 offen offset:0 lds
    ds_read_b128 a[48:51], v181 offset:8192
    ds_read_b128 a[52:55], v181 offset:10240
    ds_read_b128 a[56:59], v181 offset:12288
    ds_read_b128 a[60:63], v181 offset:14336
    s_waitcnt lgkmcnt(0)
    v_mfma_f32_16x16x32_bf16 v[0:3], v[128:131], a[32:35], v[0:3]
    ds_read_b64_tr_b16 v[144:145], v160 offset:20480
    v_mfma_f32_16x16x32_bf16 v[0:3], v[132:135], a[48:51], v[0:3]
    buffer_load_dwordx4 v177, s[36:39], s54 offen offset:1024 lds
    v_mfma_f32_16x16x32_bf16 v[4:7], v[128:131], a[36:39], v[4:7]
    ds_read_b64_tr_b16 v[146:147], v160 offset:22528
    v_mfma_f32_16x16x32_bf16 v[4:7], v[132:135], a[52:55], v[4:7]
    v_mfma_f32_16x16x32_bf16 v[8:11], v[128:131], a[40:43], v[8:11]
    ds_read_b64_tr_b16 v[148:149], v160 offset:28672
    v_mfma_f32_16x16x32_bf16 v[8:11], v[132:135], a[56:59], v[8:11]
    buffer_load_dwordx4 v178, s[36:39], s54 offen offset:2048 lds
    v_mfma_f32_16x16x32_bf16 v[12:15], v[128:131], a[44:47], v[12:15]
    ds_read_b64_tr_b16 v[150:151], v160 offset:30720
    v_mfma_f32_16x16x32_bf16 v[12:15], v[132:135], a[60:63], v[12:15]
    v_mfma_f32_16x16x32_bf16 v[224:227], v[188:191], v[136:139], 0
    v_mfma_f32_16x16x32_bf16 v[228:231], v[188:191], v[140:143], 0
    s_waitcnt lgkmcnt(0)
    v_mfma_f32_16x16x32_bf16 v[32:35], v[144:147], a[32:35], v[32:35]
    v_add_u32 v220, 0x2000, v220
    v_mfma_f32_16x16x32_bf16 v[32:35], v[148:151], a[48:51], v[32:35]
    ds_read_b64_tr_b16 v[152:153], v220 offset:0
    v_mfma_f32_16x16x32_bf16 v[36:39], v[144:147], a[36:39], v[36:39]
    ds_read_b64_tr_b16 v[154:155], v220 offset:2048
    v_mfma_f32_16x16x32_bf16 v[36:39], v[148:151], a[52:55], v[36:39]
    ds_read_b64_tr_b16 v[156:157], v220 offset:4096
    ds_read_b64_tr_b16 v[158:159], v220 offset:6144
    ds_read_b64_tr_b16 v[128:129], v162 offset:16384
    ds_read_b64_tr_b16 v[130:131], v162 offset:18432
    v_mfma_f32_16x16x32_bf16 v[40:43], v[144:147], a[40:43], v[40:43]
    ds_read_b64_tr_b16 v[132:133], v162 offset:24576
    v_mfma_f32_16x16x32_bf16 v[40:43], v[148:151], a[56:59], v[40:43]
    buffer_load_dwordx4 v179, s[36:39], s54 offen offset:3072 lds
    v_mfma_f32_16x16x32_bf16 v[44:47], v[144:147], a[44:47], v[44:47]
    s_add_u32 m0, s34, 4096
    ds_read_b64_tr_b16 v[134:135], v162 offset:26624
    s_add_u32 s54, s32, 36864
    v_mfma_f32_16x16x32_bf16 v[44:47], v[148:151], a[60:63], v[44:47]
    s_waitcnt lgkmcnt(4)
    v_mfma_f32_16x16x32_bf16 v[224:227], v[188:191], v[152:155], v[224:227]
    v_mfma_f32_16x16x32_bf16 v[228:231], v[188:191], v[156:159], v[228:231]
    s_waitcnt lgkmcnt(0)
    v_mfma_f32_16x16x32_bf16 v[64:67], v[128:131], a[32:35], v[64:67]
    s_barrier
    v_add_u32 v220, 0x2000, v220
    v_mfma_f32_16x16x32_bf16 v[64:67], v[132:135], a[48:51], v[64:67]
    ds_read_b64_tr_b16 v[136:137], v220 offset:0
    v_mfma_f32_16x16x32_bf16 v[68:71], v[128:131], a[36:39], v[68:71]
    ds_read_b64_tr_b16 v[138:139], v220 offset:2048
    v_mfma_f32_16x16x32_bf16 v[68:71], v[132:135], a[52:55], v[68:71]
    ds_read_b64_tr_b16 v[140:141], v220 offset:4096
    ds_read_b64_tr_b16 v[142:143], v220 offset:6144
    ds_read_b64_tr_b16 v[144:145], v162 offset:20480
    ds_read_b64_tr_b16 v[146:147], v162 offset:22528
    v_mfma_f32_16x16x32_bf16 v[72:75], v[128:131], a[40:43], v[72:75]
    ds_read_b64_tr_b16 v[148:149], v162 offset:28672
    v_mfma_f32_16x16x32_bf16 v[72:75], v[132:135], a[56:59], v[72:75]
    buffer_load_dwordx4 v176, s[36:39], s54 offen offset:0 lds
    v_mfma_f32_16x16x32_bf16 v[76:79], v[128:131], a[44:47], v[76:79]
    ds_read_b64_tr_b16 v[150:151], v162 offset:30720
    v_mfma_f32_16x16x32_bf16 v[76:79], v[132:135], a[60:63], v[76:79]
    s_waitcnt lgkmcnt(4)
    buffer_load_dwordx4 v177, s[36:39], s54 offen offset:1024 lds
    v_mfma_f32_16x16x32_bf16 v[224:227], v[236:239], v[136:139], v[224:227]
    v_mfma_f32_16x16x32_bf16 v[228:231], v[236:239], v[140:143], v[228:231]
    s_waitcnt lgkmcnt(0)
    v_mfma_f32_16x16x32_bf16 v[96:99], v[144:147], a[32:35], v[96:99]
    v_add_u32 v220, 0x2000, v220
    v_mfma_f32_16x16x32_bf16 v[96:99], v[148:151], a[48:51], v[96:99]
    ds_read_b64_tr_b16 v[152:153], v220 offset:0
    v_mfma_f32_16x16x32_bf16 v[100:103], v[144:147], a[36:39], v[100:103]
    ds_read_b64_tr_b16 v[154:155], v220 offset:2048
    v_mfma_f32_16x16x32_bf16 v[100:103], v[148:151], a[52:55], v[100:103]
    ds_read_b64_tr_b16 v[156:157], v220 offset:4096
    ds_read_b64_tr_b16 v[158:159], v220 offset:6144
    ds_read_b64_tr_b16 v[128:129], v161 offset:16384
    ds_read_b64_tr_b16 v[130:131], v161 offset:18432
    v_mfma_f32_16x16x32_bf16 v[104:107], v[144:147], a[40:43], v[104:107]
    ds_read_b64_tr_b16 v[132:133], v161 offset:24576
    v_mfma_f32_16x16x32_bf16 v[104:107], v[148:151], a[56:59], v[104:107]
    buffer_load_dwordx4 v178, s[36:39], s54 offen offset:2048 lds
    v_mfma_f32_16x16x32_bf16 v[108:111], v[144:147], a[44:47], v[108:111]
    ds_read_b64_tr_b16 v[134:135], v161 offset:26624
    v_mfma_f32_16x16x32_bf16 v[108:111], v[148:151], a[60:63], v[108:111]
    s_waitcnt lgkmcnt(4)
    v_mfma_f32_16x16x32_bf16 v[224:227], v[236:239], v[152:155], v[224:227]
    v_mfma_f32_16x16x32_bf16 v[228:231], v[236:239], v[156:159], v[228:231]
    s_waitcnt lgkmcnt(0)
    v_mfma_f32_16x16x32_bf16 v[16:19], v[128:131], a[32:35], v[16:19]
    s_waitcnt vmcnt(11)
    ds_read_b64_tr_b16 v[136:137], v161 offset:20480
    v_mfma_f32_16x16x32_bf16 v[16:19], v[132:135], a[48:51], v[16:19]
    ds_read_b64_tr_b16 v[138:139], v161 offset:22528
    v_mfma_f32_16x16x32_bf16 v[20:23], v[128:131], a[36:39], v[20:23]
    ds_read_b64_tr_b16 v[140:141], v161 offset:28672
    v_mfma_f32_16x16x32_bf16 v[20:23], v[132:135], a[52:55], v[20:23]
    ds_read_b64_tr_b16 v[142:143], v161 offset:30720
    ds_read_b64_tr_b16 v[144:145], v163 offset:16384
    ds_read_b64_tr_b16 v[146:147], v163 offset:18432
    v_mfma_f32_16x16x32_bf16 v[24:27], v[128:131], a[40:43], v[24:27]
    ds_read_b64_tr_b16 v[148:149], v163 offset:24576
    v_mfma_f32_16x16x32_bf16 v[24:27], v[132:135], a[56:59], v[24:27]
    buffer_load_dwordx4 v179, s[36:39], s54 offen offset:3072 lds
    v_mfma_f32_16x16x32_bf16 v[28:31], v[128:131], a[44:47], v[28:31]
    s_add_u32 s32, s32, 128
    ds_read_b64_tr_b16 v[150:151], v163 offset:26624
    v_mfma_f32_16x16x32_bf16 v[28:31], v[132:135], a[60:63], v[28:31]
    s_waitcnt lgkmcnt(4)
    ds_read_b128 a[64:67], v180 offset:16384
    v_mfma_f32_16x16x32_bf16 v[48:51], v[136:139], a[32:35], v[48:51]
    ds_read_b64_tr_b16 v[152:153], v163 offset:20480
    v_mfma_f32_16x16x32_bf16 v[48:51], v[140:143], a[48:51], v[48:51]
    s_cmp_ge_u32 s32, 1152
    s_cmov_b32 s32, 0
    ds_read_b128 a[68:71], v180 offset:18432
    v_mfma_f32_16x16x32_bf16 v[52:55], v[136:139], a[36:39], v[52:55]
    s_add_u32 m0, s53, 49152
    ds_read_b64_tr_b16 v[154:155], v163 offset:22528
    s_add_u32 s55, s6, 0
    v_mfma_f32_16x16x32_bf16 v[52:55], v[140:143], a[52:55], v[52:55]
    buffer_load_dwordx4 v172, s[28:31], s55 offen lds
    v_mfma_f32_16x16x32_bf16 v[56:59], v[136:139], a[40:43], v[56:59]
    ds_read_b64_tr_b16 v[156:157], v163 offset:28672
    v_mfma_f32_16x16x32_bf16 v[56:59], v[140:143], a[56:59], v[56:59]
    buffer_load_dwordx4 v173, s[28:31], s55 offen offset:1024 lds
    v_mfma_f32_16x16x32_bf16 v[60:63], v[136:139], a[44:47], v[60:63]
    s_add_u32 m0, s53, 57344
    ds_read_b64_tr_b16 v[158:159], v163 offset:30720
    s_add_u32 s55, s6, 294912
    v_mfma_f32_16x16x32_bf16 v[60:63], v[140:143], a[60:63], v[60:63]
    s_waitcnt lgkmcnt(6)
    ds_read_b128 a[72:75], v180 offset:20480
    v_mfma_f32_16x16x32_bf16 v[80:83], v[144:147], a[32:35], v[80:83]
    s_waitcnt vmcnt(10)
    s_barrier
    v_mfma_f32_16x16x32_bf16 v[80:83], v[148:151], a[48:51], v[80:83]
    ds_read_b64_tr_b16 v[128:129], v160 offset:32768
    v_mfma_f32_16x16x32_bf16 v[84:87], v[144:147], a[36:39], v[84:87]
    ds_read_b64_tr_b16 v[130:131], v160 offset:34816
    v_mfma_f32_16x16x32_bf16 v[84:87], v[148:151], a[52:55], v[84:87]
    buffer_load_dwordx4 v172, s[28:31], s55 offen lds
    v_mfma_f32_16x16x32_bf16 v[88:91], v[144:147], a[40:43], v[88:91]
    ds_read_b64_tr_b16 v[132:133], v160 offset:40960
    v_mfma_f32_16x16x32_bf16 v[88:91], v[148:151], a[56:59], v[88:91]
    buffer_load_dwordx4 v173, s[28:31], s55 offen offset:1024 lds
    v_mfma_f32_16x16x32_bf16 v[92:95], v[144:147], a[44:47], v[92:95]
    s_add_u32 s7, s6, 589824
    ds_read_b64_tr_b16 v[134:135], v160 offset:43008
    v_mfma_f32_16x16x32_bf16 v[92:95], v[148:151], a[60:63], v[92:95]
    s_waitcnt lgkmcnt(5)
    ds_read_b128 a[76:79], v180 offset:22528
    v_mfma_f32_16x16x32_bf16 v[112:115], v[152:155], a[32:35], v[112:115]
    ds_read_b64_tr_b16 v[136:137], v160 offset:36864
    v_mfma_f32_16x16x32_bf16 v[112:115], v[156:159], a[48:51], v[112:115]
    s_cmp_ge_u32 s7, 5308416
    s_cmov_b32 s7, 0
    ds_read_b128 a[80:83], v181 offset:16384
    v_mfma_f32_16x16x32_bf16 v[116:119], v[152:155], a[36:39], v[116:119]
    ds_read_b64_tr_b16 v[138:139], v160 offset:38912
    s_add_u32 m0, s34, 8192
    v_mfma_f32_16x16x32_bf16 v[116:119], v[156:159], a[52:55], v[116:119]
    s_add_u32 s54, s32, 0
    ds_read_b128 a[84:87], v181 offset:18432
    v_mfma_f32_16x16x32_bf16 v[120:123], v[152:155], a[40:43], v[120:123]
    ds_read_b64_tr_b16 v[140:141], v160 offset:45056
    v_mfma_f32_16x16x32_bf16 v[120:123], v[156:159], a[56:59], v[120:123]
    buffer_load_dwordx4 v176, s[36:39], s54 offen offset:0 lds
    v_mfma_f32_16x16x32_bf16 v[124:127], v[152:155], a[44:47], v[124:127]
    ds_read_b64_tr_b16 v[142:143], v160 offset:47104
    v_mfma_f32_16x16x32_bf16 v[124:127], v[156:159], a[60:63], v[124:127]
    s_waitcnt lgkmcnt(7)
    buffer_load_dwordx4 v177, s[36:39], s54 offen offset:1024 lds
    ds_read_b128 a[88:91], v181 offset:20480
    ds_read_b128 a[92:95], v181 offset:22528
    s_waitcnt lgkmcnt(0)
    v_mfma_f32_16x16x32_bf16 v[0:3], v[128:131], a[64:67], v[0:3]
    s_mov_b32 vcc_lo, 0xffff0000
    ds_read_b64_tr_b16 v[144:145], v162 offset:32768
    s_mov_b32 vcc_hi, 0
    v_mfma_f32_16x16x32_bf16 v[0:3], v[132:135], a[80:83], v[0:3]
    v_cndmask_b32 v224, v224, v228, vcc
    v_cvt_pk_bf16_f32 v225, v224, v224
    v_mfma_f32_16x16x32_bf16 v[4:7], v[128:131], a[68:71], v[4:7]
    ds_read_b64_tr_b16 v[146:147], v162 offset:34816
    v_and_b32 v225, 0xffff0000, v225
    v_mfma_f32_16x16x32_bf16 v[4:7], v[132:135], a[84:87], v[4:7]
    v_sub_f32 v226, v224, v225
    v_cvt_pk_bf16_f32 v224, v225, v226
    v_mfma_f32_16x16x32_bf16 v[8:11], v[128:131], a[72:75], v[8:11]
    s_add_u32 s49, s82, 0
    ds_read_b64_tr_b16 v[148:149], v162 offset:40960
    v_mfma_f32_16x16x32_bf16 v[8:11], v[132:135], a[88:91], v[8:11]
    buffer_load_dwordx4 v178, s[36:39], s54 offen offset:2048 lds
    v_mfma_f32_16x16x32_bf16 v[12:15], v[128:131], a[76:79], v[12:15]
    ds_read_b64_tr_b16 v[150:151], v162 offset:43008
    v_mfma_f32_16x16x32_bf16 v[12:15], v[132:135], a[92:95], v[12:15]
    buffer_store_dword v224, v221, s[24:27], s49 offen sc0 sc1
    v_mfma_f32_16x16x32_bf16 v[32:35], v[136:139], a[64:67], v[32:35]
    ds_read_b64_tr_b16 v[152:153], v162 offset:36864
    v_mfma_f32_16x16x32_bf16 v[32:35], v[140:143], a[80:83], v[32:35]
    buffer_load_dwordx4 v179, s[36:39], s54 offen offset:3072 lds
    v_mfma_f32_16x16x32_bf16 v[36:39], v[136:139], a[68:71], v[36:39]
    s_add_u32 m0, s34, 12288
    ds_read_b64_tr_b16 v[154:155], v162 offset:38912
    s_add_u32 s54, s32, 36864
    v_mfma_f32_16x16x32_bf16 v[36:39], v[140:143], a[84:87], v[36:39]
    v_mfma_f32_16x16x32_bf16 v[40:43], v[136:139], a[72:75], v[40:43]
    ds_read_b64_tr_b16 v[156:157], v162 offset:45056
    v_mfma_f32_16x16x32_bf16 v[40:43], v[140:143], a[88:91], v[40:43]
    buffer_load_dwordx4 v176, s[36:39], s54 offen offset:0 lds
    v_mfma_f32_16x16x32_bf16 v[44:47], v[136:139], a[76:79], v[44:47]
    ds_read_b64_tr_b16 v[158:159], v162 offset:47104
    v_mfma_f32_16x16x32_bf16 v[44:47], v[140:143], a[92:95], v[44:47]
    s_waitcnt lgkmcnt(4)
    v_mfma_f32_16x16x32_bf16 v[64:67], v[144:147], a[64:67], v[64:67]
    s_barrier
    v_mfma_f32_16x16x32_bf16 v[64:67], v[148:151], a[80:83], v[64:67]
    ds_read_b64_tr_b16 v[128:129], v161 offset:32768
    v_mfma_f32_16x16x32_bf16 v[68:71], v[144:147], a[68:71], v[68:71]
    ds_read_b64_tr_b16 v[130:131], v161 offset:34816
    v_mfma_f32_16x16x32_bf16 v[68:71], v[148:151], a[84:87], v[68:71]
    buffer_load_dwordx4 v177, s[36:39], s54 offen offset:1024 lds
    v_mfma_f32_16x16x32_bf16 v[72:75], v[144:147], a[72:75], v[72:75]
    ds_read_b64_tr_b16 v[132:133], v161 offset:40960
    v_mfma_f32_16x16x32_bf16 v[72:75], v[148:151], a[88:91], v[72:75]
    buffer_load_dwordx4 v178, s[36:39], s54 offen offset:2048 lds
    v_mfma_f32_16x16x32_bf16 v[76:79], v[144:147], a[76:79], v[76:79]
    ds_read_b64_tr_b16 v[134:135], v161 offset:43008
    v_mfma_f32_16x16x32_bf16 v[76:79], v[148:151], a[92:95], v[76:79]
    s_waitcnt lgkmcnt(4)
    v_mfma_f32_16x16x32_bf16 v[96:99], v[152:155], a[64:67], v[96:99]
    ds_read_b64_tr_b16 v[136:137], v161 offset:36864
    v_mfma_f32_16x16x32_bf16 v[96:99], v[156:159], a[80:83], v[96:99]
    v_mfma_f32_16x16x32_bf16 v[100:103], v[152:155], a[68:71], v[100:103]
    ds_read_b64_tr_b16 v[138:139], v161 offset:38912
    v_mfma_f32_16x16x32_bf16 v[100:103], v[156:159], a[84:87], v[100:103]
    v_mfma_f32_16x16x32_bf16 v[104:107], v[152:155], a[72:75], v[104:107]
    ds_read_b64_tr_b16 v[140:141], v161 offset:45056
    v_mfma_f32_16x16x32_bf16 v[104:107], v[156:159], a[88:91], v[104:107]
    buffer_load_dwordx4 v179, s[36:39], s54 offen offset:3072 lds
    v_mfma_f32_16x16x32_bf16 v[108:111], v[152:155], a[76:79], v[108:111]
    s_add_u32 s32, s32, 128
    ds_read_b64_tr_b16 v[142:143], v161 offset:47104
    v_mfma_f32_16x16x32_bf16 v[108:111], v[156:159], a[92:95], v[108:111]
    s_waitcnt lgkmcnt(4)
    s_cmp_ge_u32 s32, 1152
    s_cmov_b32 s32, 0
    v_mfma_f32_16x16x32_bf16 v[16:19], v[128:131], a[64:67], v[16:19]
    s_add_u32 m0, s53, 0
    ds_read_b64_tr_b16 v[144:145], v163 offset:32768
    s_add_u32 s55, s7, 0
    v_mfma_f32_16x16x32_bf16 v[16:19], v[132:135], a[80:83], v[16:19]
    buffer_load_dwordx4 v172, s[28:31], s55 offen lds
    v_mfma_f32_16x16x32_bf16 v[20:23], v[128:131], a[68:71], v[20:23]
    s_waitcnt vmcnt(14)
    ds_read_b64_tr_b16 v[146:147], v163 offset:34816
    v_mfma_f32_16x16x32_bf16 v[20:23], v[132:135], a[84:87], v[20:23]
    ds_read_b128 a[96:99], v180 offset:0
    v_mfma_f32_16x16x32_bf16 v[24:27], v[128:131], a[72:75], v[24:27]
    ds_read_b64_tr_b16 v[148:149], v163 offset:40960
    v_mfma_f32_16x16x32_bf16 v[24:27], v[132:135], a[88:91], v[24:27]
    buffer_load_dwordx4 v173, s[28:31], s55 offen offset:1024 lds
    v_mfma_f32_16x16x32_bf16 v[28:31], v[128:131], a[76:79], v[28:31]
    s_add_u32 m0, s53, 8192
    ds_read_b64_tr_b16 v[150:151], v163 offset:43008
    s_add_u32 s55, s7, 294912
    v_mfma_f32_16x16x32_bf16 v[28:31], v[132:135], a[92:95], v[28:31]
    s_waitcnt lgkmcnt(5)
    ds_read_b128 a[100:103], v180 offset:2048
    v_mfma_f32_16x16x32_bf16 v[48:51], v[136:139], a[64:67], v[48:51]
    ds_read_b64_tr_b16 v[152:153], v163 offset:36864
    v_mfma_f32_16x16x32_bf16 v[48:51], v[140:143], a[80:83], v[48:51]
    buffer_load_dwordx4 v172, s[28:31], s55 offen lds
    v_mfma_f32_16x16x32_bf16 v[52:55], v[136:139], a[68:71], v[52:55]
    ds_read_b64_tr_b16 v[154:155], v163 offset:38912
    v_mfma_f32_16x16x32_bf16 v[52:55], v[140:143], a[84:87], v[52:55]
    ds_read_b128 a[104:107], v180 offset:4096
    v_mfma_f32_16x16x32_bf16 v[56:59], v[136:139], a[72:75], v[56:59]
    ds_read_b64_tr_b16 v[156:157], v163 offset:45056
    v_mfma_f32_16x16x32_bf16 v[56:59], v[140:143], a[88:91], v[56:59]
    buffer_load_dwordx4 v173, s[28:31], s55 offen offset:1024 lds
    v_mfma_f32_16x16x32_bf16 v[60:63], v[136:139], a[76:79], v[60:63]
    s_add_u32 s10, s7, 589824
    ds_read_b64_tr_b16 v[158:159], v163 offset:47104
    v_mfma_f32_16x16x32_bf16 v[60:63], v[140:143], a[92:95], v[60:63]
    s_waitcnt lgkmcnt(6)
    ds_read_b128 a[108:111], v180 offset:6144
    v_mfma_f32_16x16x32_bf16 v[80:83], v[144:147], a[64:67], v[80:83]
    s_waitcnt vmcnt(13)
    s_barrier
    v_mfma_f32_16x16x32_bf16 v[80:83], v[148:151], a[80:83], v[80:83]
    ds_read_b64_tr_b16 v[128:129], v160 offset:49152
    v_mfma_f32_16x16x32_bf16 v[84:87], v[144:147], a[68:71], v[84:87]
    ds_read_b64_tr_b16 v[130:131], v160 offset:51200
    v_mfma_f32_16x16x32_bf16 v[84:87], v[148:151], a[84:87], v[84:87]
    s_cmp_ge_u32 s10, 5308416
    s_cmov_b32 s10, 0
    ds_read_b128 a[112:115], v181 offset:0
    v_mfma_f32_16x16x32_bf16 v[88:91], v[144:147], a[72:75], v[88:91]
    ds_read_b64_tr_b16 v[132:133], v160 offset:57344
    s_add_u32 m0, s34, 16384
    v_mfma_f32_16x16x32_bf16 v[88:91], v[148:151], a[88:91], v[88:91]
    s_add_u32 s54, s32, 0
    ds_read_b128 a[116:119], v181 offset:2048
    v_mfma_f32_16x16x32_bf16 v[92:95], v[144:147], a[76:79], v[92:95]
    ds_read_b64_tr_b16 v[134:135], v160 offset:59392
    v_mfma_f32_16x16x32_bf16 v[92:95], v[148:151], a[92:95], v[92:95]
    s_waitcnt lgkmcnt(7)
    buffer_load_dwordx4 v176, s[36:39], s54 offen offset:0 lds
    v_mfma_f32_16x16x32_bf16 v[112:115], v[152:155], a[64:67], v[112:115]
    ds_read_b64_tr_b16 v[136:137], v160 offset:53248
    v_mfma_f32_16x16x32_bf16 v[112:115], v[156:159], a[80:83], v[112:115]
    buffer_load_dwordx4 v177, s[36:39], s54 offen offset:1024 lds
    v_mfma_f32_16x16x32_bf16 v[116:119], v[152:155], a[68:71], v[116:119]
    ds_read_b64_tr_b16 v[138:139], v160 offset:55296
    v_mfma_f32_16x16x32_bf16 v[116:119], v[156:159], a[84:87], v[116:119]
    ds_read_b128 a[120:123], v181 offset:4096
    v_mfma_f32_16x16x32_bf16 v[120:123], v[152:155], a[72:75], v[120:123]
    ds_read_b64_tr_b16 v[140:141], v160 offset:61440
    v_mfma_f32_16x16x32_bf16 v[120:123], v[156:159], a[88:91], v[120:123]
    buffer_load_dwordx4 v178, s[36:39], s54 offen offset:2048 lds
    v_mfma_f32_16x16x32_bf16 v[124:127], v[152:155], a[76:79], v[124:127]
    ds_read_b64_tr_b16 v[142:143], v160 offset:63488
    v_mfma_f32_16x16x32_bf16 v[124:127], v[156:159], a[92:95], v[124:127]
    s_waitcnt lgkmcnt(5)
    ds_read_b128 a[124:127], v181 offset:6144
    s_waitcnt lgkmcnt(0)
    v_mfma_f32_16x16x32_bf16 v[0:3], v[128:131], a[96:99], v[0:3]
    ds_read_b64_tr_b16 v[144:145], v162 offset:49152
    v_mfma_f32_16x16x32_bf16 v[0:3], v[132:135], a[112:115], v[0:3]
    buffer_load_dwordx4 v179, s[36:39], s54 offen offset:3072 lds
    v_mfma_f32_16x16x32_bf16 v[4:7], v[128:131], a[100:103], v[4:7]
    s_add_u32 m0, s34, 20480
    ds_read_b64_tr_b16 v[146:147], v162 offset:51200
    s_add_u32 s54, s32, 36864
    v_mfma_f32_16x16x32_bf16 v[4:7], v[132:135], a[116:119], v[4:7]
    v_mfma_f32_16x16x32_bf16 v[8:11], v[128:131], a[104:107], v[8:11]
    ds_read_b64_tr_b16 v[148:149], v162 offset:57344
    v_mfma_f32_16x16x32_bf16 v[8:11], v[132:135], a[120:123], v[8:11]
    buffer_load_dwordx4 v176, s[36:39], s54 offen offset:0 lds
    v_mfma_f32_16x16x32_bf16 v[12:15], v[128:131], a[108:111], v[12:15]
    ds_read_b64_tr_b16 v[150:151], v162 offset:59392
    v_mfma_f32_16x16x32_bf16 v[12:15], v[132:135], a[124:127], v[12:15]
    v_mfma_f32_16x16x32_bf16 v[32:35], v[136:139], a[96:99], v[32:35]
    ds_read_b64_tr_b16 v[152:153], v162 offset:53248
    v_mfma_f32_16x16x32_bf16 v[32:35], v[140:143], a[112:115], v[32:35]
    buffer_load_dwordx4 v177, s[36:39], s54 offen offset:1024 lds
    v_mfma_f32_16x16x32_bf16 v[36:39], v[136:139], a[100:103], v[36:39]
    ds_read_b64_tr_b16 v[154:155], v162 offset:55296
    v_mfma_f32_16x16x32_bf16 v[36:39], v[140:143], a[116:119], v[36:39]
    v_mfma_f32_16x16x32_bf16 v[40:43], v[136:139], a[104:107], v[40:43]
    ds_read_b64_tr_b16 v[156:157], v162 offset:61440
    v_mfma_f32_16x16x32_bf16 v[40:43], v[140:143], a[120:123], v[40:43]
    buffer_load_dwordx4 v178, s[36:39], s54 offen offset:2048 lds
    v_mfma_f32_16x16x32_bf16 v[44:47], v[136:139], a[108:111], v[44:47]
    ds_read_b64_tr_b16 v[158:159], v162 offset:63488
    v_mfma_f32_16x16x32_bf16 v[44:47], v[140:143], a[124:127], v[44:47]
    s_waitcnt lgkmcnt(4)
    v_mfma_f32_16x16x32_bf16 v[64:67], v[144:147], a[96:99], v[64:67]
    s_waitcnt vmcnt(16)
    s_barrier
    s_lshl2_add_u32 s49, s50, s83
    v_mfma_f32_16x16x32_bf16 v[64:67], v[148:151], a[112:115], v[64:67]
    s_add_u32 s49, s49, 0
    ds_read_b64_tr_b16 v[128:129], v161 offset:49152
    v_mfma_f32_16x16x32_bf16 v[68:71], v[144:147], a[100:103], v[68:71]
    ds_read_b64_tr_b16 v[130:131], v161 offset:51200
    v_mfma_f32_16x16x32_bf16 v[68:71], v[148:151], a[116:119], v[68:71]
    buffer_store_dword v218, v216, s[24:27], s49 offen sc0 sc1
    v_mfma_f32_16x16x32_bf16 v[72:75], v[144:147], a[104:107], v[72:75]
    ds_read_b64_tr_b16 v[132:133], v161 offset:57344
    v_mfma_f32_16x16x32_bf16 v[72:75], v[148:151], a[120:123], v[72:75]
    buffer_load_dwordx4 v179, s[36:39], s54 offen offset:3072 lds
    v_mfma_f32_16x16x32_bf16 v[76:79], v[144:147], a[108:111], v[76:79]
    s_add_u32 s32, s32, 128
    ds_read_b64_tr_b16 v[134:135], v161 offset:59392
    v_mfma_f32_16x16x32_bf16 v[76:79], v[148:151], a[124:127], v[76:79]
    s_waitcnt lgkmcnt(4)
    s_cmp_ge_u32 s32, 1152
    s_cmov_b32 s32, 0
    v_mfma_f32_16x16x32_bf16 v[96:99], v[152:155], a[96:99], v[96:99]
    s_add_u32 m0, s53, 16384
    ds_read_b64_tr_b16 v[136:137], v161 offset:53248
    s_add_u32 s55, s10, 0
    v_mfma_f32_16x16x32_bf16 v[96:99], v[156:159], a[112:115], v[96:99]
    buffer_load_dwordx4 v172, s[28:31], s55 offen lds
    v_mfma_f32_16x16x32_bf16 v[100:103], v[152:155], a[100:103], v[100:103]
    ds_read_b64_tr_b16 v[138:139], v161 offset:55296
    v_mfma_f32_16x16x32_bf16 v[100:103], v[156:159], a[116:119], v[100:103]
    v_mfma_f32_16x16x32_bf16 v[104:107], v[152:155], a[104:107], v[104:107]
    ds_read_b64_tr_b16 v[140:141], v161 offset:61440
    v_mfma_f32_16x16x32_bf16 v[104:107], v[156:159], a[120:123], v[104:107]
    buffer_load_dwordx4 v173, s[28:31], s55 offen offset:1024 lds
    v_mfma_f32_16x16x32_bf16 v[108:111], v[152:155], a[108:111], v[108:111]
    s_add_u32 m0, s53, 24576
    ds_read_b64_tr_b16 v[142:143], v161 offset:63488
    s_add_u32 s55, s10, 294912
    v_mfma_f32_16x16x32_bf16 v[108:111], v[156:159], a[124:127], v[108:111]
    s_waitcnt lgkmcnt(4)
    v_mfma_f32_16x16x32_bf16 v[16:19], v[128:131], a[96:99], v[16:19]
    s_waitcnt vmcnt(15)
    ds_read_b64_tr_b16 v[144:145], v163 offset:49152
    v_mfma_f32_16x16x32_bf16 v[16:19], v[132:135], a[112:115], v[16:19]
    buffer_load_dwordx4 v172, s[28:31], s55 offen lds
    v_mfma_f32_16x16x32_bf16 v[20:23], v[128:131], a[100:103], v[20:23]
    ds_read_b64_tr_b16 v[146:147], v163 offset:51200
    v_mfma_f32_16x16x32_bf16 v[20:23], v[132:135], a[116:119], v[20:23]
    ds_read_b128 a[128:131], v180 offset:8192
    v_mfma_f32_16x16x32_bf16 v[24:27], v[128:131], a[104:107], v[24:27]
    ds_read_b64_tr_b16 v[148:149], v163 offset:57344
    v_mfma_f32_16x16x32_bf16 v[24:27], v[132:135], a[120:123], v[24:27]
    buffer_load_dwordx4 v173, s[28:31], s55 offen offset:1024 lds
    v_mfma_f32_16x16x32_bf16 v[28:31], v[128:131], a[108:111], v[28:31]
    s_add_u32 s11, s10, 589824
    ds_read_b64_tr_b16 v[150:151], v163 offset:59392
    v_mfma_f32_16x16x32_bf16 v[28:31], v[132:135], a[124:127], v[28:31]
    s_waitcnt lgkmcnt(5)
    ds_read_b128 a[132:135], v180 offset:10240
    v_mfma_f32_16x16x32_bf16 v[48:51], v[136:139], a[96:99], v[48:51]
    ds_read_b64_tr_b16 v[152:153], v163 offset:53248
    v_mfma_f32_16x16x32_bf16 v[48:51], v[140:143], a[112:115], v[48:51]
    s_cmp_ge_u32 s11, 5308416
    s_cmov_b32 s11, 0
    ds_read_b128 a[136:139], v180 offset:12288
    v_mfma_f32_16x16x32_bf16 v[52:55], v[136:139], a[100:103], v[52:55]
    ds_read_b64_tr_b16 v[154:155], v163 offset:55296
    s_add_u32 m0, s34, 0
    v_mfma_f32_16x16x32_bf16 v[52:55], v[140:143], a[116:119], v[52:55]
    s_add_u32 s54, s32, 0
    ds_read_b128 a[140:143], v180 offset:14336
    v_mfma_f32_16x16x32_bf16 v[56:59], v[136:139], a[104:107], v[56:59]
    ds_read_b64_tr_b16 v[156:157], v163 offset:61440
    v_mfma_f32_16x16x32_bf16 v[56:59], v[140:143], a[120:123], v[56:59]
    buffer_load_dwordx4 v176, s[36:39], s54 offen offset:0 lds
    v_mfma_f32_16x16x32_bf16 v[60:63], v[136:139], a[108:111], v[60:63]
    ds_read_b64_tr_b16 v[158:159], v163 offset:63488
    v_mfma_f32_16x16x32_bf16 v[60:63], v[140:143], a[124:127], v[60:63]
    s_waitcnt lgkmcnt(7)
    ds_read_b128 a[144:147], v181 offset:8192
    v_mfma_f32_16x16x32_bf16 v[80:83], v[144:147], a[96:99], v[80:83]
    s_waitcnt vmcnt(14)
    s_barrier
    v_mfma_f32_16x16x32_bf16 v[80:83], v[148:151], a[112:115], v[80:83]
    ds_read_b64_tr_b16 v[128:129], v160 offset:0
    v_mfma_f32_16x16x32_bf16 v[84:87], v[144:147], a[100:103], v[84:87]
    ds_read_b64_tr_b16 v[130:131], v160 offset:2048
    v_mfma_f32_16x16x32_bf16 v[84:87], v[148:151], a[116:119], v[84:87]
    buffer_load_dwordx4 v177, s[36:39], s54 offen offset:1024 lds
    v_mfma_f32_16x16x32_bf16 v[88:91], v[144:147], a[104:107], v[88:91]
    ds_read_b64_tr_b16 v[132:133], v160 offset:8192
    v_mfma_f32_16x16x32_bf16 v[88:91], v[148:151], a[120:123], v[88:91]
    buffer_load_dwordx4 v178, s[36:39], s54 offen offset:2048 lds
    v_mfma_f32_16x16x32_bf16 v[92:95], v[144:147], a[108:111], v[92:95]
    ds_read_b64_tr_b16 v[134:135], v160 offset:10240
    v_mfma_f32_16x16x32_bf16 v[92:95], v[148:151], a[124:127], v[92:95]
    s_waitcnt lgkmcnt(5)
    ds_read_b128 a[148:151], v181 offset:10240
    v_mfma_f32_16x16x32_bf16 v[112:115], v[152:155], a[96:99], v[112:115]
    ds_read_b64_tr_b16 v[136:137], v160 offset:4096
    v_mfma_f32_16x16x32_bf16 v[112:115], v[156:159], a[112:115], v[112:115]
    buffer_load_dwordx4 v179, s[36:39], s54 offen offset:3072 lds
    v_mfma_f32_16x16x32_bf16 v[116:119], v[152:155], a[100:103], v[116:119]
    s_add_u32 m0, s34, 4096
    ds_read_b64_tr_b16 v[138:139], v160 offset:6144
    s_add_u32 s54, s32, 36864
    v_mfma_f32_16x16x32_bf16 v[116:119], v[156:159], a[116:119], v[116:119]
    ds_read_b128 a[152:155], v181 offset:12288
    v_mfma_f32_16x16x32_bf16 v[120:123], v[152:155], a[104:107], v[120:123]
    ds_read_b64_tr_b16 v[140:141], v160 offset:12288
    v_mfma_f32_16x16x32_bf16 v[120:123], v[156:159], a[120:123], v[120:123]
    buffer_load_dwordx4 v176, s[36:39], s54 offen offset:0 lds
    v_mfma_f32_16x16x32_bf16 v[124:127], v[152:155], a[108:111], v[124:127]
    ds_read_b64_tr_b16 v[142:143], v160 offset:14336
    v_mfma_f32_16x16x32_bf16 v[124:127], v[156:159], a[124:127], v[124:127]
    s_waitcnt lgkmcnt(6)
    ds_read_b128 a[156:159], v181 offset:14336
    s_waitcnt lgkmcnt(0)
    v_mfma_f32_16x16x32_bf16 v[0:3], v[128:131], a[128:131], v[0:3]
    ds_read_b64_tr_b16 v[144:145], v162 offset:0
    v_mfma_f32_16x16x32_bf16 v[0:3], v[132:135], a[144:147], v[0:3]
    buffer_load_dwordx4 v177, s[36:39], s54 offen offset:1024 lds
    v_mfma_f32_16x16x32_bf16 v[4:7], v[128:131], a[132:135], v[4:7]
    ds_read_b64_tr_b16 v[146:147], v162 offset:2048
    v_mfma_f32_16x16x32_bf16 v[4:7], v[132:135], a[148:151], v[4:7]
    v_mfma_f32_16x16x32_bf16 v[8:11], v[128:131], a[136:139], v[8:11]
    ds_read_b64_tr_b16 v[148:149], v162 offset:8192
    v_mfma_f32_16x16x32_bf16 v[8:11], v[132:135], a[152:155], v[8:11]
    v_mfma_f32_16x16x32_bf16 v[12:15], v[128:131], a[140:143], v[12:15]
    ds_read_b64_tr_b16 v[150:151], v162 offset:10240
    v_mfma_f32_16x16x32_bf16 v[12:15], v[132:135], a[156:159], v[12:15]
    v_mfma_f32_16x16x32_bf16 v[32:35], v[136:139], a[128:131], v[32:35]
    ds_read_b64_tr_b16 v[152:153], v162 offset:4096
    v_mfma_f32_16x16x32_bf16 v[32:35], v[140:143], a[144:147], v[32:35]
    buffer_load_dwordx4 v178, s[36:39], s54 offen offset:2048 lds
    v_mfma_f32_16x16x32_bf16 v[36:39], v[136:139], a[132:135], v[36:39]
    ds_read_b64_tr_b16 v[154:155], v162 offset:6144
    v_mfma_f32_16x16x32_bf16 v[36:39], v[140:143], a[148:151], v[36:39]
    v_mfma_f32_16x16x32_bf16 v[40:43], v[136:139], a[136:139], v[40:43]
    ds_read_b64_tr_b16 v[156:157], v162 offset:12288
    v_mfma_f32_16x16x32_bf16 v[40:43], v[140:143], a[152:155], v[40:43]
    buffer_load_dwordx4 v179, s[36:39], s54 offen offset:3072 lds
    v_mfma_f32_16x16x32_bf16 v[44:47], v[136:139], a[140:143], v[44:47]
    s_add_u32 s32, s32, 128
    ds_read_b64_tr_b16 v[158:159], v162 offset:14336
    v_mfma_f32_16x16x32_bf16 v[44:47], v[140:143], a[156:159], v[44:47]
    s_waitcnt lgkmcnt(4)
    s_cmp_ge_u32 s32, 1152
    s_cmov_b32 s32, 0
    v_mfma_f32_16x16x32_bf16 v[64:67], v[144:147], a[128:131], v[64:67]
    s_barrier
    s_add_u32 m0, s53, 32768
    v_mfma_f32_16x16x32_bf16 v[64:67], v[148:151], a[144:147], v[64:67]
    s_add_u32 s55, s11, 0
    ds_read_b64_tr_b16 v[128:129], v161 offset:0
    v_and_b32 v223, 15, v174
    v_mfma_f32_16x16x32_bf16 v[68:71], v[144:147], a[132:135], v[68:71]
    s_lshl_b32 s52, s50, 12
    ds_read_b64_tr_b16 v[130:131], v161 offset:2048
    s_lshl_b32 s60, s48, 10
    v_mfma_f32_16x16x32_bf16 v[68:71], v[148:151], a[148:151], v[68:71]
    buffer_load_dwordx4 v172, s[28:31], s55 offen lds
    v_mfma_f32_16x16x32_bf16 v[72:75], v[144:147], a[136:139], v[72:75]
    s_add_u32 s52, s52, s60
    ds_read_b64_tr_b16 v[132:133], v161 offset:8192
    v_lshl_add_u32 v223, v223, 4, s52
    v_mfma_f32_16x16x32_bf16 v[72:75], v[148:151], a[152:155], v[72:75]
    buffer_load_dwordx4 v173, s[28:31], s55 offen offset:1024 lds
    v_mfma_f32_16x16x32_bf16 v[76:79], v[144:147], a[140:143], v[76:79]
    s_add_u32 m0, s53, 40960
    ds_read_b64_tr_b16 v[134:135], v161 offset:10240
    s_add_u32 s55, s11, 294912
    v_mfma_f32_16x16x32_bf16 v[76:79], v[148:151], a[156:159], v[76:79]
    s_waitcnt lgkmcnt(4)
    s_mov_b32 s49, 0
    v_mfma_f32_16x16x32_bf16 v[96:99], v[152:155], a[128:131], v[96:99]
    ds_read_b64_tr_b16 v[136:137], v161 offset:4096
    v_mfma_f32_16x16x32_bf16 v[96:99], v[156:159], a[144:147], v[96:99]
    buffer_load_dwordx4 v172, s[28:31], s55 offen lds
    v_mfma_f32_16x16x32_bf16 v[100:103], v[152:155], a[132:135], v[100:103]
    ds_read_b64_tr_b16 v[138:139], v161 offset:6144
    v_mfma_f32_16x16x32_bf16 v[100:103], v[156:159], a[148:151], v[100:103]
    buffer_load_dwordx4 v[200:203], v223, s[24:27], s49 offen offset:0 sc0 sc1
    v_mfma_f32_16x16x32_bf16 v[104:107], v[152:155], a[136:139], v[104:107]
    ds_read_b64_tr_b16 v[140:141], v161 offset:12288
    v_mfma_f32_16x16x32_bf16 v[104:107], v[156:159], a[152:155], v[104:107]
    buffer_load_dwordx4 v173, s[28:31], s55 offen offset:1024 lds
    v_mfma_f32_16x16x32_bf16 v[108:111], v[152:155], a[140:143], v[108:111]
    s_add_u32 s20, s11, 589824
    ds_read_b64_tr_b16 v[142:143], v161 offset:14336
    v_mfma_f32_16x16x32_bf16 v[108:111], v[156:159], a[156:159], v[108:111]
    s_waitcnt lgkmcnt(4)
    buffer_load_dwordx4 v[204:207], v223, s[24:27], s49 offen offset:256 sc0 sc1
    v_mfma_f32_16x16x32_bf16 v[16:19], v[128:131], a[128:131], v[16:19]
    ds_read_b64_tr_b16 v[144:145], v163 offset:0
    v_mfma_f32_16x16x32_bf16 v[16:19], v[132:135], a[144:147], v[16:19]
    buffer_load_dwordx4 v[208:211], v223, s[24:27], s49 offen offset:512 sc0 sc1
    v_mfma_f32_16x16x32_bf16 v[20:23], v[128:131], a[132:135], v[20:23]
    ds_read_b64_tr_b16 v[146:147], v163 offset:2048
    v_mfma_f32_16x16x32_bf16 v[20:23], v[132:135], a[148:151], v[20:23]
    buffer_load_dwordx4 v[212:215], v223, s[24:27], s49 offen offset:768 sc0 sc1
    v_mfma_f32_16x16x32_bf16 v[24:27], v[128:131], a[136:139], v[24:27]
    s_waitcnt vmcnt(20)
    ds_read_b64_tr_b16 v[148:149], v163 offset:8192
    v_mfma_f32_16x16x32_bf16 v[24:27], v[132:135], a[152:155], v[24:27]
    s_cmp_ge_u32 s20, 5308416
    s_cmov_b32 s20, 0
    ds_read_b128 a[160:163], v180 offset:16384
    v_mfma_f32_16x16x32_bf16 v[28:31], v[128:131], a[140:143], v[28:31]
    ds_read_b64_tr_b16 v[150:151], v163 offset:10240
    s_add_u32 m0, s34, 8192
    v_mfma_f32_16x16x32_bf16 v[28:31], v[132:135], a[156:159], v[28:31]
    s_waitcnt lgkmcnt(5)
    ds_read_b128 a[164:167], v180 offset:18432
    s_add_u32 s54, s32, 0
    v_mfma_f32_16x16x32_bf16 v[48:51], v[136:139], a[128:131], v[48:51]
    ds_read_b64_tr_b16 v[152:153], v163 offset:4096
    v_mfma_f32_16x16x32_bf16 v[48:51], v[140:143], a[144:147], v[48:51]
    buffer_load_dwordx4 v176, s[36:39], s54 offen offset:0 lds
    v_mfma_f32_16x16x32_bf16 v[52:55], v[136:139], a[132:135], v[52:55]
    ds_read_b64_tr_b16 v[154:155], v163 offset:6144
    v_mfma_f32_16x16x32_bf16 v[52:55], v[140:143], a[148:151], v[52:55]
    buffer_load_dwordx4 v177, s[36:39], s54 offen offset:1024 lds
    v_mfma_f32_16x16x32_bf16 v[56:59], v[136:139], a[136:139], v[56:59]
    ds_read_b64_tr_b16 v[156:157], v163 offset:12288
    v_mfma_f32_16x16x32_bf16 v[56:59], v[140:143], a[152:155], v[56:59]
    ds_read_b128 a[168:171], v180 offset:20480
    v_mfma_f32_16x16x32_bf16 v[60:63], v[136:139], a[140:143], v[60:63]
    ds_read_b64_tr_b16 v[158:159], v163 offset:14336
    v_mfma_f32_16x16x32_bf16 v[60:63], v[140:143], a[156:159], v[60:63]
    s_waitcnt lgkmcnt(6)
    ds_read_b128 a[172:175], v180 offset:22528
    v_mfma_f32_16x16x32_bf16 v[80:83], v[144:147], a[128:131], v[80:83]
    s_waitcnt vmcnt(18)
    s_barrier
    v_mfma_f32_16x16x32_bf16 v[80:83], v[148:151], a[144:147], v[80:83]
    ds_read_b64_tr_b16 v[128:129], v160 offset:16384
    v_mfma_f32_16x16x32_bf16 v[84:87], v[144:147], a[132:135], v[84:87]
    ds_read_b64_tr_b16 v[130:131], v160 offset:18432
    v_mfma_f32_16x16x32_bf16 v[84:87], v[148:151], a[148:151], v[84:87]
    buffer_load_dwordx4 v178, s[36:39], s54 offen offset:2048 lds
    v_mfma_f32_16x16x32_bf16 v[88:91], v[144:147], a[136:139], v[88:91]
    ds_read_b64_tr_b16 v[132:133], v160 offset:24576
    v_mfma_f32_16x16x32_bf16 v[88:91], v[148:151], a[152:155], v[88:91]
    buffer_load_dwordx4 v179, s[36:39], s54 offen offset:3072 lds
    v_mfma_f32_16x16x32_bf16 v[92:95], v[144:147], a[140:143], v[92:95]
    s_add_u32 m0, s34, 12288
    ds_read_b64_tr_b16 v[134:135], v160 offset:26624
    s_add_u32 s54, s32, 36864
    v_mfma_f32_16x16x32_bf16 v[92:95], v[148:151], a[156:159], v[92:95]
    s_waitcnt lgkmcnt(5)
    ds_read_b128 a[176:179], v181 offset:16384
    v_mfma_f32_16x16x32_bf16 v[112:115], v[152:155], a[128:131], v[112:115]
    ds_read_b64_tr_b16 v[136:137], v160 offset:20480
    v_mfma_f32_16x16x32_bf16 v[112:115], v[156:159], a[144:147], v[112:115]
    buffer_load_dwordx4 v176, s[36:39], s54 offen offset:0 lds
    v_mfma_f32_16x16x32_bf16 v[116:119], v[152:155], a[132:135], v[116:119]
    ds_read_b64_tr_b16 v[138:139], v160 offset:22528
    v_mfma_f32_16x16x32_bf16 v[116:119], v[156:159], a[148:151], v[116:119]
    ds_read_b128 a[180:183], v181 offset:18432
    v_mfma_f32_16x16x32_bf16 v[120:123], v[152:155], a[136:139], v[120:123]
    ds_read_b64_tr_b16 v[140:141], v160 offset:28672
    v_mfma_f32_16x16x32_bf16 v[120:123], v[156:159], a[152:155], v[120:123]
    buffer_load_dwordx4 v177, s[36:39], s54 offen offset:1024 lds
    v_mfma_f32_16x16x32_bf16 v[124:127], v[152:155], a[140:143], v[124:127]
    ds_read_b64_tr_b16 v[142:143], v160 offset:30720
    v_mfma_f32_16x16x32_bf16 v[124:127], v[156:159], a[156:159], v[124:127]
    s_waitcnt lgkmcnt(6)
    ds_read_b128 a[184:187], v181 offset:20480
    ds_read_b128 a[188:191], v181 offset:22528
    s_waitcnt lgkmcnt(0)
    v_mfma_f32_16x16x32_bf16 v[0:3], v[128:131], a[160:163], v[0:3]
    s_mov_b32 s49, s83
    ds_read_b64_tr_b16 v[144:145], v162 offset:16384
    v_mfma_f32_16x16x32_bf16 v[0:3], v[132:135], a[176:179], v[0:3]
    buffer_load_dwordx4 v178, s[36:39], s54 offen offset:2048 lds
    v_mfma_f32_16x16x32_bf16 v[4:7], v[128:131], a[164:167], v[4:7]
    ds_read_b64_tr_b16 v[146:147], v162 offset:18432
    v_mfma_f32_16x16x32_bf16 v[4:7], v[132:135], a[180:183], v[4:7]
    buffer_load_dword v219, v217, s[24:27], s49 offen sc0 sc1
    v_mfma_f32_16x16x32_bf16 v[8:11], v[128:131], a[168:171], v[8:11]
    s_waitcnt vmcnt(16)
    ds_read_b64_tr_b16 v[148:149], v162 offset:24576
    v_mfma_f32_16x16x32_bf16 v[8:11], v[132:135], a[184:187], v[8:11]
    ds_read_b128 a[192:195], v180 offset:0
    v_mfma_f32_16x16x32_bf16 v[12:15], v[128:131], a[172:175], v[12:15]
    ds_read_b64_tr_b16 v[150:151], v162 offset:26624
    v_mfma_f32_16x16x32_bf16 v[12:15], v[132:135], a[188:191], v[12:15]
    ds_read_b128 a[196:199], v180 offset:2048
    v_mfma_f32_16x16x32_bf16 v[32:35], v[136:139], a[160:163], v[32:35]
    ds_read_b64_tr_b16 v[152:153], v162 offset:20480
    v_mfma_f32_16x16x32_bf16 v[32:35], v[140:143], a[176:179], v[32:35]
    buffer_load_dwordx4 v179, s[36:39], s54 offen offset:3072 lds
    v_mfma_f32_16x16x32_bf16 v[36:39], v[136:139], a[164:167], v[36:39]
    s_add_u32 s32, s32, 128
    ds_read_b64_tr_b16 v[154:155], v162 offset:22528
    v_mfma_f32_16x16x32_bf16 v[36:39], v[140:143], a[180:183], v[36:39]
    s_cmp_ge_u32 s32, 1152
    s_cmov_b32 s32, 0
    ds_read_b128 a[200:203], v180 offset:4096
    v_mfma_f32_16x16x32_bf16 v[40:43], v[136:139], a[168:171], v[40:43]
    s_add_u32 m0, s53, 49152
    ds_read_b64_tr_b16 v[156:157], v162 offset:28672
    s_add_u32 s55, s20, 0
    v_mfma_f32_16x16x32_bf16 v[40:43], v[140:143], a[184:187], v[40:43]
    buffer_load_dwordx4 v172, s[28:31], s55 offen lds
    v_mfma_f32_16x16x32_bf16 v[44:47], v[136:139], a[172:175], v[44:47]
    ds_read_b64_tr_b16 v[158:159], v162 offset:30720
    v_mfma_f32_16x16x32_bf16 v[44:47], v[140:143], a[188:191], v[44:47]
    s_waitcnt lgkmcnt(6)
    ds_read_b128 a[204:207], v180 offset:6144
    v_mfma_f32_16x16x32_bf16 v[64:67], v[144:147], a[160:163], v[64:67]
    s_barrier
    v_mfma_f32_16x16x32_bf16 v[64:67], v[148:151], a[176:179], v[64:67]
    ds_read_b64_tr_b16 v[128:129], v161 offset:16384
    v_mfma_f32_16x16x32_bf16 v[68:71], v[144:147], a[164:167], v[68:71]
    ds_read_b64_tr_b16 v[130:131], v161 offset:18432
    v_mfma_f32_16x16x32_bf16 v[68:71], v[148:151], a[180:183], v[68:71]
    buffer_load_dwordx4 v173, s[28:31], s55 offen offset:1024 lds
    v_mfma_f32_16x16x32_bf16 v[72:75], v[144:147], a[168:171], v[72:75]
    s_add_u32 m0, s53, 57344
    ds_read_b64_tr_b16 v[132:133], v161 offset:24576
    s_add_u32 s55, s20, 294912
    v_mfma_f32_16x16x32_bf16 v[72:75], v[148:151], a[184:187], v[72:75]
    buffer_load_dwordx4 v172, s[28:31], s55 offen lds
    v_mfma_f32_16x16x32_bf16 v[76:79], v[144:147], a[172:175], v[76:79]
    ds_read_b64_tr_b16 v[134:135], v161 offset:26624
    v_mfma_f32_16x16x32_bf16 v[76:79], v[148:151], a[188:191], v[76:79]
    s_waitcnt lgkmcnt(5)
    ds_read_b128 a[208:211], v181 offset:0
    v_mfma_f32_16x16x32_bf16 v[96:99], v[152:155], a[160:163], v[96:99]
    ds_read_b64_tr_b16 v[136:137], v161 offset:20480
    v_mfma_f32_16x16x32_bf16 v[96:99], v[156:159], a[176:179], v[96:99]
    buffer_load_dwordx4 v173, s[28:31], s55 offen offset:1024 lds
    v_mfma_f32_16x16x32_bf16 v[100:103], v[152:155], a[164:167], v[100:103]
    s_add_u32 s21, s20, 589824
    ds_read_b64_tr_b16 v[138:139], v161 offset:22528
    v_mfma_f32_16x16x32_bf16 v[100:103], v[156:159], a[180:183], v[100:103]
    s_cmp_ge_u32 s21, 5308416
    s_cmov_b32 s21, 0
    ds_read_b128 a[212:215], v181 offset:2048
    v_mfma_f32_16x16x32_bf16 v[104:107], v[152:155], a[168:171], v[104:107]
    ds_read_b64_tr_b16 v[140:141], v161 offset:28672
    s_add_u32 m0, s34, 16384
    v_mfma_f32_16x16x32_bf16 v[104:107], v[156:159], a[184:187], v[104:107]
    s_add_u32 s54, s32, 0
    ds_read_b128 a[216:219], v181 offset:4096
    v_mfma_f32_16x16x32_bf16 v[108:111], v[152:155], a[172:175], v[108:111]
    ds_read_b64_tr_b16 v[142:143], v161 offset:30720
    v_mfma_f32_16x16x32_bf16 v[108:111], v[156:159], a[188:191], v[108:111]
    s_waitcnt lgkmcnt(7)
    buffer_load_dwordx4 v176, s[36:39], s54 offen offset:0 lds
    v_mfma_f32_16x16x32_bf16 v[16:19], v[128:131], a[160:163], v[16:19]
    ds_read_b64_tr_b16 v[144:145], v163 offset:16384
    v_mfma_f32_16x16x32_bf16 v[16:19], v[132:135], a[176:179], v[16:19]
    ds_read_b128 a[220:223], v181 offset:6144
    v_mfma_f32_16x16x32_bf16 v[20:23], v[128:131], a[164:167], v[20:23]
    ds_read_b64_tr_b16 v[146:147], v163 offset:18432
    v_mfma_f32_16x16x32_bf16 v[20:23], v[132:135], a[180:183], v[20:23]
    v_mfma_f32_16x16x32_bf16 v[24:27], v[128:131], a[168:171], v[24:27]
    ds_read_b64_tr_b16 v[148:149], v163 offset:24576
    v_mfma_f32_16x16x32_bf16 v[24:27], v[132:135], a[184:187], v[24:27]
    buffer_load_dwordx4 v177, s[36:39], s54 offen offset:1024 lds
    v_mfma_f32_16x16x32_bf16 v[28:31], v[128:131], a[172:175], v[28:31]
    ds_read_b64_tr_b16 v[150:151], v163 offset:26624
    v_mfma_f32_16x16x32_bf16 v[28:31], v[132:135], a[188:191], v[28:31]
    s_waitcnt lgkmcnt(5)
    v_mfma_f32_16x16x32_bf16 v[48:51], v[136:139], a[160:163], v[48:51]
    ds_read_b64_tr_b16 v[152:153], v163 offset:20480
    v_mfma_f32_16x16x32_bf16 v[48:51], v[140:143], a[176:179], v[48:51]
    buffer_load_dwordx4 v178, s[36:39], s54 offen offset:2048 lds
    v_mfma_f32_16x16x32_bf16 v[52:55], v[136:139], a[164:167], v[52:55]
    ds_read_b64_tr_b16 v[154:155], v163 offset:22528
    v_mfma_f32_16x16x32_bf16 v[52:55], v[140:143], a[180:183], v[52:55]
    v_mfma_f32_16x16x32_bf16 v[56:59], v[136:139], a[168:171], v[56:59]
    ds_read_b64_tr_b16 v[156:157], v163 offset:28672
    v_mfma_f32_16x16x32_bf16 v[56:59], v[140:143], a[184:187], v[56:59]
    buffer_load_dwordx4 v179, s[36:39], s54 offen offset:3072 lds
    v_mfma_f32_16x16x32_bf16 v[60:63], v[136:139], a[172:175], v[60:63]
    s_add_u32 m0, s34, 20480
    ds_read_b64_tr_b16 v[158:159], v163 offset:30720
    s_add_u32 s54, s32, 36864
    v_mfma_f32_16x16x32_bf16 v[60:63], v[140:143], a[188:191], v[60:63]
    s_waitcnt lgkmcnt(4)
    v_mfma_f32_16x16x32_bf16 v[80:83], v[144:147], a[160:163], v[80:83]
    s_waitcnt vmcnt(20)
    s_barrier
    v_mfma_f32_16x16x32_bf16 v[80:83], v[148:151], a[176:179], v[80:83]
    ds_read_b64_tr_b16 v[128:129], v160 offset:32768
    v_mfma_f32_16x16x32_bf16 v[84:87], v[144:147], a[164:167], v[84:87]
    ds_read_b64_tr_b16 v[130:131], v160 offset:34816
    v_mfma_f32_16x16x32_bf16 v[84:87], v[148:151], a[180:183], v[84:87]
    buffer_load_dwordx4 v176, s[36:39], s54 offen offset:0 lds
    v_mfma_f32_16x16x32_bf16 v[88:91], v[144:147], a[168:171], v[88:91]
    ds_read_b64_tr_b16 v[132:133], v160 offset:40960
    v_mfma_f32_16x16x32_bf16 v[88:91], v[148:151], a[184:187], v[88:91]
    buffer_load_dwordx4 v177, s[36:39], s54 offen offset:1024 lds
    v_mfma_f32_16x16x32_bf16 v[92:95], v[144:147], a[172:175], v[92:95]
    ds_read_b64_tr_b16 v[134:135], v160 offset:43008
    v_mfma_f32_16x16x32_bf16 v[92:95], v[148:151], a[188:191], v[92:95]
    s_waitcnt lgkmcnt(4)
    s_waitcnt vmcnt(11)
    v_cmp_eq_u32 vcc, s79, v219
    v_mfma_f32_16x16x32_bf16 v[112:115], v[152:155], a[160:163], v[112:115]
    ds_read_b64_tr_b16 v[136:137], v160 offset:36864
    v_mfma_f32_16x16x32_bf16 v[112:115], v[156:159], a[176:179], v[112:115]
    buffer_load_dwordx4 v178, s[36:39], s54 offen offset:2048 lds
    v_mfma_f32_16x16x32_bf16 v[116:119], v[152:155], a[164:167], v[116:119]
    ds_read_b64_tr_b16 v[138:139], v160 offset:38912
    v_mfma_f32_16x16x32_bf16 v[116:119], v[156:159], a[180:183], v[116:119]
    s_andn2_b32 s61, 0xff, vcc_lo
    s_cbranch_scc1 Lslow_2
Lback_3:
    s_add_u32 s49, s82, 0
    v_mfma_f32_16x16x32_bf16 v[120:123], v[152:155], a[168:171], v[120:123]
    ds_read_b64_tr_b16 v[140:141], v160 offset:45056
    v_mfma_f32_16x16x32_bf16 v[120:123], v[156:159], a[184:187], v[120:123]
    buffer_load_dwordx4 v[192:195], v222, s[24:27], s49 offen offset:0 sc0 sc1
    v_mfma_f32_16x16x32_bf16 v[124:127], v[152:155], a[172:175], v[124:127]
    ds_read_b64_tr_b16 v[142:143], v160 offset:47104
    v_mfma_f32_16x16x32_bf16 v[124:127], v[156:159], a[188:191], v[124:127]
    s_waitcnt lgkmcnt(4)
    buffer_load_dwordx4 v[196:199], v222, s[24:27], s49 offen offset:1024 sc0 sc1
    v_mfma_f32_16x16x32_bf16 v[0:3], v[128:131], a[192:195], v[0:3]
    s_waitcnt vmcnt(13)
    ds_read_b64_tr_b16 v[144:145], v161 offset:32768
    v_mfma_f32_16x16x32_bf16 v[0:3], v[132:135], a[208:211], v[0:3]
    buffer_load_dwordx4 v179, s[36:39], s54 offen offset:3072 lds
    v_mfma_f32_16x16x32_bf16 v[4:7], v[128:131], a[196:199], v[4:7]
    s_add_u32 s32, s32, 128
    ds_read_b64_tr_b16 v[146:147], v161 offset:34816
    v_mfma_f32_16x16x32_bf16 v[4:7], v[132:135], a[212:215], v[4:7]
    s_cmp_ge_u32 s32, 1152
    s_cmov_b32 s32, 0
    ds_read_b128 a[224:227], v180 offset:8192
    ds_read_b128 a[228:231], v180 offset:10240
    v_mfma_f32_16x16x32_bf16 v[8:11], v[128:131], a[200:203], v[8:11]
    s_add_u32 m0, s53, 0
    ds_read_b64_tr_b16 v[148:149], v161 offset:40960
    s_add_u32 s55, s21, 0
    v_mfma_f32_16x16x32_bf16 v[8:11], v[132:135], a[216:219], v[8:11]
    buffer_load_dwordx4 v172, s[28:31], s55 offen lds
    v_mfma_f32_16x16x32_bf16 v[12:15], v[128:131], a[204:207], v[12:15]
    ds_read_b64_tr_b16 v[150:151], v161 offset:43008
    v_mfma_f32_16x16x32_bf16 v[12:15], v[132:135], a[220:223], v[12:15]
    s_waitcnt lgkmcnt(6)
    ds_read_b128 a[232:235], v180 offset:12288
    ds_read_b128 a[236:239], v180 offset:14336
    v_mfma_f32_16x16x32_bf16 v[32:35], v[136:139], a[192:195], v[32:35]
    ds_read_b64_tr_b16 v[152:153], v161 offset:36864
    v_mfma_f32_16x16x32_bf16 v[32:35], v[140:143], a[208:211], v[32:35]
    buffer_load_dwordx4 v173, s[28:31], s55 offen offset:1024 lds
    v_mfma_f32_16x16x32_bf16 v[36:39], v[136:139], a[196:199], v[36:39]
    s_add_u32 m0, s53, 8192
    ds_read_b64_tr_b16 v[154:155], v161 offset:38912
    s_add_u32 s55, s21, 294912
    v_mfma_f32_16x16x32_bf16 v[36:39], v[140:143], a[212:215], v[36:39]
    ds_read_b128 a[240:243], v181 offset:8192
    ds_read_b128 a[244:247], v181 offset:10240
    v_mfma_f32_16x16x32_bf16 v[40:43], v[136:139], a[200:203], v[40:43]
    ds_read_b64_tr_b16 v[156:157], v161 offset:45056
    v_mfma_f32_16x16x32_bf16 v[40:43], v[140:143], a[216:219], v[40:43]
    buffer_load_dwordx4 v172, s[28:31], s55 offen lds
    v_mfma_f32_16x16x32_bf16 v[44:47], v[136:139], a[204:207], v[44:47]
    ds_read_b64_tr_b16 v[158:159], v161 offset:47104
    v_mfma_f32_16x16x32_bf16 v[44:47], v[140:143], a[220:223], v[44:47]
    s_waitcnt lgkmcnt(8)
    ds_read_b128 a[248:251], v181 offset:12288
    ds_read_b128 a[252:255], v181 offset:14336
    v_mfma_f32_16x16x32_bf16 v[16:19], v[144:147], a[192:195], v[16:19]
    s_waitcnt vmcnt(13)
    s_barrier
    v_mfma_f32_16x16x32_bf16 v[16:19], v[148:151], a[208:211], v[16:19]
    ds_read_b64_tr_b16 v[128:129], v160 offset:49152
    v_cmp_eq_u32 s[60:61], s79, v201
    v_mfma_f32_16x16x32_bf16 v[20:23], v[144:147], a[196:199], v[20:23]
    ds_read_b64_tr_b16 v[130:131], v160 offset:51200
    v_cmp_eq_u32 vcc, s79, v203
    v_mfma_f32_16x16x32_bf16 v[20:23], v[148:151], a[212:215], v[20:23]
    buffer_load_dwordx4 v173, s[28:31], s55 offen offset:1024 lds
    s_and_b64 s[60:61], s[60:61], vcc
    v_mfma_f32_16x16x32_bf16 v[24:27], v[144:147], a[200:203], v[24:27]
    s_add_u32 m0, s53, 65536
    ds_read_b64_tr_b16 v[132:133], v160 offset:57344
    s_add_u32 s55, s33, 128
    v_mfma_f32_16x16x32_bf16 v[24:27], v[148:151], a[216:219], v[24:27]
    v_cmp_eq_u32 vcc, s79, v205
    s_and_b64 s[60:61], s[60:61], vcc
    v_mfma_f32_16x16x32_bf16 v[28:31], v[144:147], a[204:207], v[28:31]
    ds_read_b64_tr_b16 v[134:135], v160 offset:59392
    v_cmp_eq_u32 vcc, s79, v207
    v_mfma_f32_16x16x32_bf16 v[28:31], v[148:151], a[220:223], v[28:31]
    s_waitcnt lgkmcnt(6)
    s_and_b64 s[60:61], s[60:61], vcc
    v_cmp_eq_u32 vcc, s79, v209
    s_and_b64 s[60:61], s[60:61], vcc
    v_mfma_f32_16x16x32_bf16 v[48:51], v[152:155], a[192:195], v[48:51]
    ds_read_b64_tr_b16 v[136:137], v160 offset:53248
    v_cmp_eq_u32 vcc, s79, v211
    v_mfma_f32_16x16x32_bf16 v[48:51], v[156:159], a[208:211], v[48:51]
    buffer_load_dwordx4 v172, s[28:31], s55 offen lds
    v_mfma_f32_16x16x32_bf16 v[52:55], v[152:155], a[196:199], v[52:55]
    s_and_b64 s[60:61], s[60:61], vcc
    ds_read_b64_tr_b16 v[138:139], v160 offset:55296
    v_cmp_eq_u32 vcc, s79, v213
    v_mfma_f32_16x16x32_bf16 v[52:55], v[156:159], a[212:215], v[52:55]
    s_and_b64 s[60:61], s[60:61], vcc
    v_cmp_eq_u32 vcc, s79, v215
    s_and_b64 s[60:61], s[60:61], vcc
    s_cmp_lg_u64 s[60:61], -1
    s_cbranch_scc1 Lslow_5
Lback_6:
    v_mfma_f32_16x16x32_bf16 v[56:59], v[152:155], a[200:203], v[56:59]
    ds_read_b64_tr_b16 v[140:141], v160 offset:61440
    v_mov_b32 v201, v200
    v_mfma_f32_16x16x32_bf16 v[56:59], v[156:159], a[216:219], v[56:59]
    buffer_load_dwordx4 v173, s[28:31], s55 offen offset:1024 lds
    v_mfma_f32_16x16x32_bf16 v[60:63], v[152:155], a[204:207], v[60:63]
    s_add_u32 m0, s53, 90112
    ds_read_b64_tr_b16 v[142:143], v160 offset:63488
    s_add_u32 s55, s33, 295040
    v_mfma_f32_16x16x32_bf16 v[60:63], v[156:159], a[220:223], v[60:63]
    s_waitcnt lgkmcnt(4)
    v_mul_f32 v203, v202, v202
    v_mfma_f32_16x16x32_bf16 v[0:3], v[128:131], a[224:227], v[0:3]
    ds_read_b64_tr_b16 v[144:145], v161 offset:49152
    v_mfma_f32_16x16x32_bf16 v[0:3], v[132:135], a[240:243], v[0:3]
    buffer_load_dwordx4 v172, s[28:31], s55 offen lds
    v_mfma_f32_16x16x32_bf16 v[4:7], v[128:131], a[228:231], v[4:7]
    ds_read_b64_tr_b16 v[146:147], v161 offset:51200
    v_mfma_f32_16x16x32_bf16 v[4:7], v[132:135], a[244:247], v[4:7]
    v_rcp_f32 v202, v202
    v_mov_b32 v205, v204
    v_mfma_f32_16x16x32_bf16 v[8:11], v[128:131], a[232:235], v[8:11]
    ds_read_b64_tr_b16 v[148:149], v161 offset:57344
    v_mul_f32 v207, v206, v206
    v_mfma_f32_16x16x32_bf16 v[8:11], v[132:135], a[248:251], v[8:11]
    buffer_load_dwordx4 v173, s[28:31], s55 offen offset:1024 lds
    v_mfma_f32_16x16x32_bf16 v[12:15], v[128:131], a[236:239], v[12:15]
    s_add_u32 m0, s53, 114688
    ds_read_b64_tr_b16 v[150:151], v161 offset:59392
    s_lshr_b32 s55, s33, 2
    v_mfma_f32_16x16x32_bf16 v[12:15], v[132:135], a[252:255], v[12:15]
    s_waitcnt lgkmcnt(4)
    s_add_u32 s55, s55, 4718720
    v_rcp_f32 v206, v206
    v_mfma_f32_16x16x32_bf16 v[32:35], v[136:139], a[224:227], v[32:35]
    ds_read_b64_tr_b16 v[152:153], v161 offset:53248
    v_mov_b32 v209, v208
    v_mfma_f32_16x16x32_bf16 v[32:35], v[140:143], a[240:243], v[32:35]
    buffer_load_dwordx4 v172, s[28:31], s55 offen lds
    v_mfma_f32_16x16x32_bf16 v[36:39], v[136:139], a[228:231], v[36:39]
    s_sub_u32 s55, s55, 147328
    ds_read_b64_tr_b16 v[154:155], v161 offset:55296
    v_mul_f32 v211, v210, v210
    v_mfma_f32_16x16x32_bf16 v[36:39], v[140:143], a[244:247], v[36:39]
    v_rcp_f32 v210, v210
    v_mfma_f32_16x16x32_bf16 v[40:43], v[136:139], a[232:235], v[40:43]
    ds_read_b64_tr_b16 v[156:157], v161 offset:61440
    v_mov_b32 v213, v212
    v_mfma_f32_16x16x32_bf16 v[40:43], v[140:143], a[248:251], v[40:43]
    buffer_load_dwordx4 v173, s[28:31], s55 offen offset:1024 lds
    v_mfma_f32_16x16x32_bf16 v[44:47], v[136:139], a[236:239], v[44:47]
    s_add_u32 m0, s53, 139264
    ds_read_b64_tr_b16 v[158:159], v161 offset:63488
    s_add_u32 s55, s33, 256
    v_mfma_f32_16x16x32_bf16 v[44:47], v[140:143], a[252:255], v[44:47]
    s_waitcnt lgkmcnt(4)
    v_mul_f32 v215, v214, v214
    v_mfma_f32_16x16x32_bf16 v[16:19], v[144:147], a[224:227], v[16:19]
    s_waitcnt vmcnt(6)
    s_barrier
    v_mfma_f32_16x16x32_bf16 v[16:19], v[148:151], a[240:243], v[16:19]
    ds_read_b64_tr_b16 v[128:129], v160 offset:0
    v_mfma_f32_16x16x32_bf16 v[20:23], v[144:147], a[228:231], v[20:23]
    ds_read_b64_tr_b16 v[130:131], v160 offset:2048
    v_mfma_f32_16x16x32_bf16 v[20:23], v[148:151], a[244:247], v[20:23]
    v_rcp_f32 v214, v214
    v_mfma_f32_16x16x32_bf16 v[24:27], v[144:147], a[232:235], v[24:27]
    ds_read_b64_tr_b16 v[132:133], v160 offset:8192
    v_mul_f32 v202, 0xbfb8aa3b, v202
    v_mfma_f32_16x16x32_bf16 v[24:27], v[148:151], a[248:251], v[24:27]
    buffer_load_dwordx4 v172, s[28:31], s55 offen lds
    v_mfma_f32_16x16x32_bf16 v[28:31], v[144:147], a[236:239], v[28:31]
    ds_read_b64_tr_b16 v[134:135], v160 offset:10240
    v_mul_f32 v206, 0xbfb8aa3b, v206
    v_mfma_f32_16x16x32_bf16 v[28:31], v[148:151], a[252:255], v[28:31]
    s_waitcnt lgkmcnt(4)
    v_mul_f32 v210, 0xbfb8aa3b, v210
    v_mul_f32 v214, 0xbfb8aa3b, v214
    v_mfma_f32_16x16x32_bf16 v[48:51], v[152:155], a[224:227], v[48:51]
    ds_read_b64_tr_b16 v[136:137], v160 offset:4096
    v_mfma_f32_16x16x32_bf16 v[48:51], v[156:159], a[240:243], v[48:51]
    buffer_load_dwordx4 v173, s[28:31], s55 offen offset:1024 lds
    v_mfma_f32_16x16x32_bf16 v[52:55], v[152:155], a[228:231], v[52:55]
    s_add_u32 m0, s53, 16384
    ds_read_b64_tr_b16 v[138:139], v160 offset:6144
    s_add_u32 s55, s33, 295168
    v_mfma_f32_16x16x32_bf16 v[52:55], v[156:159], a[244:247], v[52:55]
    ds_read_b128 v[224:227], v180 offset:16384
    v_mfma_f32_16x16x32_bf16 v[56:59], v[152:155], a[232:235], v[56:59]
    ds_read_b64_tr_b16 v[140:141], v160 offset:12288
    v_mfma_f32_16x16x32_bf16 v[56:59], v[156:159], a[248:251], v[56:59]
    buffer_load_dwordx4 v172, s[28:31], s55 offen lds
    v_mfma_f32_16x16x32_bf16 v[60:63], v[152:155], a[236:239], v[60:63]
    ds_read_b64_tr_b16 v[142:143], v160 offset:14336
    v_mfma_f32_16x16x32_bf16 v[60:63], v[156:159], a[252:255], v[60:63]
    s_waitcnt lgkmcnt(5)
    ds_read_b128 v[228:231], v180 offset:18432
    ds_read_b128 v[232:235], v180 offset:20480
    ds_read_b128 v[236:239], v180 offset:22528
    ds_read_b128 v[240:243], v181 offset:16384
    ds_read_b128 v[244:247], v181 offset:18432
    ds_read_b128 v[248:251], v181 offset:20480
    ds_read_b128 v[252:255], v181 offset:22528
    s_waitcnt lgkmcnt(0)
    v_mfma_f32_16x16x32_bf16 v[0:3], v[128:131], v[224:227], v[0:3]
    ds_read_b64_tr_b16 v[144:145], v161 offset:0
    v_mfma_f32_16x16x32_bf16 v[0:3], v[132:135], v[240:243], v[0:3]
    buffer_load_dwordx4 v173, s[28:31], s55 offen offset:1024 lds
    v_mfma_f32_16x16x32_bf16 v[4:7], v[128:131], v[228:231], v[4:7]
    ds_read_b64_tr_b16 v[146:147], v161 offset:2048
    v_mfma_f32_16x16x32_bf16 v[4:7], v[132:135], v[244:247], v[4:7]
    v_mfma_f32_16x16x32_bf16 v[8:11], v[128:131], v[232:235], v[8:11]
    ds_read_b64_tr_b16 v[148:149], v161 offset:8192
    v_mfma_f32_16x16x32_bf16 v[8:11], v[132:135], v[248:251], v[8:11]
    v_mfma_f32_16x16x32_bf16 v[12:15], v[128:131], v[236:239], v[12:15]
    ds_read_b64_tr_b16 v[150:151], v161 offset:10240
    v_mfma_f32_16x16x32_bf16 v[12:15], v[132:135], v[252:255], v[12:15]
    v_mfma_f32_16x16x32_bf16 v[32:35], v[136:139], v[224:227], v[32:35]
    ds_read_b64_tr_b16 v[152:153], v161 offset:4096
    v_mfma_f32_16x16x32_bf16 v[32:35], v[140:143], v[240:243], v[32:35]
    v_mfma_f32_16x16x32_bf16 v[36:39], v[136:139], v[228:231], v[36:39]
    ds_read_b64_tr_b16 v[154:155], v161 offset:6144
    v_mfma_f32_16x16x32_bf16 v[36:39], v[140:143], v[244:247], v[36:39]
    v_mfma_f32_16x16x32_bf16 v[40:43], v[136:139], v[232:235], v[40:43]
    ds_read_b64_tr_b16 v[156:157], v161 offset:12288
    v_mfma_f32_16x16x32_bf16 v[40:43], v[140:143], v[248:251], v[40:43]
    v_mfma_f32_16x16x32_bf16 v[44:47], v[136:139], v[236:239], v[44:47]
    ds_read_b64_tr_b16 v[158:159], v161 offset:14336
    v_mfma_f32_16x16x32_bf16 v[44:47], v[140:143], v[252:255], v[44:47]
    s_waitcnt lgkmcnt(4)
    v_mfma_f32_16x16x16_bf16 v[0:3], v[192:193], v[200:201], v[0:3]
    s_barrier
    v_mfma_f32_16x16x16_bf16 v[4:7], v[192:193], v[204:205], v[4:7]
    ds_read_b64_tr_b16 v[128:129], v162 offset:32768
    v_mfma_f32_16x16x16_bf16 v[8:11], v[192:193], v[208:209], v[8:11]
    ds_read_b64_tr_b16 v[130:131], v162 offset:34816
    v_mfma_f32_16x16x16_bf16 v[12:15], v[192:193], v[212:213], v[12:15]
    v_mfma_f32_16x16x16_bf16 v[16:19], v[194:195], v[200:201], v[16:19]
    v_mfma_f32_16x16x16_bf16 v[20:23], v[194:195], v[204:205], v[20:23]
    v_mfma_f32_16x16x16_bf16 v[24:27], v[194:195], v[208:209], v[24:27]
    v_mfma_f32_16x16x16_bf16 v[28:31], v[194:195], v[212:213], v[28:31]
    v_mfma_f32_16x16x16_bf16 v[32:35], v[196:197], v[200:201], v[32:35]
    v_mfma_f32_16x16x16_bf16 v[36:39], v[196:197], v[204:205], v[36:39]
    v_mfma_f32_16x16x16_bf16 v[40:43], v[196:197], v[208:209], v[40:43]
    v_mfma_f32_16x16x16_bf16 v[44:47], v[196:197], v[212:213], v[44:47]
    v_mfma_f32_16x16x16_bf16 v[48:51], v[198:199], v[200:201], v[48:51]
    v_mfma_f32_16x16x16_bf16 v[52:55], v[198:199], v[204:205], v[52:55]
    v_mfma_f32_16x16x16_bf16 v[56:59], v[198:199], v[208:209], v[56:59]
    v_mfma_f32_16x16x16_bf16 v[60:63], v[198:199], v[212:213], v[60:63]
    v_mfma_f32_16x16x32_bf16 v[16:19], v[144:147], v[224:227], v[16:19]
    s_add_u32 s49, s82, 2048
    v_mfma_f32_16x16x32_bf16 v[16:19], v[148:151], v[240:243], v[16:19]
    buffer_load_dwordx4 v[192:195], v222, s[24:27], s49 offen offset:0 sc0 sc1
    v_mfma_f32_16x16x32_bf16 v[20:23], v[144:147], v[228:231], v[20:23]
    buffer_load_dwordx4 v[196:199], v222, s[24:27], s49 offen offset:1024 sc0 sc1
    v_mfma_f32_16x16x32_bf16 v[20:23], v[148:151], v[244:247], v[20:23]
    v_mfma_f32_16x16x32_bf16 v[24:27], v[144:147], v[232:235], v[24:27]
    ds_read_b64_tr_b16 v[132:133], v162 offset:40960
    v_mfma_f32_16x16x32_bf16 v[24:27], v[148:151], v[248:251], v[24:27]
    v_mfma_f32_16x16x32_bf16 v[28:31], v[144:147], v[236:239], v[28:31]
    ds_read_b64_tr_b16 v[134:135], v162 offset:43008
    v_mfma_f32_16x16x32_bf16 v[28:31], v[148:151], v[252:255], v[28:31]
    s_waitcnt lgkmcnt(4)
    v_mfma_f32_16x16x32_bf16 v[48:51], v[152:155], v[224:227], v[48:51]
    ds_read_b64_tr_b16 v[136:137], v162 offset:36864
    v_mfma_f32_16x16x32_bf16 v[48:51], v[156:159], v[240:243], v[48:51]
    v_mfma_f32_16x16x32_bf16 v[52:55], v[152:155], v[228:231], v[52:55]
    ds_read_b64_tr_b16 v[138:139], v162 offset:38912
    v_mfma_f32_16x16x32_bf16 v[52:55], v[156:159], v[244:247], v[52:55]
    v_mfma_f32_16x16x32_bf16 v[56:59], v[152:155], v[232:235], v[56:59]
    ds_read_b64_tr_b16 v[140:141], v162 offset:45056
    v_mfma_f32_16x16x32_bf16 v[56:59], v[156:159], v[248:251], v[56:59]
    v_mfma_f32_16x16x32_bf16 v[60:63], v[152:155], v[236:239], v[60:63]
    ds_read_b64_tr_b16 v[142:143], v162 offset:47104
    v_mfma_f32_16x16x32_bf16 v[60:63], v[156:159], v[252:255], v[60:63]
    s_waitcnt lgkmcnt(4)
    v_mfma_f32_16x16x32_bf16 v[64:67], v[128:131], a[192:195], v[64:67]
    ds_read_b64_tr_b16 v[144:145], v163 offset:32768
    v_mfma_f32_16x16x32_bf16 v[64:67], v[132:135], a[208:211], v[64:67]
    v_mfma_f32_16x16x32_bf16 v[68:71], v[128:131], a[196:199], v[68:71]
    ds_read_b64_tr_b16 v[146:147], v163 offset:34816
    v_mfma_f32_16x16x32_bf16 v[68:71], v[132:135], a[212:215], v[68:71]
    v_mfma_f32_16x16x32_bf16 v[72:75], v[128:131], a[200:203], v[72:75]
    ds_read_b64_tr_b16 v[148:149], v163 offset:40960
    v_mfma_f32_16x16x32_bf16 v[72:75], v[132:135], a[216:219], v[72:75]
    v_mfma_f32_16x16x32_bf16 v[76:79], v[128:131], a[204:207], v[76:79]
    ds_read_b64_tr_b16 v[150:151], v163 offset:43008
    v_mfma_f32_16x16x32_bf16 v[76:79], v[132:135], a[220:223], v[76:79]
    s_waitcnt lgkmcnt(4)
    v_mfma_f32_16x16x32_bf16 v[96:99], v[136:139], a[192:195], v[96:99]
    s_add_u32 s58, s57, 0
    ds_read_b64_tr_b16 v[152:153], v163 offset:36864
    v_mul_f32 v32, v0, v32
    v_mul_f32 v0, v0, v202
    v_mfma_f32_16x16x32_bf16 v[96:99], v[140:143], a[208:211], v[96:99]
    v_exp_f32 v0, v0
    v_mul_f32 v33, v1, v33
    v_mfma_f32_16x16x32_bf16 v[100:103], v[136:139], a[196:199], v[100:103]
    ds_read_b64_tr_b16 v[154:155], v163 offset:38912
    v_mul_f32 v1, v1, v202
    v_mul_f32 v34, v2, v34
    v_mul_f32 v2, v2, v202
    v_mfma_f32_16x16x32_bf16 v[100:103], v[140:143], a[212:215], v[100:103]
    v_exp_f32 v1, v1
    v_mul_f32 v35, v3, v35
    v_mfma_f32_16x16x32_bf16 v[104:107], v[136:139], a[200:203], v[104:107]
    ds_read_b64_tr_b16 v[156:157], v163 offset:45056
    v_mul_f32 v3, v3, v202
    v_mul_f32 v48, v16, v48
    v_mul_f32 v16, v16, v202
    v_mfma_f32_16x16x32_bf16 v[104:107], v[140:143], a[216:219], v[104:107]
    v_exp_f32 v2, v2
    v_mul_f32 v49, v17, v49
    v_mfma_f32_16x16x32_bf16 v[108:111], v[136:139], a[204:207], v[108:111]
    ds_read_b64_tr_b16 v[158:159], v163 offset:47104
    v_mul_f32 v17, v17, v202
    v_mul_f32 v50, v18, v50
    v_mul_f32 v18, v18, v202
    v_mfma_f32_16x16x32_bf16 v[108:111], v[140:143], a[220:223], v[108:111]
    s_waitcnt lgkmcnt(4)
    v_exp_f32 v3, v3
    v_mul_f32 v51, v19, v51
    v_mfma_f32_16x16x32_bf16 v[80:83], v[144:147], a[192:195], v[80:83]
    ds_read_b64_tr_b16 v[128:129], v162 offset:49152
    v_mul_f32 v19, v19, v202
    v_exp_f32 v16, v16
    v_mfma_f32_16x16x32_bf16 v[80:83], v[148:151], a[208:211], v[80:83]
    v_exp_f32 v17, v17
    v_exp_f32 v18, v18
    v_mfma_f32_16x16x32_bf16 v[84:87], v[144:147], a[196:199], v[84:87]
    ds_read_b64_tr_b16 v[130:131], v162 offset:51200
    v_fma_f32 v0, v0, v203, v203
    v_exp_f32 v19, v19
    v_mfma_f32_16x16x32_bf16 v[84:87], v[148:151], a[212:215], v[84:87]
    v_rcp_f32 v0, v0
    v_mfma_f32_16x16x32_bf16 v[88:91], v[144:147], a[200:203], v[88:91]
    ds_read_b64_tr_b16 v[132:133], v162 offset:57344
    v_fma_f32 v1, v1, v203, v203
    v_fma_f32 v2, v2, v203, v203
    v_fma_f32 v3, v3, v203, v203
    v_mfma_f32_16x16x32_bf16 v[88:91], v[148:151], a[216:219], v[88:91]
    v_rcp_f32 v1, v1
    v_fma_f32 v16, v16, v203, v203
    v_mfma_f32_16x16x32_bf16 v[92:95], v[144:147], a[204:207], v[92:95]
    ds_read_b64_tr_b16 v[134:135], v162 offset:59392
    v_fma_f32 v17, v17, v203, v203
    v_fma_f32 v18, v18, v203, v203
    v_fma_f32 v19, v19, v203, v203
    v_mfma_f32_16x16x32_bf16 v[92:95], v[148:151], a[220:223], v[92:95]
    s_waitcnt lgkmcnt(4)
    v_rcp_f32 v2, v2
    v_rcp_f32 v3, v3
    v_mfma_f32_16x16x32_bf16 v[112:115], v[152:155], a[192:195], v[112:115]
    ds_read_b64_tr_b16 v[136:137], v162 offset:53248
    v_mul_f32 v0, v0, v32
    v_rcp_f32 v16, v16
    v_mfma_f32_16x16x32_bf16 v[112:115], v[156:159], a[208:211], v[112:115]
    v_rcp_f32 v17, v17
    v_rcp_f32 v18, v18
    v_mfma_f32_16x16x32_bf16 v[116:119], v[152:155], a[196:199], v[116:119]
    ds_read_b64_tr_b16 v[138:139], v162 offset:55296
    v_mul_f32 v1, v1, v33
    v_rcp_f32 v19, v19
    v_mfma_f32_16x16x32_bf16 v[116:119], v[156:159], a[212:215], v[116:119]
    v_mul_f32 v2, v2, v34
    v_mul_f32 v3, v3, v35
    v_mfma_f32_16x16x32_bf16 v[120:123], v[152:155], a[200:203], v[120:123]
    ds_read_b64_tr_b16 v[140:141], v162 offset:61440
    v_mul_f32 v16, v16, v48
    v_mul_f32 v17, v17, v49
    v_mul_f32 v18, v18, v50
    v_mfma_f32_16x16x32_bf16 v[120:123], v[156:159], a[216:219], v[120:123]
    v_mul_f32 v19, v19, v51
    v_cvt_pk_bf16_f32 v32, v0, v1
    v_cvt_pk_bf16_f32 v33, v2, v3
    v_mfma_f32_16x16x32_bf16 v[124:127], v[152:155], a[204:207], v[124:127]
    ds_read_b64_tr_b16 v[142:143], v162 offset:63488
    v_cvt_pk_bf16_f32 v34, v16, v17
    v_cvt_pk_bf16_f32 v35, v18, v19
    v_mul_f32 v36, v4, v36
    v_mfma_f32_16x16x32_bf16 v[124:127], v[156:159], a[220:223], v[124:127]
    s_waitcnt lgkmcnt(4)
    buffer_store_dwordx4 v[32:35], v175, s[24:27], s58 offen offset:0 sc0 sc1
    v_mul_f32 v4, v4, v206
    v_mfma_f32_16x16x32_bf16 v[64:67], v[128:131], a[224:227], v[64:67]
    s_barrier
    v_mul_f32 v37, v5, v37
    v_mul_f32 v5, v5, v206
    v_mul_f32 v38, v6, v38
    v_mfma_f32_16x16x32_bf16 v[64:67], v[132:135], a[240:243], v[64:67]
    ds_read_b64_tr_b16 v[144:145], v163 offset:49152
    v_mul_f32 v6, v6, v206
    v_mul_f32 v39, v7, v39
    v_mul_f32 v7, v7, v206
    v_mfma_f32_16x16x32_bf16 v[68:71], v[128:131], a[228:231], v[68:71]
    ds_read_b64_tr_b16 v[146:147], v163 offset:51200
    v_mul_f32 v52, v20, v52
    v_mul_f32 v20, v20, v206
    v_mul_f32 v53, v21, v53
    v_mfma_f32_16x16x32_bf16 v[68:71], v[132:135], a[244:247], v[68:71]
    v_exp_f32 v4, v4
    v_mfma_f32_16x16x32_bf16 v[72:75], v[128:131], a[232:235], v[72:75]
    ds_read_b64_tr_b16 v[148:149], v163 offset:57344
    v_mul_f32 v21, v21, v206
    v_mul_f32 v54, v22, v54
    v_mul_f32 v22, v22, v206
    v_mfma_f32_16x16x32_bf16 v[72:75], v[132:135], a[248:251], v[72:75]
    v_exp_f32 v5, v5
    v_mul_f32 v55, v23, v55
    v_mfma_f32_16x16x32_bf16 v[76:79], v[128:131], a[236:239], v[76:79]
    ds_read_b64_tr_b16 v[150:151], v163 offset:59392
    v_mul_f32 v23, v23, v206
    v_exp_f32 v6, v6
    v_mfma_f32_16x16x32_bf16 v[76:79], v[132:135], a[252:255], v[76:79]
    s_waitcnt lgkmcnt(4)
    v_exp_f32 v7, v7
    v_mfma_f32_16x16x32_bf16 v[96:99], v[136:139], a[224:227], v[96:99]
    ds_read_b64_tr_b16 v[152:153], v163 offset:53248
    v_fma_f32 v4, v4, v207, v207
    v_exp_f32 v20, v20
    v_mfma_f32_16x16x32_bf16 v[96:99], v[140:143], a[240:243], v[96:99]
    v_exp_f32 v21, v21
    v_exp_f32 v22, v22
    v_mfma_f32_16x16x32_bf16 v[100:103], v[136:139], a[228:231], v[100:103]
    ds_read_b64_tr_b16 v[154:155], v163 offset:55296
    v_fma_f32 v5, v5, v207, v207
    v_exp_f32 v23, v23
    v_mfma_f32_16x16x32_bf16 v[100:103], v[140:143], a[244:247], v[100:103]
    v_rcp_f32 v4, v4
    v_mfma_f32_16x16x32_bf16 v[104:107], v[136:139], a[232:235], v[104:107]
    ds_read_b64_tr_b16 v[156:157], v163 offset:61440
    v_fma_f32 v6, v6, v207, v207
    v_fma_f32 v7, v7, v207, v207
    v_fma_f32 v20, v20, v207, v207
    v_mfma_f32_16x16x32_bf16 v[104:107], v[140:143], a[248:251], v[104:107]
    v_rcp_f32 v5, v5
    v_fma_f32 v21, v21, v207, v207
    v_mfma_f32_16x16x32_bf16 v[108:111], v[136:139], a[236:239], v[108:111]
    ds_read_b64_tr_b16 v[158:159], v163 offset:63488
    v_fma_f32 v22, v22, v207, v207
    v_fma_f32 v23, v23, v207, v207
    v_rcp_f32 v6, v6
    v_mfma_f32_16x16x32_bf16 v[108:111], v[140:143], a[252:255], v[108:111]
    s_waitcnt lgkmcnt(4)
    v_rcp_f32 v7, v7
    v_mfma_f32_16x16x32_bf16 v[80:83], v[144:147], a[224:227], v[80:83]
    ds_read_b64_tr_b16 v[128:129], v162 offset:0
    v_mul_f32 v4, v4, v36
    v_rcp_f32 v20, v20
    v_mfma_f32_16x16x32_bf16 v[80:83], v[148:151], a[240:243], v[80:83]
    v_rcp_f32 v21, v21
    v_rcp_f32 v22, v22
    v_mfma_f32_16x16x32_bf16 v[84:87], v[144:147], a[228:231], v[84:87]
    ds_read_b64_tr_b16 v[130:131], v162 offset:2048
    v_mul_f32 v5, v5, v37
    v_rcp_f32 v23, v23
    v_mfma_f32_16x16x32_bf16 v[84:87], v[148:151], a[244:247], v[84:87]
    v_mul_f32 v6, v6, v38
    v_mul_f32 v7, v7, v39
    v_mfma_f32_16x16x32_bf16 v[88:91], v[144:147], a[232:235], v[88:91]
    ds_read_b64_tr_b16 v[132:133], v162 offset:8192
    v_mul_f32 v20, v20, v52
    v_mul_f32 v21, v21, v53
    v_mul_f32 v22, v22, v54
    v_mfma_f32_16x16x32_bf16 v[88:91], v[148:151], a[248:251], v[88:91]
    v_mul_f32 v23, v23, v55
    v_cvt_pk_bf16_f32 v36, v4, v5
    v_cvt_pk_bf16_f32 v37, v6, v7
    v_mfma_f32_16x16x32_bf16 v[92:95], v[144:147], a[236:239], v[92:95]
    ds_read_b64_tr_b16 v[134:135], v162 offset:10240
    v_cvt_pk_bf16_f32 v38, v20, v21
    v_cvt_pk_bf16_f32 v39, v22, v23
    v_mul_f32 v40, v8, v40
    v_mfma_f32_16x16x32_bf16 v[92:95], v[148:151], a[252:255], v[92:95]
    s_waitcnt lgkmcnt(4)
    buffer_store_dwordx4 v[36:39], v175, s[24:27], s58 offen offset:1024 sc0 sc1
    v_mul_f32 v8, v8, v210
    v_mfma_f32_16x16x32_bf16 v[112:115], v[152:155], a[224:227], v[112:115]
    ds_read_b64_tr_b16 v[136:137], v162 offset:4096
    v_mul_f32 v41, v9, v41
    v_mul_f32 v9, v9, v210
    v_mul_f32 v42, v10, v42
    v_mfma_f32_16x16x32_bf16 v[112:115], v[156:159], a[240:243], v[112:115]
    v_exp_f32 v8, v8
    v_mul_f32 v10, v10, v210
    v_mfma_f32_16x16x32_bf16 v[116:119], v[152:155], a[228:231], v[116:119]
    ds_read_b64_tr_b16 v[138:139], v162 offset:6144
    v_mul_f32 v43, v11, v43
    v_mul_f32 v11, v11, v210
    v_mul_f32 v56, v24, v56
    v_mfma_f32_16x16x32_bf16 v[116:119], v[156:159], a[244:247], v[116:119]
    v_exp_f32 v9, v9
    v_mfma_f32_16x16x32_bf16 v[120:123], v[152:155], a[232:235], v[120:123]
    ds_read_b64_tr_b16 v[140:141], v162 offset:12288
    v_mul_f32 v24, v24, v210
    v_mul_f32 v57, v25, v57
    v_mul_f32 v25, v25, v210
    v_mfma_f32_16x16x32_bf16 v[120:123], v[156:159], a[248:251], v[120:123]
    v_exp_f32 v10, v10
    v_mul_f32 v58, v26, v58
    v_mfma_f32_16x16x32_bf16 v[124:127], v[152:155], a[236:239], v[124:127]
    ds_read_b64_tr_b16 v[142:143], v162 offset:14336
    v_mul_f32 v26, v26, v210
    v_mul_f32 v59, v27, v59
    v_mul_f32 v27, v27, v210
    v_mfma_f32_16x16x32_bf16 v[124:127], v[156:159], a[252:255], v[124:127]
    s_waitcnt lgkmcnt(4)
    v_exp_f32 v11, v11
    v_mfma_f32_16x16x32_bf16 v[64:67], v[128:131], v[224:227], v[64:67]
    s_waitcnt vmcnt(10)
    s_barrier
    s_add_u32 m0, s53, 24576
    v_exp_f32 v24, v24
    v_exp_f32 v25, v25
    v_mfma_f32_16x16x32_bf16 v[64:67], v[132:135], v[240:243], v[64:67]
    s_add_u32 s55, s4, 128
    ds_read_b64_tr_b16 v[144:145], v163 offset:0
    v_fma_f32 v8, v8, v211, v211
    v_exp_f32 v26, v26
    v_mfma_f32_16x16x32_bf16 v[68:71], v[128:131], v[228:231], v[68:71]
    ds_read_b64_tr_b16 v[146:147], v163 offset:2048
    v_fma_f32 v9, v9, v211, v211
    v_exp_f32 v27, v27
    v_mfma_f32_16x16x32_bf16 v[68:71], v[132:135], v[244:247], v[68:71]
    buffer_load_dwordx4 v172, s[28:31], s55 offen lds
    v_fma_f32 v10, v10, v211, v211
    v_mfma_f32_16x16x32_bf16 v[72:75], v[128:131], v[232:235], v[72:75]
    ds_read_b64_tr_b16 v[148:149], v163 offset:8192
    v_fma_f32 v11, v11, v211, v211
    v_fma_f32 v24, v24, v211, v211
    v_fma_f32 v25, v25, v211, v211
    v_mfma_f32_16x16x32_bf16 v[72:75], v[132:135], v[248:251], v[72:75]
    buffer_load_dwordx4 v173, s[28:31], s55 offen offset:1024 lds
    v_fma_f32 v26, v26, v211, v211
    v_fma_f32 v27, v27, v211, v211
    v_rcp_f32 v8, v8
    v_mfma_f32_16x16x32_bf16 v[76:79], v[128:131], v[236:239], v[76:79]
    s_add_u32 m0, s53, 73728
    ds_read_b64_tr_b16 v[150:151], v163 offset:10240
    s_add_u32 s55, s4, 295040
    v_rcp_f32 v9, v9
    v_mfma_f32_16x16x32_bf16 v[76:79], v[132:135], v[252:255], v[76:79]
    s_waitcnt lgkmcnt(4)
    v_rcp_f32 v10, v10
    v_mfma_f32_16x16x32_bf16 v[96:99], v[136:139], v[224:227], v[96:99]
    ds_read_b64_tr_b16 v[152:153], v163 offset:4096
    v_mul_f32 v8, v8, v40
    v_rcp_f32 v11, v11
    v_mfma_f32_16x16x32_bf16 v[96:99], v[140:143], v[240:243], v[96:99]
    buffer_load_dwordx4 v172, s[28:31], s55 offen lds
    v_rcp_f32 v24, v24
    v_rcp_f32 v25, v25
    v_mfma_f32_16x16x32_bf16 v[100:103], v[136:139], v[228:231], v[100:103]
    ds_read_b64_tr_b16 v[154:155], v163 offset:6144
    v_mul_f32 v9, v9, v41
    v_rcp_f32 v26, v26
    v_mfma_f32_16x16x32_bf16 v[100:103], v[140:143], v[244:247], v[100:103]
    v_rcp_f32 v27, v27
    v_mfma_f32_16x16x32_bf16 v[104:107], v[136:139], v[232:235], v[104:107]
    ds_read_b64_tr_b16 v[156:157], v163 offset:12288
    v_mul_f32 v10, v10, v42
    v_mul_f32 v11, v11, v43
    v_mul_f32 v24, v24, v56
    v_mfma_f32_16x16x32_bf16 v[104:107], v[140:143], v[248:251], v[104:107]
    buffer_load_dwordx4 v173, s[28:31], s55 offen offset:1024 lds
    v_mul_f32 v25, v25, v57
    v_mul_f32 v26, v26, v58
    v_mul_f32 v27, v27, v59
    v_mfma_f32_16x16x32_bf16 v[108:111], v[136:139], v[236:239], v[108:111]
    s_add_u32 m0, s53, 98304
    ds_read_b64_tr_b16 v[158:159], v163 offset:14336
    s_add_u32 s55, s5, 128
    v_cvt_pk_bf16_f32 v40, v8, v9
    v_cvt_pk_bf16_f32 v41, v10, v11
    v_cvt_pk_bf16_f32 v42, v24, v25
    v_mfma_f32_16x16x32_bf16 v[108:111], v[140:143], v[252:255], v[108:111]
    s_waitcnt lgkmcnt(4)
    v_cvt_pk_bf16_f32 v43, v26, v27
    v_mul_f32 v44, v12, v44
    v_mfma_f32_16x16x32_bf16 v[80:83], v[144:147], v[224:227], v[80:83]
    ds_read_b64_tr_b16 v[128:129], v164 offset:0
    v_mul_f32 v12, v12, v214
    v_mul_f32 v45, v13, v45
    v_mul_f32 v13, v13, v214
    v_mfma_f32_16x16x32_bf16 v[80:83], v[148:151], v[240:243], v[80:83]
    buffer_load_dwordx4 v172, s[28:31], s55 offen lds
    v_mul_f32 v46, v14, v46
    v_mul_f32 v14, v14, v214
    v_mul_f32 v47, v15, v47
    v_mfma_f32_16x16x32_bf16 v[84:87], v[144:147], v[228:231], v[84:87]
    ds_read_b64_tr_b16 v[130:131], v164 offset:2048
    v_mul_f32 v15, v15, v214
    v_mul_f32 v60, v28, v60
    v_mul_f32 v28, v28, v214
    v_mfma_f32_16x16x32_bf16 v[84:87], v[148:151], v[244:247], v[84:87]
    buffer_store_dwordx4 v[40:43], v175, s[24:27], s58 offen offset:2048 sc0 sc1
    v_mul_f32 v61, v29, v61
    v_mfma_f32_16x16x32_bf16 v[88:91], v[144:147], v[232:235], v[88:91]
    ds_read_b64_tr_b16 v[132:133], v164 offset:24576
    v_mul_f32 v29, v29, v214
    v_mul_f32 v62, v30, v62
    v_mul_f32 v30, v30, v214
    v_mfma_f32_16x16x32_bf16 v[88:91], v[148:151], v[248:251], v[88:91]
    buffer_load_dwordx4 v173, s[28:31], s55 offen offset:1024 lds
    v_mul_f32 v63, v31, v63
    v_mul_f32 v31, v31, v214
    v_mfma_f32_16x16x32_bf16 v[92:95], v[144:147], v[236:239], v[92:95]
    s_add_u32 m0, s53, 122880
    ds_read_b64_tr_b16 v[134:135], v164 offset:26624
    s_add_u32 s55, s5, 295040
    v_exp_f32 v12, v12
    v_exp_f32 v13, v13
    v_mfma_f32_16x16x32_bf16 v[92:95], v[148:151], v[252:255], v[92:95]
    s_waitcnt lgkmcnt(4)
    v_exp_f32 v14, v14
    v_mfma_f32_16x16x32_bf16 v[112:115], v[152:155], v[224:227], v[112:115]
    v_add_u32 v220, 0xa000, v220
    v_fma_f32 v12, v12, v215, v215
    v_exp_f32 v15, v15
    v_mfma_f32_16x16x32_bf16 v[112:115], v[156:159], v[240:243], v[112:115]
    ds_read_b64_tr_b16 v[136:137], v220 offset:0
    v_fma_f32 v13, v13, v215, v215
    v_exp_f32 v28, v28
    v_mfma_f32_16x16x32_bf16 v[116:119], v[152:155], v[228:231], v[116:119]
    ds_read_b64_tr_b16 v[138:139], v220 offset:2048
    v_fma_f32 v14, v14, v215, v215
    v_exp_f32 v29, v29
    v_mfma_f32_16x16x32_bf16 v[116:119], v[156:159], v[244:247], v[116:119]
    buffer_load_dwordx4 v172, s[28:31], s55 offen lds
    v_exp_f32 v30, v30
    v_mfma_f32_16x16x32_bf16 v[120:123], v[152:155], v[232:235], v[120:123]
    ds_read_b64_tr_b16 v[140:141], v220 offset:4096
    v_fma_f32 v15, v15, v215, v215
    v_exp_f32 v31, v31
    v_mfma_f32_16x16x32_bf16 v[120:123], v[156:159], v[248:251], v[120:123]
    v_rcp_f32 v12, v12
    v_mfma_f32_16x16x32_bf16 v[124:127], v[152:155], v[236:239], v[124:127]
    ds_read_b64_tr_b16 v[142:143], v220 offset:6144
    v_fma_f32 v28, v28, v215, v215
    v_fma_f32 v29, v29, v215, v215
    v_fma_f32 v30, v30, v215, v215
    v_mfma_f32_16x16x32_bf16 v[124:127], v[156:159], v[252:255], v[124:127]
    s_waitcnt lgkmcnt(4)
    v_rcp_f32 v13, v13
    s_waitcnt vmcnt(10)
    v_mfma_f32_16x16x16_bf16 v[64:67], v[192:193], v[200:201], v[64:67]
    s_barrier
    v_fma_f32 v31, v31, v215, v215
    v_rcp_f32 v14, v14
    v_mfma_f32_16x16x16_bf16 v[68:71], v[192:193], v[204:205], v[68:71]
    ds_read_b64_tr_b16 v[144:145], v164 offset:4096
    v_mul_f32 v12, v12, v44
    v_rcp_f32 v15, v15
    v_mfma_f32_16x16x16_bf16 v[72:75], v[192:193], v[208:209], v[72:75]
    ds_read_b64_tr_b16 v[146:147], v164 offset:6144
    v_mul_f32 v13, v13, v45
    v_mfma_f32_16x16x16_bf16 v[76:79], v[192:193], v[212:213], v[76:79]
    buffer_load_dwordx4 v173, s[28:31], s55 offen offset:1024 lds
    v_rcp_f32 v28, v28
    v_mfma_f32_16x16x16_bf16 v[80:83], v[194:195], v[200:201], v[80:83]
    s_add_u32 m0, s53, 147456
    s_add_u32 s55, s6, 128
    v_mul_f32 v14, v14, v46
    v_rcp_f32 v29, v29
    v_mfma_f32_16x16x16_bf16 v[84:87], v[194:195], v[204:205], v[84:87]
    buffer_load_dwordx4 v172, s[28:31], s55 offen lds
    v_rcp_f32 v30, v30
    v_mfma_f32_16x16x16_bf16 v[88:91], v[194:195], v[208:209], v[88:91]
    v_rcp_f32 v31, v31
    v_mfma_f32_16x16x16_bf16 v[92:95], v[194:195], v[212:213], v[92:95]
    v_mul_f32 v15, v15, v47
    v_mul_f32 v28, v28, v60
    v_mfma_f32_16x16x16_bf16 v[96:99], v[196:197], v[200:201], v[96:99]
    buffer_load_dwordx4 v173, s[28:31], s55 offen offset:1024 lds
    v_mul_f32 v29, v29, v61
    v_mul_f32 v30, v30, v62
    v_mul_f32 v31, v31, v63
    v_mfma_f32_16x16x16_bf16 v[100:103], v[196:197], v[204:205], v[100:103]
    s_add_u32 m0, s53, 81920
    s_add_u32 s55, s6, 295040
    v_cvt_pk_bf16_f32 v44, v12, v13
    v_cvt_pk_bf16_f32 v45, v14, v15
    v_mfma_f32_16x16x16_bf16 v[104:107], v[196:197], v[208:209], v[104:107]
    v_cvt_pk_bf16_f32 v46, v28, v29
    v_cvt_pk_bf16_f32 v47, v30, v31
    v_mfma_f32_16x16x16_bf16 v[108:111], v[196:197], v[212:213], v[108:111]
    buffer_store_dwordx4 v[44:47], v175, s[24:27], s58 offen offset:3072 sc0 sc1
    v_mfma_f32_16x16x16_bf16 v[112:115], v[198:199], v[200:201], v[112:115]
    buffer_load_dwordx4 v172, s[28:31], s55 offen lds
    v_mfma_f32_16x16x16_bf16 v[116:119], v[198:199], v[204:205], v[116:119]
    v_mfma_f32_16x16x16_bf16 v[120:123], v[198:199], v[208:209], v[120:123]
    v_mfma_f32_16x16x16_bf16 v[124:127], v[198:199], v[212:213], v[124:127]
    v_mfma_f32_16x16x32_bf16 v[0:3], v[128:131], a[0:3], 0
    buffer_load_dwordx4 v173, s[28:31], s55 offen offset:1024 lds
    v_mfma_f32_16x16x32_bf16 v[0:3], v[132:135], a[16:19], v[0:3]
    s_add_u32 m0, s53, 106496
    s_add_u32 s55, s7, 128
    v_mfma_f32_16x16x32_bf16 v[4:7], v[128:131], a[4:7], 0
    v_mfma_f32_16x16x32_bf16 v[4:7], v[132:135], a[20:23], v[4:7]
    v_mfma_f32_16x16x32_bf16 v[8:11], v[128:131], a[8:11], 0
    ds_read_b64_tr_b16 v[148:149], v164 offset:28672
    v_mfma_f32_16x16x32_bf16 v[8:11], v[132:135], a[24:27], v[8:11]
    buffer_load_dwordx4 v172, s[28:31], s55 offen lds
    v_mfma_f32_16x16x32_bf16 v[12:15], v[128:131], a[12:15], 0
    ds_read_b64_tr_b16 v[150:151], v164 offset:30720
    v_mfma_f32_16x16x32_bf16 v[12:15], v[132:135], a[28:31], v[12:15]
    s_waitcnt lgkmcnt(4)
    v_mfma_f32_16x16x32_bf16 v[176:179], v[188:191], v[136:139], 0
    v_mfma_f32_16x16x32_bf16 v[180:183], v[188:191], v[140:143], 0
    s_waitcnt lgkmcnt(0)
    v_mfma_f32_16x16x32_bf16 v[32:35], v[144:147], a[0:3], 0
    s_add_u32 s58, s57, 131072
    v_add_u32 v220, 0x6000, v220
    v_mul_f32 v96, v64, v96
    v_mfma_f32_16x16x32_bf16 v[32:35], v[148:151], a[16:19], v[32:35]
    ds_read_b64_tr_b16 v[152:153], v220 offset:0
    v_mul_f32 v64, v64, v202
    v_mfma_f32_16x16x32_bf16 v[36:39], v[144:147], a[4:7], 0
    ds_read_b64_tr_b16 v[154:155], v220 offset:2048
    v_mul_f32 v97, v65, v97
    v_mfma_f32_16x16x32_bf16 v[36:39], v[148:151], a[20:23], v[36:39]
    ds_read_b64_tr_b16 v[156:157], v220 offset:4096
    v_mul_f32 v65, v65, v202
    ds_read_b64_tr_b16 v[158:159], v220 offset:6144
    ds_read_b64_tr_b16 v[128:129], v165 offset:0
    ds_read_b64_tr_b16 v[130:131], v165 offset:2048
    v_mfma_f32_16x16x32_bf16 v[40:43], v[144:147], a[8:11], 0
    ds_read_b64_tr_b16 v[132:133], v165 offset:24576
    v_mul_f32 v98, v66, v98
    v_mfma_f32_16x16x32_bf16 v[40:43], v[148:151], a[24:27], v[40:43]
    buffer_load_dwordx4 v173, s[28:31], s55 offen offset:1024 lds
    v_mfma_f32_16x16x32_bf16 v[44:47], v[144:147], a[12:15], 0
    s_add_u32 m0, s53, 131072
    ds_read_b64_tr_b16 v[134:135], v165 offset:26624
    s_add_u32 s55, s7, 295040
    v_mfma_f32_16x16x32_bf16 v[44:47], v[148:151], a[28:31], v[44:47]
    s_waitcnt lgkmcnt(4)
    v_exp_f32 v64, v64
    v_mfma_f32_16x16x32_bf16 v[176:179], v[188:191], v[152:155], v[176:179]
    v_mfma_f32_16x16x32_bf16 v[180:183], v[188:191], v[156:159], v[180:183]
    s_waitcnt lgkmcnt(0)
    v_mfma_f32_16x16x32_bf16 v[16:19], v[128:131], a[0:3], 0
    s_waitcnt vmcnt(12)
    s_barrier
    v_add_u32 v220, 0xc000, v220
    v_mfma_f32_16x16x32_bf16 v[16:19], v[132:135], a[16:19], v[16:19]
    ds_read_b64_tr_b16 v[136:137], v220 offset:0
    v_mul_f32 v66, v66, v202
    v_mfma_f32_16x16x32_bf16 v[20:23], v[128:131], a[4:7], 0
    ds_read_b64_tr_b16 v[138:139], v220 offset:2048
    v_mul_f32 v99, v67, v99
    v_mfma_f32_16x16x32_bf16 v[20:23], v[132:135], a[20:23], v[20:23]
    ds_read_b64_tr_b16 v[140:141], v220 offset:4096
    v_mul_f32 v67, v67, v202
    ds_read_b64_tr_b16 v[142:143], v220 offset:6144
    ds_read_b64_tr_b16 v[144:145], v165 offset:4096
    ds_read_b64_tr_b16 v[146:147], v165 offset:6144
    v_mfma_f32_16x16x32_bf16 v[24:27], v[128:131], a[8:11], 0
    ds_read_b64_tr_b16 v[148:149], v165 offset:28672
    v_mul_f32 v112, v80, v112
    v_mfma_f32_16x16x32_bf16 v[24:27], v[132:135], a[24:27], v[24:27]
    buffer_load_dwordx4 v172, s[28:31], s55 offen lds
    v_mfma_f32_16x16x32_bf16 v[28:31], v[128:131], a[12:15], 0
    ds_read_b64_tr_b16 v[150:151], v165 offset:30720
    v_mul_f32 v80, v80, v202
    v_mfma_f32_16x16x32_bf16 v[28:31], v[132:135], a[28:31], v[28:31]
    s_waitcnt lgkmcnt(4)
    buffer_load_dwordx4 v173, s[28:31], s55 offen offset:1024 lds
    v_mfma_f32_16x16x32_bf16 v[192:195], v[188:191], v[136:139], 0
    s_add_u32 m0, s53, 155648
    s_add_u32 s55, s10, 128
    v_mfma_f32_16x16x32_bf16 v[196:199], v[188:191], v[140:143], 0
    s_waitcnt lgkmcnt(0)
    v_mfma_f32_16x16x32_bf16 v[48:51], v[144:147], a[0:3], 0
    v_add_u32 v220, 0xfffe2000, v220
    v_mul_f32 v113, v81, v113
    v_mfma_f32_16x16x32_bf16 v[48:51], v[148:151], a[16:19], v[48:51]
    ds_read_b64_tr_b16 v[152:153], v220 offset:0
    v_mul_f32 v81, v81, v202
    v_mfma_f32_16x16x32_bf16 v[52:55], v[144:147], a[4:7], 0
    ds_read_b64_tr_b16 v[154:155], v220 offset:2048
    v_mul_f32 v114, v82, v114
    v_mfma_f32_16x16x32_bf16 v[52:55], v[148:151], a[20:23], v[52:55]
    ds_read_b64_tr_b16 v[156:157], v220 offset:4096
    v_mul_f32 v82, v82, v202
    ds_read_b64_tr_b16 v[158:159], v220 offset:6144
    ds_read_b64_tr_b16 v[128:129], v160 offset:24576
    ds_read_b64_tr_b16 v[130:131], v160 offset:26624
    v_mfma_f32_16x16x32_bf16 v[56:59], v[144:147], a[8:11], 0
    ds_read_b64_tr_b16 v[132:133], v164 offset:8192
    v_mul_f32 v115, v83, v115
    v_mfma_f32_16x16x32_bf16 v[56:59], v[148:151], a[24:27], v[56:59]
    buffer_load_dwordx4 v172, s[28:31], s55 offen lds
    v_mfma_f32_16x16x32_bf16 v[60:63], v[144:147], a[12:15], 0
    ds_read_b64_tr_b16 v[134:135], v164 offset:10240
    v_mul_f32 v83, v83, v202
    v_mfma_f32_16x16x32_bf16 v[60:63], v[148:151], a[28:31], v[60:63]
    s_waitcnt lgkmcnt(4)
    v_exp_f32 v65, v65
    v_mfma_f32_16x16x32_bf16 v[192:195], v[188:191], v[152:155], v[192:195]
    v_mfma_f32_16x16x32_bf16 v[196:199], v[188:191], v[156:159], v[196:199]
    s_waitcnt lgkmcnt(0)
    v_mfma_f32_16x16x32_bf16 v[0:3], v[128:131], a[32:35], v[0:3]
    v_add_u32 v220, 0x18000, v220
    v_fma_f32 v64, v64, v203, v203
    v_mfma_f32_16x16x32_bf16 v[0:3], v[132:135], a[48:51], v[0:3]
    ds_read_b64_tr_b16 v[136:137], v220 offset:0
    v_fma_f32 v65, v65, v203, v203
    v_mfma_f32_16x16x32_bf16 v[4:7], v[128:131], a[36:39], v[4:7]
    ds_read_b64_tr_b16 v[138:139], v220 offset:2048
    v_mul_f32 v100, v68, v100
    v_mfma_f32_16x16x32_bf16 v[4:7], v[132:135], a[52:55], v[4:7]
    ds_read_b64_tr_b16 v[140:141], v220 offset:4096
    v_mul_f32 v68, v68, v206
    ds_read_b64_tr_b16 v[142:143], v220 offset:6144
    ds_read_b64_tr_b16 v[144:145], v160 offset:28672
    ds_read_b64_tr_b16 v[146:147], v160 offset:30720
    v_mfma_f32_16x16x32_bf16 v[8:11], v[128:131], a[40:43], v[8:11]
    ds_read_b64_tr_b16 v[148:149], v164 offset:12288
    v_mul_f32 v101, v69, v101
    v_mfma_f32_16x16x32_bf16 v[8:11], v[132:135], a[56:59], v[8:11]
    buffer_load_dwordx4 v173, s[28:31], s55 offen offset:1024 lds
    v_mfma_f32_16x16x32_bf16 v[12:15], v[128:131], a[44:47], v[12:15]
    s_add_u32 m0, s53, 32768
    ds_read_b64_tr_b16 v[150:151], v164 offset:14336
    s_add_u32 s55, s10, 295040
    v_mfma_f32_16x16x32_bf16 v[12:15], v[132:135], a[60:63], v[12:15]
    s_waitcnt lgkmcnt(4)
    buffer_load_dwordx4 v172, s[28:31], s55 offen lds
    v_mfma_f32_16x16x32_bf16 v[176:179], v[184:187], v[136:139], v[176:179]
    v_mfma_f32_16x16x32_bf16 v[180:183], v[184:187], v[140:143], v[180:183]
    s_waitcnt lgkmcnt(0)
    v_mfma_f32_16x16x32_bf16 v[32:35], v[144:147], a[32:35], v[32:35]
    ds_read_b64_tr_b16 v[152:153], v220 offset:0
    v_mul_f32 v69, v69, v206
    v_mfma_f32_16x16x32_bf16 v[32:35], v[148:151], a[48:51], v[32:35]
    ds_read_b64_tr_b16 v[154:155], v220 offset:2048
    v_mul_f32 v102, v70, v102
    v_mfma_f32_16x16x32_bf16 v[36:39], v[144:147], a[36:39], v[36:39]
    ds_read_b64_tr_b16 v[156:157], v220 offset:4096
    v_mul_f32 v70, v70, v206
    v_mfma_f32_16x16x32_bf16 v[36:39], v[148:151], a[52:55], v[36:39]
    ds_read_b64_tr_b16 v[158:159], v220 offset:6144
    v_mul_f32 v103, v71, v103
    ds_read_b64_tr_b16 v[128:129], v161 offset:24576
    ds_read_b64_tr_b16 v[130:131], v161 offset:26624
    v_mfma_f32_16x16x32_bf16 v[40:43], v[144:147], a[40:43], v[40:43]
    ds_read_b64_tr_b16 v[132:133], v165 offset:8192
    v_mul_f32 v71, v71, v206
    v_mfma_f32_16x16x32_bf16 v[40:43], v[148:151], a[56:59], v[40:43]
    buffer_load_dwordx4 v173, s[28:31], s55 offen offset:1024 lds
    v_mfma_f32_16x16x32_bf16 v[44:47], v[144:147], a[44:47], v[44:47]
    s_add_u32 m0, s53, 40960
    ds_read_b64_tr_b16 v[134:135], v165 offset:10240
    s_add_u32 s55, s11, 128
    v_mfma_f32_16x16x32_bf16 v[44:47], v[148:151], a[60:63], v[44:47]
    s_waitcnt lgkmcnt(4)
    v_exp_f32 v66, v66
    v_xor_b32 v188, v188, v184
    v_xor_b32 v189, v189, v184
    v_xor_b32 v190, v190, v184
    v_xor_b32 v191, v191, v184
    s_nop 1
    v_mfma_f32_16x16x32_bf16 v[192:195], v[188:191], v[152:155], v[192:195]
    v_mfma_f32_16x16x32_bf16 v[196:199], v[188:191], v[156:159], v[196:199]
    s_waitcnt lgkmcnt(0)
    v_mfma_f32_16x16x32_bf16 v[16:19], v[128:131], a[32:35], v[16:19]
    s_waitcnt vmcnt(13)
    s_barrier
    v_fma_f32 v66, v66, v203, v203
    v_mfma_f32_16x16x32_bf16 v[16:19], v[132:135], a[48:51], v[16:19]
    ds_read_b64_tr_b16 v[136:137], v161 offset:28672
    v_mul_f32 v116, v84, v116
    v_mfma_f32_16x16x32_bf16 v[20:23], v[128:131], a[36:39], v[20:23]
    ds_read_b64_tr_b16 v[138:139], v161 offset:30720
    v_mul_f32 v84, v84, v206
    v_mfma_f32_16x16x32_bf16 v[20:23], v[132:135], a[52:55], v[20:23]
    ds_read_b64_tr_b16 v[140:141], v165 offset:12288
    v_mul_f32 v117, v85, v117
    ds_read_b64_tr_b16 v[142:143], v165 offset:14336
    ds_read_b64_tr_b16 v[144:145], v164 offset:32768
    ds_read_b64_tr_b16 v[146:147], v164 offset:34816
    v_mfma_f32_16x16x32_bf16 v[24:27], v[128:131], a[40:43], v[24:27]
    ds_read_b64_tr_b16 v[148:149], v164 offset:57344
    v_mul_f32 v85, v85, v206
    v_mfma_f32_16x16x32_bf16 v[24:27], v[132:135], a[56:59], v[24:27]
    buffer_load_dwordx4 v172, s[28:31], s55 offen lds
    v_mfma_f32_16x16x32_bf16 v[28:31], v[128:131], a[44:47], v[28:31]
    ds_read_b64_tr_b16 v[150:151], v164 offset:59392
    v_mul_f32 v118, v86, v118
    v_mfma_f32_16x16x32_bf16 v[28:31], v[132:135], a[60:63], v[28:31]
    s_waitcnt lgkmcnt(4)
    buffer_load_dwordx4 v173, s[28:31], s55 offen offset:1024 lds
    v_mfma_f32_16x16x32_bf16 v[48:51], v[136:139], a[32:35], v[48:51]
    s_add_u32 m0, s53, 49152
    ds_read_b64_tr_b16 v[152:153], v164 offset:36864
    s_add_u32 s55, s11, 295040
    v_mfma_f32_16x16x32_bf16 v[48:51], v[140:143], a[48:51], v[48:51]
    v_exp_f32 v67, v67
    v_mfma_f32_16x16x32_bf16 v[52:55], v[136:139], a[36:39], v[52:55]
    ds_read_b64_tr_b16 v[154:155], v164 offset:38912
    v_fma_f32 v67, v67, v203, v203
    v_mfma_f32_16x16x32_bf16 v[52:55], v[140:143], a[52:55], v[52:55]
    v_exp_f32 v80, v80
    v_mfma_f32_16x16x32_bf16 v[56:59], v[136:139], a[40:43], v[56:59]
    ds_read_b64_tr_b16 v[156:157], v164 offset:61440
    v_fma_f32 v80, v80, v203, v203
    v_mfma_f32_16x16x32_bf16 v[56:59], v[140:143], a[56:59], v[56:59]
    buffer_load_dwordx4 v172, s[28:31], s55 offen lds
    v_mfma_f32_16x16x32_bf16 v[60:63], v[136:139], a[44:47], v[60:63]
    ds_read_b64_tr_b16 v[158:159], v164 offset:63488
    v_mul_f32 v86, v86, v206
    v_mfma_f32_16x16x32_bf16 v[60:63], v[140:143], a[60:63], v[60:63]
    s_waitcnt lgkmcnt(4)
    v_exp_f32 v81, v81
    v_mfma_f32_16x16x32_bf16 v[0:3], v[144:147], a[64:67], v[0:3]
    s_mov_b32 vcc_lo, 0xffff0000
    ds_read_b64_tr_b16 v[128:129], v165 offset:32768
    s_mov_b32 vcc_hi, 0
    v_mfma_f32_16x16x32_bf16 v[0:3], v[148:151], a[80:83], v[0:3]
    buffer_load_dwordx4 v173, s[28:31], s55 offen offset:1024 lds
    v_mfma_f32_16x16x32_bf16 v[4:7], v[144:147], a[68:71], v[4:7]
    s_add_u32 m0, s53, 57344
    ds_read_b64_tr_b16 v[130:131], v165 offset:34816
    s_add_u32 s55, s20, 128
    v_mfma_f32_16x16x32_bf16 v[4:7], v[148:151], a[84:87], v[4:7]
    v_cndmask_b32 v176, v176, v180, vcc
    v_cvt_pk_bf16_f32 v177, v176, v176
    v_mfma_f32_16x16x32_bf16 v[8:11], v[144:147], a[72:75], v[8:11]
    ds_read_b64_tr_b16 v[132:133], v165 offset:57344
    v_and_b32 v177, 0xffff0000, v177
    v_mfma_f32_16x16x32_bf16 v[8:11], v[148:151], a[88:91], v[8:11]
    buffer_load_dwordx4 v172, s[28:31], s55 offen lds
    v_mfma_f32_16x16x32_bf16 v[12:15], v[144:147], a[76:79], v[12:15]
    ds_read_b64_tr_b16 v[134:135], v165 offset:59392
    v_sub_f32 v178, v176, v177
    v_mfma_f32_16x16x32_bf16 v[12:15], v[148:151], a[92:95], v[12:15]
    s_waitcnt lgkmcnt(4)
    v_cvt_pk_bf16_f32 v176, v177, v178
    s_add_u32 s49, s82, 4096
    v_mfma_f32_16x16x32_bf16 v[32:35], v[152:155], a[64:67], v[32:35]
    ds_read_b64_tr_b16 v[136:137], v165 offset:36864
    v_fma_f32 v81, v81, v203, v203
    v_mfma_f32_16x16x32_bf16 v[32:35], v[156:159], a[80:83], v[32:35]
    buffer_load_dwordx4 v173, s[28:31], s55 offen offset:1024 lds
    v_mfma_f32_16x16x32_bf16 v[36:39], v[152:155], a[68:71], v[36:39]
    s_add_u32 m0, s53, 0
    ds_read_b64_tr_b16 v[138:139], v165 offset:38912
    s_add_u32 s55, s20, 295040
    v_mfma_f32_16x16x32_bf16 v[36:39], v[156:159], a[84:87], v[36:39]
    buffer_store_dword v176, v221, s[24:27], s49 offen sc0 sc1
    v_mfma_f32_16x16x32_bf16 v[40:43], v[152:155], a[72:75], v[40:43]
    s_mov_b32 vcc_lo, 0xffff0000
    ds_read_b64_tr_b16 v[140:141], v165 offset:61440
    s_mov_b32 vcc_hi, 0
    v_exp_f32 v82, v82
    v_mfma_f32_16x16x32_bf16 v[40:43], v[156:159], a[88:91], v[40:43]
    buffer_load_dwordx4 v172, s[28:31], s55 offen lds
    v_mfma_f32_16x16x32_bf16 v[44:47], v[152:155], a[76:79], v[44:47]
    ds_read_b64_tr_b16 v[142:143], v165 offset:63488
    v_cndmask_b32 v192, v192, v196, vcc
    v_exp_f32 v83, v83
    v_mfma_f32_16x16x32_bf16 v[44:47], v[156:159], a[92:95], v[44:47]
    s_waitcnt lgkmcnt(4)
    v_cvt_pk_bf16_f32 v193, v192, v192
    v_and_b32 v193, 0xffff0000, v193
    v_mfma_f32_16x16x32_bf16 v[16:19], v[128:131], a[64:67], v[16:19]
    s_waitcnt vmcnt(16)
    s_barrier
    v_sub_f32 v194, v192, v193
    v_fma_f32 v82, v82, v203, v203
    v_mfma_f32_16x16x32_bf16 v[16:19], v[132:135], a[80:83], v[16:19]
    ds_read_b64_tr_b16 v[144:145], v168 offset:16384
    v_cvt_pk_bf16_f32 v192, v193, v194
    v_fma_f32 v83, v83, v203, v203
    v_mfma_f32_16x16x32_bf16 v[20:23], v[128:131], a[68:71], v[20:23]
    s_add_u32 s49, s82, 8192
    ds_read_b64_tr_b16 v[146:147], v168 offset:18432
    v_mul_f32 v119, v87, v119
    v_mfma_f32_16x16x32_bf16 v[20:23], v[132:135], a[84:87], v[20:23]
    buffer_store_dword v192, v221, s[24:27], s49 offen sc0 sc1
    v_mfma_f32_16x16x32_bf16 v[24:27], v[128:131], a[72:75], v[24:27]
    ds_read_b64_tr_b16 v[148:149], v164 offset:16384
    v_mul_f32 v87, v87, v206
    v_rcp_f32 v64, v64
    v_mfma_f32_16x16x32_bf16 v[24:27], v[132:135], a[88:91], v[24:27]
    buffer_load_dwordx4 v173, s[28:31], s55 offen offset:1024 lds
    v_mfma_f32_16x16x32_bf16 v[28:31], v[128:131], a[76:79], v[28:31]
    s_add_u32 m0, s53, 8192
    ds_read_b64_tr_b16 v[150:151], v164 offset:18432
    s_add_u32 s55, s21, 128
    v_rcp_f32 v65, v65
    v_mfma_f32_16x16x32_bf16 v[28:31], v[132:135], a[92:95], v[28:31]
    s_waitcnt lgkmcnt(4)
    v_rcp_f32 v66, v66
    v_mfma_f32_16x16x32_bf16 v[48:51], v[136:139], a[64:67], v[48:51]
    ds_read_b64_tr_b16 v[152:153], v168 offset:20480
    v_mul_f32 v64, v64, v96
    v_mfma_f32_16x16x32_bf16 v[48:51], v[140:143], a[80:83], v[48:51]
    buffer_load_dwordx4 v172, s[28:31], s55 offen lds
    v_mfma_f32_16x16x32_bf16 v[52:55], v[136:139], a[68:71], v[52:55]
    ds_read_b64_tr_b16 v[154:155], v168 offset:22528
    v_mul_f32 v65, v65, v97
    v_mfma_f32_16x16x32_bf16 v[52:55], v[140:143], a[84:87], v[52:55]
    v_rcp_f32 v67, v67
    v_mfma_f32_16x16x32_bf16 v[56:59], v[136:139], a[72:75], v[56:59]
    ds_read_b64_tr_b16 v[156:157], v164 offset:20480
    v_mul_f32 v66, v66, v98
    v_mfma_f32_16x16x32_bf16 v[56:59], v[140:143], a[88:91], v[56:59]
    buffer_load_dwordx4 v173, s[28:31], s55 offen offset:1024 lds
    v_rcp_f32 v80, v80
    v_mfma_f32_16x16x32_bf16 v[60:63], v[136:139], a[76:79], v[60:63]
    s_add_u32 m0, s53, 114688
    ds_read_b64_tr_b16 v[158:159], v164 offset:22528
    s_add_u32 s55, s21, 295040
    v_mfma_f32_16x16x32_bf16 v[60:63], v[140:143], a[92:95], v[60:63]
    s_waitcnt lgkmcnt(4)
    v_rcp_f32 v81, v81
    v_mfma_f32_16x16x32_bf16 v[0:3], v[144:147], a[96:99], v[0:3]
    ds_read_b64_tr_b16 v[128:129], v169 offset:16384
    v_mul_f32 v67, v67, v99
    v_mfma_f32_16x16x32_bf16 v[0:3], v[148:151], a[112:115], v[0:3]
    buffer_load_dwordx4 v172, s[28:31], s55 offen lds
    v_mfma_f32_16x16x32_bf16 v[4:7], v[144:147], a[100:103], v[4:7]
    ds_read_b64_tr_b16 v[130:131], v169 offset:18432
    v_mul_f32 v80, v80, v112
    v_mfma_f32_16x16x32_bf16 v[4:7], v[148:151], a[116:119], v[4:7]
    v_rcp_f32 v82, v82
    v_mfma_f32_16x16x32_bf16 v[8:11], v[144:147], a[104:107], v[8:11]
    ds_read_b64_tr_b16 v[132:133], v165 offset:16384
    v_mul_f32 v81, v81, v113
    v_mfma_f32_16x16x32_bf16 v[8:11], v[148:151], a[120:123], v[8:11]
    buffer_load_dwordx4 v173, s[28:31], s55 offen offset:1024 lds
    v_rcp_f32 v83, v83
    v_mfma_f32_16x16x32_bf16 v[12:15], v[144:147], a[108:111], v[12:15]
    ds_read_b64_tr_b16 v[134:135], v165 offset:18432
    v_mul_f32 v82, v82, v114
    v_mfma_f32_16x16x32_bf16 v[12:15], v[148:151], a[124:127], v[12:15]
    s_waitcnt lgkmcnt(4)
    v_exp_f32 v68, v68
    v_mfma_f32_16x16x32_bf16 v[32:35], v[152:155], a[96:99], v[32:35]
    ds_read_b64_tr_b16 v[136:137], v169 offset:20480
    v_mul_f32 v83, v83, v115
    v_mfma_f32_16x16x32_bf16 v[32:35], v[156:159], a[112:115], v[32:35]
    v_exp_f32 v69, v69
    v_mfma_f32_16x16x32_bf16 v[36:39], v[152:155], a[100:103], v[36:39]
    ds_read_b64_tr_b16 v[138:139], v169 offset:22528
    v_cvt_pk_bf16_f32 v96, v64, v65
    v_mfma_f32_16x16x32_bf16 v[36:39], v[156:159], a[116:119], v[36:39]
    v_exp_f32 v70, v70
    v_mfma_f32_16x16x32_bf16 v[40:43], v[152:155], a[104:107], v[40:43]
    ds_read_b64_tr_b16 v[140:141], v165 offset:20480
    v_cvt_pk_bf16_f32 v97, v66, v67
    v_mfma_f32_16x16x32_bf16 v[40:43], v[156:159], a[120:123], v[40:43]
    v_exp_f32 v71, v71
    v_mfma_f32_16x16x32_bf16 v[44:47], v[152:155], a[108:111], v[44:47]
    ds_read_b64_tr_b16 v[142:143], v165 offset:22528
    v_cvt_pk_bf16_f32 v98, v80, v81
    v_mfma_f32_16x16x32_bf16 v[44:47], v[156:159], a[124:127], v[44:47]
    s_waitcnt lgkmcnt(4)
    v_exp_f32 v84, v84
    v_mfma_f32_16x16x32_bf16 v[16:19], v[128:131], a[96:99], v[16:19]
    s_waitcnt vmcnt(18)
    s_barrier
    v_cvt_pk_bf16_f32 v99, v82, v83
    v_mfma_f32_16x16x32_bf16 v[16:19], v[132:135], a[112:115], v[16:19]
    ds_read_b64_tr_b16 v[144:145], v164 offset:40960
    v_fma_f32 v68, v68, v207, v207
    v_mfma_f32_16x16x32_bf16 v[20:23], v[128:131], a[100:103], v[20:23]
    ds_read_b64_tr_b16 v[146:147], v164 offset:43008
    v_fma_f32 v69, v69, v207, v207
    v_mfma_f32_16x16x32_bf16 v[20:23], v[132:135], a[116:119], v[20:23]
    buffer_store_dwordx4 v[96:99], v175, s[24:27], s58 offen offset:0 sc0 sc1
    v_fma_f32 v70, v70, v207, v207
    v_mfma_f32_16x16x32_bf16 v[24:27], v[128:131], a[104:107], v[24:27]
    ds_read_b64_tr_b16 v[148:149], v168 offset:0
    v_fma_f32 v71, v71, v207, v207
    v_mfma_f32_16x16x32_bf16 v[24:27], v[132:135], a[120:123], v[24:27]
    v_exp_f32 v85, v85
    v_mfma_f32_16x16x32_bf16 v[28:31], v[128:131], a[108:111], v[28:31]
    ds_read_b64_tr_b16 v[150:151], v168 offset:2048
    v_fma_f32 v84, v84, v207, v207
    v_mfma_f32_16x16x32_bf16 v[28:31], v[132:135], a[124:127], v[28:31]
    s_waitcnt lgkmcnt(4)
    v_exp_f32 v86, v86
    v_mfma_f32_16x16x32_bf16 v[48:51], v[136:139], a[96:99], v[48:51]
    ds_read_b64_tr_b16 v[152:153], v164 offset:45056
    v_fma_f32 v85, v85, v207, v207
    v_mfma_f32_16x16x32_bf16 v[48:51], v[140:143], a[112:115], v[48:51]
    v_exp_f32 v87, v87
    v_mfma_f32_16x16x32_bf16 v[52:55], v[136:139], a[100:103], v[52:55]
    ds_read_b64_tr_b16 v[154:155], v164 offset:47104
    v_fma_f32 v86, v86, v207, v207
    v_mfma_f32_16x16x32_bf16 v[52:55], v[140:143], a[116:119], v[52:55]
    v_rcp_f32 v68, v68
    v_mfma_f32_16x16x32_bf16 v[56:59], v[136:139], a[104:107], v[56:59]
    ds_read_b64_tr_b16 v[156:157], v168 offset:4096
    v_fma_f32 v87, v87, v207, v207
    v_mfma_f32_16x16x32_bf16 v[56:59], v[140:143], a[120:123], v[56:59]
    v_rcp_f32 v69, v69
    v_mfma_f32_16x16x32_bf16 v[60:63], v[136:139], a[108:111], v[60:63]
    ds_read_b64_tr_b16 v[158:159], v168 offset:6144
    v_mul_f32 v68, v68, v100
    v_mfma_f32_16x16x32_bf16 v[60:63], v[140:143], a[124:127], v[60:63]
    s_waitcnt lgkmcnt(4)
    v_rcp_f32 v70, v70
    v_mfma_f32_16x16x32_bf16 v[0:3], v[144:147], a[128:131], v[0:3]
    ds_read_b64_tr_b16 v[128:129], v165 offset:40960
    v_mul_f32 v69, v69, v101
    v_mfma_f32_16x16x32_bf16 v[0:3], v[148:151], a[144:147], v[0:3]
    v_rcp_f32 v71, v71
    v_mfma_f32_16x16x32_bf16 v[4:7], v[144:147], a[132:135], v[4:7]
    ds_read_b64_tr_b16 v[130:131], v165 offset:43008
    v_mul_f32 v70, v70, v102
    v_mfma_f32_16x16x32_bf16 v[4:7], v[148:151], a[148:151], v[4:7]
    v_rcp_f32 v84, v84
    v_mfma_f32_16x16x32_bf16 v[8:11], v[144:147], a[136:139], v[8:11]
    ds_read_b64_tr_b16 v[132:133], v169 offset:0
    v_mul_f32 v71, v71, v103
    v_mfma_f32_16x16x32_bf16 v[8:11], v[148:151], a[152:155], v[8:11]
    v_rcp_f32 v85, v85
    v_mfma_f32_16x16x32_bf16 v[12:15], v[144:147], a[140:143], v[12:15]
    ds_read_b64_tr_b16 v[134:135], v169 offset:2048
    v_mul_f32 v84, v84, v116
    v_mfma_f32_16x16x32_bf16 v[12:15], v[148:151], a[156:159], v[12:15]
    s_waitcnt lgkmcnt(4)
    v_rcp_f32 v86, v86
    v_mfma_f32_16x16x32_bf16 v[32:35], v[152:155], a[128:131], v[32:35]
    ds_read_b64_tr_b16 v[136:137], v165 offset:45056
    v_mul_f32 v85, v85, v117
    v_mfma_f32_16x16x32_bf16 v[32:35], v[156:159], a[144:147], v[32:35]
    v_rcp_f32 v87, v87
    v_mfma_f32_16x16x32_bf16 v[36:39], v[152:155], a[132:135], v[36:39]
    ds_read_b64_tr_b16 v[138:139], v165 offset:47104
    v_mul_f32 v86, v86, v118
    v_mfma_f32_16x16x32_bf16 v[36:39], v[156:159], a[148:151], v[36:39]
    v_mul_f32 v87, v87, v119
    v_cvt_pk_bf16_f32 v100, v68, v69
    v_mfma_f32_16x16x32_bf16 v[40:43], v[152:155], a[136:139], v[40:43]
    ds_read_b64_tr_b16 v[140:141], v169 offset:4096
    v_cvt_pk_bf16_f32 v101, v70, v71
    v_mfma_f32_16x16x32_bf16 v[40:43], v[156:159], a[152:155], v[40:43]
    v_cvt_pk_bf16_f32 v102, v84, v85
    v_cvt_pk_bf16_f32 v103, v86, v87
    v_mfma_f32_16x16x32_bf16 v[44:47], v[152:155], a[140:143], v[44:47]
    ds_read_b64_tr_b16 v[142:143], v169 offset:6144
    v_mul_f32 v104, v72, v104
    v_mfma_f32_16x16x32_bf16 v[44:47], v[156:159], a[156:159], v[44:47]
    s_waitcnt lgkmcnt(4)
    buffer_store_dwordx4 v[100:103], v175, s[24:27], s58 offen offset:1024 sc0 sc1
    v_mul_f32 v72, v72, v210
    v_mfma_f32_16x16x32_bf16 v[16:19], v[128:131], a[128:131], v[16:19]
    s_waitcnt vmcnt(7)
    s_barrier
    s_lshl2_add_u32 s49, s50, s83
    v_mfma_f32_16x16x32_bf16 v[16:19], v[132:135], a[144:147], v[16:19]
    s_add_u32 s49, s49, 32
    ds_read_b64_tr_b16 v[144:145], v168 offset:24576
    v_mul_f32 v105, v73, v105
    v_mfma_f32_16x16x32_bf16 v[20:23], v[128:131], a[132:135], v[20:23]
    ds_read_b64_tr_b16 v[146:147], v168 offset:26624
    v_mul_f32 v73, v73, v210
    v_mfma_f32_16x16x32_bf16 v[20:23], v[132:135], a[148:151], v[20:23]
    buffer_store_dword v218, v216, s[24:27], s49 offen sc0 sc1
    v_mfma_f32_16x16x32_bf16 v[24:27], v[128:131], a[136:139], v[24:27]
    ds_read_b64_tr_b16 v[148:149], v160 offset:32768
    v_mul_f32 v106, v74, v106
    v_mfma_f32_16x16x32_bf16 v[24:27], v[132:135], a[152:155], v[24:27]
    v_exp_f32 v72, v72
    v_mfma_f32_16x16x32_bf16 v[28:31], v[128:131], a[140:143], v[28:31]
    ds_read_b64_tr_b16 v[150:151], v160 offset:34816
    v_mul_f32 v74, v74, v210
    v_mfma_f32_16x16x32_bf16 v[28:31], v[132:135], a[156:159], v[28:31]
    s_waitcnt lgkmcnt(4)
    v_exp_f32 v73, v73
    v_mfma_f32_16x16x32_bf16 v[48:51], v[136:139], a[128:131], v[48:51]
    ds_read_b64_tr_b16 v[152:153], v168 offset:28672
    v_mul_f32 v107, v75, v107
    v_mfma_f32_16x16x32_bf16 v[48:51], v[140:143], a[144:147], v[48:51]
    v_exp_f32 v74, v74
    v_mfma_f32_16x16x32_bf16 v[52:55], v[136:139], a[132:135], v[52:55]
    ds_read_b64_tr_b16 v[154:155], v168 offset:30720
    v_mul_f32 v75, v75, v210
    v_mfma_f32_16x16x32_bf16 v[52:55], v[140:143], a[148:151], v[52:55]
    v_exp_f32 v75, v75
    v_mfma_f32_16x16x32_bf16 v[56:59], v[136:139], a[136:139], v[56:59]
    ds_read_b64_tr_b16 v[156:157], v160 offset:36864
    v_mul_f32 v120, v88, v120
    v_mfma_f32_16x16x32_bf16 v[56:59], v[140:143], a[152:155], v[56:59]
    v_mul_f32 v88, v88, v210
    v_mul_f32 v121, v89, v121
    v_mfma_f32_16x16x32_bf16 v[60:63], v[136:139], a[140:143], v[60:63]
    ds_read_b64_tr_b16 v[158:159], v160 offset:38912
    v_mul_f32 v89, v89, v210
    v_mfma_f32_16x16x32_bf16 v[60:63], v[140:143], a[156:159], v[60:63]
    s_waitcnt lgkmcnt(4)
    v_exp_f32 v88, v88
    v_mfma_f32_16x16x32_bf16 v[0:3], v[144:147], a[160:163], v[0:3]
    ds_read_b64_tr_b16 v[128:129], v169 offset:24576
    v_mul_f32 v122, v90, v122
    v_mfma_f32_16x16x32_bf16 v[0:3], v[148:151], a[176:179], v[0:3]
    v_exp_f32 v89, v89
    v_mfma_f32_16x16x32_bf16 v[4:7], v[144:147], a[164:167], v[4:7]
    ds_read_b64_tr_b16 v[130:131], v169 offset:26624
    v_mul_f32 v90, v90, v210
    v_mfma_f32_16x16x32_bf16 v[4:7], v[148:151], a[180:183], v[4:7]
    v_exp_f32 v90, v90
    v_mfma_f32_16x16x32_bf16 v[8:11], v[144:147], a[168:171], v[8:11]
    ds_read_b64_tr_b16 v[132:133], v161 offset:32768
    v_mul_f32 v123, v91, v123
    v_mfma_f32_16x16x32_bf16 v[8:11], v[148:151], a[184:187], v[8:11]
    v_mul_f32 v91, v91, v210
    v_fma_f32 v72, v72, v211, v211
    v_mfma_f32_16x16x32_bf16 v[12:15], v[144:147], a[172:175], v[12:15]
    ds_read_b64_tr_b16 v[134:135], v161 offset:34816
    v_fma_f32 v73, v73, v211, v211
    v_mfma_f32_16x16x32_bf16 v[12:15], v[148:151], a[188:191], v[12:15]
    s_waitcnt lgkmcnt(4)
    v_exp_f32 v91, v91
    v_mfma_f32_16x16x32_bf16 v[32:35], v[152:155], a[160:163], v[32:35]
    ds_read_b64_tr_b16 v[136:137], v169 offset:28672
    v_fma_f32 v74, v74, v211, v211
    v_mfma_f32_16x16x32_bf16 v[32:35], v[156:159], a[176:179], v[32:35]
    v_rcp_f32 v72, v72
    v_mfma_f32_16x16x32_bf16 v[36:39], v[152:155], a[164:167], v[36:39]
    ds_read_b64_tr_b16 v[138:139], v169 offset:30720
    v_fma_f32 v75, v75, v211, v211
    v_mfma_f32_16x16x32_bf16 v[36:39], v[156:159], a[180:183], v[36:39]
    v_rcp_f32 v73, v73
    v_mfma_f32_16x16x32_bf16 v[40:43], v[152:155], a[168:171], v[40:43]
    ds_read_b64_tr_b16 v[140:141], v161 offset:36864
    v_fma_f32 v88, v88, v211, v211
    v_mfma_f32_16x16x32_bf16 v[40:43], v[156:159], a[184:187], v[40:43]
    v_rcp_f32 v74, v74
    v_mfma_f32_16x16x32_bf16 v[44:47], v[152:155], a[172:175], v[44:47]
    ds_read_b64_tr_b16 v[142:143], v161 offset:38912
    v_fma_f32 v89, v89, v211, v211
    v_mfma_f32_16x16x32_bf16 v[44:47], v[156:159], a[188:191], v[44:47]
    s_waitcnt lgkmcnt(4)
    v_rcp_f32 v75, v75
    v_mfma_f32_16x16x32_bf16 v[16:19], v[128:131], a[160:163], v[16:19]
    s_barrier
    v_fma_f32 v90, v90, v211, v211
    v_mfma_f32_16x16x32_bf16 v[16:19], v[132:135], a[176:179], v[16:19]
    ds_read_b64_tr_b16 v[144:145], v160 offset:40960
    v_fma_f32 v91, v91, v211, v211
    v_mfma_f32_16x16x32_bf16 v[20:23], v[128:131], a[164:167], v[20:23]
    ds_read_b64_tr_b16 v[146:147], v160 offset:43008
    v_mul_f32 v72, v72, v104
    v_mfma_f32_16x16x32_bf16 v[20:23], v[132:135], a[180:183], v[20:23]
    v_rcp_f32 v88, v88
    v_mfma_f32_16x16x32_bf16 v[24:27], v[128:131], a[168:171], v[24:27]
    ds_read_b64_tr_b16 v[148:149], v160 offset:49152
    v_mul_f32 v73, v73, v105
    v_mfma_f32_16x16x32_bf16 v[24:27], v[132:135], a[184:187], v[24:27]
    v_rcp_f32 v89, v89
    v_mfma_f32_16x16x32_bf16 v[28:31], v[128:131], a[172:175], v[28:31]
    ds_read_b64_tr_b16 v[150:151], v160 offset:51200
    v_mul_f32 v74, v74, v106
    v_mfma_f32_16x16x32_bf16 v[28:31], v[132:135], a[188:191], v[28:31]
    s_waitcnt lgkmcnt(4)
    v_rcp_f32 v90, v90
    v_mfma_f32_16x16x32_bf16 v[48:51], v[136:139], a[160:163], v[48:51]
    ds_read_b64_tr_b16 v[152:153], v160 offset:45056
    v_mul_f32 v75, v75, v107
    v_mfma_f32_16x16x32_bf16 v[48:51], v[140:143], a[176:179], v[48:51]
    v_rcp_f32 v91, v91
    v_mfma_f32_16x16x32_bf16 v[52:55], v[136:139], a[164:167], v[52:55]
    ds_read_b64_tr_b16 v[154:155], v160 offset:47104
    v_mul_f32 v88, v88, v120
    v_mfma_f32_16x16x32_bf16 v[52:55], v[140:143], a[180:183], v[52:55]
    v_mul_f32 v89, v89, v121
    v_mul_f32 v90, v90, v122
    v_mfma_f32_16x16x32_bf16 v[56:59], v[136:139], a[168:171], v[56:59]
    ds_read_b64_tr_b16 v[156:157], v160 offset:53248
    v_mul_f32 v91, v91, v123
    v_mfma_f32_16x16x32_bf16 v[56:59], v[140:143], a[184:187], v[56:59]
    v_cvt_pk_bf16_f32 v104, v72, v73
    v_cvt_pk_bf16_f32 v105, v74, v75
    v_mfma_f32_16x16x32_bf16 v[60:63], v[136:139], a[172:175], v[60:63]
    ds_read_b64_tr_b16 v[158:159], v160 offset:55296
    v_cvt_pk_bf16_f32 v106, v88, v89
    v_mfma_f32_16x16x32_bf16 v[60:63], v[140:143], a[188:191], v[60:63]
    s_waitcnt lgkmcnt(4)
    v_cvt_pk_bf16_f32 v107, v90, v91
    v_mul_f32 v108, v76, v108
    v_mfma_f32_16x16x32_bf16 v[0:3], v[144:147], a[192:195], v[0:3]
    ds_read_b64_tr_b16 v[128:129], v161 offset:40960
    v_mul_f32 v76, v76, v214
    v_mfma_f32_16x16x32_bf16 v[0:3], v[148:151], a[208:211], v[0:3]
    buffer_store_dwordx4 v[104:107], v175, s[24:27], s58 offen offset:2048 sc0 sc1
    v_mul_f32 v109, v77, v109
    v_mfma_f32_16x16x32_bf16 v[4:7], v[144:147], a[196:199], v[4:7]
    ds_read_b64_tr_b16 v[130:131], v161 offset:43008
    v_mul_f32 v77, v77, v214
    v_mfma_f32_16x16x32_bf16 v[4:7], v[148:151], a[212:215], v[4:7]
    v_exp_f32 v76, v76
    v_mfma_f32_16x16x32_bf16 v[8:11], v[144:147], a[200:203], v[8:11]
    ds_read_b64_tr_b16 v[132:133], v161 offset:49152
    v_mul_f32 v110, v78, v110
    v_mfma_f32_16x16x32_bf16 v[8:11], v[148:151], a[216:219], v[8:11]
    v_exp_f32 v77, v77
    v_mfma_f32_16x16x32_bf16 v[12:15], v[144:147], a[204:207], v[12:15]
    ds_read_b64_tr_b16 v[134:135], v161 offset:51200
    v_mul_f32 v78, v78, v214
    v_mfma_f32_16x16x32_bf16 v[12:15], v[148:151], a[220:223], v[12:15]
    s_waitcnt lgkmcnt(4)
    v_exp_f32 v78, v78
    v_mfma_f32_16x16x32_bf16 v[32:35], v[152:155], a[192:195], v[32:35]
    ds_read_b64_tr_b16 v[136:137], v161 offset:45056
    v_mul_f32 v111, v79, v111
    v_mfma_f32_16x16x32_bf16 v[32:35], v[156:159], a[208:211], v[32:35]
    v_mul_f32 v79, v79, v214
    v_mul_f32 v124, v92, v124
    v_mfma_f32_16x16x32_bf16 v[36:39], v[152:155], a[196:199], v[36:39]
    ds_read_b64_tr_b16 v[138:139], v161 offset:47104
    v_mul_f32 v92, v92, v214
    v_mfma_f32_16x16x32_bf16 v[36:39], v[156:159], a[212:215], v[36:39]
    v_exp_f32 v79, v79
    v_mfma_f32_16x16x32_bf16 v[40:43], v[152:155], a[200:203], v[40:43]
    ds_read_b64_tr_b16 v[140:141], v161 offset:53248
    v_mul_f32 v125, v93, v125
    v_mfma_f32_16x16x32_bf16 v[40:43], v[156:159], a[216:219], v[40:43]
    v_exp_f32 v92, v92
    v_mfma_f32_16x16x32_bf16 v[44:47], v[152:155], a[204:207], v[44:47]
    ds_read_b64_tr_b16 v[142:143], v161 offset:55296
    v_mul_f32 v93, v93, v214
    v_mfma_f32_16x16x32_bf16 v[44:47], v[156:159], a[220:223], v[44:47]
    s_waitcnt lgkmcnt(4)
    v_exp_f32 v93, v93
    v_mfma_f32_16x16x32_bf16 v[16:19], v[128:131], a[192:195], v[16:19]
    s_waitcnt vmcnt(8)
    s_barrier
    s_mov_b32 s49, s83
    v_mfma_f32_16x16x32_bf16 v[16:19], v[132:135], a[208:211], v[16:19]
    ds_read_b64_tr_b16 v[144:145], v160 offset:57344
    v_mul_f32 v126, v94, v126
    v_mfma_f32_16x16x32_bf16 v[20:23], v[128:131], a[196:199], v[20:23]
    ds_read_b64_tr_b16 v[146:147], v160 offset:59392
    v_mul_f32 v94, v94, v214
    v_mfma_f32_16x16x32_bf16 v[20:23], v[132:135], a[212:215], v[20:23]
    buffer_load_dword v219, v217, s[24:27], s49 offen sc0 sc1
    v_mfma_f32_16x16x32_bf16 v[24:27], v[128:131], a[200:203], v[24:27]
    ds_read_b64_tr_b16 v[148:149], v160 offset:0
    v_mul_f32 v127, v95, v127
    v_mfma_f32_16x16x32_bf16 v[24:27], v[132:135], a[216:219], v[24:27]
    v_exp_f32 v94, v94
    v_mfma_f32_16x16x32_bf16 v[28:31], v[128:131], a[204:207], v[28:31]
    ds_read_b64_tr_b16 v[150:151], v160 offset:2048
    v_mul_f32 v95, v95, v214
    v_mfma_f32_16x16x32_bf16 v[28:31], v[132:135], a[220:223], v[28:31]
    s_waitcnt lgkmcnt(4)
    v_exp_f32 v95, v95
    v_mfma_f32_16x16x32_bf16 v[48:51], v[136:139], a[192:195], v[48:51]
    ds_read_b64_tr_b16 v[152:153], v160 offset:61440
    v_fma_f32 v76, v76, v215, v215
    v_mfma_f32_16x16x32_bf16 v[48:51], v[140:143], a[208:211], v[48:51]
    v_rcp_f32 v76, v76
    v_mfma_f32_16x16x32_bf16 v[52:55], v[136:139], a[196:199], v[52:55]
    ds_read_b64_tr_b16 v[154:155], v160 offset:63488
    v_fma_f32 v77, v77, v215, v215
    v_mfma_f32_16x16x32_bf16 v[52:55], v[140:143], a[212:215], v[52:55]
    v_rcp_f32 v77, v77
    v_mfma_f32_16x16x32_bf16 v[56:59], v[136:139], a[200:203], v[56:59]
    ds_read_b64_tr_b16 v[156:157], v160 offset:4096
    v_fma_f32 v78, v78, v215, v215
    v_mfma_f32_16x16x32_bf16 v[56:59], v[140:143], a[216:219], v[56:59]
    v_rcp_f32 v78, v78
    v_mfma_f32_16x16x32_bf16 v[60:63], v[136:139], a[204:207], v[60:63]
    ds_read_b64_tr_b16 v[158:159], v160 offset:6144
    v_fma_f32 v79, v79, v215, v215
    v_mfma_f32_16x16x32_bf16 v[60:63], v[140:143], a[220:223], v[60:63]
    s_waitcnt lgkmcnt(4)
    v_rcp_f32 v79, v79
    v_mfma_f32_16x16x32_bf16 v[0:3], v[144:147], a[224:227], v[0:3]
    ds_read_b64_tr_b16 v[128:129], v161 offset:57344
    v_fma_f32 v92, v92, v215, v215
    v_mfma_f32_16x16x32_bf16 v[0:3], v[148:151], a[240:243], v[0:3]
    v_rcp_f32 v92, v92
    v_mfma_f32_16x16x32_bf16 v[4:7], v[144:147], a[228:231], v[4:7]
    ds_read_b64_tr_b16 v[130:131], v161 offset:59392
    v_fma_f32 v93, v93, v215, v215
    v_mfma_f32_16x16x32_bf16 v[4:7], v[148:151], a[244:247], v[4:7]
    v_rcp_f32 v93, v93
    v_mfma_f32_16x16x32_bf16 v[8:11], v[144:147], a[232:235], v[8:11]
    ds_read_b64_tr_b16 v[132:133], v161 offset:0
    v_fma_f32 v94, v94, v215, v215
    v_mfma_f32_16x16x32_bf16 v[8:11], v[148:151], a[248:251], v[8:11]
    v_rcp_f32 v94, v94
    v_mfma_f32_16x16x32_bf16 v[12:15], v[144:147], a[236:239], v[12:15]
    ds_read_b64_tr_b16 v[134:135], v161 offset:2048
    v_fma_f32 v95, v95, v215, v215
    v_mfma_f32_16x16x32_bf16 v[12:15], v[148:151], a[252:255], v[12:15]
    s_waitcnt lgkmcnt(4)
    v_rcp_f32 v95, v95
    v_mfma_f32_16x16x32_bf16 v[32:35], v[152:155], a[224:227], v[32:35]
    ds_read_b64_tr_b16 v[136:137], v161 offset:61440
    v_mul_f32 v76, v76, v108
    v_mfma_f32_16x16x32_bf16 v[32:35], v[156:159], a[240:243], v[32:35]
    v_mul_f32 v77, v77, v109
    v_mul_f32 v78, v78, v110
    v_mfma_f32_16x16x32_bf16 v[36:39], v[152:155], a[228:231], v[36:39]
    ds_read_b64_tr_b16 v[138:139], v161 offset:63488
    v_mul_f32 v79, v79, v111
    v_mfma_f32_16x16x32_bf16 v[36:39], v[156:159], a[244:247], v[36:39]
    v_mul_f32 v92, v92, v124
    v_mul_f32 v93, v93, v125
    v_mfma_f32_16x16x32_bf16 v[40:43], v[152:155], a[232:235], v[40:43]
    ds_read_b64_tr_b16 v[140:141], v161 offset:4096
    v_mul_f32 v94, v94, v126
    v_mfma_f32_16x16x32_bf16 v[40:43], v[156:159], a[248:251], v[40:43]
    v_mul_f32 v95, v95, v127
    v_cvt_pk_bf16_f32 v108, v76, v77
    v_mfma_f32_16x16x32_bf16 v[44:47], v[152:155], a[236:239], v[44:47]
    ds_read_b64_tr_b16 v[142:143], v161 offset:6144
    v_cvt_pk_bf16_f32 v109, v78, v79
    v_mfma_f32_16x16x32_bf16 v[44:47], v[156:159], a[252:255], v[44:47]
    s_waitcnt lgkmcnt(4)
    v_cvt_pk_bf16_f32 v110, v92, v93
    v_cvt_pk_bf16_f32 v111, v94, v95
    v_mfma_f32_16x16x32_bf16 v[16:19], v[128:131], a[224:227], v[16:19]
    s_waitcnt vmcnt(5)
    s_barrier
    v_mfma_f32_16x16x32_bf16 v[16:19], v[132:135], a[240:243], v[16:19]
    ds_read_b64_tr_b16 v[144:145], v160 offset:8192
    v_mfma_f32_16x16x32_bf16 v[20:23], v[128:131], a[228:231], v[20:23]
    ds_read_b64_tr_b16 v[146:147], v160 offset:10240
    v_mfma_f32_16x16x32_bf16 v[20:23], v[132:135], a[244:247], v[20:23]
    buffer_store_dwordx4 v[108:111], v175, s[24:27], s58 offen offset:3072 sc0 sc1
    v_mfma_f32_16x16x32_bf16 v[24:27], v[128:131], a[232:235], v[24:27]
    ds_read_b64_tr_b16 v[148:149], v164 offset:49152
    v_mfma_f32_16x16x32_bf16 v[24:27], v[132:135], a[248:251], v[24:27]
    v_mfma_f32_16x16x32_bf16 v[28:31], v[128:131], a[236:239], v[28:31]
    ds_read_b64_tr_b16 v[150:151], v164 offset:51200
    v_mfma_f32_16x16x32_bf16 v[28:31], v[132:135], a[252:255], v[28:31]
    s_waitcnt lgkmcnt(4)
    v_mfma_f32_16x16x32_bf16 v[48:51], v[136:139], a[224:227], v[48:51]
    ds_read_b64_tr_b16 v[152:153], v160 offset:12288
    v_mfma_f32_16x16x32_bf16 v[48:51], v[140:143], a[240:243], v[48:51]
    v_mfma_f32_16x16x32_bf16 v[52:55], v[136:139], a[228:231], v[52:55]
    ds_read_b64_tr_b16 v[154:155], v160 offset:14336
    v_mfma_f32_16x16x32_bf16 v[52:55], v[140:143], a[244:247], v[52:55]
    v_mfma_f32_16x16x32_bf16 v[56:59], v[136:139], a[232:235], v[56:59]
    ds_read_b64_tr_b16 v[156:157], v164 offset:53248
    v_mfma_f32_16x16x32_bf16 v[56:59], v[140:143], a[248:251], v[56:59]
    v_mfma_f32_16x16x32_bf16 v[60:63], v[136:139], a[236:239], v[60:63]
    ds_read_b64_tr_b16 v[158:159], v164 offset:55296
    v_mfma_f32_16x16x32_bf16 v[60:63], v[140:143], a[252:255], v[60:63]
    s_waitcnt lgkmcnt(4)
    v_mfma_f32_16x16x32_bf16 v[0:3], v[144:147], v[224:227], v[0:3]
    ds_read_b64_tr_b16 v[128:129], v161 offset:8192
    v_mfma_f32_16x16x32_bf16 v[0:3], v[148:151], v[240:243], v[0:3]
    v_mfma_f32_16x16x32_bf16 v[4:7], v[144:147], v[228:231], v[4:7]
    ds_read_b64_tr_b16 v[130:131], v161 offset:10240
    v_mfma_f32_16x16x32_bf16 v[4:7], v[148:151], v[244:247], v[4:7]
    v_mfma_f32_16x16x32_bf16 v[8:11], v[144:147], v[232:235], v[8:11]
    ds_read_b64_tr_b16 v[132:133], v165 offset:49152
    v_mfma_f32_16x16x32_bf16 v[8:11], v[148:151], v[248:251], v[8:11]
    v_mfma_f32_16x16x32_bf16 v[12:15], v[144:147], v[236:239], v[12:15]
    ds_read_b64_tr_b16 v[134:135], v165 offset:51200
    v_mfma_f32_16x16x32_bf16 v[12:15], v[148:151], v[252:255], v[12:15]
    s_waitcnt lgkmcnt(4)
    v_mfma_f32_16x16x32_bf16 v[32:35], v[152:155], v[224:227], v[32:35]
    ds_read_b64_tr_b16 v[136:137], v161 offset:12288
    v_mfma_f32_16x16x32_bf16 v[32:35], v[156:159], v[240:243], v[32:35]
    v_mfma_f32_16x16x32_bf16 v[36:39], v[152:155], v[228:231], v[36:39]
    ds_read_b64_tr_b16 v[138:139], v161 offset:14336
    v_mfma_f32_16x16x32_bf16 v[36:39], v[156:159], v[244:247], v[36:39]
    v_mfma_f32_16x16x32_bf16 v[40:43], v[152:155], v[232:235], v[40:43]
    ds_read_b64_tr_b16 v[140:141], v165 offset:53248
    v_mfma_f32_16x16x32_bf16 v[40:43], v[156:159], v[248:251], v[40:43]
    v_mfma_f32_16x16x32_bf16 v[44:47], v[152:155], v[236:239], v[44:47]
    ds_read_b64_tr_b16 v[142:143], v165 offset:55296
    v_mfma_f32_16x16x32_bf16 v[44:47], v[156:159], v[252:255], v[44:47]
    s_waitcnt lgkmcnt(4)
    v_mfma_f32_16x16x32_bf16 v[16:19], v[128:131], v[224:227], v[16:19]
    ds_read_b64_tr_b16 v[144:145], v166 offset:0
    v_mfma_f32_16x16x32_bf16 v[16:19], v[132:135], v[240:243], v[16:19]
    s_waitcnt vmcnt(1)
    v_cmp_eq_u32 vcc, s79, v219
    v_mfma_f32_16x16x32_bf16 v[20:23], v[128:131], v[228:231], v[20:23]
    ds_read_b64_tr_b16 v[146:147], v166 offset:2048
    v_mfma_f32_16x16x32_bf16 v[20:23], v[132:135], v[244:247], v[20:23]
    s_andn2_b32 s61, 0xff00, vcc_lo
    s_cbranch_scc1 Lslow_8
Lback_9:
    s_add_u32 s49, s82, 4096
    v_mfma_f32_16x16x32_bf16 v[24:27], v[128:131], v[232:235], v[24:27]
    ds_read_b64_tr_b16 v[148:149], v166 offset:24576
    v_mfma_f32_16x16x32_bf16 v[24:27], v[132:135], v[248:251], v[24:27]
    buffer_load_dwordx4 v[192:195], v222, s[24:27], s49 offen offset:0 sc0 sc1
    v_mfma_f32_16x16x32_bf16 v[28:31], v[128:131], v[236:239], v[28:31]
    ds_read_b64_tr_b16 v[150:151], v166 offset:26624
    v_mfma_f32_16x16x32_bf16 v[28:31], v[132:135], v[252:255], v[28:31]
    s_waitcnt lgkmcnt(4)
    buffer_load_dwordx4 v[196:199], v222, s[24:27], s49 offen offset:1024 sc0 sc1
    v_mfma_f32_16x16x32_bf16 v[48:51], v[136:139], v[224:227], v[48:51]
    ds_read_b64_tr_b16 v[152:153], v166 offset:4096
    v_mfma_f32_16x16x32_bf16 v[48:51], v[140:143], v[240:243], v[48:51]
    v_mfma_f32_16x16x32_bf16 v[52:55], v[136:139], v[228:231], v[52:55]
    ds_read_b64_tr_b16 v[154:155], v166 offset:6144
    v_mfma_f32_16x16x32_bf16 v[52:55], v[140:143], v[244:247], v[52:55]
    v_mfma_f32_16x16x32_bf16 v[56:59], v[136:139], v[232:235], v[56:59]
    ds_read_b64_tr_b16 v[156:157], v166 offset:28672
    v_mfma_f32_16x16x32_bf16 v[56:59], v[140:143], v[248:251], v[56:59]
    v_mfma_f32_16x16x32_bf16 v[60:63], v[136:139], v[236:239], v[60:63]
    ds_read_b64_tr_b16 v[158:159], v166 offset:30720
    v_mfma_f32_16x16x32_bf16 v[60:63], v[140:143], v[252:255], v[60:63]
    s_waitcnt lgkmcnt(4)
    v_mfma_f32_16x16x32_bf16 v[64:67], v[144:147], a[0:3], 0
    s_sub_u32 s52, s2, 0
    ds_read_b64_tr_b16 v[128:129], v167 offset:0
    s_lshl2_add_u32 s52, s52, s48
    v_mfma_f32_16x16x32_bf16 v[64:67], v[148:151], a[16:19], v[64:67]
    s_lshl_b32 s52, s52, 13
    v_lshlrev_b32 v223, 7, v174
    v_mfma_f32_16x16x32_bf16 v[68:71], v[144:147], a[4:7], 0
    ds_read_b64_tr_b16 v[130:131], v167 offset:2048
    v_mfma_f32_16x16x32_bf16 v[68:71], v[148:151], a[20:23], v[68:71]
    buffer_load_dword v219, v223, s[40:43], s52 offen
    v_mfma_f32_16x16x32_bf16 v[72:75], v[144:147], a[8:11], 0
    ds_read_b64_tr_b16 v[132:133], v167 offset:24576
    v_mfma_f32_16x16x32_bf16 v[72:75], v[148:151], a[24:27], v[72:75]
    s_cmp_lt_u32 s52, 5308416
    s_cmov_b32 s52, 0x7f000000
    s_sub_u32 s52, s52, 5308416
    v_mfma_f32_16x16x32_bf16 v[76:79], v[144:147], a[12:15], 0
    ds_read_b64_tr_b16 v[134:135], v167 offset:26624
    v_mfma_f32_16x16x32_bf16 v[76:79], v[148:151], a[28:31], v[76:79]
    s_waitcnt lgkmcnt(4)
    buffer_load_dword v219, v223, s[44:47], s52 offen
    v_mfma_f32_16x16x32_bf16 v[96:99], v[152:155], a[0:3], 0
    ds_read_b64_tr_b16 v[136:137], v167 offset:4096
    v_mfma_f32_16x16x32_bf16 v[96:99], v[156:159], a[16:19], v[96:99]
    v_mfma_f32_16x16x32_bf16 v[100:103], v[152:155], a[4:7], 0
    ds_read_b64_tr_b16 v[138:139], v167 offset:6144
    v_mfma_f32_16x16x32_bf16 v[100:103], v[156:159], a[20:23], v[100:103]
    v_mfma_f32_16x16x32_bf16 v[104:107], v[152:155], a[8:11], 0
    ds_read_b64_tr_b16 v[140:141], v167 offset:28672
    v_mfma_f32_16x16x32_bf16 v[104:107], v[156:159], a[24:27], v[104:107]
    v_mfma_f32_16x16x32_bf16 v[108:111], v[152:155], a[12:15], 0
    ds_read_b64_tr_b16 v[142:143], v167 offset:30720
    v_mfma_f32_16x16x32_bf16 v[108:111], v[156:159], a[28:31], v[108:111]
    s_waitcnt lgkmcnt(4)
    v_mfma_f32_16x16x32_bf16 v[80:83], v[128:131], a[0:3], 0
    ds_read_b64_tr_b16 v[144:145], v162 offset:24576
    v_mfma_f32_16x16x32_bf16 v[80:83], v[132:135], a[16:19], v[80:83]
    v_mfma_f32_16x16x32_bf16 v[84:87], v[128:131], a[4:7], 0
    ds_read_b64_tr_b16 v[146:147], v162 offset:26624
    v_mfma_f32_16x16x32_bf16 v[84:87], v[132:135], a[20:23], v[84:87]
    v_mfma_f32_16x16x32_bf16 v[88:91], v[128:131], a[8:11], 0
    ds_read_b64_tr_b16 v[148:149], v166 offset:8192
    v_mfma_f32_16x16x32_bf16 v[88:91], v[132:135], a[24:27], v[88:91]
    v_mfma_f32_16x16x32_bf16 v[92:95], v[128:131], a[12:15], 0
    ds_read_b64_tr_b16 v[150:151], v166 offset:10240
    v_mfma_f32_16x16x32_bf16 v[92:95], v[132:135], a[28:31], v[92:95]
    s_waitcnt lgkmcnt(4)
    v_mfma_f32_16x16x32_bf16 v[112:115], v[136:139], a[0:3], 0
    ds_read_b64_tr_b16 v[152:153], v162 offset:28672
    v_mfma_f32_16x16x32_bf16 v[112:115], v[140:143], a[16:19], v[112:115]
    v_mfma_f32_16x16x32_bf16 v[116:119], v[136:139], a[4:7], 0
    ds_read_b64_tr_b16 v[154:155], v162 offset:30720
    v_mfma_f32_16x16x32_bf16 v[116:119], v[140:143], a[20:23], v[116:119]
    v_mfma_f32_16x16x32_bf16 v[120:123], v[136:139], a[8:11], 0
    ds_read_b64_tr_b16 v[156:157], v166 offset:12288
    v_mfma_f32_16x16x32_bf16 v[120:123], v[140:143], a[24:27], v[120:123]
    v_mfma_f32_16x16x32_bf16 v[124:127], v[136:139], a[12:15], 0
    ds_read_b64_tr_b16 v[158:159], v166 offset:14336
    v_mfma_f32_16x16x32_bf16 v[124:127], v[140:143], a[28:31], v[124:127]
    s_waitcnt lgkmcnt(4)
    v_mfma_f32_16x16x32_bf16 v[64:67], v[144:147], a[32:35], v[64:67]
    ds_read_b64_tr_b16 v[128:129], v163 offset:24576
    v_mfma_f32_16x16x32_bf16 v[64:67], v[148:151], a[48:51], v[64:67]
    v_mfma_f32_16x16x32_bf16 v[68:71], v[144:147], a[36:39], v[68:71]
    ds_read_b64_tr_b16 v[130:131], v163 offset:26624
    v_mfma_f32_16x16x32_bf16 v[68:71], v[148:151], a[52:55], v[68:71]
    v_mfma_f32_16x16x32_bf16 v[72:75], v[144:147], a[40:43], v[72:75]
    ds_read_b64_tr_b16 v[132:133], v167 offset:8192
    v_mfma_f32_16x16x32_bf16 v[72:75], v[148:151], a[56:59], v[72:75]
    v_mfma_f32_16x16x32_bf16 v[76:79], v[144:147], a[44:47], v[76:79]
    ds_read_b64_tr_b16 v[134:135], v167 offset:10240
    v_mfma_f32_16x16x32_bf16 v[76:79], v[148:151], a[60:63], v[76:79]
    s_waitcnt lgkmcnt(4)
    v_mfma_f32_16x16x32_bf16 v[96:99], v[152:155], a[32:35], v[96:99]
    ds_read_b64_tr_b16 v[136:137], v163 offset:28672
    v_mfma_f32_16x16x32_bf16 v[96:99], v[156:159], a[48:51], v[96:99]
    v_mfma_f32_16x16x32_bf16 v[100:103], v[152:155], a[36:39], v[100:103]
    ds_read_b64_tr_b16 v[138:139], v163 offset:30720
    v_mfma_f32_16x16x32_bf16 v[100:103], v[156:159], a[52:55], v[100:103]
    v_mfma_f32_16x16x32_bf16 v[104:107], v[152:155], a[40:43], v[104:107]
    ds_read_b64_tr_b16 v[140:141], v167 offset:12288
    v_mfma_f32_16x16x32_bf16 v[104:107], v[156:159], a[56:59], v[104:107]
    v_mfma_f32_16x16x32_bf16 v[108:111], v[152:155], a[44:47], v[108:111]
    ds_read_b64_tr_b16 v[142:143], v167 offset:14336
    v_mfma_f32_16x16x32_bf16 v[108:111], v[156:159], a[60:63], v[108:111]
    s_waitcnt lgkmcnt(4)
    v_mfma_f32_16x16x32_bf16 v[80:83], v[128:131], a[32:35], v[80:83]
    s_waitcnt vmcnt(4)
    s_barrier
    s_add_u32 s49, s69, 32768
    v_mfma_f32_16x16x32_bf16 v[80:83], v[132:135], a[48:51], v[80:83]
    ds_read_b64_tr_b16 v[144:145], v166 offset:32768
    v_mfma_f32_16x16x32_bf16 v[84:87], v[128:131], a[36:39], v[84:87]
    ds_read_b64_tr_b16 v[146:147], v166 offset:34816
    v_mfma_f32_16x16x32_bf16 v[84:87], v[132:135], a[52:55], v[84:87]
    buffer_store_dword v218, v216, s[24:27], s49 offen sc0 sc1
    v_mfma_f32_16x16x32_bf16 v[88:91], v[128:131], a[40:43], v[88:91]
    ds_read_b64_tr_b16 v[148:149], v166 offset:57344
    v_mfma_f32_16x16x32_bf16 v[88:91], v[132:135], a[56:59], v[88:91]
    v_mfma_f32_16x16x32_bf16 v[92:95], v[128:131], a[44:47], v[92:95]
    ds_read_b64_tr_b16 v[150:151], v166 offset:59392
    v_mfma_f32_16x16x32_bf16 v[92:95], v[132:135], a[60:63], v[92:95]
    s_waitcnt lgkmcnt(4)
    v_mfma_f32_16x16x32_bf16 v[112:115], v[136:139], a[32:35], v[112:115]
    ds_read_b64_tr_b16 v[152:153], v166 offset:36864
    v_mfma_f32_16x16x32_bf16 v[112:115], v[140:143], a[48:51], v[112:115]
    v_mfma_f32_16x16x32_bf16 v[116:119], v[136:139], a[36:39], v[116:119]
    ds_read_b64_tr_b16 v[154:155], v166 offset:38912
    v_mfma_f32_16x16x32_bf16 v[116:119], v[140:143], a[52:55], v[116:119]
    v_mfma_f32_16x16x32_bf16 v[120:123], v[136:139], a[40:43], v[120:123]
    ds_read_b64_tr_b16 v[156:157], v166 offset:61440
    v_mfma_f32_16x16x32_bf16 v[120:123], v[140:143], a[56:59], v[120:123]
    v_mfma_f32_16x16x32_bf16 v[124:127], v[136:139], a[44:47], v[124:127]
    ds_read_b64_tr_b16 v[158:159], v166 offset:63488
    v_mfma_f32_16x16x32_bf16 v[124:127], v[140:143], a[60:63], v[124:127]
    s_waitcnt lgkmcnt(4)
    s_waitcnt vmcnt(3)
    v_mfma_f32_16x16x16_bf16 v[0:3], v[192:193], v[200:201], v[0:3]
    ds_read_b64_tr_b16 v[128:129], v167 offset:32768
    v_mfma_f32_16x16x16_bf16 v[4:7], v[192:193], v[204:205], v[4:7]
    v_mfma_f32_16x16x16_bf16 v[8:11], v[192:193], v[208:209], v[8:11]
    ds_read_b64_tr_b16 v[130:131], v167 offset:34816
    v_mfma_f32_16x16x16_bf16 v[12:15], v[192:193], v[212:213], v[12:15]
    v_mfma_f32_16x16x16_bf16 v[16:19], v[194:195], v[200:201], v[16:19]
    v_mfma_f32_16x16x16_bf16 v[20:23], v[194:195], v[204:205], v[20:23]
    v_mfma_f32_16x16x16_bf16 v[24:27], v[194:195], v[208:209], v[24:27]
    v_mfma_f32_16x16x16_bf16 v[28:31], v[194:195], v[212:213], v[28:31]
    v_mfma_f32_16x16x16_bf16 v[32:35], v[196:197], v[200:201], v[32:35]
    v_mfma_f32_16x16x16_bf16 v[36:39], v[196:197], v[204:205], v[36:39]
    v_mfma_f32_16x16x16_bf16 v[40:43], v[196:197], v[208:209], v[40:43]
    v_mfma_f32_16x16x16_bf16 v[44:47], v[196:197], v[212:213], v[44:47]
    v_mfma_f32_16x16x16_bf16 v[48:51], v[198:199], v[200:201], v[48:51]
    v_mfma_f32_16x16x16_bf16 v[52:55], v[198:199], v[204:205], v[52:55]
    v_mfma_f32_16x16x16_bf16 v[56:59], v[198:199], v[208:209], v[56:59]
    v_mfma_f32_16x16x16_bf16 v[60:63], v[198:199], v[212:213], v[60:63]
    v_mfma_f32_16x16x32_bf16 v[64:67], v[144:147], a[64:67], v[64:67]
    s_add_u32 s49, s82, 6144
    v_mfma_f32_16x16x32_bf16 v[64:67], v[148:151], a[80:83], v[64:67]
    buffer_load_dwordx4 v[192:195], v222, s[24:27], s49 offen offset:0 sc0 sc1
    v_mfma_f32_16x16x32_bf16 v[68:71], v[144:147], a[68:71], v[68:71]
    buffer_load_dwordx4 v[196:199], v222, s[24:27], s49 offen offset:1024 sc0 sc1
    v_mfma_f32_16x16x32_bf16 v[68:71], v[148:151], a[84:87], v[68:71]
    v_mfma_f32_16x16x32_bf16 v[72:75], v[144:147], a[72:75], v[72:75]
    ds_read_b64_tr_b16 v[132:133], v167 offset:57344
    v_mfma_f32_16x16x32_bf16 v[72:75], v[148:151], a[88:91], v[72:75]
    v_mfma_f32_16x16x32_bf16 v[76:79], v[144:147], a[76:79], v[76:79]
    ds_read_b64_tr_b16 v[134:135], v167 offset:59392
    v_mfma_f32_16x16x32_bf16 v[76:79], v[148:151], a[92:95], v[76:79]
    s_waitcnt lgkmcnt(4)
    v_mfma_f32_16x16x32_bf16 v[96:99], v[152:155], a[64:67], v[96:99]
    s_add_u32 s58, s57, 262144
    ds_read_b64_tr_b16 v[136:137], v167 offset:36864
    v_mul_f32 v32, v0, v32
    v_mfma_f32_16x16x32_bf16 v[96:99], v[156:159], a[80:83], v[96:99]
    v_mul_f32 v0, v0, v202
    v_mul_f32 v33, v1, v33
    v_mfma_f32_16x16x32_bf16 v[100:103], v[152:155], a[68:71], v[100:103]
    ds_read_b64_tr_b16 v[138:139], v167 offset:38912
    v_mul_f32 v1, v1, v202
    v_mfma_f32_16x16x32_bf16 v[100:103], v[156:159], a[84:87], v[100:103]
    v_exp_f32 v0, v0
    v_mfma_f32_16x16x32_bf16 v[104:107], v[152:155], a[72:75], v[104:107]
    ds_read_b64_tr_b16 v[140:141], v167 offset:61440
    v_mul_f32 v34, v2, v34
    v_mul_f32 v2, v2, v202
    v_mfma_f32_16x16x32_bf16 v[104:107], v[156:159], a[88:91], v[104:107]
    v_exp_f32 v1, v1
    v_mfma_f32_16x16x32_bf16 v[108:111], v[152:155], a[76:79], v[108:111]
    ds_read_b64_tr_b16 v[142:143], v167 offset:63488
    v_mul_f32 v35, v3, v35
    v_mfma_f32_16x16x32_bf16 v[108:111], v[156:159], a[92:95], v[108:111]
    s_waitcnt lgkmcnt(4)
    v_exp_f32 v2, v2
    v_mfma_f32_16x16x32_bf16 v[80:83], v[128:131], a[64:67], v[80:83]
    ds_read_b64_tr_b16 v[144:145], v170 offset:16384
    v_mul_f32 v3, v3, v202
    v_mul_f32 v48, v16, v48
    v_mfma_f32_16x16x32_bf16 v[80:83], v[132:135], a[80:83], v[80:83]
    v_exp_f32 v3, v3
    v_mfma_f32_16x16x32_bf16 v[84:87], v[128:131], a[68:71], v[84:87]
    ds_read_b64_tr_b16 v[146:147], v170 offset:18432
    v_mul_f32 v16, v16, v202
    v_mfma_f32_16x16x32_bf16 v[84:87], v[132:135], a[84:87], v[84:87]
    v_exp_f32 v16, v16
    v_mfma_f32_16x16x32_bf16 v[88:91], v[128:131], a[72:75], v[88:91]
    ds_read_b64_tr_b16 v[148:149], v166 offset:16384
    v_mul_f32 v49, v17, v49
    v_mul_f32 v17, v17, v202
    v_mfma_f32_16x16x32_bf16 v[88:91], v[132:135], a[88:91], v[88:91]
    v_exp_f32 v17, v17
    v_mfma_f32_16x16x32_bf16 v[92:95], v[128:131], a[76:79], v[92:95]
    ds_read_b64_tr_b16 v[150:151], v166 offset:18432
    v_mul_f32 v50, v18, v50
    v_mfma_f32_16x16x32_bf16 v[92:95], v[132:135], a[92:95], v[92:95]
    s_waitcnt lgkmcnt(4)
    v_mul_f32 v18, v18, v202
    v_mul_f32 v51, v19, v51
    v_mfma_f32_16x16x32_bf16 v[112:115], v[136:139], a[64:67], v[112:115]
    ds_read_b64_tr_b16 v[152:153], v170 offset:20480
    v_mul_f32 v19, v19, v202
    v_exp_f32 v18, v18
    v_mfma_f32_16x16x32_bf16 v[112:115], v[140:143], a[80:83], v[112:115]
    v_exp_f32 v19, v19
    v_mfma_f32_16x16x32_bf16 v[116:119], v[136:139], a[68:71], v[116:119]
    ds_read_b64_tr_b16 v[154:155], v170 offset:22528
    v_fma_f32 v0, v0, v203, v203
    v_mfma_f32_16x16x32_bf16 v[116:119], v[140:143], a[84:87], v[116:119]
    v_rcp_f32 v0, v0
    v_mfma_f32_16x16x32_bf16 v[120:123], v[136:139], a[72:75], v[120:123]
    ds_read_b64_tr_b16 v[156:157], v166 offset:20480
    v_fma_f32 v1, v1, v203, v203
    v_fma_f32 v2, v2, v203, v203
    v_mfma_f32_16x16x32_bf16 v[120:123], v[140:143], a[88:91], v[120:123]
    v_rcp_f32 v1, v1
    v_mfma_f32_16x16x32_bf16 v[124:127], v[136:139], a[76:79], v[124:127]
    ds_read_b64_tr_b16 v[158:159], v166 offset:22528
    v_fma_f32 v3, v3, v203, v203
    v_mfma_f32_16x16x32_bf16 v[124:127], v[140:143], a[92:95], v[124:127]
    s_waitcnt lgkmcnt(4)
    v_rcp_f32 v2, v2
    v_mfma_f32_16x16x32_bf16 v[64:67], v[144:147], a[96:99], v[64:67]
    s_barrier
    v_fma_f32 v16, v16, v203, v203
    v_fma_f32 v17, v17, v203, v203
    v_mfma_f32_16x16x32_bf16 v[64:67], v[148:151], a[112:115], v[64:67]
    ds_read_b64_tr_b16 v[128:129], v171 offset:16384
    v_fma_f32 v18, v18, v203, v203
    v_mfma_f32_16x16x32_bf16 v[68:71], v[144:147], a[100:103], v[68:71]
    ds_read_b64_tr_b16 v[130:131], v171 offset:18432
    v_fma_f32 v19, v19, v203, v203
    v_mfma_f32_16x16x32_bf16 v[68:71], v[148:151], a[116:119], v[68:71]
    v_rcp_f32 v3, v3
    v_mfma_f32_16x16x32_bf16 v[72:75], v[144:147], a[104:107], v[72:75]
    ds_read_b64_tr_b16 v[132:133], v167 offset:16384
    v_mul_f32 v0, v0, v32
    v_rcp_f32 v16, v16
    v_mfma_f32_16x16x32_bf16 v[72:75], v[148:151], a[120:123], v[72:75]
    v_rcp_f32 v17, v17
    v_mfma_f32_16x16x32_bf16 v[76:79], v[144:147], a[108:111], v[76:79]
    ds_read_b64_tr_b16 v[134:135], v167 offset:18432
    v_mul_f32 v1, v1, v33
    v_mfma_f32_16x16x32_bf16 v[76:79], v[148:151], a[124:127], v[76:79]
    s_waitcnt lgkmcnt(4)
    v_rcp_f32 v18, v18
    v_mfma_f32_16x16x32_bf16 v[96:99], v[152:155], a[96:99], v[96:99]
    ds_read_b64_tr_b16 v[136:137], v171 offset:20480
    v_mul_f32 v2, v2, v34
    v_rcp_f32 v19, v19
    v_mfma_f32_16x16x32_bf16 v[96:99], v[156:159], a[112:115], v[96:99]
    v_mul_f32 v3, v3, v35
    v_mul_f32 v16, v16, v48
    v_mfma_f32_16x16x32_bf16 v[100:103], v[152:155], a[100:103], v[100:103]
    ds_read_b64_tr_b16 v[138:139], v171 offset:22528
    v_mul_f32 v17, v17, v49
    v_mfma_f32_16x16x32_bf16 v[100:103], v[156:159], a[116:119], v[100:103]
    v_mul_f32 v18, v18, v50
    v_mul_f32 v19, v19, v51
    v_mfma_f32_16x16x32_bf16 v[104:107], v[152:155], a[104:107], v[104:107]
    ds_read_b64_tr_b16 v[140:141], v167 offset:20480
    v_cvt_pk_bf16_f32 v32, v0, v1
    v_cvt_pk_bf16_f32 v33, v2, v3
    v_mfma_f32_16x16x32_bf16 v[104:107], v[156:159], a[120:123], v[104:107]
    v_cvt_pk_bf16_f32 v34, v16, v17
    v_cvt_pk_bf16_f32 v35, v18, v19
    v_mfma_f32_16x16x32_bf16 v[108:111], v[152:155], a[108:111], v[108:111]
    ds_read_b64_tr_b16 v[142:143], v167 offset:22528
    v_mul_f32 v36, v4, v36
    v_mfma_f32_16x16x32_bf16 v[108:111], v[156:159], a[124:127], v[108:111]
    s_waitcnt lgkmcnt(4)
    buffer_store_dwordx4 v[32:35], v175, s[24:27], s58 offen offset:0 sc0 sc1
    v_mul_f32 v4, v4, v206
    v_mfma_f32_16x16x32_bf16 v[80:83], v[128:131], a[96:99], v[80:83]
    ds_read_b64_tr_b16 v[144:145], v166 offset:40960
    v_mul_f32 v37, v5, v37
    v_mfma_f32_16x16x32_bf16 v[80:83], v[132:135], a[112:115], v[80:83]
    v_exp_f32 v4, v4
    v_mfma_f32_16x16x32_bf16 v[84:87], v[128:131], a[100:103], v[84:87]
    ds_read_b64_tr_b16 v[146:147], v166 offset:43008
    v_mul_f32 v5, v5, v206
    v_mfma_f32_16x16x32_bf16 v[84:87], v[132:135], a[116:119], v[84:87]
    v_exp_f32 v5, v5
    v_mfma_f32_16x16x32_bf16 v[88:91], v[128:131], a[104:107], v[88:91]
    ds_read_b64_tr_b16 v[148:149], v170 offset:0
    v_mul_f32 v38, v6, v38
    v_mfma_f32_16x16x32_bf16 v[88:91], v[132:135], a[120:123], v[88:91]
    v_mul_f32 v6, v6, v206
    v_mul_f32 v39, v7, v39
    v_mfma_f32_16x16x32_bf16 v[92:95], v[128:131], a[108:111], v[92:95]
    ds_read_b64_tr_b16 v[150:151], v170 offset:2048
    v_mul_f32 v7, v7, v206
    v_mfma_f32_16x16x32_bf16 v[92:95], v[132:135], a[124:127], v[92:95]
    s_waitcnt lgkmcnt(4)
    v_exp_f32 v6, v6
    v_mfma_f32_16x16x32_bf16 v[112:115], v[136:139], a[96:99], v[112:115]
    ds_read_b64_tr_b16 v[152:153], v166 offset:45056
    v_mul_f32 v52, v20, v52
    v_mfma_f32_16x16x32_bf16 v[112:115], v[140:143], a[112:115], v[112:115]
    v_exp_f32 v7, v7
    v_mfma_f32_16x16x32_bf16 v[116:119], v[136:139], a[100:103], v[116:119]
    ds_read_b64_tr_b16 v[154:155], v166 offset:47104
    v_mul_f32 v20, v20, v206
    v_mfma_f32_16x16x32_bf16 v[116:119], v[140:143], a[116:119], v[116:119]
    v_exp_f32 v20, v20
    v_mfma_f32_16x16x32_bf16 v[120:123], v[136:139], a[104:107], v[120:123]
    ds_read_b64_tr_b16 v[156:157], v170 offset:4096
    v_mul_f32 v53, v21, v53
    v_mfma_f32_16x16x32_bf16 v[120:123], v[140:143], a[120:123], v[120:123]
    v_mul_f32 v21, v21, v206
    v_mul_f32 v54, v22, v54
    v_mfma_f32_16x16x32_bf16 v[124:127], v[136:139], a[108:111], v[124:127]
    ds_read_b64_tr_b16 v[158:159], v170 offset:6144
    v_mul_f32 v22, v22, v206
    v_mfma_f32_16x16x32_bf16 v[124:127], v[140:143], a[124:127], v[124:127]
    s_waitcnt lgkmcnt(4)
    v_exp_f32 v21, v21
    v_mfma_f32_16x16x32_bf16 v[64:67], v[144:147], a[128:131], v[64:67]
    ds_read_b64_tr_b16 v[128:129], v167 offset:40960
    v_mul_f32 v55, v23, v55
    v_mfma_f32_16x16x32_bf16 v[64:67], v[148:151], a[144:147], v[64:67]
    v_exp_f32 v22, v22
    v_mfma_f32_16x16x32_bf16 v[68:71], v[144:147], a[132:135], v[68:71]
    ds_read_b64_tr_b16 v[130:131], v167 offset:43008
    v_mul_f32 v23, v23, v206
    v_mfma_f32_16x16x32_bf16 v[68:71], v[148:151], a[148:151], v[68:71]
    v_exp_f32 v23, v23
    v_mfma_f32_16x16x32_bf16 v[72:75], v[144:147], a[136:139], v[72:75]
    ds_read_b64_tr_b16 v[132:133], v171 offset:0
    v_fma_f32 v4, v4, v207, v207
    v_mfma_f32_16x16x32_bf16 v[72:75], v[148:151], a[152:155], v[72:75]
    v_rcp_f32 v4, v4
    v_mfma_f32_16x16x32_bf16 v[76:79], v[144:147], a[140:143], v[76:79]
    ds_read_b64_tr_b16 v[134:135], v171 offset:2048
    v_fma_f32 v5, v5, v207, v207
    v_mfma_f32_16x16x32_bf16 v[76:79], v[148:151], a[156:159], v[76:79]
    s_waitcnt lgkmcnt(4)
    v_rcp_f32 v5, v5
    v_mfma_f32_16x16x32_bf16 v[96:99], v[152:155], a[128:131], v[96:99]
    ds_read_b64_tr_b16 v[136:137], v167 offset:45056
    v_fma_f32 v6, v6, v207, v207
    v_mfma_f32_16x16x32_bf16 v[96:99], v[156:159], a[144:147], v[96:99]
    v_rcp_f32 v6, v6
    v_mfma_f32_16x16x32_bf16 v[100:103], v[152:155], a[132:135], v[100:103]
    ds_read_b64_tr_b16 v[138:139], v167 offset:47104
    v_fma_f32 v7, v7, v207, v207
    v_mfma_f32_16x16x32_bf16 v[100:103], v[156:159], a[148:151], v[100:103]
    v_rcp_f32 v7, v7
    v_mfma_f32_16x16x32_bf16 v[104:107], v[152:155], a[136:139], v[104:107]
    ds_read_b64_tr_b16 v[140:141], v171 offset:4096
    v_fma_f32 v20, v20, v207, v207
    v_mfma_f32_16x16x32_bf16 v[104:107], v[156:159], a[152:155], v[104:107]
    v_rcp_f32 v20, v20
    v_mfma_f32_16x16x32_bf16 v[108:111], v[152:155], a[140:143], v[108:111]
    ds_read_b64_tr_b16 v[142:143], v171 offset:6144
    v_fma_f32 v21, v21, v207, v207
    v_mfma_f32_16x16x32_bf16 v[108:111], v[156:159], a[156:159], v[108:111]
    s_waitcnt lgkmcnt(4)
    v_rcp_f32 v21, v21
    v_mfma_f32_16x16x32_bf16 v[80:83], v[128:131], a[128:131], v[80:83]
    ds_read_b64_tr_b16 v[144:145], v170 offset:24576
    v_fma_f32 v22, v22, v207, v207
    v_mfma_f32_16x16x32_bf16 v[80:83], v[132:135], a[144:147], v[80:83]
    v_rcp_f32 v22, v22
    v_mfma_f32_16x16x32_bf16 v[84:87], v[128:131], a[132:135], v[84:87]
    ds_read_b64_tr_b16 v[146:147], v170 offset:26624
    v_fma_f32 v23, v23, v207, v207
    v_mfma_f32_16x16x32_bf16 v[84:87], v[132:135], a[148:151], v[84:87]
    v_rcp_f32 v23, v23
    v_mfma_f32_16x16x32_bf16 v[88:91], v[128:131], a[136:139], v[88:91]
    ds_read_b64_tr_b16 v[148:149], v162 offset:32768
    v_mul_f32 v4, v4, v36
    v_mfma_f32_16x16x32_bf16 v[88:91], v[132:135], a[152:155], v[88:91]
    v_mul_f32 v5, v5, v37
    v_mul_f32 v6, v6, v38
    v_mfma_f32_16x16x32_bf16 v[92:95], v[128:131], a[140:143], v[92:95]
    ds_read_b64_tr_b16 v[150:151], v162 offset:34816
    v_mul_f32 v7, v7, v39
    v_mfma_f32_16x16x32_bf16 v[92:95], v[132:135], a[156:159], v[92:95]
    s_waitcnt lgkmcnt(4)
    v_mul_f32 v20, v20, v52
    v_mul_f32 v21, v21, v53
    v_mfma_f32_16x16x32_bf16 v[112:115], v[136:139], a[128:131], v[112:115]
    ds_read_b64_tr_b16 v[152:153], v170 offset:28672
    v_mul_f32 v22, v22, v54
    v_mfma_f32_16x16x32_bf16 v[112:115], v[140:143], a[144:147], v[112:115]
    v_mul_f32 v23, v23, v55
    v_cvt_pk_bf16_f32 v36, v4, v5
    v_mfma_f32_16x16x32_bf16 v[116:119], v[136:139], a[132:135], v[116:119]
    ds_read_b64_tr_b16 v[154:155], v170 offset:30720
    v_cvt_pk_bf16_f32 v37, v6, v7
    v_mfma_f32_16x16x32_bf16 v[116:119], v[140:143], a[148:151], v[116:119]
    v_cvt_pk_bf16_f32 v38, v20, v21
    v_cvt_pk_bf16_f32 v39, v22, v23
    v_mfma_f32_16x16x32_bf16 v[120:123], v[136:139], a[136:139], v[120:123]
    ds_read_b64_tr_b16 v[156:157], v162 offset:36864
    v_mul_f32 v40, v8, v40
    v_mfma_f32_16x16x32_bf16 v[120:123], v[140:143], a[152:155], v[120:123]
    buffer_store_dwordx4 v[36:39], v175, s[24:27], s58 offen offset:1024 sc0 sc1
    v_mul_f32 v8, v8, v210
    v_mfma_f32_16x16x32_bf16 v[124:127], v[136:139], a[140:143], v[124:127]
    ds_read_b64_tr_b16 v[158:159], v162 offset:38912
    v_mul_f32 v41, v9, v41
    v_mfma_f32_16x16x32_bf16 v[124:127], v[140:143], a[156:159], v[124:127]
    s_waitcnt lgkmcnt(4)
    v_exp_f32 v8, v8
    v_mfma_f32_16x16x32_bf16 v[64:67], v[144:147], a[160:163], v[64:67]
    s_barrier
    v_mul_f32 v9, v9, v210
    v_mfma_f32_16x16x32_bf16 v[64:67], v[148:151], a[176:179], v[64:67]
    ds_read_b64_tr_b16 v[128:129], v171 offset:24576
    v_mul_f32 v42, v10, v42
    v_mfma_f32_16x16x32_bf16 v[68:71], v[144:147], a[164:167], v[68:71]
    ds_read_b64_tr_b16 v[130:131], v171 offset:26624
    v_mul_f32 v10, v10, v210
    v_mfma_f32_16x16x32_bf16 v[68:71], v[148:151], a[180:183], v[68:71]
    v_exp_f32 v9, v9
    v_mfma_f32_16x16x32_bf16 v[72:75], v[144:147], a[168:171], v[72:75]
    ds_read_b64_tr_b16 v[132:133], v163 offset:32768
    v_mul_f32 v43, v11, v43
    v_mfma_f32_16x16x32_bf16 v[72:75], v[148:151], a[184:187], v[72:75]
    v_exp_f32 v10, v10
    v_mfma_f32_16x16x32_bf16 v[76:79], v[144:147], a[172:175], v[76:79]
    ds_read_b64_tr_b16 v[134:135], v163 offset:34816
    v_mul_f32 v11, v11, v210
    v_mfma_f32_16x16x32_bf16 v[76:79], v[148:151], a[188:191], v[76:79]
    s_waitcnt lgkmcnt(4)
    v_exp_f32 v11, v11
    v_mfma_f32_16x16x32_bf16 v[96:99], v[152:155], a[160:163], v[96:99]
    ds_read_b64_tr_b16 v[136:137], v171 offset:28672
    v_mul_f32 v56, v24, v56
    v_mfma_f32_16x16x32_bf16 v[96:99], v[156:159], a[176:179], v[96:99]
    v_mul_f32 v24, v24, v210
    v_mul_f32 v57, v25, v57
    v_mfma_f32_16x16x32_bf16 v[100:103], v[152:155], a[164:167], v[100:103]
    ds_read_b64_tr_b16 v[138:139], v171 offset:30720
    v_mul_f32 v25, v25, v210
    v_mfma_f32_16x16x32_bf16 v[100:103], v[156:159], a[180:183], v[100:103]
    v_exp_f32 v24, v24
    v_mfma_f32_16x16x32_bf16 v[104:107], v[152:155], a[168:171], v[104:107]
    ds_read_b64_tr_b16 v[140:141], v163 offset:36864
    v_mul_f32 v58, v26, v58
    v_mfma_f32_16x16x32_bf16 v[104:107], v[156:159], a[184:187], v[104:107]
    v_exp_f32 v25, v25
    v_mfma_f32_16x16x32_bf16 v[108:111], v[152:155], a[172:175], v[108:111]
    ds_read_b64_tr_b16 v[142:143], v163 offset:38912
    v_mul_f32 v26, v26, v210
    v_mfma_f32_16x16x32_bf16 v[108:111], v[156:159], a[188:191], v[108:111]
    s_waitcnt lgkmcnt(4)
    v_exp_f32 v26, v26
    v_mfma_f32_16x16x32_bf16 v[80:83], v[128:131], a[160:163], v[80:83]
    s_add_u32 m0, s53, 65536
    ds_read_b64_tr_b16 v[144:145], v162 offset:40960
    s_add_u32 s55, s4, 256
    v_mfma_f32_16x16x32_bf16 v[80:83], v[132:135], a[176:179], v[80:83]
    buffer_load_dwordx4 v172, s[28:31], s55 offen lds
    v_mfma_f32_16x16x32_bf16 v[84:87], v[128:131], a[164:167], v[84:87]
    ds_read_b64_tr_b16 v[146:147], v162 offset:43008
    v_mul_f32 v59, v27, v59
    v_mfma_f32_16x16x32_bf16 v[84:87], v[132:135], a[180:183], v[84:87]
    buffer_load_dwordx4 v173, s[28:31], s55 offen offset:1024 lds
    v_mfma_f32_16x16x32_bf16 v[88:91], v[128:131], a[168:171], v[88:91]
    s_add_u32 m0, s53, 90112
    ds_read_b64_tr_b16 v[148:149], v162 offset:49152
    s_add_u32 s55, s4, 295168
    v_mfma_f32_16x16x32_bf16 v[88:91], v[132:135], a[184:187], v[88:91]
    v_mul_f32 v27, v27, v210
    v_fma_f32 v8, v8, v211, v211
    v_mfma_f32_16x16x32_bf16 v[92:95], v[128:131], a[172:175], v[92:95]
    ds_read_b64_tr_b16 v[150:151], v162 offset:51200
    v_fma_f32 v9, v9, v211, v211
    v_mfma_f32_16x16x32_bf16 v[92:95], v[132:135], a[188:191], v[92:95]
    s_waitcnt lgkmcnt(4)
    v_exp_f32 v27, v27
    v_mfma_f32_16x16x32_bf16 v[112:115], v[136:139], a[160:163], v[112:115]
    ds_read_b64_tr_b16 v[152:153], v162 offset:45056
    v_fma_f32 v10, v10, v211, v211
    v_mfma_f32_16x16x32_bf16 v[112:115], v[140:143], a[176:179], v[112:115]
    buffer_load_dwordx4 v172, s[28:31], s55 offen lds
    v_mfma_f32_16x16x32_bf16 v[116:119], v[136:139], a[164:167], v[116:119]
    ds_read_b64_tr_b16 v[154:155], v162 offset:47104
    v_fma_f32 v11, v11, v211, v211
    v_mfma_f32_16x16x32_bf16 v[116:119], v[140:143], a[180:183], v[116:119]
    v_rcp_f32 v8, v8
    v_mfma_f32_16x16x32_bf16 v[120:123], v[136:139], a[168:171], v[120:123]
    ds_read_b64_tr_b16 v[156:157], v162 offset:53248
    v_fma_f32 v24, v24, v211, v211
    v_mfma_f32_16x16x32_bf16 v[120:123], v[140:143], a[184:187], v[120:123]
    buffer_load_dwordx4 v173, s[28:31], s55 offen offset:1024 lds
    v_mfma_f32_16x16x32_bf16 v[124:127], v[136:139], a[172:175], v[124:127]
    s_add_u32 m0, s53, 24576
    ds_read_b64_tr_b16 v[158:159], v162 offset:55296
    s_add_u32 s55, s5, 256
    v_mfma_f32_16x16x32_bf16 v[124:127], v[140:143], a[188:191], v[124:127]
    s_waitcnt lgkmcnt(4)
    v_rcp_f32 v9, v9
    v_mfma_f32_16x16x32_bf16 v[64:67], v[144:147], a[192:195], v[64:67]
    ds_read_b64_tr_b16 v[128:129], v163 offset:40960
    v_fma_f32 v25, v25, v211, v211
    v_mfma_f32_16x16x32_bf16 v[64:67], v[148:151], a[208:211], v[64:67]
    buffer_load_dwordx4 v172, s[28:31], s55 offen lds
    v_mfma_f32_16x16x32_bf16 v[68:71], v[144:147], a[196:199], v[68:71]
    ds_read_b64_tr_b16 v[130:131], v163 offset:43008
    v_fma_f32 v26, v26, v211, v211
    v_mfma_f32_16x16x32_bf16 v[68:71], v[148:151], a[212:215], v[68:71]
    v_rcp_f32 v10, v10
    v_mfma_f32_16x16x32_bf16 v[72:75], v[144:147], a[200:203], v[72:75]
    ds_read_b64_tr_b16 v[132:133], v163 offset:49152
    v_fma_f32 v27, v27, v211, v211
    v_mfma_f32_16x16x32_bf16 v[72:75], v[148:151], a[216:219], v[72:75]
    buffer_load_dwordx4 v173, s[28:31], s55 offen offset:1024 lds
    v_mfma_f32_16x16x32_bf16 v[76:79], v[144:147], a[204:207], v[76:79]
    s_add_u32 m0, s53, 73728
    ds_read_b64_tr_b16 v[134:135], v163 offset:51200
    s_add_u32 s55, s5, 295168
    v_mfma_f32_16x16x32_bf16 v[76:79], v[148:151], a[220:223], v[76:79]
    s_waitcnt lgkmcnt(4)
    v_rcp_f32 v11, v11
    v_mfma_f32_16x16x32_bf16 v[96:99], v[152:155], a[192:195], v[96:99]
    ds_read_b64_tr_b16 v[136:137], v163 offset:45056
    v_mul_f32 v8, v8, v40
    v_mfma_f32_16x16x32_bf16 v[96:99], v[156:159], a[208:211], v[96:99]
    buffer_load_dwordx4 v172, s[28:31], s55 offen lds
    v_mfma_f32_16x16x32_bf16 v[100:103], v[152:155], a[196:199], v[100:103]
    ds_read_b64_tr_b16 v[138:139], v163 offset:47104
    v_mul_f32 v9, v9, v41
    v_mfma_f32_16x16x32_bf16 v[100:103], v[156:159], a[212:215], v[100:103]
    v_rcp_f32 v24, v24
    v_mfma_f32_16x16x32_bf16 v[104:107], v[152:155], a[200:203], v[104:107]
    ds_read_b64_tr_b16 v[140:141], v163 offset:53248
    v_mul_f32 v10, v10, v42
    v_mfma_f32_16x16x32_bf16 v[104:107], v[156:159], a[216:219], v[104:107]
    v_rcp_f32 v25, v25
    v_mfma_f32_16x16x32_bf16 v[108:111], v[152:155], a[204:207], v[108:111]
    ds_read_b64_tr_b16 v[142:143], v163 offset:55296
    v_mul_f32 v11, v11, v43
    v_mfma_f32_16x16x32_bf16 v[108:111], v[156:159], a[220:223], v[108:111]
    s_waitcnt lgkmcnt(4)
    v_rcp_f32 v26, v26
    v_mfma_f32_16x16x32_bf16 v[80:83], v[128:131], a[192:195], v[80:83]
    ds_read_b64_tr_b16 v[144:145], v162 offset:57344
    v_mul_f32 v24, v24, v56
    v_mfma_f32_16x16x32_bf16 v[80:83], v[132:135], a[208:211], v[80:83]
    buffer_load_dwordx4 v173, s[28:31], s55 offen offset:1024 lds
    v_mfma_f32_16x16x32_bf16 v[84:87], v[128:131], a[196:199], v[84:87]
    s_add_u32 m0, s53, 98304
    ds_read_b64_tr_b16 v[146:147], v162 offset:59392
    s_add_u32 s55, s6, 256
    v_mfma_f32_16x16x32_bf16 v[84:87], v[132:135], a[212:215], v[84:87]
    v_rcp_f32 v27, v27
    v_mfma_f32_16x16x32_bf16 v[88:91], v[128:131], a[200:203], v[88:91]
    ds_read_b64_tr_b16 v[148:149], v162 offset:0
    v_mul_f32 v25, v25, v57
    v_mfma_f32_16x16x32_bf16 v[88:91], v[132:135], a[216:219], v[88:91]
    buffer_load_dwordx4 v172, s[28:31], s55 offen lds
    v_mfma_f32_16x16x32_bf16 v[92:95], v[128:131], a[204:207], v[92:95]
    ds_read_b64_tr_b16 v[150:151], v162 offset:2048
    v_mul_f32 v26, v26, v58
    v_mfma_f32_16x16x32_bf16 v[92:95], v[132:135], a[220:223], v[92:95]
    s_waitcnt lgkmcnt(4)
    v_mul_f32 v27, v27, v59
    v_cvt_pk_bf16_f32 v40, v8, v9
    v_mfma_f32_16x16x32_bf16 v[112:115], v[136:139], a[192:195], v[112:115]
    ds_read_b64_tr_b16 v[152:153], v162 offset:61440
    v_cvt_pk_bf16_f32 v41, v10, v11
    v_mfma_f32_16x16x32_bf16 v[112:115], v[140:143], a[208:211], v[112:115]
    buffer_load_dwordx4 v173, s[28:31], s55 offen offset:1024 lds
    v_mfma_f32_16x16x32_bf16 v[116:119], v[136:139], a[196:199], v[116:119]
    s_add_u32 m0, s53, 122880
    ds_read_b64_tr_b16 v[154:155], v162 offset:63488
    s_add_u32 s55, s6, 295168
    v_mfma_f32_16x16x32_bf16 v[116:119], v[140:143], a[212:215], v[116:119]
    v_cvt_pk_bf16_f32 v42, v24, v25
    v_cvt_pk_bf16_f32 v43, v26, v27
    v_mfma_f32_16x16x32_bf16 v[120:123], v[136:139], a[200:203], v[120:123]
    ds_read_b64_tr_b16 v[156:157], v162 offset:4096
    v_mul_f32 v44, v12, v44
    v_mfma_f32_16x16x32_bf16 v[120:123], v[140:143], a[216:219], v[120:123]
    buffer_load_dwordx4 v172, s[28:31], s55 offen lds
    v_mfma_f32_16x16x32_bf16 v[124:127], v[136:139], a[204:207], v[124:127]
    ds_read_b64_tr_b16 v[158:159], v162 offset:6144
    v_mul_f32 v12, v12, v214
    v_mfma_f32_16x16x32_bf16 v[124:127], v[140:143], a[220:223], v[124:127]
    s_waitcnt lgkmcnt(4)
    buffer_store_dwordx4 v[40:43], v175, s[24:27], s58 offen offset:2048 sc0 sc1
    v_mul_f32 v45, v13, v45
    v_mfma_f32_16x16x32_bf16 v[64:67], v[144:147], a[224:227], v[64:67]
    s_barrier
    v_mul_f32 v13, v13, v214
    v_mfma_f32_16x16x32_bf16 v[64:67], v[148:151], a[240:243], v[64:67]
    ds_read_b64_tr_b16 v[128:129], v163 offset:57344
    v_mul_f32 v46, v14, v46
    v_mfma_f32_16x16x32_bf16 v[68:71], v[144:147], a[228:231], v[68:71]
    ds_read_b64_tr_b16 v[130:131], v163 offset:59392
    v_mul_f32 v14, v14, v214
    v_mfma_f32_16x16x32_bf16 v[68:71], v[148:151], a[244:247], v[68:71]
    buffer_load_dwordx4 v173, s[28:31], s55 offen offset:1024 lds
    v_mfma_f32_16x16x32_bf16 v[72:75], v[144:147], a[232:235], v[72:75]
    s_add_u32 m0, s53, 147456
    ds_read_b64_tr_b16 v[132:133], v163 offset:0
    s_add_u32 s55, s7, 256
    v_mfma_f32_16x16x32_bf16 v[72:75], v[148:151], a[248:251], v[72:75]
    buffer_load_dwordx4 v172, s[28:31], s55 offen lds
    v_mfma_f32_16x16x32_bf16 v[76:79], v[144:147], a[236:239], v[76:79]
    ds_read_b64_tr_b16 v[134:135], v163 offset:2048
    v_mul_f32 v47, v15, v47
    v_mfma_f32_16x16x32_bf16 v[76:79], v[148:151], a[252:255], v[76:79]
    s_waitcnt lgkmcnt(4)
    v_exp_f32 v12, v12
    v_mfma_f32_16x16x32_bf16 v[96:99], v[152:155], a[224:227], v[96:99]
    ds_read_b64_tr_b16 v[136:137], v163 offset:61440
    v_mul_f32 v15, v15, v214
    v_mfma_f32_16x16x32_bf16 v[96:99], v[156:159], a[240:243], v[96:99]
    v_exp_f32 v13, v13
    v_mfma_f32_16x16x32_bf16 v[100:103], v[152:155], a[228:231], v[100:103]
    ds_read_b64_tr_b16 v[138:139], v163 offset:63488
    v_mul_f32 v60, v28, v60
    v_mfma_f32_16x16x32_bf16 v[100:103], v[156:159], a[244:247], v[100:103]
    v_exp_f32 v14, v14
    v_mfma_f32_16x16x32_bf16 v[104:107], v[152:155], a[232:235], v[104:107]
    ds_read_b64_tr_b16 v[140:141], v163 offset:4096
    v_mul_f32 v28, v28, v214
    v_mfma_f32_16x16x32_bf16 v[104:107], v[156:159], a[248:251], v[104:107]
    buffer_load_dwordx4 v173, s[28:31], s55 offen offset:1024 lds
    v_mfma_f32_16x16x32_bf16 v[108:111], v[152:155], a[236:239], v[108:111]
    s_add_u32 m0, s53, 81920
    ds_read_b64_tr_b16 v[142:143], v163 offset:6144
    s_add_u32 s55, s7, 295168
    v_mfma_f32_16x16x32_bf16 v[108:111], v[156:159], a[252:255], v[108:111]
    s_waitcnt lgkmcnt(4)
    v_exp_f32 v15, v15
    v_mfma_f32_16x16x32_bf16 v[80:83], v[128:131], a[224:227], v[80:83]
    ds_read_b64_tr_b16 v[144:145], v162 offset:8192
    v_mul_f32 v61, v29, v61
    v_mfma_f32_16x16x32_bf16 v[80:83], v[132:135], a[240:243], v[80:83]
    buffer_load_dwordx4 v172, s[28:31], s55 offen lds
    v_mfma_f32_16x16x32_bf16 v[84:87], v[128:131], a[228:231], v[84:87]
    ds_read_b64_tr_b16 v[146:147], v162 offset:10240
    v_mul_f32 v29, v29, v214
    v_mfma_f32_16x16x32_bf16 v[84:87], v[132:135], a[244:247], v[84:87]
    v_exp_f32 v28, v28
    v_mfma_f32_16x16x32_bf16 v[88:91], v[128:131], a[232:235], v[88:91]
    ds_read_b64_tr_b16 v[148:149], v166 offset:49152
    v_mul_f32 v62, v30, v62
    v_mfma_f32_16x16x32_bf16 v[88:91], v[132:135], a[248:251], v[88:91]
    buffer_load_dwordx4 v173, s[28:31], s55 offen offset:1024 lds
    v_mfma_f32_16x16x32_bf16 v[92:95], v[128:131], a[236:239], v[92:95]
    s_add_u32 m0, s53, 106496
    ds_read_b64_tr_b16 v[150:151], v166 offset:51200
    s_add_u32 s55, s10, 256
    v_mfma_f32_16x16x32_bf16 v[92:95], v[132:135], a[252:255], v[92:95]
    s_waitcnt lgkmcnt(4)
    v_exp_f32 v29, v29
    v_mfma_f32_16x16x32_bf16 v[112:115], v[136:139], a[224:227], v[112:115]
    ds_read_b64_tr_b16 v[152:153], v162 offset:12288
    v_mul_f32 v30, v30, v214
    v_mfma_f32_16x16x32_bf16 v[112:115], v[140:143], a[240:243], v[112:115]
    buffer_load_dwordx4 v172, s[28:31], s55 offen lds
    v_mfma_f32_16x16x32_bf16 v[116:119], v[136:139], a[228:231], v[116:119]
    ds_read_b64_tr_b16 v[154:155], v162 offset:14336
    v_mul_f32 v63, v31, v63
    v_mfma_f32_16x16x32_bf16 v[116:119], v[140:143], a[244:247], v[116:119]
    v_exp_f32 v30, v30
    v_mfma_f32_16x16x32_bf16 v[120:123], v[136:139], a[232:235], v[120:123]
    ds_read_b64_tr_b16 v[156:157], v166 offset:53248
    v_mul_f32 v31, v31, v214
    v_mfma_f32_16x16x32_bf16 v[120:123], v[140:143], a[248:251], v[120:123]
    buffer_load_dwordx4 v173, s[28:31], s55 offen offset:1024 lds
    v_mfma_f32_16x16x32_bf16 v[124:127], v[136:139], a[236:239], v[124:127]
    s_add_u32 m0, s53, 131072
    ds_read_b64_tr_b16 v[158:159], v166 offset:55296
    s_add_u32 s55, s10, 295168
    v_mfma_f32_16x16x32_bf16 v[124:127], v[140:143], a[252:255], v[124:127]
    s_waitcnt lgkmcnt(4)
    v_exp_f32 v31, v31
    v_mfma_f32_16x16x32_bf16 v[64:67], v[144:147], v[224:227], v[64:67]
    ds_read_b64_tr_b16 v[128:129], v163 offset:8192
    v_fma_f32 v12, v12, v215, v215
    v_mfma_f32_16x16x32_bf16 v[64:67], v[148:151], v[240:243], v[64:67]
    buffer_load_dwordx4 v172, s[28:31], s55 offen lds
    v_mfma_f32_16x16x32_bf16 v[68:71], v[144:147], v[228:231], v[68:71]
    ds_read_b64_tr_b16 v[130:131], v163 offset:10240
    v_fma_f32 v13, v13, v215, v215
    v_mfma_f32_16x16x32_bf16 v[68:71], v[148:151], v[244:247], v[68:71]
    v_rcp_f32 v12, v12
    v_mfma_f32_16x16x32_bf16 v[72:75], v[144:147], v[232:235], v[72:75]
    ds_read_b64_tr_b16 v[132:133], v167 offset:49152
    v_fma_f32 v14, v14, v215, v215
    v_mfma_f32_16x16x32_bf16 v[72:75], v[148:151], v[248:251], v[72:75]
    v_rcp_f32 v13, v13
    v_mfma_f32_16x16x32_bf16 v[76:79], v[144:147], v[236:239], v[76:79]
    ds_read_b64_tr_b16 v[134:135], v167 offset:51200
    v_fma_f32 v15, v15, v215, v215
    v_mfma_f32_16x16x32_bf16 v[76:79], v[148:151], v[252:255], v[76:79]
    s_waitcnt lgkmcnt(4)
    v_rcp_f32 v14, v14
    v_mfma_f32_16x16x32_bf16 v[96:99], v[152:155], v[224:227], v[96:99]
    ds_read_b64_tr_b16 v[136:137], v163 offset:12288
    v_fma_f32 v28, v28, v215, v215
    v_mfma_f32_16x16x32_bf16 v[96:99], v[156:159], v[240:243], v[96:99]
    buffer_load_dwordx4 v173, s[28:31], s55 offen offset:1024 lds
    v_mfma_f32_16x16x32_bf16 v[100:103], v[152:155], v[228:231], v[100:103]
    s_add_u32 m0, s53, 155648
    ds_read_b64_tr_b16 v[138:139], v163 offset:14336
    s_add_u32 s55, s11, 256
    v_mfma_f32_16x16x32_bf16 v[100:103], v[156:159], v[244:247], v[100:103]
    v_rcp_f32 v15, v15
    v_mfma_f32_16x16x32_bf16 v[104:107], v[152:155], v[232:235], v[104:107]
    ds_read_b64_tr_b16 v[140:141], v167 offset:53248
    v_fma_f32 v29, v29, v215, v215
    v_mfma_f32_16x16x32_bf16 v[104:107], v[156:159], v[248:251], v[104:107]
    buffer_load_dwordx4 v172, s[28:31], s55 offen lds
    v_mfma_f32_16x16x32_bf16 v[108:111], v[152:155], v[236:239], v[108:111]
    ds_read_b64_tr_b16 v[142:143], v167 offset:55296
    v_fma_f32 v30, v30, v215, v215
    v_mfma_f32_16x16x32_bf16 v[108:111], v[156:159], v[252:255], v[108:111]
    s_waitcnt lgkmcnt(4)
    v_rcp_f32 v28, v28
    v_mfma_f32_16x16x32_bf16 v[80:83], v[128:131], v[224:227], v[80:83]
    ds_read_b64_tr_b16 v[144:145], v168 offset:8192
    v_fma_f32 v31, v31, v215, v215
    v_mfma_f32_16x16x32_bf16 v[80:83], v[132:135], v[240:243], v[80:83]
    buffer_load_dwordx4 v173, s[28:31], s55 offen offset:1024 lds
    v_mfma_f32_16x16x32_bf16 v[84:87], v[128:131], v[228:231], v[84:87]
    s_add_u32 m0, s53, 32768
    ds_read_b64_tr_b16 v[146:147], v168 offset:10240
    s_add_u32 s55, s11, 295168
    v_mfma_f32_16x16x32_bf16 v[84:87], v[132:135], v[244:247], v[84:87]
    v_rcp_f32 v29, v29
    v_mfma_f32_16x16x32_bf16 v[88:91], v[128:131], v[232:235], v[88:91]
    ds_read_b64_tr_b16 v[148:149], v160 offset:16384
    v_mul_f32 v12, v12, v44
    v_mfma_f32_16x16x32_bf16 v[88:91], v[132:135], v[248:251], v[88:91]
    buffer_load_dwordx4 v172, s[28:31], s55 offen lds
    v_mfma_f32_16x16x32_bf16 v[92:95], v[128:131], v[236:239], v[92:95]
    ds_read_b64_tr_b16 v[150:151], v160 offset:18432
    v_mul_f32 v13, v13, v45
    v_mfma_f32_16x16x32_bf16 v[92:95], v[132:135], v[252:255], v[92:95]
    s_waitcnt lgkmcnt(4)
    v_rcp_f32 v30, v30
    v_mfma_f32_16x16x32_bf16 v[112:115], v[136:139], v[224:227], v[112:115]
    ds_read_b64_tr_b16 v[152:153], v168 offset:12288
    v_mul_f32 v14, v14, v46
    v_mfma_f32_16x16x32_bf16 v[112:115], v[140:143], v[240:243], v[112:115]
    buffer_load_dwordx4 v173, s[28:31], s55 offen offset:1024 lds
    v_mfma_f32_16x16x32_bf16 v[116:119], v[136:139], v[228:231], v[116:119]
    s_add_u32 m0, s53, 40960
    ds_read_b64_tr_b16 v[154:155], v168 offset:14336
    s_add_u32 s55, s20, 256
    v_mfma_f32_16x16x32_bf16 v[116:119], v[140:143], v[244:247], v[116:119]
    v_rcp_f32 v31, v31
    v_mfma_f32_16x16x32_bf16 v[120:123], v[136:139], v[232:235], v[120:123]
    ds_read_b64_tr_b16 v[156:157], v160 offset:20480
    v_mul_f32 v15, v15, v47
    v_mfma_f32_16x16x32_bf16 v[120:123], v[140:143], v[248:251], v[120:123]
    v_mul_f32 v28, v28, v60
    v_mul_f32 v29, v29, v61
    v_mfma_f32_16x16x32_bf16 v[124:127], v[136:139], v[236:239], v[124:127]
    ds_read_b64_tr_b16 v[158:159], v160 offset:22528
    v_mul_f32 v30, v30, v62
    v_mfma_f32_16x16x32_bf16 v[124:127], v[140:143], v[252:255], v[124:127]
    s_waitcnt lgkmcnt(4)
    v_mul_f32 v31, v31, v63
    v_cvt_pk_bf16_f32 v44, v12, v13
    s_waitcnt vmcnt(27)
    v_mfma_f32_16x16x16_bf16 v[64:67], v[192:193], v[200:201], v[64:67]
    s_barrier
    v_cvt_pk_bf16_f32 v45, v14, v15
    v_mfma_f32_16x16x16_bf16 v[68:71], v[192:193], v[204:205], v[68:71]
    ds_read_b64_tr_b16 v[128:129], v169 offset:8192
    v_cvt_pk_bf16_f32 v46, v28, v29
    v_mfma_f32_16x16x16_bf16 v[72:75], v[192:193], v[208:209], v[72:75]
    ds_read_b64_tr_b16 v[130:131], v169 offset:10240
    v_cvt_pk_bf16_f32 v47, v30, v31
    v_mfma_f32_16x16x16_bf16 v[76:79], v[192:193], v[212:213], v[76:79]
    buffer_load_dwordx4 v172, s[28:31], s55 offen lds
    v_mfma_f32_16x16x16_bf16 v[80:83], v[194:195], v[200:201], v[80:83]
    buffer_load_dwordx4 v173, s[28:31], s55 offen offset:1024 lds
    v_mfma_f32_16x16x16_bf16 v[84:87], v[194:195], v[204:205], v[84:87]
    buffer_store_dwordx4 v[44:47], v175, s[24:27], s58 offen offset:3072 sc0 sc1
    s_add_u32 m0, s53, 49152
    v_mfma_f32_16x16x16_bf16 v[88:91], v[194:195], v[208:209], v[88:91]
    s_add_u32 s55, s20, 295168
    v_mfma_f32_16x16x16_bf16 v[92:95], v[194:195], v[212:213], v[92:95]
    v_mfma_f32_16x16x16_bf16 v[96:99], v[196:197], v[200:201], v[96:99]
    buffer_load_dwordx4 v172, s[28:31], s55 offen lds
    v_mfma_f32_16x16x16_bf16 v[100:103], v[196:197], v[204:205], v[100:103]
    v_mfma_f32_16x16x16_bf16 v[104:107], v[196:197], v[208:209], v[104:107]
    v_mfma_f32_16x16x16_bf16 v[108:111], v[196:197], v[212:213], v[108:111]
    v_mfma_f32_16x16x16_bf16 v[112:115], v[198:199], v[200:201], v[112:115]
    buffer_load_dwordx4 v173, s[28:31], s55 offen offset:1024 lds
    v_mfma_f32_16x16x16_bf16 v[116:119], v[198:199], v[204:205], v[116:119]
    s_add_u32 m0, s53, 57344
    s_add_u32 s55, s21, 256
    v_mfma_f32_16x16x16_bf16 v[120:123], v[198:199], v[208:209], v[120:123]
    v_mfma_f32_16x16x16_bf16 v[124:127], v[198:199], v[212:213], v[124:127]
    v_mfma_f32_16x16x32_bf16 v[0:3], v[144:147], a[0:3], 0
    buffer_load_dwordx4 v172, s[28:31], s55 offen lds
    v_mfma_f32_16x16x32_bf16 v[0:3], v[148:151], a[16:19], v[0:3]
    s_add_u32 s49, s82, 8192
    v_mfma_f32_16x16x32_bf16 v[4:7], v[144:147], a[4:7], 0
    buffer_load_dwordx4 v[192:195], v222, s[24:27], s49 offen offset:0 sc0 sc1
    v_mfma_f32_16x16x32_bf16 v[4:7], v[148:151], a[20:23], v[4:7]
    buffer_load_dwordx4 v[196:199], v222, s[24:27], s49 offen offset:1024 sc0 sc1
    v_mfma_f32_16x16x32_bf16 v[8:11], v[144:147], a[8:11], 0
    ds_read_b64_tr_b16 v[132:133], v161 offset:16384
    v_mfma_f32_16x16x32_bf16 v[8:11], v[148:151], a[24:27], v[8:11]
    buffer_load_dwordx4 v173, s[28:31], s55 offen offset:1024 lds
    v_mfma_f32_16x16x32_bf16 v[12:15], v[144:147], a[12:15], 0
    s_add_u32 m0, s53, 0
    ds_read_b64_tr_b16 v[134:135], v161 offset:18432
    s_add_u32 s55, s21, 295168
    v_mfma_f32_16x16x32_bf16 v[12:15], v[148:151], a[28:31], v[12:15]
    s_waitcnt lgkmcnt(4)
    v_mfma_f32_16x16x32_bf16 v[32:35], v[152:155], a[0:3], 0
    s_add_u32 s58, s57, 393216
    ds_read_b64_tr_b16 v[136:137], v169 offset:12288
    v_mul_f32 v96, v64, v96
    v_mfma_f32_16x16x32_bf16 v[32:35], v[156:159], a[16:19], v[32:35]
    v_mul_f32 v64, v64, v202
    v_mul_f32 v97, v65, v97
    v_mfma_f32_16x16x32_bf16 v[36:39], v[152:155], a[4:7], 0
    ds_read_b64_tr_b16 v[138:139], v169 offset:14336
    v_mul_f32 v65, v65, v202
    v_mfma_f32_16x16x32_bf16 v[36:39], v[156:159], a[20:23], v[36:39]
    v_exp_f32 v64, v64
    v_mfma_f32_16x16x32_bf16 v[40:43], v[152:155], a[8:11], 0
    ds_read_b64_tr_b16 v[140:141], v161 offset:20480
    v_mul_f32 v98, v66, v98
    v_mfma_f32_16x16x32_bf16 v[40:43], v[156:159], a[24:27], v[40:43]
    buffer_load_dwordx4 v172, s[28:31], s55 offen lds
    v_mfma_f32_16x16x32_bf16 v[44:47], v[152:155], a[12:15], 0
    ds_read_b64_tr_b16 v[142:143], v161 offset:22528
    v_mul_f32 v66, v66, v202
    v_mfma_f32_16x16x32_bf16 v[44:47], v[156:159], a[28:31], v[44:47]
    s_waitcnt lgkmcnt(4)
    v_exp_f32 v65, v65
    v_mfma_f32_16x16x32_bf16 v[16:19], v[128:131], a[0:3], 0
    s_waitcnt vmcnt(31)
    s_barrier
    v_mul_f32 v99, v67, v99
    v_mfma_f32_16x16x32_bf16 v[16:19], v[132:135], a[16:19], v[16:19]
    ds_read_b64_tr_b16 v[144:145], v164 offset:0
    v_mul_f32 v67, v67, v202
    v_mfma_f32_16x16x32_bf16 v[20:23], v[128:131], a[4:7], 0
    ds_read_b64_tr_b16 v[146:147], v164 offset:2048
    v_mul_f32 v112, v80, v112
    v_mfma_f32_16x16x32_bf16 v[20:23], v[132:135], a[20:23], v[20:23]
    buffer_load_dwordx4 v173, s[28:31], s55 offen offset:1024 lds
    v_mfma_f32_16x16x32_bf16 v[24:27], v[128:131], a[8:11], 0
    ds_read_b64_tr_b16 v[148:149], v164 offset:24576
    v_mul_f32 v80, v80, v202
    v_mfma_f32_16x16x32_bf16 v[24:27], v[132:135], a[24:27], v[24:27]
    v_exp_f32 v66, v66
    v_mfma_f32_16x16x32_bf16 v[28:31], v[128:131], a[12:15], 0
    ds_read_b64_tr_b16 v[150:151], v164 offset:26624
    v_mul_f32 v113, v81, v113
    v_mfma_f32_16x16x32_bf16 v[28:31], v[132:135], a[28:31], v[28:31]
    s_waitcnt lgkmcnt(4)
    v_exp_f32 v67, v67
    v_mfma_f32_16x16x32_bf16 v[48:51], v[136:139], a[0:3], 0
    ds_read_b64_tr_b16 v[152:153], v164 offset:4096
    v_mul_f32 v81, v81, v202
    v_mfma_f32_16x16x32_bf16 v[48:51], v[140:143], a[16:19], v[48:51]
    v_exp_f32 v80, v80
    v_mfma_f32_16x16x32_bf16 v[52:55], v[136:139], a[4:7], 0
    ds_read_b64_tr_b16 v[154:155], v164 offset:6144
    v_mul_f32 v114, v82, v114
    v_mfma_f32_16x16x32_bf16 v[52:55], v[140:143], a[20:23], v[52:55]
    v_exp_f32 v81, v81
    v_mfma_f32_16x16x32_bf16 v[56:59], v[136:139], a[8:11], 0
    ds_read_b64_tr_b16 v[156:157], v164 offset:28672
    v_mul_f32 v82, v82, v202
    v_mfma_f32_16x16x32_bf16 v[56:59], v[140:143], a[24:27], v[56:59]
    v_exp_f32 v82, v82
    v_mfma_f32_16x16x32_bf16 v[60:63], v[136:139], a[12:15], 0
    ds_read_b64_tr_b16 v[158:159], v164 offset:30720
    v_mul_f32 v115, v83, v115
    v_mfma_f32_16x16x32_bf16 v[60:63], v[140:143], a[28:31], v[60:63]
    s_waitcnt lgkmcnt(4)
    v_mul_f32 v83, v83, v202
    v_fma_f32 v64, v64, v203, v203
    v_mfma_f32_16x16x32_bf16 v[0:3], v[144:147], a[32:35], v[0:3]
    ds_read_b64_tr_b16 v[128:129], v165 offset:0
    v_fma_f32 v65, v65, v203, v203
    v_mfma_f32_16x16x32_bf16 v[0:3], v[148:151], a[48:51], v[0:3]
    v_exp_f32 v83, v83
    v_mfma_f32_16x16x32_bf16 v[4:7], v[144:147], a[36:39], v[4:7]
    ds_read_b64_tr_b16 v[130:131], v165 offset:2048
    v_fma_f32 v66, v66, v203, v203
    v_mfma_f32_16x16x32_bf16 v[4:7], v[148:151], a[52:55], v[4:7]
    v_rcp_f32 v64, v64
    v_mfma_f32_16x16x32_bf16 v[8:11], v[144:147], a[40:43], v[8:11]
    ds_read_b64_tr_b16 v[132:133], v165 offset:24576
    v_fma_f32 v67, v67, v203, v203
    v_mfma_f32_16x16x32_bf16 v[8:11], v[148:151], a[56:59], v[8:11]
    v_rcp_f32 v65, v65
    v_mfma_f32_16x16x32_bf16 v[12:15], v[144:147], a[44:47], v[12:15]
    ds_read_b64_tr_b16 v[134:135], v165 offset:26624
    v_fma_f32 v80, v80, v203, v203
    v_mfma_f32_16x16x32_bf16 v[12:15], v[148:151], a[60:63], v[12:15]
    s_waitcnt lgkmcnt(4)
    v_rcp_f32 v66, v66
    v_mfma_f32_16x16x32_bf16 v[32:35], v[152:155], a[32:35], v[32:35]
    ds_read_b64_tr_b16 v[136:137], v165 offset:4096
    v_fma_f32 v81, v81, v203, v203
    v_mfma_f32_16x16x32_bf16 v[32:35], v[156:159], a[48:51], v[32:35]
    v_rcp_f32 v67, v67
    v_mfma_f32_16x16x32_bf16 v[36:39], v[152:155], a[36:39], v[36:39]
    ds_read_b64_tr_b16 v[138:139], v165 offset:6144
    v_fma_f32 v82, v82, v203, v203
    v_mfma_f32_16x16x32_bf16 v[36:39], v[156:159], a[52:55], v[36:39]
    v_rcp_f32 v80, v80
    v_mfma_f32_16x16x32_bf16 v[40:43], v[152:155], a[40:43], v[40:43]
    ds_read_b64_tr_b16 v[140:141], v165 offset:28672
    v_fma_f32 v83, v83, v203, v203
    v_mfma_f32_16x16x32_bf16 v[40:43], v[156:159], a[56:59], v[40:43]
    v_rcp_f32 v81, v81
    v_mfma_f32_16x16x32_bf16 v[44:47], v[152:155], a[44:47], v[44:47]
    ds_read_b64_tr_b16 v[142:143], v165 offset:30720
    v_mul_f32 v64, v64, v96
    v_mfma_f32_16x16x32_bf16 v[44:47], v[156:159], a[60:63], v[44:47]
    s_waitcnt lgkmcnt(4)
    v_rcp_f32 v82, v82
    v_mfma_f32_16x16x32_bf16 v[16:19], v[128:131], a[32:35], v[16:19]
    s_waitcnt vmcnt(8)
    s_barrier
    s_add_u32 s49, s69, 40960
    v_mfma_f32_16x16x32_bf16 v[16:19], v[132:135], a[48:51], v[16:19]
    ds_read_b64_tr_b16 v[144:145], v160 offset:24576
    v_mul_f32 v65, v65, v97
    v_mfma_f32_16x16x32_bf16 v[20:23], v[128:131], a[36:39], v[20:23]
    ds_read_b64_tr_b16 v[146:147], v160 offset:26624
    v_mul_f32 v66, v66, v98
    v_mfma_f32_16x16x32_bf16 v[20:23], v[132:135], a[52:55], v[20:23]
    buffer_store_dword v218, v216, s[24:27], s49 offen sc0 sc1
    v_mfma_f32_16x16x32_bf16 v[24:27], v[128:131], a[40:43], v[24:27]
    ds_read_b64_tr_b16 v[148:149], v164 offset:8192
    v_mul_f32 v67, v67, v99
    v_mfma_f32_16x16x32_bf16 v[24:27], v[132:135], a[56:59], v[24:27]
    v_rcp_f32 v83, v83
    v_mfma_f32_16x16x32_bf16 v[28:31], v[128:131], a[44:47], v[28:31]
    ds_read_b64_tr_b16 v[150:151], v164 offset:10240
    v_mul_f32 v80, v80, v112
    v_mfma_f32_16x16x32_bf16 v[28:31], v[132:135], a[60:63], v[28:31]
    s_waitcnt lgkmcnt(4)
    v_mul_f32 v81, v81, v113
    v_mul_f32 v82, v82, v114
    v_mfma_f32_16x16x32_bf16 v[48:51], v[136:139], a[32:35], v[48:51]
    ds_read_b64_tr_b16 v[152:153], v160 offset:28672
    v_mul_f32 v83, v83, v115
    v_mfma_f32_16x16x32_bf16 v[48:51], v[140:143], a[48:51], v[48:51]
    v_cvt_pk_bf16_f32 v96, v64, v65
    v_cvt_pk_bf16_f32 v97, v66, v67
    v_mfma_f32_16x16x32_bf16 v[52:55], v[136:139], a[36:39], v[52:55]
    ds_read_b64_tr_b16 v[154:155], v160 offset:30720
    v_cvt_pk_bf16_f32 v98, v80, v81
    v_mfma_f32_16x16x32_bf16 v[52:55], v[140:143], a[52:55], v[52:55]
    v_cvt_pk_bf16_f32 v99, v82, v83
    v_mul_f32 v100, v68, v100
    v_mfma_f32_16x16x32_bf16 v[56:59], v[136:139], a[40:43], v[56:59]
    ds_read_b64_tr_b16 v[156:157], v164 offset:12288
    v_mul_f32 v68, v68, v206
    v_mfma_f32_16x16x32_bf16 v[56:59], v[140:143], a[56:59], v[56:59]
    buffer_store_dwordx4 v[96:99], v175, s[24:27], s58 offen offset:0 sc0 sc1
    v_mul_f32 v101, v69, v101
    v_mfma_f32_16x16x32_bf16 v[60:63], v[136:139], a[44:47], v[60:63]
    ds_read_b64_tr_b16 v[158:159], v164 offset:14336
    v_mul_f32 v69, v69, v206
    v_mfma_f32_16x16x32_bf16 v[60:63], v[140:143], a[60:63], v[60:63]
    s_waitcnt lgkmcnt(4)
    v_exp_f32 v68, v68
    v_mfma_f32_16x16x32_bf16 v[0:3], v[144:147], a[64:67], v[0:3]
    ds_read_b64_tr_b16 v[128:129], v161 offset:24576
    v_mul_f32 v102, v70, v102
    v_mfma_f32_16x16x32_bf16 v[0:3], v[148:151], a[80:83], v[0:3]
    v_exp_f32 v69, v69
    v_mfma_f32_16x16x32_bf16 v[4:7], v[144:147], a[68:71], v[4:7]
    ds_read_b64_tr_b16 v[130:131], v161 offset:26624
    v_mul_f32 v70, v70, v206
    v_mfma_f32_16x16x32_bf16 v[4:7], v[148:151], a[84:87], v[4:7]
    v_exp_f32 v70, v70
    v_mfma_f32_16x16x32_bf16 v[8:11], v[144:147], a[72:75], v[8:11]
    ds_read_b64_tr_b16 v[132:133], v165 offset:8192
    v_mul_f32 v103, v71, v103
    v_mfma_f32_16x16x32_bf16 v[8:11], v[148:151], a[88:91], v[8:11]
    v_mul_f32 v71, v71, v206
    v_mul_f32 v116, v84, v116
    v_mfma_f32_16x16x32_bf16 v[12:15], v[144:147], a[76:79], v[12:15]
    ds_read_b64_tr_b16 v[134:135], v165 offset:10240
    v_mul_f32 v84, v84, v206
    v_mfma_f32_16x16x32_bf16 v[12:15], v[148:151], a[92:95], v[12:15]
    s_waitcnt lgkmcnt(4)
    v_exp_f32 v71, v71
    v_mfma_f32_16x16x32_bf16 v[32:35], v[152:155], a[64:67], v[32:35]
    ds_read_b64_tr_b16 v[136:137], v161 offset:28672
    v_mul_f32 v117, v85, v117
    v_mfma_f32_16x16x32_bf16 v[32:35], v[156:159], a[80:83], v[32:35]
    v_exp_f32 v84, v84
    v_mfma_f32_16x16x32_bf16 v[36:39], v[152:155], a[68:71], v[36:39]
    ds_read_b64_tr_b16 v[138:139], v161 offset:30720
    v_mul_f32 v85, v85, v206
    v_mfma_f32_16x16x32_bf16 v[36:39], v[156:159], a[84:87], v[36:39]
    v_exp_f32 v85, v85
    v_mfma_f32_16x16x32_bf16 v[40:43], v[152:155], a[72:75], v[40:43]
    ds_read_b64_tr_b16 v[140:141], v165 offset:12288
    v_mul_f32 v118, v86, v118
    v_mfma_f32_16x16x32_bf16 v[40:43], v[156:159], a[88:91], v[40:43]
    v_mul_f32 v86, v86, v206
    v_mul_f32 v119, v87, v119
    v_mfma_f32_16x16x32_bf16 v[44:47], v[152:155], a[76:79], v[44:47]
    ds_read_b64_tr_b16 v[142:143], v165 offset:14336
    v_mul_f32 v87, v87, v206
    v_mfma_f32_16x16x32_bf16 v[44:47], v[156:159], a[92:95], v[44:47]
    s_waitcnt lgkmcnt(4)
    v_exp_f32 v86, v86
    v_mfma_f32_16x16x32_bf16 v[16:19], v[128:131], a[64:67], v[16:19]
    s_barrier
    v_fma_f32 v68, v68, v207, v207
    v_mfma_f32_16x16x32_bf16 v[16:19], v[132:135], a[80:83], v[16:19]
    ds_read_b64_tr_b16 v[144:145], v164 offset:32768
    v_fma_f32 v69, v69, v207, v207
    v_mfma_f32_16x16x32_bf16 v[20:23], v[128:131], a[68:71], v[20:23]
    ds_read_b64_tr_b16 v[146:147], v164 offset:34816
    v_fma_f32 v70, v70, v207, v207
    v_mfma_f32_16x16x32_bf16 v[20:23], v[132:135], a[84:87], v[20:23]
    v_exp_f32 v87, v87
    v_mfma_f32_16x16x32_bf16 v[24:27], v[128:131], a[72:75], v[24:27]
    ds_read_b64_tr_b16 v[148:149], v164 offset:57344
    v_fma_f32 v71, v71, v207, v207
    v_mfma_f32_16x16x32_bf16 v[24:27], v[132:135], a[88:91], v[24:27]
    v_rcp_f32 v68, v68
    v_mfma_f32_16x16x32_bf16 v[28:31], v[128:131], a[76:79], v[28:31]
    ds_read_b64_tr_b16 v[150:151], v164 offset:59392
    v_fma_f32 v84, v84, v207, v207
    v_mfma_f32_16x16x32_bf16 v[28:31], v[132:135], a[92:95], v[28:31]
    s_waitcnt lgkmcnt(4)
    v_rcp_f32 v69, v69
    v_mfma_f32_16x16x32_bf16 v[48:51], v[136:139], a[64:67], v[48:51]
    ds_read_b64_tr_b16 v[152:153], v164 offset:36864
    v_fma_f32 v85, v85, v207, v207
    v_mfma_f32_16x16x32_bf16 v[48:51], v[140:143], a[80:83], v[48:51]
    v_rcp_f32 v70, v70
    v_mfma_f32_16x16x32_bf16 v[52:55], v[136:139], a[68:71], v[52:55]
    ds_read_b64_tr_b16 v[154:155], v164 offset:38912
    v_fma_f32 v86, v86, v207, v207
    v_mfma_f32_16x16x32_bf16 v[52:55], v[140:143], a[84:87], v[52:55]
    v_rcp_f32 v71, v71
    v_mfma_f32_16x16x32_bf16 v[56:59], v[136:139], a[72:75], v[56:59]
    ds_read_b64_tr_b16 v[156:157], v164 offset:61440
    v_fma_f32 v87, v87, v207, v207
    v_mfma_f32_16x16x32_bf16 v[56:59], v[140:143], a[88:91], v[56:59]
    v_rcp_f32 v84, v84
    v_mfma_f32_16x16x32_bf16 v[60:63], v[136:139], a[76:79], v[60:63]
    ds_read_b64_tr_b16 v[158:159], v164 offset:63488
    v_mul_f32 v68, v68, v100
    v_mfma_f32_16x16x32_bf16 v[60:63], v[140:143], a[92:95], v[60:63]
    s_waitcnt lgkmcnt(4)
    v_rcp_f32 v85, v85
    v_mfma_f32_16x16x32_bf16 v[0:3], v[144:147], a[96:99], v[0:3]
    ds_read_b64_tr_b16 v[128:129], v165 offset:32768
    v_lshrrev_b32 v220, 3, v174
    v_mfma_f32_16x16x32_bf16 v[0:3], v[148:151], a[112:115], v[0:3]
    v_and_b32 v221, 6, v220
    v_xor_b32 v221, v221, v174
    v_mfma_f32_16x16x32_bf16 v[4:7], v[144:147], a[100:103], v[4:7]
    ds_read_b64_tr_b16 v[130:131], v165 offset:34816
    v_and_b32 v221, 7, v221
    v_mfma_f32_16x16x32_bf16 v[4:7], v[148:151], a[116:119], v[4:7]
    v_mul_u32_u24 v220, 1152, v220
    v_lshl_add_u32 v172, v221, 4, v220
    s_mul_i32 s52, s68, 384
    v_mfma_f32_16x16x32_bf16 v[8:11], v[144:147], a[104:107], v[8:11]
    s_and_b32 s60, s48, 1
    ds_read_b64_tr_b16 v[132:133], v165 offset:57344
    s_mul_i32 s60, s60, 18432
    v_mfma_f32_16x16x32_bf16 v[8:11], v[148:151], a[120:123], v[8:11]
    s_add_u32 s52, s52, s60
    v_add_u32 v172, s52, v172
    v_add_u32 v173, 8192, v172
    v_mfma_f32_16x16x32_bf16 v[12:15], v[144:147], a[108:111], v[12:15]
    s_and_b32 s52, s51, 1
    ds_read_b64_tr_b16 v[134:135], v165 offset:59392
    s_lshl1_add_u32 s52, s50, s52
    v_mfma_f32_16x16x32_bf16 v[12:15], v[148:151], a[124:127], v[12:15]
    s_waitcnt lgkmcnt(4)
    s_mul_i32 s9, s52, 3
    s_add_u32 s9, s9, s68
    v_mfma_f32_16x16x32_bf16 v[32:35], v[152:155], a[96:99], v[32:35]
    s_lshl_b32 s9, s9, 7
    ds_read_b64_tr_b16 v[136:137], v165 offset:36864
    s_add_u32 s9, s9, 540672
    v_mfma_f32_16x16x32_bf16 v[32:35], v[156:159], a[112:115], v[32:35]
    s_and_b32 s60, s48, 1
    s_lshl1_add_u32 s52, s52, s60
    s_lshl_b32 s52, s52, 12
    v_mfma_f32_16x16x32_bf16 v[36:39], v[152:155], a[100:103], v[36:39]
    ds_read_b64_tr_b16 v[138:139], v165 offset:38912
    v_lshl_add_u32 v220, v174, 4, s52
    v_mfma_f32_16x16x32_bf16 v[36:39], v[156:159], a[116:119], v[36:39]
    s_add_u32 m0, s66, 8192
    s_add_u32 s55, s14, 36864
    s_add_u32 s55, s55, s74
    v_mfma_f32_16x16x32_bf16 v[40:43], v[152:155], a[104:107], v[40:43]
    ds_read_b64_tr_b16 v[140:141], v165 offset:61440
    v_mul_f32 v69, v69, v101
    v_mfma_f32_16x16x32_bf16 v[40:43], v[156:159], a[120:123], v[40:43]
    buffer_load_dwordx4 v172, s[40:43], s55 offen lds
    v_mfma_f32_16x16x32_bf16 v[44:47], v[152:155], a[108:111], v[44:47]
    ds_read_b64_tr_b16 v[142:143], v165 offset:63488
    v_mul_f32 v70, v70, v102
    v_mfma_f32_16x16x32_bf16 v[44:47], v[156:159], a[124:127], v[44:47]
    s_waitcnt lgkmcnt(4)
    buffer_load_dwordx4 v173, s[40:43], s55 offen offset:1024 lds
    v_mfma_f32_16x16x32_bf16 v[16:19], v[128:131], a[96:99], v[16:19]
    s_add_u32 m0, s66, 114688
    ds_read_b64_tr_b16 v[144:145], v168 offset:16384
    s_add_u32 s55, s15, 36864
    v_mfma_f32_16x16x32_bf16 v[16:19], v[132:135], a[112:115], v[16:19]
    s_add_u32 s55, s55, s74
    v_rcp_f32 v86, v86
    v_mfma_f32_16x16x32_bf16 v[20:23], v[128:131], a[100:103], v[20:23]
    ds_read_b64_tr_b16 v[146:147], v168 offset:18432
    v_mul_f32 v71, v71, v103
    v_mfma_f32_16x16x32_bf16 v[20:23], v[132:135], a[116:119], v[20:23]
    v_rcp_f32 v87, v87
    v_mfma_f32_16x16x32_bf16 v[24:27], v[128:131], a[104:107], v[24:27]
    ds_read_b64_tr_b16 v[148:149], v164 offset:16384
    v_mul_f32 v84, v84, v116
    v_mfma_f32_16x16x32_bf16 v[24:27], v[132:135], a[120:123], v[24:27]
    buffer_load_dwordx4 v172, s[40:43], s55 offen lds
    v_mfma_f32_16x16x32_bf16 v[28:31], v[128:131], a[108:111], v[28:31]
    ds_read_b64_tr_b16 v[150:151], v164 offset:18432
    v_mul_f32 v85, v85, v117
    v_mfma_f32_16x16x32_bf16 v[28:31], v[132:135], a[124:127], v[28:31]
    s_waitcnt lgkmcnt(4)
    v_mul_f32 v86, v86, v118
    v_mul_f32 v87, v87, v119
    v_mfma_f32_16x16x32_bf16 v[48:51], v[136:139], a[96:99], v[48:51]
    ds_read_b64_tr_b16 v[152:153], v168 offset:20480
    v_cvt_pk_bf16_f32 v100, v68, v69
    v_mfma_f32_16x16x32_bf16 v[48:51], v[140:143], a[112:115], v[48:51]
    buffer_load_dwordx4 v173, s[40:43], s55 offen offset:1024 lds
    v_mfma_f32_16x16x32_bf16 v[52:55], v[136:139], a[100:103], v[52:55]
    ds_read_b64_tr_b16 v[154:155], v168 offset:22528
    v_cvt_pk_bf16_f32 v101, v70, v71
    v_mfma_f32_16x16x32_bf16 v[52:55], v[140:143], a[116:119], v[52:55]
    v_cvt_pk_bf16_f32 v102, v84, v85
    v_cvt_pk_bf16_f32 v103, v86, v87
    v_mfma_f32_16x16x32_bf16 v[56:59], v[136:139], a[104:107], v[56:59]
    ds_read_b64_tr_b16 v[156:157], v164 offset:20480
    v_mul_f32 v104, v72, v104
    v_mfma_f32_16x16x32_bf16 v[56:59], v[140:143], a[120:123], v[56:59]
    buffer_store_dwordx4 v[100:103], v175, s[24:27], s58 offen offset:1024 sc0 sc1
    v_mul_f32 v72, v72, v210
    v_mfma_f32_16x16x32_bf16 v[60:63], v[136:139], a[108:111], v[60:63]
    ds_read_b64_tr_b16 v[158:159], v164 offset:22528
    v_mul_f32 v105, v73, v105
    v_mfma_f32_16x16x32_bf16 v[60:63], v[140:143], a[124:127], v[60:63]
    s_waitcnt lgkmcnt(4)
    v_exp_f32 v72, v72
    v_mfma_f32_16x16x32_bf16 v[0:3], v[144:147], a[128:131], v[0:3]
    ds_read_b64_tr_b16 v[128:129], v169 offset:16384
    v_mul_f32 v73, v73, v210
    v_mfma_f32_16x16x32_bf16 v[0:3], v[148:151], a[144:147], v[0:3]
    v_exp_f32 v73, v73
    v_mfma_f32_16x16x32_bf16 v[4:7], v[144:147], a[132:135], v[4:7]
    ds_read_b64_tr_b16 v[130:131], v169 offset:18432
    v_mul_f32 v106, v74, v106
    v_mfma_f32_16x16x32_bf16 v[4:7], v[148:151], a[148:151], v[4:7]
    v_mul_f32 v74, v74, v210
    v_mul_f32 v107, v75, v107
    v_mfma_f32_16x16x32_bf16 v[8:11], v[144:147], a[136:139], v[8:11]
    ds_read_b64_tr_b16 v[132:133], v165 offset:16384
    v_mul_f32 v75, v75, v210
    v_mfma_f32_16x16x32_bf16 v[8:11], v[148:151], a[152:155], v[8:11]
    v_exp_f32 v74, v74
    v_mfma_f32_16x16x32_bf16 v[12:15], v[144:147], a[140:143], v[12:15]
    ds_read_b64_tr_b16 v[134:135], v165 offset:18432
    v_mul_f32 v120, v88, v120
    v_mfma_f32_16x16x32_bf16 v[12:15], v[148:151], a[156:159], v[12:15]
    s_waitcnt lgkmcnt(4)
    v_exp_f32 v75, v75
    v_mfma_f32_16x16x32_bf16 v[32:35], v[152:155], a[128:131], v[32:35]
    ds_read_b64_tr_b16 v[136:137], v169 offset:20480
    v_mul_f32 v88, v88, v210
    v_mfma_f32_16x16x32_bf16 v[32:35], v[156:159], a[144:147], v[32:35]
    v_exp_f32 v88, v88
    v_mfma_f32_16x16x32_bf16 v[36:39], v[152:155], a[132:135], v[36:39]
    ds_read_b64_tr_b16 v[138:139], v169 offset:22528
    v_mul_f32 v121, v89, v121
    v_mfma_f32_16x16x32_bf16 v[36:39], v[156:159], a[148:151], v[36:39]
    v_mul_f32 v89, v89, v210
    v_mul_f32 v122, v90, v122
    v_mfma_f32_16x16x32_bf16 v[40:43], v[152:155], a[136:139], v[40:43]
    ds_read_b64_tr_b16 v[140:141], v165 offset:20480
    v_mul_f32 v90, v90, v210
    v_mfma_f32_16x16x32_bf16 v[40:43], v[156:159], a[152:155], v[40:43]
    v_exp_f32 v89, v89
    v_mfma_f32_16x16x32_bf16 v[44:47], v[152:155], a[140:143], v[44:47]
    ds_read_b64_tr_b16 v[142:143], v165 offset:22528
    v_mul_f32 v123, v91, v123
    v_mfma_f32_16x16x32_bf16 v[44:47], v[156:159], a[156:159], v[44:47]
    s_waitcnt lgkmcnt(4)
    v_exp_f32 v90, v90
    v_mfma_f32_16x16x32_bf16 v[16:19], v[128:131], a[128:131], v[16:19]
    ds_read_b64_tr_b16 v[144:145], v164 offset:40960
    v_mul_f32 v91, v91, v210
    v_mfma_f32_16x16x32_bf16 v[16:19], v[132:135], a[144:147], v[16:19]
    v_exp_f32 v91, v91
    v_mfma_f32_16x16x32_bf16 v[20:23], v[128:131], a[132:135], v[20:23]
    ds_read_b64_tr_b16 v[146:147], v164 offset:43008
    v_fma_f32 v72, v72, v211, v211
    v_mfma_f32_16x16x32_bf16 v[20:23], v[132:135], a[148:151], v[20:23]
    v_rcp_f32 v72, v72
    v_mfma_f32_16x16x32_bf16 v[24:27], v[128:131], a[136:139], v[24:27]
    ds_read_b64_tr_b16 v[148:149], v168 offset:0
    v_fma_f32 v73, v73, v211, v211
    v_mfma_f32_16x16x32_bf16 v[24:27], v[132:135], a[152:155], v[24:27]
    v_rcp_f32 v73, v73
    v_mfma_f32_16x16x32_bf16 v[28:31], v[128:131], a[140:143], v[28:31]
    ds_read_b64_tr_b16 v[150:151], v168 offset:2048
    v_fma_f32 v74, v74, v211, v211
    v_mfma_f32_16x16x32_bf16 v[28:31], v[132:135], a[156:159], v[28:31]
    s_waitcnt lgkmcnt(4)
    v_rcp_f32 v74, v74
    v_mfma_f32_16x16x32_bf16 v[48:51], v[136:139], a[128:131], v[48:51]
    ds_read_b64_tr_b16 v[152:153], v164 offset:45056
    v_fma_f32 v75, v75, v211, v211
    v_mfma_f32_16x16x32_bf16 v[48:51], v[140:143], a[144:147], v[48:51]
    v_rcp_f32 v75, v75
    v_mfma_f32_16x16x32_bf16 v[52:55], v[136:139], a[132:135], v[52:55]
    ds_read_b64_tr_b16 v[154:155], v164 offset:47104
    v_fma_f32 v88, v88, v211, v211
    v_mfma_f32_16x16x32_bf16 v[52:55], v[140:143], a[148:151], v[52:55]
    v_rcp_f32 v88, v88
    v_mfma_f32_16x16x32_bf16 v[56:59], v[136:139], a[136:139], v[56:59]
    ds_read_b64_tr_b16 v[156:157], v168 offset:4096
    v_fma_f32 v89, v89, v211, v211
    v_mfma_f32_16x16x32_bf16 v[56:59], v[140:143], a[152:155], v[56:59]
    v_rcp_f32 v89, v89
    v_mfma_f32_16x16x32_bf16 v[60:63], v[136:139], a[140:143], v[60:63]
    ds_read_b64_tr_b16 v[158:159], v168 offset:6144
    v_fma_f32 v90, v90, v211, v211
    v_mfma_f32_16x16x32_bf16 v[60:63], v[140:143], a[156:159], v[60:63]
    s_waitcnt lgkmcnt(4)
    v_rcp_f32 v90, v90
    v_mfma_f32_16x16x32_bf16 v[0:3], v[144:147], a[160:163], v[0:3]
    ds_read_b64_tr_b16 v[128:129], v165 offset:40960
    v_fma_f32 v91, v91, v211, v211
    v_mfma_f32_16x16x32_bf16 v[0:3], v[148:151], a[176:179], v[0:3]
    v_rcp_f32 v91, v91
    v_mfma_f32_16x16x32_bf16 v[4:7], v[144:147], a[164:167], v[4:7]
    ds_read_b64_tr_b16 v[130:131], v165 offset:43008
    v_mul_f32 v72, v72, v104
    v_mfma_f32_16x16x32_bf16 v[4:7], v[148:151], a[180:183], v[4:7]
    v_mul_f32 v73, v73, v105
    v_mul_f32 v74, v74, v106
    v_mfma_f32_16x16x32_bf16 v[8:11], v[144:147], a[168:171], v[8:11]
    ds_read_b64_tr_b16 v[132:133], v169 offset:0
    v_mul_f32 v75, v75, v107
    v_mfma_f32_16x16x32_bf16 v[8:11], v[148:151], a[184:187], v[8:11]
    v_mul_f32 v88, v88, v120
    v_mul_f32 v89, v89, v121
    v_mfma_f32_16x16x32_bf16 v[12:15], v[144:147], a[172:175], v[12:15]
    ds_read_b64_tr_b16 v[134:135], v169 offset:2048
    v_mul_f32 v90, v90, v122
    v_mfma_f32_16x16x32_bf16 v[12:15], v[148:151], a[188:191], v[12:15]
    s_waitcnt lgkmcnt(4)
    v_mul_f32 v91, v91, v123
    v_cvt_pk_bf16_f32 v104, v72, v73
    v_mfma_f32_16x16x32_bf16 v[32:35], v[152:155], a[160:163], v[32:35]
    ds_read_b64_tr_b16 v[136:137], v165 offset:45056
    v_cvt_pk_bf16_f32 v105, v74, v75
    v_mfma_f32_16x16x32_bf16 v[32:35], v[156:159], a[176:179], v[32:35]
    v_cvt_pk_bf16_f32 v106, v88, v89
    v_cvt_pk_bf16_f32 v107, v90, v91
    v_mfma_f32_16x16x32_bf16 v[36:39], v[152:155], a[164:167], v[36:39]
    ds_read_b64_tr_b16 v[138:139], v165 offset:47104
    v_mul_f32 v108, v76, v108
    v_mfma_f32_16x16x32_bf16 v[36:39], v[156:159], a[180:183], v[36:39]
    buffer_store_dwordx4 v[104:107], v175, s[24:27], s58 offen offset:2048 sc0 sc1
    v_mul_f32 v76, v76, v214
    v_mfma_f32_16x16x32_bf16 v[40:43], v[152:155], a[168:171], v[40:43]
    ds_read_b64_tr_b16 v[140:141], v169 offset:4096
    v_mul_f32 v109, v77, v109
    v_mfma_f32_16x16x32_bf16 v[40:43], v[156:159], a[184:187], v[40:43]
    v_exp_f32 v76, v76
    v_mfma_f32_16x16x32_bf16 v[44:47], v[152:155], a[172:175], v[44:47]
    ds_read_b64_tr_b16 v[142:143], v169 offset:6144
    v_mul_f32 v77, v77, v214
    v_mfma_f32_16x16x32_bf16 v[44:47], v[156:159], a[188:191], v[44:47]
    s_waitcnt lgkmcnt(4)
    v_exp_f32 v77, v77
    v_mfma_f32_16x16x32_bf16 v[16:19], v[128:131], a[160:163], v[16:19]
    ds_read_b64_tr_b16 v[144:145], v168 offset:24576
    v_mul_f32 v110, v78, v110
    v_mfma_f32_16x16x32_bf16 v[16:19], v[132:135], a[176:179], v[16:19]
    v_mul_f32 v78, v78, v214
    v_mul_f32 v111, v79, v111
    v_mfma_f32_16x16x32_bf16 v[20:23], v[128:131], a[164:167], v[20:23]
    ds_read_b64_tr_b16 v[146:147], v168 offset:26624
    v_mul_f32 v79, v79, v214
    v_mfma_f32_16x16x32_bf16 v[20:23], v[132:135], a[180:183], v[20:23]
    v_exp_f32 v78, v78
    v_mfma_f32_16x16x32_bf16 v[24:27], v[128:131], a[168:171], v[24:27]
    ds_read_b64_tr_b16 v[148:149], v160 offset:32768
    v_mul_f32 v124, v92, v124
    v_mfma_f32_16x16x32_bf16 v[24:27], v[132:135], a[184:187], v[24:27]
    v_exp_f32 v79, v79
    v_mfma_f32_16x16x32_bf16 v[28:31], v[128:131], a[172:175], v[28:31]
    ds_read_b64_tr_b16 v[150:151], v160 offset:34816
    v_mul_f32 v92, v92, v214
    v_mfma_f32_16x16x32_bf16 v[28:31], v[132:135], a[188:191], v[28:31]
    s_waitcnt lgkmcnt(4)
    v_exp_f32 v92, v92
    v_mfma_f32_16x16x32_bf16 v[48:51], v[136:139], a[160:163], v[48:51]
    ds_read_b64_tr_b16 v[152:153], v168 offset:28672
    v_mul_f32 v125, v93, v125
    v_mfma_f32_16x16x32_bf16 v[48:51], v[140:143], a[176:179], v[48:51]
    v_mul_f32 v93, v93, v214
    v_mul_f32 v126, v94, v126
    v_mfma_f32_16x16x32_bf16 v[52:55], v[136:139], a[164:167], v[52:55]
    ds_read_b64_tr_b16 v[154:155], v168 offset:30720
    v_mul_f32 v94, v94, v214
    v_mfma_f32_16x16x32_bf16 v[52:55], v[140:143], a[180:183], v[52:55]
    v_exp_f32 v93, v93
    v_mfma_f32_16x16x32_bf16 v[56:59], v[136:139], a[168:171], v[56:59]
    ds_read_b64_tr_b16 v[156:157], v160 offset:36864
    v_mul_f32 v127, v95, v127
    v_mfma_f32_16x16x32_bf16 v[56:59], v[140:143], a[184:187], v[56:59]
    v_exp_f32 v94, v94
    v_mfma_f32_16x16x32_bf16 v[60:63], v[136:139], a[172:175], v[60:63]
    ds_read_b64_tr_b16 v[158:159], v160 offset:38912
    v_mul_f32 v95, v95, v214
    v_mfma_f32_16x16x32_bf16 v[60:63], v[140:143], a[188:191], v[60:63]
    s_waitcnt lgkmcnt(4)
    v_exp_f32 v95, v95
    v_mfma_f32_16x16x32_bf16 v[0:3], v[144:147], a[192:195], v[0:3]
    ds_read_b64_tr_b16 v[128:129], v169 offset:24576
    v_fma_f32 v76, v76, v215, v215
    v_mfma_f32_16x16x32_bf16 v[0:3], v[148:151], a[208:211], v[0:3]
    v_rcp_f32 v76, v76
    v_mfma_f32_16x16x32_bf16 v[4:7], v[144:147], a[196:199], v[4:7]
    ds_read_b64_tr_b16 v[130:131], v169 offset:26624
    v_fma_f32 v77, v77, v215, v215
    v_mfma_f32_16x16x32_bf16 v[4:7], v[148:151], a[212:215], v[4:7]
    v_rcp_f32 v77, v77
    v_mfma_f32_16x16x32_bf16 v[8:11], v[144:147], a[200:203], v[8:11]
    ds_read_b64_tr_b16 v[132:133], v161 offset:32768
    v_fma_f32 v78, v78, v215, v215
    v_mfma_f32_16x16x32_bf16 v[8:11], v[148:151], a[216:219], v[8:11]
    v_rcp_f32 v78, v78
    v_mfma_f32_16x16x32_bf16 v[12:15], v[144:147], a[204:207], v[12:15]
    ds_read_b64_tr_b16 v[134:135], v161 offset:34816
    v_fma_f32 v79, v79, v215, v215
    v_mfma_f32_16x16x32_bf16 v[12:15], v[148:151], a[220:223], v[12:15]
    s_waitcnt lgkmcnt(4)
    v_rcp_f32 v79, v79
    v_mfma_f32_16x16x32_bf16 v[32:35], v[152:155], a[192:195], v[32:35]
    ds_read_b64_tr_b16 v[136:137], v169 offset:28672
    v_fma_f32 v92, v92, v215, v215
    v_mfma_f32_16x16x32_bf16 v[32:35], v[156:159], a[208:211], v[32:35]
    v_rcp_f32 v92, v92
    v_mfma_f32_16x16x32_bf16 v[36:39], v[152:155], a[196:199], v[36:39]
    ds_read_b64_tr_b16 v[138:139], v169 offset:30720
    v_fma_f32 v93, v93, v215, v215
    v_mfma_f32_16x16x32_bf16 v[36:39], v[156:159], a[212:215], v[36:39]
    v_rcp_f32 v93, v93
    v_mfma_f32_16x16x32_bf16 v[40:43], v[152:155], a[200:203], v[40:43]
    ds_read_b64_tr_b16 v[140:141], v161 offset:36864
    v_fma_f32 v94, v94, v215, v215
    v_mfma_f32_16x16x32_bf16 v[40:43], v[156:159], a[216:219], v[40:43]
    v_rcp_f32 v94, v94
    v_mfma_f32_16x16x32_bf16 v[44:47], v[152:155], a[204:207], v[44:47]
    ds_read_b64_tr_b16 v[142:143], v161 offset:38912
    v_fma_f32 v95, v95, v215, v215
    v_mfma_f32_16x16x32_bf16 v[44:47], v[156:159], a[220:223], v[44:47]
    s_waitcnt lgkmcnt(4)
    v_rcp_f32 v95, v95
    v_mfma_f32_16x16x32_bf16 v[16:19], v[128:131], a[192:195], v[16:19]
    s_waitcnt vmcnt(14)
    s_barrier
    s_add_u32 s49, s71, 40960
    v_mfma_f32_16x16x32_bf16 v[16:19], v[132:135], a[208:211], v[16:19]
    ds_read_b64_tr_b16 v[144:145], v160 offset:40960
    v_mul_f32 v76, v76, v108
    v_mfma_f32_16x16x32_bf16 v[20:23], v[128:131], a[196:199], v[20:23]
    ds_read_b64_tr_b16 v[146:147], v160 offset:43008
    v_mul_f32 v77, v77, v109
    v_mfma_f32_16x16x32_bf16 v[20:23], v[132:135], a[212:215], v[20:23]
    buffer_load_dword v223, v217, s[24:27], s49 offen sc0 sc1
    v_mfma_f32_16x16x32_bf16 v[24:27], v[128:131], a[200:203], v[24:27]
    ds_read_b64_tr_b16 v[148:149], v160 offset:49152
    v_mul_f32 v78, v78, v110
    v_mfma_f32_16x16x32_bf16 v[24:27], v[132:135], a[216:219], v[24:27]
    v_mul_f32 v79, v79, v111
    v_mul_f32 v92, v92, v124
    v_mfma_f32_16x16x32_bf16 v[28:31], v[128:131], a[204:207], v[28:31]
    ds_read_b64_tr_b16 v[150:151], v160 offset:51200
    v_mul_f32 v93, v93, v125
    v_mfma_f32_16x16x32_bf16 v[28:31], v[132:135], a[220:223], v[28:31]
    s_waitcnt lgkmcnt(4)
    v_mul_f32 v94, v94, v126
    v_mul_f32 v95, v95, v127
    v_mfma_f32_16x16x32_bf16 v[48:51], v[136:139], a[192:195], v[48:51]
    ds_read_b64_tr_b16 v[152:153], v160 offset:45056
    v_cvt_pk_bf16_f32 v108, v76, v77
    v_mfma_f32_16x16x32_bf16 v[48:51], v[140:143], a[208:211], v[48:51]
    v_cvt_pk_bf16_f32 v109, v78, v79
    v_cvt_pk_bf16_f32 v110, v92, v93
    v_mfma_f32_16x16x32_bf16 v[52:55], v[136:139], a[196:199], v[52:55]
    ds_read_b64_tr_b16 v[154:155], v160 offset:47104
    v_cvt_pk_bf16_f32 v111, v94, v95
    v_mfma_f32_16x16x32_bf16 v[52:55], v[140:143], a[212:215], v[52:55]
    buffer_store_dwordx4 v[108:111], v175, s[24:27], s58 offen offset:3072 sc0 sc1
    v_mfma_f32_16x16x32_bf16 v[56:59], v[136:139], a[200:203], v[56:59]
    ds_read_b64_tr_b16 v[156:157], v160 offset:53248
    v_mfma_f32_16x16x32_bf16 v[56:59], v[140:143], a[216:219], v[56:59]
    v_mfma_f32_16x16x32_bf16 v[60:63], v[136:139], a[204:207], v[60:63]
    ds_read_b64_tr_b16 v[158:159], v160 offset:55296
    v_mfma_f32_16x16x32_bf16 v[60:63], v[140:143], a[220:223], v[60:63]
    s_waitcnt lgkmcnt(4)
    v_mfma_f32_16x16x32_bf16 v[0:3], v[144:147], a[224:227], v[0:3]
    ds_read_b64_tr_b16 v[128:129], v161 offset:40960
    v_mfma_f32_16x16x32_bf16 v[0:3], v[148:151], a[240:243], v[0:3]
    v_mfma_f32_16x16x32_bf16 v[4:7], v[144:147], a[228:231], v[4:7]
    ds_read_b64_tr_b16 v[130:131], v161 offset:43008
    v_mfma_f32_16x16x32_bf16 v[4:7], v[148:151], a[244:247], v[4:7]
    v_mfma_f32_16x16x32_bf16 v[8:11], v[144:147], a[232:235], v[8:11]
    ds_read_b64_tr_b16 v[132:133], v161 offset:49152
    v_mfma_f32_16x16x32_bf16 v[8:11], v[148:151], a[248:251], v[8:11]
    v_mfma_f32_16x16x32_bf16 v[12:15], v[144:147], a[236:239], v[12:15]
    ds_read_b64_tr_b16 v[134:135], v161 offset:51200
    v_mfma_f32_16x16x32_bf16 v[12:15], v[148:151], a[252:255], v[12:15]
    s_waitcnt lgkmcnt(4)
    v_mfma_f32_16x16x32_bf16 v[32:35], v[152:155], a[224:227], v[32:35]
    ds_read_b64_tr_b16 v[136:137], v161 offset:45056
    v_mfma_f32_16x16x32_bf16 v[32:35], v[156:159], a[240:243], v[32:35]
    v_mfma_f32_16x16x32_bf16 v[36:39], v[152:155], a[228:231], v[36:39]
    ds_read_b64_tr_b16 v[138:139], v161 offset:47104
    v_mfma_f32_16x16x32_bf16 v[36:39], v[156:159], a[244:247], v[36:39]
    v_mfma_f32_16x16x32_bf16 v[40:43], v[152:155], a[232:235], v[40:43]
    ds_read_b64_tr_b16 v[140:141], v161 offset:53248
    v_mfma_f32_16x16x32_bf16 v[40:43], v[156:159], a[248:251], v[40:43]
    v_mfma_f32_16x16x32_bf16 v[44:47], v[152:155], a[236:239], v[44:47]
    ds_read_b64_tr_b16 v[142:143], v161 offset:55296
    v_mfma_f32_16x16x32_bf16 v[44:47], v[156:159], a[252:255], v[44:47]
    s_waitcnt lgkmcnt(4)
    v_mfma_f32_16x16x32_bf16 v[16:19], v[128:131], a[224:227], v[16:19]
    s_waitcnt vmcnt(10)
    s_barrier
    v_mfma_f32_16x16x32_bf16 v[16:19], v[132:135], a[240:243], v[16:19]
    ds_read_b64_tr_b16 v[144:145], v160 offset:57344
    v_mfma_f32_16x16x32_bf16 v[20:23], v[128:131], a[228:231], v[20:23]
    ds_read_b64_tr_b16 v[146:147], v160 offset:59392
    v_mfma_f32_16x16x32_bf16 v[20:23], v[132:135], a[244:247], v[20:23]
    v_mfma_f32_16x16x32_bf16 v[24:27], v[128:131], a[232:235], v[24:27]
    ds_read_b64_tr_b16 v[148:149], v160 offset:0
    v_mfma_f32_16x16x32_bf16 v[24:27], v[132:135], a[248:251], v[24:27]
    v_mfma_f32_16x16x32_bf16 v[28:31], v[128:131], a[236:239], v[28:31]
    ds_read_b64_tr_b16 v[150:151], v160 offset:2048
    v_mfma_f32_16x16x32_bf16 v[28:31], v[132:135], a[252:255], v[28:31]
    s_waitcnt lgkmcnt(4)
    v_mfma_f32_16x16x32_bf16 v[48:51], v[136:139], a[224:227], v[48:51]
    ds_read_b64_tr_b16 v[152:153], v160 offset:61440
    v_mfma_f32_16x16x32_bf16 v[48:51], v[140:143], a[240:243], v[48:51]
    v_mfma_f32_16x16x32_bf16 v[52:55], v[136:139], a[228:231], v[52:55]
    ds_read_b64_tr_b16 v[154:155], v160 offset:63488
    v_mfma_f32_16x16x32_bf16 v[52:55], v[140:143], a[244:247], v[52:55]
    v_mfma_f32_16x16x32_bf16 v[56:59], v[136:139], a[232:235], v[56:59]
    ds_read_b64_tr_b16 v[156:157], v160 offset:4096
    v_mfma_f32_16x16x32_bf16 v[56:59], v[140:143], a[248:251], v[56:59]
    v_mfma_f32_16x16x32_bf16 v[60:63], v[136:139], a[236:239], v[60:63]
    ds_read_b64_tr_b16 v[158:159], v160 offset:6144
    v_mfma_f32_16x16x32_bf16 v[60:63], v[140:143], a[252:255], v[60:63]
    s_waitcnt lgkmcnt(4)
    v_mfma_f32_16x16x32_bf16 v[0:3], v[144:147], v[224:227], v[0:3]
    ds_read_b64_tr_b16 v[128:129], v161 offset:57344
    v_mfma_f32_16x16x32_bf16 v[0:3], v[148:151], v[240:243], v[0:3]
    v_mfma_f32_16x16x32_bf16 v[4:7], v[144:147], v[228:231], v[4:7]
    ds_read_b64_tr_b16 v[130:131], v161 offset:59392
    v_mfma_f32_16x16x32_bf16 v[4:7], v[148:151], v[244:247], v[4:7]
    v_mfma_f32_16x16x32_bf16 v[8:11], v[144:147], v[232:235], v[8:11]
    ds_read_b64_tr_b16 v[132:133], v161 offset:0
    v_mfma_f32_16x16x32_bf16 v[8:11], v[148:151], v[248:251], v[8:11]
    v_mfma_f32_16x16x32_bf16 v[12:15], v[144:147], v[236:239], v[12:15]
    ds_read_b64_tr_b16 v[134:135], v161 offset:2048
    v_mfma_f32_16x16x32_bf16 v[12:15], v[148:151], v[252:255], v[12:15]
    s_waitcnt lgkmcnt(4)
    v_mfma_f32_16x16x32_bf16 v[32:35], v[152:155], v[224:227], v[32:35]
    ds_read_b64_tr_b16 v[136:137], v161 offset:61440
    v_mfma_f32_16x16x32_bf16 v[32:35], v[156:159], v[240:243], v[32:35]
    v_mfma_f32_16x16x32_bf16 v[36:39], v[152:155], v[228:231], v[36:39]
    ds_read_b64_tr_b16 v[138:139], v161 offset:63488
    v_mfma_f32_16x16x32_bf16 v[36:39], v[156:159], v[244:247], v[36:39]
    v_mfma_f32_16x16x32_bf16 v[40:43], v[152:155], v[232:235], v[40:43]
    ds_read_b64_tr_b16 v[140:141], v161 offset:4096
    v_mfma_f32_16x16x32_bf16 v[40:43], v[156:159], v[248:251], v[40:43]
    v_mfma_f32_16x16x32_bf16 v[44:47], v[152:155], v[236:239], v[44:47]
    ds_read_b64_tr_b16 v[142:143], v161 offset:6144
    v_mfma_f32_16x16x32_bf16 v[44:47], v[156:159], v[252:255], v[44:47]
    s_waitcnt lgkmcnt(4)
    v_mfma_f32_16x16x32_bf16 v[16:19], v[128:131], v[224:227], v[16:19]
    ds_read_b64_tr_b16 v[144:145], v170 offset:8192
    v_mfma_f32_16x16x32_bf16 v[16:19], v[132:135], v[240:243], v[16:19]
    s_waitcnt vmcnt(1)
    v_cmp_eq_u32 vcc, s79, v223
    v_mfma_f32_16x16x32_bf16 v[20:23], v[128:131], v[228:231], v[20:23]
    ds_read_b64_tr_b16 v[146:147], v170 offset:10240
    v_mfma_f32_16x16x32_bf16 v[20:23], v[132:135], v[244:247], v[20:23]
    s_andn2_b32 s61, 7, vcc_lo
    s_cbranch_scc1 Lslow_11
Lback_12:
    v_mfma_f32_16x16x32_bf16 v[24:27], v[128:131], v[232:235], v[24:27]
    ds_read_b64_tr_b16 v[148:149], v162 offset:16384
    v_mfma_f32_16x16x32_bf16 v[24:27], v[132:135], v[248:251], v[24:27]
    v_mfma_f32_16x16x32_bf16 v[28:31], v[128:131], v[236:239], v[28:31]
    ds_read_b64_tr_b16 v[150:151], v162 offset:18432
    v_mfma_f32_16x16x32_bf16 v[28:31], v[132:135], v[252:255], v[28:31]
    s_waitcnt lgkmcnt(4)
    v_mfma_f32_16x16x32_bf16 v[48:51], v[136:139], v[224:227], v[48:51]
    ds_read_b64_tr_b16 v[152:153], v170 offset:12288
    v_mfma_f32_16x16x32_bf16 v[48:51], v[140:143], v[240:243], v[48:51]
    v_mfma_f32_16x16x32_bf16 v[52:55], v[136:139], v[228:231], v[52:55]
    ds_read_b64_tr_b16 v[154:155], v170 offset:14336
    v_mfma_f32_16x16x32_bf16 v[52:55], v[140:143], v[244:247], v[52:55]
    v_mfma_f32_16x16x32_bf16 v[56:59], v[136:139], v[232:235], v[56:59]
    ds_read_b64_tr_b16 v[156:157], v162 offset:20480
    v_mfma_f32_16x16x32_bf16 v[56:59], v[140:143], v[248:251], v[56:59]
    v_mfma_f32_16x16x32_bf16 v[60:63], v[136:139], v[236:239], v[60:63]
    ds_read_b64_tr_b16 v[158:159], v162 offset:22528
    v_mfma_f32_16x16x32_bf16 v[60:63], v[140:143], v[252:255], v[60:63]
    s_waitcnt lgkmcnt(4)
    v_mfma_f32_16x16x16_bf16 v[0:3], v[192:193], v[200:201], v[0:3]
    ds_read_b64_tr_b16 v[128:129], v171 offset:8192
    v_mfma_f32_16x16x16_bf16 v[4:7], v[192:193], v[204:205], v[4:7]
    v_mfma_f32_16x16x16_bf16 v[8:11], v[192:193], v[208:209], v[8:11]
    ds_read_b64_tr_b16 v[130:131], v171 offset:10240
    v_mfma_f32_16x16x16_bf16 v[12:15], v[192:193], v[212:213], v[12:15]
    v_mfma_f32_16x16x16_bf16 v[16:19], v[194:195], v[200:201], v[16:19]
    v_mfma_f32_16x16x16_bf16 v[20:23], v[194:195], v[204:205], v[20:23]
    v_mfma_f32_16x16x16_bf16 v[24:27], v[194:195], v[208:209], v[24:27]
    v_mfma_f32_16x16x16_bf16 v[28:31], v[194:195], v[212:213], v[28:31]
    v_mfma_f32_16x16x16_bf16 v[32:35], v[196:197], v[200:201], v[32:35]
    v_mfma_f32_16x16x16_bf16 v[36:39], v[196:197], v[204:205], v[36:39]
    v_mfma_f32_16x16x16_bf16 v[40:43], v[196:197], v[208:209], v[40:43]
    v_mfma_f32_16x16x16_bf16 v[44:47], v[196:197], v[212:213], v[44:47]
    v_mfma_f32_16x16x16_bf16 v[48:51], v[198:199], v[200:201], v[48:51]
    v_mfma_f32_16x16x16_bf16 v[52:55], v[198:199], v[204:205], v[52:55]
    v_mfma_f32_16x16x16_bf16 v[56:59], v[198:199], v[208:209], v[56:59]
    v_mfma_f32_16x16x16_bf16 v[60:63], v[198:199], v[212:213], v[60:63]
    v_mfma_f32_16x16x32_bf16 v[64:67], v[144:147], a[0:3], 0
    s_add_u32 s49, s82, 10240
    v_mfma_f32_16x16x32_bf16 v[64:67], v[148:151], a[16:19], v[64:67]
    buffer_load_dwordx4 v[192:195], v222, s[24:27], s49 offen offset:0 sc0 sc1
    v_mfma_f32_16x16x32_bf16 v[68:71], v[144:147], a[4:7], 0
    buffer_load_dwordx4 v[196:199], v222, s[24:27], s49 offen offset:1024 sc0 sc1
    v_mfma_f32_16x16x32_bf16 v[68:71], v[148:151], a[20:23], v[68:71]
    v_mfma_f32_16x16x32_bf16 v[72:75], v[144:147], a[8:11], 0
    ds_read_b64_tr_b16 v[132:133], v163 offset:16384
    v_mfma_f32_16x16x32_bf16 v[72:75], v[148:151], a[24:27], v[72:75]
    v_mfma_f32_16x16x32_bf16 v[76:79], v[144:147], a[12:15], 0
    ds_read_b64_tr_b16 v[134:135], v163 offset:18432
    v_mfma_f32_16x16x32_bf16 v[76:79], v[148:151], a[28:31], v[76:79]
    s_waitcnt lgkmcnt(4)
    v_mfma_f32_16x16x32_bf16 v[96:99], v[152:155], a[0:3], 0
    s_add_u32 s58, s57, 524288
    ds_read_b64_tr_b16 v[136:137], v171 offset:12288
    v_mul_f32 v32, v0, v32
    v_mfma_f32_16x16x32_bf16 v[96:99], v[156:159], a[16:19], v[96:99]
    v_mul_f32 v0, v0, v202
    v_mul_f32 v33, v1, v33
    v_mfma_f32_16x16x32_bf16 v[100:103], v[152:155], a[4:7], 0
    ds_read_b64_tr_b16 v[138:139], v171 offset:14336
    v_mul_f32 v1, v1, v202
    v_mfma_f32_16x16x32_bf16 v[100:103], v[156:159], a[20:23], v[100:103]
    v_exp_f32 v0, v0
    v_mfma_f32_16x16x32_bf16 v[104:107], v[152:155], a[8:11], 0
    ds_read_b64_tr_b16 v[140:141], v163 offset:20480
    v_mul_f32 v34, v2, v34
    v_mfma_f32_16x16x32_bf16 v[104:107], v[156:159], a[24:27], v[104:107]
    v_exp_f32 v1, v1
    v_mfma_f32_16x16x32_bf16 v[108:111], v[152:155], a[12:15], 0
    ds_read_b64_tr_b16 v[142:143], v163 offset:22528
    v_mul_f32 v2, v2, v202
    v_mfma_f32_16x16x32_bf16 v[108:111], v[156:159], a[28:31], v[108:111]
    s_waitcnt lgkmcnt(4)
    v_exp_f32 v2, v2
    v_mfma_f32_16x16x32_bf16 v[80:83], v[128:131], a[0:3], 0
    ds_read_b64_tr_b16 v[144:145], v166 offset:0
    v_mul_f32 v35, v3, v35
    v_mfma_f32_16x16x32_bf16 v[80:83], v[132:135], a[16:19], v[80:83]
    v_mul_f32 v3, v3, v202
    v_mul_f32 v48, v16, v48
    v_mfma_f32_16x16x32_bf16 v[84:87], v[128:131], a[4:7], 0
    ds_read_b64_tr_b16 v[146:147], v166 offset:2048
    v_mul_f32 v16, v16, v202
    v_mfma_f32_16x16x32_bf16 v[84:87], v[132:135], a[20:23], v[84:87]
    v_exp_f32 v3, v3
    v_mfma_f32_16x16x32_bf16 v[88:91], v[128:131], a[8:11], 0
    ds_read_b64_tr_b16 v[148:149], v166 offset:24576
    v_mul_f32 v49, v17, v49
    v_mfma_f32_16x16x32_bf16 v[88:91], v[132:135], a[24:27], v[88:91]
    v_exp_f32 v16, v16
    v_mfma_f32_16x16x32_bf16 v[92:95], v[128:131], a[12:15], 0
    ds_read_b64_tr_b16 v[150:151], v166 offset:26624
    v_mul_f32 v17, v17, v202
    v_mfma_f32_16x16x32_bf16 v[92:95], v[132:135], a[28:31], v[92:95]
    s_waitcnt lgkmcnt(4)
    v_exp_f32 v17, v17
    v_mfma_f32_16x16x32_bf16 v[112:115], v[136:139], a[0:3], 0
    ds_read_b64_tr_b16 v[152:153], v166 offset:4096
    v_mul_f32 v50, v18, v50
    v_mfma_f32_16x16x32_bf16 v[112:115], v[140:143], a[16:19], v[112:115]
    v_mul_f32 v18, v18, v202
    v_mul_f32 v51, v19, v51
    v_mfma_f32_16x16x32_bf16 v[116:119], v[136:139], a[4:7], 0
    ds_read_b64_tr_b16 v[154:155], v166 offset:6144
    v_mul_f32 v19, v19, v202
    v_mfma_f32_16x16x32_bf16 v[116:119], v[140:143], a[20:23], v[116:119]
    v_exp_f32 v18, v18
    v_mfma_f32_16x16x32_bf16 v[120:123], v[136:139], a[8:11], 0
    ds_read_b64_tr_b16 v[156:157], v166 offset:28672
    v_fma_f32 v0, v0, v203, v203
    v_mfma_f32_16x16x32_bf16 v[120:123], v[140:143], a[24:27], v[120:123]
    v_exp_f32 v19, v19
    v_mfma_f32_16x16x32_bf16 v[124:127], v[136:139], a[12:15], 0
    ds_read_b64_tr_b16 v[158:159], v166 offset:30720
    v_fma_f32 v1, v1, v203, v203
    v_mfma_f32_16x16x32_bf16 v[124:127], v[140:143], a[28:31], v[124:127]
    s_waitcnt lgkmcnt(4)
    v_rcp_f32 v0, v0
    v_mfma_f32_16x16x32_bf16 v[64:67], v[144:147], a[32:35], v[64:67]
    s_waitcnt vmcnt(2)
    s_barrier
    s_add_u32 s54, s12, 131072
    v_mfma_f32_16x16x32_bf16 v[64:67], v[148:151], a[48:51], v[64:67]
    s_add_u32 s49, s69, 49152
    ds_read_b64_tr_b16 v[128:129], v167 offset:0
    v_fma_f32 v2, v2, v203, v203
    v_mfma_f32_16x16x32_bf16 v[68:71], v[144:147], a[36:39], v[68:71]
    ds_read_b64_tr_b16 v[130:131], v167 offset:2048
    v_fma_f32 v3, v3, v203, v203
    v_mfma_f32_16x16x32_bf16 v[68:71], v[148:151], a[52:55], v[68:71]
    buffer_load_dwordx4 a[0:3], v220, s[24:27], s54 offen offset:0 sc0 sc1
    v_mfma_f32_16x16x32_bf16 v[72:75], v[144:147], a[40:43], v[72:75]
    ds_read_b64_tr_b16 v[132:133], v167 offset:24576
    v_fma_f32 v16, v16, v203, v203
    v_mfma_f32_16x16x32_bf16 v[72:75], v[148:151], a[56:59], v[72:75]
    buffer_load_dwordx4 a[4:7], v220, s[24:27], s54 offen offset:1024 sc0 sc1
    v_mfma_f32_16x16x32_bf16 v[76:79], v[144:147], a[44:47], v[76:79]
    ds_read_b64_tr_b16 v[134:135], v167 offset:26624
    v_fma_f32 v17, v17, v203, v203
    v_mfma_f32_16x16x32_bf16 v[76:79], v[148:151], a[60:63], v[76:79]
    s_waitcnt lgkmcnt(4)
    buffer_store_dword v218, v216, s[24:27], s49 offen sc0 sc1
    v_mfma_f32_16x16x32_bf16 v[96:99], v[152:155], a[32:35], v[96:99]
    ds_read_b64_tr_b16 v[136:137], v167 offset:4096
    v_fma_f32 v18, v18, v203, v203
    v_mfma_f32_16x16x32_bf16 v[96:99], v[156:159], a[48:51], v[96:99]
    buffer_load_dwordx4 a[8:11], v220, s[24:27], s54 offen offset:2048 sc0 sc1
    v_mfma_f32_16x16x32_bf16 v[100:103], v[152:155], a[36:39], v[100:103]
    ds_read_b64_tr_b16 v[138:139], v167 offset:6144
    v_fma_f32 v19, v19, v203, v203
    v_mfma_f32_16x16x32_bf16 v[100:103], v[156:159], a[52:55], v[100:103]
    v_rcp_f32 v1, v1
    v_mfma_f32_16x16x32_bf16 v[104:107], v[152:155], a[40:43], v[104:107]
    ds_read_b64_tr_b16 v[140:141], v167 offset:28672
    v_mul_f32 v0, v0, v32
    v_mfma_f32_16x16x32_bf16 v[104:107], v[156:159], a[56:59], v[104:107]
    buffer_load_dwordx4 a[12:15], v220, s[24:27], s54 offen offset:3072 sc0 sc1
    v_mfma_f32_16x16x32_bf16 v[108:111], v[152:155], a[44:47], v[108:111]
    s_add_u32 s54, s13, 131072
    ds_read_b64_tr_b16 v[142:143], v167 offset:30720
    v_mul_f32 v1, v1, v33
    v_mfma_f32_16x16x32_bf16 v[108:111], v[156:159], a[60:63], v[108:111]
    s_waitcnt lgkmcnt(4)
    v_rcp_f32 v2, v2
    v_mfma_f32_16x16x32_bf16 v[80:83], v[128:131], a[32:35], v[80:83]
    ds_read_b64_tr_b16 v[144:145], v162 offset:24576
    v_mul_f32 v2, v2, v34
    v_mfma_f32_16x16x32_bf16 v[80:83], v[132:135], a[48:51], v[80:83]
    buffer_load_dwordx4 a[16:19], v220, s[24:27], s54 offen offset:0 sc0 sc1
    v_mfma_f32_16x16x32_bf16 v[84:87], v[128:131], a[36:39], v[84:87]
    ds_read_b64_tr_b16 v[146:147], v162 offset:26624
    v_cvt_pk_bf16_f32 v32, v0, v1
    v_mfma_f32_16x16x32_bf16 v[84:87], v[132:135], a[52:55], v[84:87]
    v_rcp_f32 v3, v3
    v_mfma_f32_16x16x32_bf16 v[88:91], v[128:131], a[40:43], v[88:91]
    ds_read_b64_tr_b16 v[148:149], v166 offset:8192
    v_mul_f32 v3, v3, v35
    v_mfma_f32_16x16x32_bf16 v[88:91], v[132:135], a[56:59], v[88:91]
    buffer_load_dwordx4 a[20:23], v220, s[24:27], s54 offen offset:1024 sc0 sc1
    v_mfma_f32_16x16x32_bf16 v[92:95], v[128:131], a[44:47], v[92:95]
    ds_read_b64_tr_b16 v[150:151], v166 offset:10240
    v_cvt_pk_bf16_f32 v33, v2, v3
    v_mfma_f32_16x16x32_bf16 v[92:95], v[132:135], a[60:63], v[92:95]
    s_waitcnt lgkmcnt(4)
    v_rcp_f32 v16, v16
    v_mfma_f32_16x16x32_bf16 v[112:115], v[136:139], a[32:35], v[112:115]
    ds_read_b64_tr_b16 v[152:153], v162 offset:28672
    v_mul_f32 v16, v16, v48
    v_mfma_f32_16x16x32_bf16 v[112:115], v[140:143], a[48:51], v[112:115]
    buffer_load_dwordx4 a[24:27], v220, s[24:27], s54 offen offset:2048 sc0 sc1
    v_mfma_f32_16x16x32_bf16 v[116:119], v[136:139], a[36:39], v[116:119]
    ds_read_b64_tr_b16 v[154:155], v162 offset:30720
    v_mul_f32 v36, v4, v36
    v_mfma_f32_16x16x32_bf16 v[116:119], v[140:143], a[52:55], v[116:119]
    v_rcp_f32 v17, v17
    v_mfma_f32_16x16x32_bf16 v[120:123], v[136:139], a[40:43], v[120:123]
    ds_read_b64_tr_b16 v[156:157], v166 offset:12288
    v_mul_f32 v17, v17, v49
    v_mfma_f32_16x16x32_bf16 v[120:123], v[140:143], a[56:59], v[120:123]
    v_rcp_f32 v18, v18
    v_mfma_f32_16x16x32_bf16 v[124:127], v[136:139], a[44:47], v[124:127]
    ds_read_b64_tr_b16 v[158:159], v166 offset:14336
    v_mul_f32 v18, v18, v50
    v_mfma_f32_16x16x32_bf16 v[124:127], v[140:143], a[60:63], v[124:127]
    s_waitcnt lgkmcnt(4)
    v_rcp_f32 v19, v19
    v_mfma_f32_16x16x32_bf16 v[64:67], v[144:147], a[64:67], v[64:67]
    ds_read_b64_tr_b16 v[128:129], v163 offset:24576
    v_mul_f32 v19, v19, v51
    v_mfma_f32_16x16x32_bf16 v[64:67], v[148:151], a[80:83], v[64:67]
    buffer_load_dwordx4 a[28:31], v220, s[24:27], s54 offen offset:3072 sc0 sc1
    v_mfma_f32_16x16x32_bf16 v[68:71], v[144:147], a[68:71], v[68:71]
    s_add_u32 m0, s66, 139264
    ds_read_b64_tr_b16 v[130:131], v163 offset:26624
    s_add_u32 s55, s14, 36992
    v_mfma_f32_16x16x32_bf16 v[68:71], v[148:151], a[84:87], v[68:71]
    s_sub_u32 s55, s55, s74
    v_cvt_pk_bf16_f32 v34, v16, v17
    v_cvt_pk_bf16_f32 v35, v18, v19
    v_mfma_f32_16x16x32_bf16 v[72:75], v[144:147], a[72:75], v[72:75]
    ds_read_b64_tr_b16 v[132:133], v167 offset:8192
    v_mul_f32 v4, v4, v206
    v_mfma_f32_16x16x32_bf16 v[72:75], v[148:151], a[88:91], v[72:75]
    buffer_load_dwordx4 v172, s[40:43], s55 offen lds
    v_mfma_f32_16x16x32_bf16 v[76:79], v[144:147], a[76:79], v[76:79]
    ds_read_b64_tr_b16 v[134:135], v167 offset:10240
    v_mul_f32 v37, v5, v37
    v_mfma_f32_16x16x32_bf16 v[76:79], v[148:151], a[92:95], v[76:79]
    s_waitcnt lgkmcnt(4)
    buffer_store_dwordx4 v[32:35], v175, s[24:27], s58 offen offset:0 sc0 sc1
    v_mul_f32 v5, v5, v206
    v_mfma_f32_16x16x32_bf16 v[96:99], v[152:155], a[64:67], v[96:99]
    ds_read_b64_tr_b16 v[136:137], v163 offset:28672
    v_mul_f32 v38, v6, v38
    v_mfma_f32_16x16x32_bf16 v[96:99], v[156:159], a[80:83], v[96:99]
    buffer_load_dwordx4 v173, s[40:43], s55 offen offset:1024 lds
    v_mfma_f32_16x16x32_bf16 v[100:103], v[152:155], a[68:71], v[100:103]
    s_add_u32 m0, s66, 16384
    ds_read_b64_tr_b16 v[138:139], v163 offset:30720
    s_add_u32 s55, s15, 36992
    v_mfma_f32_16x16x32_bf16 v[100:103], v[156:159], a[84:87], v[100:103]
    s_sub_u32 s55, s55, s74
    v_exp_f32 v4, v4
    v_mfma_f32_16x16x32_bf16 v[104:107], v[152:155], a[72:75], v[104:107]
    ds_read_b64_tr_b16 v[140:141], v167 offset:12288
    v_mul_f32 v6, v6, v206
    v_mfma_f32_16x16x32_bf16 v[104:107], v[156:159], a[88:91], v[104:107]
    buffer_load_dwordx4 v172, s[40:43], s55 offen lds
    v_mfma_f32_16x16x32_bf16 v[108:111], v[152:155], a[76:79], v[108:111]
    ds_read_b64_tr_b16 v[142:143], v167 offset:14336
    v_mul_f32 v39, v7, v39
    v_mfma_f32_16x16x32_bf16 v[108:111], v[156:159], a[92:95], v[108:111]
    s_waitcnt lgkmcnt(4)
    v_exp_f32 v5, v5
    v_mfma_f32_16x16x32_bf16 v[80:83], v[128:131], a[64:67], v[80:83]
    ds_read_b64_tr_b16 v[144:145], v166 offset:32768
    v_mul_f32 v7, v7, v206
    v_mfma_f32_16x16x32_bf16 v[80:83], v[132:135], a[80:83], v[80:83]
    buffer_load_dwordx4 v173, s[40:43], s55 offen offset:1024 lds
    v_mfma_f32_16x16x32_bf16 v[84:87], v[128:131], a[68:71], v[84:87]
    s_add_u32 s54, s62, 131072
    ds_read_b64_tr_b16 v[146:147], v166 offset:34816
    v_mul_f32 v52, v20, v52
    v_mfma_f32_16x16x32_bf16 v[84:87], v[132:135], a[84:87], v[84:87]
    v_exp_f32 v6, v6
    v_mfma_f32_16x16x32_bf16 v[88:91], v[128:131], a[72:75], v[88:91]
    ds_read_b64_tr_b16 v[148:149], v166 offset:57344
    v_mul_f32 v20, v20, v206
    v_mfma_f32_16x16x32_bf16 v[88:91], v[132:135], a[88:91], v[88:91]
    buffer_load_dwordx4 a[32:35], v220, s[24:27], s54 offen offset:0 sc0 sc1
    v_mfma_f32_16x16x32_bf16 v[92:95], v[128:131], a[76:79], v[92:95]
    ds_read_b64_tr_b16 v[150:151], v166 offset:59392
    v_mul_f32 v53, v21, v53
    v_mfma_f32_16x16x32_bf16 v[92:95], v[132:135], a[92:95], v[92:95]
    s_waitcnt lgkmcnt(4)
    v_exp_f32 v7, v7
    v_mfma_f32_16x16x32_bf16 v[112:115], v[136:139], a[64:67], v[112:115]
    ds_read_b64_tr_b16 v[152:153], v166 offset:36864
    v_mul_f32 v21, v21, v206
    v_mfma_f32_16x16x32_bf16 v[112:115], v[140:143], a[80:83], v[112:115]
    v_exp_f32 v20, v20
    v_mfma_f32_16x16x32_bf16 v[116:119], v[136:139], a[68:71], v[116:119]
    ds_read_b64_tr_b16 v[154:155], v166 offset:38912
    v_mul_f32 v54, v22, v54
    v_mfma_f32_16x16x32_bf16 v[116:119], v[140:143], a[84:87], v[116:119]
    v_exp_f32 v21, v21
    v_mfma_f32_16x16x32_bf16 v[120:123], v[136:139], a[72:75], v[120:123]
    ds_read_b64_tr_b16 v[156:157], v166 offset:61440
    v_mul_f32 v22, v22, v206
    v_mfma_f32_16x16x32_bf16 v[120:123], v[140:143], a[88:91], v[120:123]
    buffer_load_dwordx4 a[36:39], v220, s[24:27], s54 offen offset:1024 sc0 sc1
    v_mfma_f32_16x16x32_bf16 v[124:127], v[136:139], a[76:79], v[124:127]
    ds_read_b64_tr_b16 v[158:159], v166 offset:63488
    v_mul_f32 v55, v23, v55
    v_mfma_f32_16x16x32_bf16 v[124:127], v[140:143], a[92:95], v[124:127]
    s_waitcnt lgkmcnt(4)
    v_exp_f32 v22, v22
    v_mfma_f32_16x16x32_bf16 v[64:67], v[144:147], a[96:99], v[64:67]
    s_barrier
    v_mul_f32 v23, v23, v206
    v_mfma_f32_16x16x32_bf16 v[64:67], v[148:151], a[112:115], v[64:67]
    ds_read_b64_tr_b16 v[128:129], v167 offset:32768
    v_fma_f32 v4, v4, v207, v207
    v_mfma_f32_16x16x32_bf16 v[68:71], v[144:147], a[100:103], v[68:71]
    ds_read_b64_tr_b16 v[130:131], v167 offset:34816
    v_fma_f32 v5, v5, v207, v207
    v_mfma_f32_16x16x32_bf16 v[68:71], v[148:151], a[116:119], v[68:71]
    buffer_load_dwordx4 a[40:43], v220, s[24:27], s54 offen offset:2048 sc0 sc1
    v_mfma_f32_16x16x32_bf16 v[72:75], v[144:147], a[104:107], v[72:75]
    ds_read_b64_tr_b16 v[132:133], v167 offset:57344
    v_fma_f32 v6, v6, v207, v207
    v_mfma_f32_16x16x32_bf16 v[72:75], v[148:151], a[120:123], v[72:75]
    buffer_load_dwordx4 a[44:47], v220, s[24:27], s54 offen offset:3072 sc0 sc1
    v_mfma_f32_16x16x32_bf16 v[76:79], v[144:147], a[108:111], v[76:79]
    s_add_u32 m0, s66, 65536
    ds_read_b64_tr_b16 v[134:135], v167 offset:59392
    s_add_u32 s55, s14, 37120
    v_mfma_f32_16x16x32_bf16 v[76:79], v[148:151], a[124:127], v[76:79]
    s_waitcnt lgkmcnt(4)
    v_exp_f32 v23, v23
    v_mfma_f32_16x16x32_bf16 v[96:99], v[152:155], a[96:99], v[96:99]
    ds_read_b64_tr_b16 v[136:137], v167 offset:36864
    v_fma_f32 v7, v7, v207, v207
    v_mfma_f32_16x16x32_bf16 v[96:99], v[156:159], a[112:115], v[96:99]
    buffer_load_dwordx4 v172, s[40:43], s55 offen lds
    v_mfma_f32_16x16x32_bf16 v[100:103], v[152:155], a[100:103], v[100:103]
    ds_read_b64_tr_b16 v[138:139], v167 offset:38912
    v_fma_f32 v20, v20, v207, v207
    v_mfma_f32_16x16x32_bf16 v[100:103], v[156:159], a[116:119], v[100:103]
    v_rcp_f32 v4, v4
    v_mfma_f32_16x16x32_bf16 v[104:107], v[152:155], a[104:107], v[104:107]
    ds_read_b64_tr_b16 v[140:141], v167 offset:61440
    v_fma_f32 v21, v21, v207, v207
    v_mfma_f32_16x16x32_bf16 v[104:107], v[156:159], a[120:123], v[104:107]
    buffer_load_dwordx4 v173, s[40:43], s55 offen offset:1024 lds
    v_mfma_f32_16x16x32_bf16 v[108:111], v[152:155], a[108:111], v[108:111]
    s_add_u32 m0, s66, 90112
    ds_read_b64_tr_b16 v[142:143], v167 offset:63488
    s_add_u32 s55, s15, 37120
    v_mfma_f32_16x16x32_bf16 v[108:111], v[156:159], a[124:127], v[108:111]
    s_waitcnt lgkmcnt(4)
    v_rcp_f32 v5, v5
    v_mfma_f32_16x16x32_bf16 v[80:83], v[128:131], a[96:99], v[80:83]
    ds_read_b64_tr_b16 v[144:145], v170 offset:16384
    v_fma_f32 v22, v22, v207, v207
    v_mfma_f32_16x16x32_bf16 v[80:83], v[132:135], a[112:115], v[80:83]
    buffer_load_dwordx4 v172, s[40:43], s55 offen lds
    v_mfma_f32_16x16x32_bf16 v[84:87], v[128:131], a[100:103], v[84:87]
    ds_read_b64_tr_b16 v[146:147], v170 offset:18432
    v_fma_f32 v23, v23, v207, v207
    v_mfma_f32_16x16x32_bf16 v[84:87], v[132:135], a[116:119], v[84:87]
    v_rcp_f32 v6, v6
    v_mfma_f32_16x16x32_bf16 v[88:91], v[128:131], a[104:107], v[88:91]
    ds_read_b64_tr_b16 v[148:149], v166 offset:16384
    v_mul_f32 v4, v4, v36
    v_mfma_f32_16x16x32_bf16 v[88:91], v[132:135], a[120:123], v[88:91]
    v_rcp_f32 v7, v7
    v_mfma_f32_16x16x32_bf16 v[92:95], v[128:131], a[108:111], v[92:95]
    ds_read_b64_tr_b16 v[150:151], v166 offset:18432
    v_mul_f32 v5, v5, v37
    v_mfma_f32_16x16x32_bf16 v[92:95], v[132:135], a[124:127], v[92:95]
    s_waitcnt lgkmcnt(4)
    v_rcp_f32 v20, v20
    v_mfma_f32_16x16x32_bf16 v[112:115], v[136:139], a[96:99], v[112:115]
    ds_read_b64_tr_b16 v[152:153], v170 offset:20480
    v_mul_f32 v6, v6, v38
    v_mfma_f32_16x16x32_bf16 v[112:115], v[140:143], a[112:115], v[112:115]
    buffer_load_dwordx4 v173, s[40:43], s55 offen offset:1024 lds
    v_mfma_f32_16x16x32_bf16 v[116:119], v[136:139], a[100:103], v[116:119]
    s_add_u32 m0, s66, 24576
    ds_read_b64_tr_b16 v[154:155], v170 offset:22528
    s_add_u32 s55, s3, 36864
    v_mfma_f32_16x16x32_bf16 v[116:119], v[140:143], a[116:119], v[116:119]
    s_add_u32 s55, s55, s74
    v_rcp_f32 v21, v21
    v_mfma_f32_16x16x32_bf16 v[120:123], v[136:139], a[104:107], v[120:123]
    ds_read_b64_tr_b16 v[156:157], v166 offset:20480
    v_mul_f32 v7, v7, v39
    v_mfma_f32_16x16x32_bf16 v[120:123], v[140:143], a[120:123], v[120:123]
    buffer_load_dwordx4 v172, s[40:43], s55 offen lds
    v_mfma_f32_16x16x32_bf16 v[124:127], v[136:139], a[108:111], v[124:127]
    ds_read_b64_tr_b16 v[158:159], v166 offset:22528
    v_mul_f32 v20, v20, v52
    v_mfma_f32_16x16x32_bf16 v[124:127], v[140:143], a[124:127], v[124:127]
    s_waitcnt lgkmcnt(4)
    v_rcp_f32 v22, v22
    v_mfma_f32_16x16x32_bf16 v[64:67], v[144:147], a[128:131], v[64:67]
    ds_read_b64_tr_b16 v[128:129], v171 offset:16384
    v_mul_f32 v21, v21, v53
    v_mfma_f32_16x16x32_bf16 v[64:67], v[148:151], a[144:147], v[64:67]
    buffer_load_dwordx4 v173, s[40:43], s55 offen offset:1024 lds
    v_mfma_f32_16x16x32_bf16 v[68:71], v[144:147], a[132:135], v[68:71]
    s_add_u32 s54, s12, 262144
    ds_read_b64_tr_b16 v[130:131], v171 offset:18432
    v_mul_f32 v22, v22, v54
    v_mfma_f32_16x16x32_bf16 v[68:71], v[148:151], a[148:151], v[68:71]
    v_rcp_f32 v23, v23
    v_mfma_f32_16x16x32_bf16 v[72:75], v[144:147], a[136:139], v[72:75]
    ds_read_b64_tr_b16 v[132:133], v167 offset:16384
    v_mul_f32 v23, v23, v55
    v_mfma_f32_16x16x32_bf16 v[72:75], v[148:151], a[152:155], v[72:75]
    buffer_load_dwordx4 a[48:51], v220, s[24:27], s54 offen offset:0 sc0 sc1
    v_mfma_f32_16x16x32_bf16 v[76:79], v[144:147], a[140:143], v[76:79]
    ds_read_b64_tr_b16 v[134:135], v167 offset:18432
    v_cvt_pk_bf16_f32 v36, v4, v5
    v_mfma_f32_16x16x32_bf16 v[76:79], v[148:151], a[156:159], v[76:79]
    s_waitcnt lgkmcnt(4)
    v_cvt_pk_bf16_f32 v37, v6, v7
    v_cvt_pk_bf16_f32 v38, v20, v21
    v_mfma_f32_16x16x32_bf16 v[96:99], v[152:155], a[128:131], v[96:99]
    ds_read_b64_tr_b16 v[136:137], v171 offset:20480
    v_cvt_pk_bf16_f32 v39, v22, v23
    v_mfma_f32_16x16x32_bf16 v[96:99], v[156:159], a[144:147], v[96:99]
    buffer_load_dwordx4 a[52:55], v220, s[24:27], s54 offen offset:1024 sc0 sc1
    v_mfma_f32_16x16x32_bf16 v[100:103], v[152:155], a[132:135], v[100:103]
    ds_read_b64_tr_b16 v[138:139], v171 offset:22528
    v_mul_f32 v40, v8, v40
    v_mfma_f32_16x16x32_bf16 v[100:103], v[156:159], a[148:151], v[100:103]
    buffer_store_dwordx4 v[36:39], v175, s[24:27], s58 offen offset:1024 sc0 sc1
    v_mul_f32 v8, v8, v210
    v_mfma_f32_16x16x32_bf16 v[104:107], v[152:155], a[136:139], v[104:107]
    ds_read_b64_tr_b16 v[140:141], v167 offset:20480
    v_mul_f32 v41, v9, v41
    v_mfma_f32_16x16x32_bf16 v[104:107], v[156:159], a[152:155], v[104:107]
    v_exp_f32 v8, v8
    v_mfma_f32_16x16x32_bf16 v[108:111], v[152:155], a[140:143], v[108:111]
    ds_read_b64_tr_b16 v[142:143], v167 offset:22528
    v_mul_f32 v9, v9, v210
    v_mfma_f32_16x16x32_bf16 v[108:111], v[156:159], a[156:159], v[108:111]
    s_waitcnt lgkmcnt(4)
    v_exp_f32 v9, v9
    v_mfma_f32_16x16x32_bf16 v[80:83], v[128:131], a[128:131], v[80:83]
    ds_read_b64_tr_b16 v[144:145], v166 offset:40960
    v_mul_f32 v42, v10, v42
    v_mfma_f32_16x16x32_bf16 v[80:83], v[132:135], a[144:147], v[80:83]
    buffer_load_dwordx4 a[56:59], v220, s[24:27], s54 offen offset:2048 sc0 sc1
    v_mfma_f32_16x16x32_bf16 v[84:87], v[128:131], a[132:135], v[84:87]
    ds_read_b64_tr_b16 v[146:147], v166 offset:43008
    v_mul_f32 v10, v10, v210
    v_mfma_f32_16x16x32_bf16 v[84:87], v[132:135], a[148:151], v[84:87]
    v_exp_f32 v10, v10
    v_mfma_f32_16x16x32_bf16 v[88:91], v[128:131], a[136:139], v[88:91]
    ds_read_b64_tr_b16 v[148:149], v170 offset:0
    v_mul_f32 v43, v11, v43
    v_mfma_f32_16x16x32_bf16 v[88:91], v[132:135], a[152:155], v[88:91]
    buffer_load_dwordx4 a[60:63], v220, s[24:27], s54 offen offset:3072 sc0 sc1
    v_mfma_f32_16x16x32_bf16 v[92:95], v[128:131], a[140:143], v[92:95]
    s_add_u32 m0, s66, 73728
    ds_read_b64_tr_b16 v[150:151], v170 offset:2048
    s_add_u32 s55, s14, 73728
    v_mfma_f32_16x16x32_bf16 v[92:95], v[132:135], a[156:159], v[92:95]
    s_waitcnt lgkmcnt(4)
    s_add_u32 s55, s55, s74
    v_mul_f32 v11, v11, v210
    v_mfma_f32_16x16x32_bf16 v[112:115], v[136:139], a[128:131], v[112:115]
    ds_read_b64_tr_b16 v[152:153], v166 offset:45056
    v_mul_f32 v56, v24, v56
    v_mfma_f32_16x16x32_bf16 v[112:115], v[140:143], a[144:147], v[112:115]
    buffer_load_dwordx4 v172, s[40:43], s55 offen lds
    v_mfma_f32_16x16x32_bf16 v[116:119], v[136:139], a[132:135], v[116:119]
    ds_read_b64_tr_b16 v[154:155], v166 offset:47104
    v_mul_f32 v24, v24, v210
    v_mfma_f32_16x16x32_bf16 v[116:119], v[140:143], a[148:151], v[116:119]
    v_exp_f32 v11, v11
    v_mfma_f32_16x16x32_bf16 v[120:123], v[136:139], a[136:139], v[120:123]
    ds_read_b64_tr_b16 v[156:157], v170 offset:4096
    v_mul_f32 v57, v25, v57
    v_mfma_f32_16x16x32_bf16 v[120:123], v[140:143], a[152:155], v[120:123]
    buffer_load_dwordx4 v173, s[40:43], s55 offen offset:1024 lds
    v_mfma_f32_16x16x32_bf16 v[124:127], v[136:139], a[140:143], v[124:127]
    s_add_u32 s54, s13, 262144
    ds_read_b64_tr_b16 v[158:159], v170 offset:6144
    v_mul_f32 v25, v25, v210
    v_mfma_f32_16x16x32_bf16 v[124:127], v[140:143], a[156:159], v[124:127]
    s_waitcnt lgkmcnt(4)
    v_exp_f32 v24, v24
    v_mfma_f32_16x16x32_bf16 v[64:67], v[144:147], a[160:163], v[64:67]
    s_barrier
    v_mul_f32 v58, v26, v58
    v_mfma_f32_16x16x32_bf16 v[64:67], v[148:151], a[176:179], v[64:67]
    ds_read_b64_tr_b16 v[128:129], v167 offset:40960
    v_mul_f32 v26, v26, v210
    v_mfma_f32_16x16x32_bf16 v[68:71], v[144:147], a[164:167], v[68:71]
    ds_read_b64_tr_b16 v[130:131], v167 offset:43008
    v_mul_f32 v59, v27, v59
    v_mfma_f32_16x16x32_bf16 v[68:71], v[148:151], a[180:183], v[68:71]
    buffer_load_dwordx4 a[64:67], v220, s[24:27], s54 offen offset:0 sc0 sc1
    v_mfma_f32_16x16x32_bf16 v[72:75], v[144:147], a[168:171], v[72:75]
    ds_read_b64_tr_b16 v[132:133], v171 offset:0
    v_mul_f32 v27, v27, v210
    v_mfma_f32_16x16x32_bf16 v[72:75], v[148:151], a[184:187], v[72:75]
    buffer_load_dwordx4 a[68:71], v220, s[24:27], s54 offen offset:1024 sc0 sc1
    v_mfma_f32_16x16x32_bf16 v[76:79], v[144:147], a[172:175], v[76:79]
    ds_read_b64_tr_b16 v[134:135], v171 offset:2048
    v_fma_f32 v8, v8, v211, v211
    v_mfma_f32_16x16x32_bf16 v[76:79], v[148:151], a[188:191], v[76:79]
    s_waitcnt lgkmcnt(4)
    v_exp_f32 v25, v25
    v_mfma_f32_16x16x32_bf16 v[96:99], v[152:155], a[160:163], v[96:99]
    ds_read_b64_tr_b16 v[136:137], v167 offset:45056
    v_fma_f32 v9, v9, v211, v211
    v_mfma_f32_16x16x32_bf16 v[96:99], v[156:159], a[176:179], v[96:99]
    v_exp_f32 v26, v26
    v_mfma_f32_16x16x32_bf16 v[100:103], v[152:155], a[164:167], v[100:103]
    ds_read_b64_tr_b16 v[138:139], v167 offset:47104
    v_fma_f32 v10, v10, v211, v211
    v_mfma_f32_16x16x32_bf16 v[100:103], v[156:159], a[180:183], v[100:103]
    v_exp_f32 v27, v27
    v_mfma_f32_16x16x32_bf16 v[104:107], v[152:155], a[168:171], v[104:107]
    ds_read_b64_tr_b16 v[140:141], v171 offset:4096
    v_fma_f32 v11, v11, v211, v211
    v_mfma_f32_16x16x32_bf16 v[104:107], v[156:159], a[184:187], v[104:107]
    buffer_load_dwordx4 a[72:75], v220, s[24:27], s54 offen offset:2048 sc0 sc1
    v_mfma_f32_16x16x32_bf16 v[108:111], v[152:155], a[172:175], v[108:111]
    ds_read_b64_tr_b16 v[142:143], v171 offset:6144
    v_fma_f32 v24, v24, v211, v211
    v_mfma_f32_16x16x32_bf16 v[108:111], v[156:159], a[188:191], v[108:111]
    s_waitcnt lgkmcnt(4)
    v_rcp_f32 v8, v8
    v_mfma_f32_16x16x32_bf16 v[80:83], v[128:131], a[160:163], v[80:83]
    ds_read_b64_tr_b16 v[144:145], v170 offset:24576
    v_fma_f32 v25, v25, v211, v211
    v_mfma_f32_16x16x32_bf16 v[80:83], v[132:135], a[176:179], v[80:83]
    buffer_load_dwordx4 a[76:79], v220, s[24:27], s54 offen offset:3072 sc0 sc1
    v_mfma_f32_16x16x32_bf16 v[84:87], v[128:131], a[164:167], v[84:87]
    s_add_u32 m0, s66, 98304
    ds_read_b64_tr_b16 v[146:147], v170 offset:26624
    s_add_u32 s55, s3, 36992
    v_mfma_f32_16x16x32_bf16 v[84:87], v[132:135], a[180:183], v[84:87]
    s_sub_u32 s55, s55, s74
    v_rcp_f32 v9, v9
    v_mfma_f32_16x16x32_bf16 v[88:91], v[128:131], a[168:171], v[88:91]
    ds_read_b64_tr_b16 v[148:149], v162 offset:32768
    v_fma_f32 v26, v26, v211, v211
    v_mfma_f32_16x16x32_bf16 v[88:91], v[132:135], a[184:187], v[88:91]
    buffer_load_dwordx4 v172, s[40:43], s55 offen lds
    v_mfma_f32_16x16x32_bf16 v[92:95], v[128:131], a[172:175], v[92:95]
    ds_read_b64_tr_b16 v[150:151], v162 offset:34816
    v_fma_f32 v27, v27, v211, v211
    v_mfma_f32_16x16x32_bf16 v[92:95], v[132:135], a[188:191], v[92:95]
    s_waitcnt lgkmcnt(4)
    v_rcp_f32 v10, v10
    v_mfma_f32_16x16x32_bf16 v[112:115], v[136:139], a[160:163], v[112:115]
    ds_read_b64_tr_b16 v[152:153], v170 offset:28672
    v_mul_f32 v8, v8, v40
    v_mfma_f32_16x16x32_bf16 v[112:115], v[140:143], a[176:179], v[112:115]
    buffer_load_dwordx4 v173, s[40:43], s55 offen offset:1024 lds
    v_mfma_f32_16x16x32_bf16 v[116:119], v[136:139], a[164:167], v[116:119]
    s_add_u32 m0, s66, 122880
    ds_read_b64_tr_b16 v[154:155], v170 offset:30720
    s_add_u32 s55, s14, 73856
    v_mfma_f32_16x16x32_bf16 v[116:119], v[140:143], a[180:183], v[116:119]
    s_sub_u32 s55, s55, s74
    v_rcp_f32 v11, v11
    v_mfma_f32_16x16x32_bf16 v[120:123], v[136:139], a[168:171], v[120:123]
    ds_read_b64_tr_b16 v[156:157], v162 offset:36864
    v_mul_f32 v9, v9, v41
    v_mfma_f32_16x16x32_bf16 v[120:123], v[140:143], a[184:187], v[120:123]
    buffer_load_dwordx4 v172, s[40:43], s55 offen lds
    v_mfma_f32_16x16x32_bf16 v[124:127], v[136:139], a[172:175], v[124:127]
    ds_read_b64_tr_b16 v[158:159], v162 offset:38912
    v_mul_f32 v10, v10, v42
    v_mfma_f32_16x16x32_bf16 v[124:127], v[140:143], a[188:191], v[124:127]
    s_waitcnt lgkmcnt(4)
    v_rcp_f32 v24, v24
    v_mfma_f32_16x16x32_bf16 v[64:67], v[144:147], a[192:195], v[64:67]
    ds_read_b64_tr_b16 v[128:129], v171 offset:24576
    v_mul_f32 v11, v11, v43
    v_mfma_f32_16x16x32_bf16 v[64:67], v[148:151], a[208:211], v[64:67]
    buffer_load_dwordx4 v173, s[40:43], s55 offen offset:1024 lds
    v_mfma_f32_16x16x32_bf16 v[68:71], v[144:147], a[196:199], v[68:71]
    s_add_u32 m0, s66, 147456
    ds_read_b64_tr_b16 v[130:131], v171 offset:26624
    s_add_u32 s55, s3, 37120
    v_mfma_f32_16x16x32_bf16 v[68:71], v[148:151], a[212:215], v[68:71]
    v_rcp_f32 v25, v25
    v_mfma_f32_16x16x32_bf16 v[72:75], v[144:147], a[200:203], v[72:75]
    ds_read_b64_tr_b16 v[132:133], v163 offset:32768
    v_mul_f32 v24, v24, v56
    v_mfma_f32_16x16x32_bf16 v[72:75], v[148:151], a[216:219], v[72:75]
    v_rcp_f32 v26, v26
    v_mfma_f32_16x16x32_bf16 v[76:79], v[144:147], a[204:207], v[76:79]
    ds_read_b64_tr_b16 v[134:135], v163 offset:34816
    v_mul_f32 v25, v25, v57
    v_mfma_f32_16x16x32_bf16 v[76:79], v[148:151], a[220:223], v[76:79]
    s_waitcnt lgkmcnt(4)
    v_rcp_f32 v27, v27
    v_mfma_f32_16x16x32_bf16 v[96:99], v[152:155], a[192:195], v[96:99]
    ds_read_b64_tr_b16 v[136:137], v171 offset:28672
    v_mul_f32 v26, v26, v58
    v_mfma_f32_16x16x32_bf16 v[96:99], v[156:159], a[208:211], v[96:99]
    buffer_load_dwordx4 v172, s[40:43], s55 offen lds
    v_mfma_f32_16x16x32_bf16 v[100:103], v[152:155], a[196:199], v[100:103]
    ds_read_b64_tr_b16 v[138:139], v171 offset:30720
    v_mul_f32 v27, v27, v59
    v_mfma_f32_16x16x32_bf16 v[100:103], v[156:159], a[212:215], v[100:103]
    v_cvt_pk_bf16_f32 v40, v8, v9
    v_cvt_pk_bf16_f32 v41, v10, v11
    v_mfma_f32_16x16x32_bf16 v[104:107], v[152:155], a[200:203], v[104:107]
    ds_read_b64_tr_b16 v[140:141], v163 offset:36864
    v_cvt_pk_bf16_f32 v42, v24, v25
    v_mfma_f32_16x16x32_bf16 v[104:107], v[156:159], a[216:219], v[104:107]
    buffer_load_dwordx4 v173, s[40:43], s55 offen offset:1024 lds
    v_mfma_f32_16x16x32_bf16 v[108:111], v[152:155], a[204:207], v[108:111]
    s_add_u32 m0, s66, 81920
    ds_read_b64_tr_b16 v[142:143], v163 offset:38912
    s_add_u32 s55, s14, 73984
    v_mfma_f32_16x16x32_bf16 v[108:111], v[156:159], a[220:223], v[108:111]
    s_waitcnt lgkmcnt(4)
    v_cvt_pk_bf16_f32 v43, v26, v27
    v_mul_f32 v44, v12, v44
    v_mfma_f32_16x16x32_bf16 v[80:83], v[128:131], a[192:195], v[80:83]
    ds_read_b64_tr_b16 v[144:145], v162 offset:40960
    v_mul_f32 v12, v12, v214
    v_mfma_f32_16x16x32_bf16 v[80:83], v[132:135], a[208:211], v[80:83]
    buffer_load_dwordx4 v172, s[40:43], s55 offen lds
    v_mfma_f32_16x16x32_bf16 v[84:87], v[128:131], a[196:199], v[84:87]
    ds_read_b64_tr_b16 v[146:147], v162 offset:43008
    v_mul_f32 v45, v13, v45
    v_mfma_f32_16x16x32_bf16 v[84:87], v[132:135], a[212:215], v[84:87]
    buffer_store_dwordx4 v[40:43], v175, s[24:27], s58 offen offset:2048 sc0 sc1
    v_mul_f32 v13, v13, v214
    v_mfma_f32_16x16x32_bf16 v[88:91], v[128:131], a[200:203], v[88:91]
    ds_read_b64_tr_b16 v[148:149], v162 offset:49152
    v_mul_f32 v46, v14, v46
    v_mfma_f32_16x16x32_bf16 v[88:91], v[132:135], a[216:219], v[88:91]
    buffer_load_dwordx4 v173, s[40:43], s55 offen offset:1024 lds
    v_mfma_f32_16x16x32_bf16 v[92:95], v[128:131], a[204:207], v[92:95]
    s_add_u32 s54, s62, 262144
    ds_read_b64_tr_b16 v[150:151], v162 offset:51200
    v_mul_f32 v14, v14, v214
    v_mfma_f32_16x16x32_bf16 v[92:95], v[132:135], a[220:223], v[92:95]
    s_waitcnt lgkmcnt(4)
    v_exp_f32 v12, v12
    v_mfma_f32_16x16x32_bf16 v[112:115], v[136:139], a[192:195], v[112:115]
    ds_read_b64_tr_b16 v[152:153], v162 offset:45056
    v_mul_f32 v47, v15, v47
    v_mfma_f32_16x16x32_bf16 v[112:115], v[140:143], a[208:211], v[112:115]
    buffer_load_dwordx4 a[80:83], v220, s[24:27], s54 offen offset:0 sc0 sc1
    v_mfma_f32_16x16x32_bf16 v[116:119], v[136:139], a[196:199], v[116:119]
    ds_read_b64_tr_b16 v[154:155], v162 offset:47104
    v_mul_f32 v15, v15, v214
    v_mfma_f32_16x16x32_bf16 v[116:119], v[140:143], a[212:215], v[116:119]
    v_exp_f32 v13, v13
    v_mfma_f32_16x16x32_bf16 v[120:123], v[136:139], a[200:203], v[120:123]
    ds_read_b64_tr_b16 v[156:157], v162 offset:53248
    v_mul_f32 v60, v28, v60
    v_mfma_f32_16x16x32_bf16 v[120:123], v[140:143], a[216:219], v[120:123]
    v_exp_f32 v14, v14
    v_mfma_f32_16x16x32_bf16 v[124:127], v[136:139], a[204:207], v[124:127]
    ds_read_b64_tr_b16 v[158:159], v162 offset:55296
    v_mul_f32 v28, v28, v214
    v_mfma_f32_16x16x32_bf16 v[124:127], v[140:143], a[220:223], v[124:127]
    s_waitcnt lgkmcnt(4)
    v_exp_f32 v15, v15
    v_mfma_f32_16x16x32_bf16 v[64:67], v[144:147], a[224:227], v[64:67]
    s_barrier
    s_add_u32 s49, s71, 49152
    v_mfma_f32_16x16x32_bf16 v[64:67], v[148:151], a[240:243], v[64:67]
    ds_read_b64_tr_b16 v[128:129], v163 offset:40960
    v_mul_f32 v61, v29, v61
    v_mfma_f32_16x16x32_bf16 v[68:71], v[144:147], a[228:231], v[68:71]
    ds_read_b64_tr_b16 v[130:131], v163 offset:43008
    v_mul_f32 v29, v29, v214
    v_mfma_f32_16x16x32_bf16 v[68:71], v[148:151], a[244:247], v[68:71]
    buffer_load_dwordx4 a[84:87], v220, s[24:27], s54 offen offset:1024 sc0 sc1
    v_mfma_f32_16x16x32_bf16 v[72:75], v[144:147], a[232:235], v[72:75]
    ds_read_b64_tr_b16 v[132:133], v163 offset:49152
    v_mul_f32 v62, v30, v62
    v_mfma_f32_16x16x32_bf16 v[72:75], v[148:151], a[248:251], v[72:75]
    buffer_load_dwordx4 a[88:91], v220, s[24:27], s54 offen offset:2048 sc0 sc1
    v_mfma_f32_16x16x32_bf16 v[76:79], v[144:147], a[236:239], v[76:79]
    ds_read_b64_tr_b16 v[134:135], v163 offset:51200
    v_mul_f32 v30, v30, v214
    v_mfma_f32_16x16x32_bf16 v[76:79], v[148:151], a[252:255], v[76:79]
    s_waitcnt lgkmcnt(4)
    buffer_load_dword v219, v217, s[24:27], s49 offen sc0 sc1
    v_mfma_f32_16x16x32_bf16 v[96:99], v[152:155], a[224:227], v[96:99]
    ds_read_b64_tr_b16 v[136:137], v163 offset:45056
    v_mul_f32 v63, v31, v63
    v_mfma_f32_16x16x32_bf16 v[96:99], v[156:159], a[240:243], v[96:99]
    buffer_load_dwordx4 a[92:95], v220, s[24:27], s54 offen offset:3072 sc0 sc1
    v_mfma_f32_16x16x32_bf16 v[100:103], v[152:155], a[228:231], v[100:103]
    ds_read_b64_tr_b16 v[138:139], v163 offset:47104
    v_mul_f32 v31, v31, v214
    v_mfma_f32_16x16x32_bf16 v[100:103], v[156:159], a[244:247], v[100:103]
    v_exp_f32 v28, v28
    v_mfma_f32_16x16x32_bf16 v[104:107], v[152:155], a[232:235], v[104:107]
    ds_read_b64_tr_b16 v[140:141], v163 offset:53248
    v_fma_f32 v12, v12, v215, v215
    v_mfma_f32_16x16x32_bf16 v[104:107], v[156:159], a[248:251], v[104:107]
    v_exp_f32 v29, v29
    v_mfma_f32_16x16x32_bf16 v[108:111], v[152:155], a[236:239], v[108:111]
    ds_read_b64_tr_b16 v[142:143], v163 offset:55296
    v_fma_f32 v13, v13, v215, v215
    v_mfma_f32_16x16x32_bf16 v[108:111], v[156:159], a[252:255], v[108:111]
    s_waitcnt lgkmcnt(4)
    v_exp_f32 v30, v30
    v_mfma_f32_16x16x32_bf16 v[80:83], v[128:131], a[224:227], v[80:83]
    ds_read_b64_tr_b16 v[144:145], v162 offset:57344
    v_fma_f32 v14, v14, v215, v215
    v_mfma_f32_16x16x32_bf16 v[80:83], v[132:135], a[240:243], v[80:83]
    v_exp_f32 v31, v31
    v_mfma_f32_16x16x32_bf16 v[84:87], v[128:131], a[228:231], v[84:87]
    ds_read_b64_tr_b16 v[146:147], v162 offset:59392
    v_fma_f32 v15, v15, v215, v215
    v_mfma_f32_16x16x32_bf16 v[84:87], v[132:135], a[244:247], v[84:87]
    v_rcp_f32 v12, v12
    v_mfma_f32_16x16x32_bf16 v[88:91], v[128:131], a[232:235], v[88:91]
    ds_read_b64_tr_b16 v[148:149], v162 offset:0
    v_fma_f32 v28, v28, v215, v215
    v_mfma_f32_16x16x32_bf16 v[88:91], v[132:135], a[248:251], v[88:91]
    v_rcp_f32 v13, v13
    v_mfma_f32_16x16x32_bf16 v[92:95], v[128:131], a[236:239], v[92:95]
    ds_read_b64_tr_b16 v[150:151], v162 offset:2048
    v_fma_f32 v29, v29, v215, v215
    v_mfma_f32_16x16x32_bf16 v[92:95], v[132:135], a[252:255], v[92:95]
    s_waitcnt lgkmcnt(4)
    v_rcp_f32 v14, v14
    v_mfma_f32_16x16x32_bf16 v[112:115], v[136:139], a[224:227], v[112:115]
    ds_read_b64_tr_b16 v[152:153], v162 offset:61440
    v_fma_f32 v30, v30, v215, v215
    v_mfma_f32_16x16x32_bf16 v[112:115], v[140:143], a[240:243], v[112:115]
    v_rcp_f32 v15, v15
    v_mfma_f32_16x16x32_bf16 v[116:119], v[136:139], a[228:231], v[116:119]
    ds_read_b64_tr_b16 v[154:155], v162 offset:63488
    v_fma_f32 v31, v31, v215, v215
    v_mfma_f32_16x16x32_bf16 v[116:119], v[140:143], a[244:247], v[116:119]
    v_rcp_f32 v28, v28
    v_mfma_f32_16x16x32_bf16 v[120:123], v[136:139], a[232:235], v[120:123]
    ds_read_b64_tr_b16 v[156:157], v162 offset:4096
    v_mul_f32 v12, v12, v44
    v_mfma_f32_16x16x32_bf16 v[120:123], v[140:143], a[248:251], v[120:123]
    v_rcp_f32 v29, v29
    v_mfma_f32_16x16x32_bf16 v[124:127], v[136:139], a[236:239], v[124:127]
    ds_read_b64_tr_b16 v[158:159], v162 offset:6144
    v_mul_f32 v13, v13, v45
    v_mfma_f32_16x16x32_bf16 v[124:127], v[140:143], a[252:255], v[124:127]
    s_waitcnt lgkmcnt(4)
    v_rcp_f32 v30, v30
    v_mfma_f32_16x16x32_bf16 v[64:67], v[144:147], v[224:227], v[64:67]
    s_waitcnt vmcnt(35)
    s_barrier
    s_add_u32 m0, s66, 106496
    v_mfma_f32_16x16x32_bf16 v[64:67], v[148:151], v[240:243], v[64:67]
    s_add_u32 s55, s15, 73728
    ds_read_b64_tr_b16 v[128:129], v163 offset:57344
    s_add_u32 s55, s55, s74
    v_mfma_f32_16x16x32_bf16 v[68:71], v[144:147], v[228:231], v[68:71]
    ds_read_b64_tr_b16 v[130:131], v163 offset:59392
    v_mul_f32 v14, v14, v46
    v_mfma_f32_16x16x32_bf16 v[68:71], v[148:151], v[244:247], v[68:71]
    buffer_load_dwordx4 v172, s[40:43], s55 offen lds
    v_mfma_f32_16x16x32_bf16 v[72:75], v[144:147], v[232:235], v[72:75]
    ds_read_b64_tr_b16 v[132:133], v163 offset:0
    v_mul_f32 v15, v15, v47
    v_mfma_f32_16x16x32_bf16 v[72:75], v[148:151], v[248:251], v[72:75]
    buffer_load_dwordx4 v173, s[40:43], s55 offen offset:1024 lds
    v_mfma_f32_16x16x32_bf16 v[76:79], v[144:147], v[236:239], v[76:79]
    s_add_u32 m0, s66, 131072
    ds_read_b64_tr_b16 v[134:135], v163 offset:2048
    s_add_u32 s55, s3, 73728
    v_mfma_f32_16x16x32_bf16 v[76:79], v[148:151], v[252:255], v[76:79]
    s_waitcnt lgkmcnt(4)
    s_add_u32 s55, s55, s74
    v_mul_f32 v28, v28, v60
    v_mfma_f32_16x16x32_bf16 v[96:99], v[152:155], v[224:227], v[96:99]
    ds_read_b64_tr_b16 v[136:137], v163 offset:61440
    v_mul_f32 v29, v29, v61
    v_mfma_f32_16x16x32_bf16 v[96:99], v[156:159], v[240:243], v[96:99]
    buffer_load_dwordx4 v172, s[40:43], s55 offen lds
    v_mfma_f32_16x16x32_bf16 v[100:103], v[152:155], v[228:231], v[100:103]
    ds_read_b64_tr_b16 v[138:139], v163 offset:63488
    v_mul_f32 v30, v30, v62
    v_mfma_f32_16x16x32_bf16 v[100:103], v[156:159], v[244:247], v[100:103]
    v_rcp_f32 v31, v31
    v_mfma_f32_16x16x32_bf16 v[104:107], v[152:155], v[232:235], v[104:107]
    ds_read_b64_tr_b16 v[140:141], v163 offset:4096
    v_mul_f32 v31, v31, v63
    v_mfma_f32_16x16x32_bf16 v[104:107], v[156:159], v[248:251], v[104:107]
    buffer_load_dwordx4 v173, s[40:43], s55 offen offset:1024 lds
    v_mfma_f32_16x16x32_bf16 v[108:111], v[152:155], v[236:239], v[108:111]
    s_add_u32 m0, s66, 155648
    ds_read_b64_tr_b16 v[142:143], v163 offset:6144
    s_add_u32 s55, s15, 73856
    v_mfma_f32_16x16x32_bf16 v[108:111], v[156:159], v[252:255], v[108:111]
    s_waitcnt lgkmcnt(4)
    s_sub_u32 s55, s55, s74
    v_cvt_pk_bf16_f32 v44, v12, v13
    v_mfma_f32_16x16x32_bf16 v[80:83], v[128:131], v[224:227], v[80:83]
    v_xor_b32 v160, s56, v160
    v_cvt_pk_bf16_f32 v45, v14, v15
    v_mfma_f32_16x16x32_bf16 v[80:83], v[132:135], v[240:243], v[80:83]
    ds_read_b64_tr_b16 v[144:145], v160 offset:8192
    v_cvt_pk_bf16_f32 v46, v28, v29
    v_mfma_f32_16x16x32_bf16 v[84:87], v[128:131], v[228:231], v[84:87]
    ds_read_b64_tr_b16 v[146:147], v160 offset:10240
    v_cvt_pk_bf16_f32 v47, v30, v31
    v_mfma_f32_16x16x32_bf16 v[84:87], v[132:135], v[244:247], v[84:87]
    buffer_load_dwordx4 v172, s[40:43], s55 offen lds
    v_mfma_f32_16x16x32_bf16 v[88:91], v[128:131], v[232:235], v[88:91]
    v_xor_b32 v164, s56, v164
    v_mfma_f32_16x16x32_bf16 v[88:91], v[132:135], v[248:251], v[88:91]
    ds_read_b64_tr_b16 v[148:149], v164 offset:49152
    v_mfma_f32_16x16x32_bf16 v[92:95], v[128:131], v[236:239], v[92:95]
    ds_read_b64_tr_b16 v[150:151], v164 offset:51200
    v_mfma_f32_16x16x32_bf16 v[92:95], v[132:135], v[252:255], v[92:95]
    s_waitcnt lgkmcnt(4)
    buffer_load_dwordx4 v173, s[40:43], s55 offen offset:1024 lds
    v_mfma_f32_16x16x32_bf16 v[112:115], v[136:139], v[224:227], v[112:115]
    s_add_u32 m0, s66, 32768
    v_xor_b32 v161, s56, v161
    s_add_u32 s55, s3, 73856
    v_mfma_f32_16x16x32_bf16 v[112:115], v[140:143], v[240:243], v[112:115]
    s_sub_u32 s55, s55, s74
    ds_read_b64_tr_b16 v[152:153], v161 offset:8192
    v_mfma_f32_16x16x32_bf16 v[116:119], v[136:139], v[228:231], v[116:119]
    ds_read_b64_tr_b16 v[154:155], v161 offset:10240
    v_mfma_f32_16x16x32_bf16 v[116:119], v[140:143], v[244:247], v[116:119]
    buffer_load_dwordx4 v172, s[40:43], s55 offen lds
    v_mfma_f32_16x16x32_bf16 v[120:123], v[136:139], v[232:235], v[120:123]
    v_xor_b32 v165, s56, v165
    v_mfma_f32_16x16x32_bf16 v[120:123], v[140:143], v[248:251], v[120:123]
    ds_read_b64_tr_b16 v[156:157], v165 offset:49152
    v_mfma_f32_16x16x32_bf16 v[124:127], v[136:139], v[236:239], v[124:127]
    ds_read_b64_tr_b16 v[158:159], v165 offset:51200
    v_mfma_f32_16x16x32_bf16 v[124:127], v[140:143], v[252:255], v[124:127]
    s_waitcnt lgkmcnt(4)
    buffer_store_dwordx4 v[44:47], v175, s[24:27], s58 offen offset:3072 sc0 sc1
    v_mfma_f32_16x16x16_bf16 v[64:67], v[192:193], v[200:201], v[64:67]
    v_xor_b32 v162, s56, v162
    v_mfma_f32_16x16x16_bf16 v[68:71], v[192:193], v[204:205], v[68:71]
    ds_read_b64_tr_b16 v[128:129], v162 offset:8192
    v_mfma_f32_16x16x16_bf16 v[72:75], v[192:193], v[208:209], v[72:75]
    ds_read_b64_tr_b16 v[130:131], v162 offset:10240
    v_mfma_f32_16x16x16_bf16 v[76:79], v[192:193], v[212:213], v[76:79]
    buffer_load_dwordx4 v173, s[40:43], s55 offen offset:1024 lds
    v_mfma_f32_16x16x16_bf16 v[80:83], v[194:195], v[200:201], v[80:83]
    s_add_u32 m0, s66, 40960
    s_add_u32 s55, s15, 73984
    v_mfma_f32_16x16x16_bf16 v[84:87], v[194:195], v[204:205], v[84:87]
    buffer_load_dwordx4 v172, s[40:43], s55 offen lds
    v_mfma_f32_16x16x16_bf16 v[88:91], v[194:195], v[208:209], v[88:91]
    v_mfma_f32_16x16x16_bf16 v[92:95], v[194:195], v[212:213], v[92:95]
    v_mfma_f32_16x16x16_bf16 v[96:99], v[196:197], v[200:201], v[96:99]
    buffer_load_dwordx4 v173, s[40:43], s55 offen offset:1024 lds
    v_mfma_f32_16x16x16_bf16 v[100:103], v[196:197], v[204:205], v[100:103]
    s_add_u32 m0, s66, 49152
    s_add_u32 s55, s3, 73984
    v_mfma_f32_16x16x16_bf16 v[104:107], v[196:197], v[208:209], v[104:107]
    v_mfma_f32_16x16x16_bf16 v[108:111], v[196:197], v[212:213], v[108:111]
    v_mfma_f32_16x16x16_bf16 v[112:115], v[198:199], v[200:201], v[112:115]
    buffer_load_dwordx4 v172, s[40:43], s55 offen lds
    v_mfma_f32_16x16x16_bf16 v[116:119], v[198:199], v[204:205], v[116:119]
    v_mfma_f32_16x16x16_bf16 v[120:123], v[198:199], v[208:209], v[120:123]
    v_mfma_f32_16x16x16_bf16 v[124:127], v[198:199], v[212:213], v[124:127]
    v_mfma_f32_16x16x32_bf16 v[0:3], v[144:147], a[0:3], 0
    buffer_load_dwordx4 v173, s[40:43], s55 offen offset:1024 lds
    v_mfma_f32_16x16x32_bf16 v[0:3], v[148:151], a[16:19], v[0:3]
    v_mfma_f32_16x16x32_bf16 v[4:7], v[144:147], a[4:7], 0
    v_mfma_f32_16x16x32_bf16 v[4:7], v[148:151], a[20:23], v[4:7]
    v_mfma_f32_16x16x32_bf16 v[8:11], v[144:147], a[8:11], 0
    v_xor_b32 v166, s56, v166
    v_mfma_f32_16x16x32_bf16 v[8:11], v[148:151], a[24:27], v[8:11]
    ds_read_b64_tr_b16 v[132:133], v166 offset:49152
    v_mfma_f32_16x16x32_bf16 v[12:15], v[144:147], a[12:15], 0
    ds_read_b64_tr_b16 v[134:135], v166 offset:51200
    v_mfma_f32_16x16x32_bf16 v[12:15], v[148:151], a[28:31], v[12:15]
    s_waitcnt lgkmcnt(4)
    v_mfma_f32_16x16x32_bf16 a[160:163], v[152:155], a[0:3], 0
    s_add_u32 s58, s57, 655360
    v_xor_b32 v163, s56, v163
    v_mul_f32 v96, v64, v96
    v_mfma_f32_16x16x32_bf16 a[160:163], v[156:159], a[16:19], a[160:163]
    ds_read_b64_tr_b16 v[136:137], v163 offset:8192
    v_mul_f32 v64, v64, v202
    v_mfma_f32_16x16x32_bf16 a[164:167], v[152:155], a[4:7], 0
    ds_read_b64_tr_b16 v[138:139], v163 offset:10240
    v_mul_f32 v97, v65, v97
    v_mul_f32 v65, v65, v202
    v_mfma_f32_16x16x32_bf16 a[164:167], v[156:159], a[20:23], a[164:167]
    v_exp_f32 v64, v64
    v_mfma_f32_16x16x32_bf16 a[168:171], v[152:155], a[8:11], 0
    v_xor_b32 v167, s56, v167
    v_mul_f32 v98, v66, v98
    v_mul_f32 v66, v66, v202
    v_mfma_f32_16x16x32_bf16 a[168:171], v[156:159], a[24:27], a[168:171]
    ds_read_b64_tr_b16 v[140:141], v167 offset:49152
    v_mul_f32 v99, v67, v99
    v_mfma_f32_16x16x32_bf16 a[172:175], v[152:155], a[12:15], 0
    ds_read_b64_tr_b16 v[142:143], v167 offset:51200
    v_mul_f32 v67, v67, v202
    v_mul_f32 v112, v80, v112
    v_mfma_f32_16x16x32_bf16 a[172:175], v[156:159], a[28:31], a[172:175]
    s_waitcnt lgkmcnt(4)
    v_exp_f32 v65, v65
    v_mfma_f32_16x16x32_bf16 v[16:19], v[128:131], a[0:3], 0
    v_xor_b32 v168, s56, v168
    v_mul_f32 v80, v80, v202
    v_mul_f32 v113, v81, v113
    v_mfma_f32_16x16x32_bf16 v[16:19], v[132:135], a[16:19], v[16:19]
    ds_read_b64_tr_b16 v[144:145], v168 offset:8192
    v_mul_f32 v81, v81, v202
    v_mfma_f32_16x16x32_bf16 v[20:23], v[128:131], a[4:7], 0
    ds_read_b64_tr_b16 v[146:147], v168 offset:10240
    v_mul_f32 v114, v82, v114
    v_mul_f32 v82, v82, v202
    v_mfma_f32_16x16x32_bf16 v[20:23], v[132:135], a[20:23], v[20:23]
    v_exp_f32 v66, v66
    v_mfma_f32_16x16x32_bf16 v[24:27], v[128:131], a[8:11], 0
    ds_read_b64_tr_b16 v[148:149], v160 offset:16384
    v_mul_f32 v115, v83, v115
    v_mul_f32 v83, v83, v202
    v_mfma_f32_16x16x32_bf16 v[24:27], v[132:135], a[24:27], v[24:27]
    v_exp_f32 v67, v67
    v_mfma_f32_16x16x32_bf16 v[28:31], v[128:131], a[12:15], 0
    ds_read_b64_tr_b16 v[150:151], v160 offset:18432
    v_fma_f32 v64, v64, v203, v203
    v_mfma_f32_16x16x32_bf16 v[28:31], v[132:135], a[28:31], v[28:31]
    s_waitcnt lgkmcnt(4)
    v_exp_f32 v80, v80
    v_mfma_f32_16x16x32_bf16 a[176:179], v[136:139], a[0:3], 0
    v_xor_b32 v169, s56, v169
    v_fma_f32 v65, v65, v203, v203
    v_exp_f32 v81, v81
    v_mfma_f32_16x16x32_bf16 a[176:179], v[140:143], a[16:19], a[176:179]
    ds_read_b64_tr_b16 v[152:153], v169 offset:8192
    v_fma_f32 v66, v66, v203, v203
    v_mfma_f32_16x16x32_bf16 a[180:183], v[136:139], a[4:7], 0
    ds_read_b64_tr_b16 v[154:155], v169 offset:10240
    v_fma_f32 v67, v67, v203, v203
    v_mfma_f32_16x16x32_bf16 a[180:183], v[140:143], a[20:23], a[180:183]
    v_exp_f32 v82, v82
    v_mfma_f32_16x16x32_bf16 a[184:187], v[136:139], a[8:11], 0
    s_waitcnt vmcnt(5)
    s_barrier
    s_add_u32 m0, s66, 57344
    v_exp_f32 v83, v83
    v_mfma_f32_16x16x32_bf16 a[184:187], v[140:143], a[24:27], a[184:187]
    s_add_u32 s55, s14, 110592
    ds_read_b64_tr_b16 v[156:157], v161 offset:16384
    s_add_u32 s55, s55, s74
    v_fma_f32 v80, v80, v203, v203
    v_mfma_f32_16x16x32_bf16 a[188:191], v[136:139], a[12:15], 0
    s_add_u32 s49, s69, 57344
    ds_read_b64_tr_b16 v[158:159], v161 offset:18432
    v_fma_f32 v81, v81, v203, v203
    v_fma_f32 v82, v82, v203, v203
    v_mfma_f32_16x16x32_bf16 a[188:191], v[140:143], a[28:31], a[188:191]
    s_waitcnt lgkmcnt(4)
    buffer_load_dwordx4 v172, s[40:43], s55 offen lds
    v_fma_f32 v83, v83, v203, v203
    v_mfma_f32_16x16x32_bf16 v[32:35], v[144:147], a[0:3], 0
    v_xor_b32 v170, s56, v170
    v_mul_f32 v100, v68, v100
    v_rcp_f32 v64, v64
    v_mfma_f32_16x16x32_bf16 v[32:35], v[148:151], a[16:19], v[32:35]
    ds_read_b64_tr_b16 v[128:129], v170 offset:8192
    v_mul_f32 v64, v64, v96
    v_mfma_f32_16x16x32_bf16 v[36:39], v[144:147], a[4:7], 0
    ds_read_b64_tr_b16 v[130:131], v170 offset:10240
    v_mul_f32 v68, v68, v206
    v_mfma_f32_16x16x32_bf16 v[36:39], v[148:151], a[20:23], v[36:39]
    buffer_load_dwordx4 v173, s[40:43], s55 offen offset:1024 lds
    v_mfma_f32_16x16x32_bf16 v[40:43], v[144:147], a[8:11], 0
    s_add_u32 m0, s66, 0
    ds_read_b64_tr_b16 v[132:133], v162 offset:16384
    s_add_u32 s55, s15, 110592
    v_rcp_f32 v65, v65
    v_mfma_f32_16x16x32_bf16 v[40:43], v[148:151], a[24:27], v[40:43]
    buffer_store_dword v218, v216, s[24:27], s49 offen sc0 sc1
    v_rcp_f32 v66, v66
    v_mfma_f32_16x16x32_bf16 v[44:47], v[144:147], a[12:15], 0
    s_add_u32 s55, s55, s74
    ds_read_b64_tr_b16 v[134:135], v162 offset:18432
    v_mul_f32 v65, v65, v97
    v_mfma_f32_16x16x32_bf16 v[44:47], v[148:151], a[28:31], v[44:47]
    s_waitcnt lgkmcnt(4)
    buffer_load_dwordx4 v172, s[40:43], s55 offen lds
    v_mfma_f32_16x16x32_bf16 a[192:195], v[152:155], a[0:3], 0
    v_xor_b32 v171, s56, v171
    v_mul_f32 v66, v66, v98
    v_rcp_f32 v67, v67
    v_mfma_f32_16x16x32_bf16 a[192:195], v[156:159], a[16:19], a[192:195]
    ds_read_b64_tr_b16 v[136:137], v171 offset:8192
    v_mul_f32 v67, v67, v99
    v_mfma_f32_16x16x32_bf16 a[196:199], v[152:155], a[4:7], 0
    ds_read_b64_tr_b16 v[138:139], v171 offset:10240
    v_cvt_pk_bf16_f32 v96, v64, v65
    v_mfma_f32_16x16x32_bf16 a[196:199], v[156:159], a[20:23], a[196:199]
    buffer_load_dwordx4 v173, s[40:43], s55 offen offset:1024 lds
    v_mfma_f32_16x16x32_bf16 a[200:203], v[152:155], a[8:11], 0
    ds_read_b64_tr_b16 v[140:141], v163 offset:16384
    v_cvt_pk_bf16_f32 v97, v66, v67
    v_rcp_f32 v80, v80
    v_mfma_f32_16x16x32_bf16 a[200:203], v[156:159], a[24:27], a[200:203]
    v_cmp_eq_u32 vcc, s79, v219
    v_mul_f32 v80, v80, v112
    v_mfma_f32_16x16x32_bf16 a[204:207], v[152:155], a[12:15], 0
    ds_read_b64_tr_b16 v[142:143], v163 offset:18432
    v_mul_f32 v101, v69, v101
    v_mfma_f32_16x16x32_bf16 a[204:207], v[156:159], a[28:31], a[204:207]
    s_waitcnt lgkmcnt(4)
    s_andn2_b32 s61, 7, vcc_lo
    s_cbranch_scc1 Lslow_14
Lback_15:
    v_mfma_f32_16x16x32_bf16 v[48:51], v[128:131], a[0:3], 0
    s_add_u32 s54, s12, 393216
    ds_read_b64_tr_b16 v[144:145], v164 offset:0
    v_mul_f32 v69, v69, v206
    v_rcp_f32 v81, v81
    v_mfma_f32_16x16x32_bf16 v[48:51], v[132:135], a[16:19], v[48:51]
    buffer_load_dwordx4 a[96:99], v220, s[24:27], s54 offen offset:0 sc0 sc1
    v_mfma_f32_16x16x32_bf16 v[52:55], v[128:131], a[4:7], 0
    ds_read_b64_tr_b16 v[146:147], v164 offset:2048
    v_mul_f32 v81, v81, v113
    v_mfma_f32_16x16x32_bf16 v[52:55], v[132:135], a[20:23], v[52:55]
    buffer_load_dwordx4 a[100:103], v220, s[24:27], s54 offen offset:1024 sc0 sc1
    v_rcp_f32 v82, v82
    v_mfma_f32_16x16x32_bf16 v[56:59], v[128:131], a[8:11], 0
    ds_read_b64_tr_b16 v[148:149], v164 offset:24576
    v_mul_f32 v82, v82, v114
    v_rcp_f32 v83, v83
    v_mfma_f32_16x16x32_bf16 v[56:59], v[132:135], a[24:27], v[56:59]
    v_exp_f32 v68, v68
    v_mfma_f32_16x16x32_bf16 v[60:63], v[128:131], a[12:15], 0
    ds_read_b64_tr_b16 v[150:151], v164 offset:26624
    v_mul_f32 v83, v83, v115
    v_mfma_f32_16x16x32_bf16 v[60:63], v[132:135], a[28:31], v[60:63]
    s_waitcnt lgkmcnt(4)
    v_exp_f32 v69, v69
    v_mfma_f32_16x16x32_bf16 a[208:211], v[136:139], a[0:3], 0
    ds_read_b64_tr_b16 v[152:153], v165 offset:0
    v_cvt_pk_bf16_f32 v98, v80, v81
    v_cvt_pk_bf16_f32 v99, v82, v83
    v_mfma_f32_16x16x32_bf16 a[208:211], v[140:143], a[16:19], a[208:211]
    buffer_load_dwordx4 a[104:107], v220, s[24:27], s54 offen offset:2048 sc0 sc1
    v_mul_f32 v102, v70, v102
    v_mfma_f32_16x16x32_bf16 a[212:215], v[136:139], a[4:7], 0
    ds_read_b64_tr_b16 v[154:155], v165 offset:2048
    v_mul_f32 v70, v70, v206
    v_mfma_f32_16x16x32_bf16 a[212:215], v[140:143], a[20:23], a[212:215]
    buffer_store_dwordx4 v[96:99], v175, s[24:27], s58 offen offset:0 sc0 sc1
    v_mul_f32 v103, v71, v103
    v_mfma_f32_16x16x32_bf16 a[216:219], v[136:139], a[8:11], 0
    ds_read_b64_tr_b16 v[156:157], v165 offset:24576
    v_mul_f32 v71, v71, v206
    v_mul_f32 v116, v84, v116
    v_mfma_f32_16x16x32_bf16 a[216:219], v[140:143], a[24:27], a[216:219]
    buffer_load_dwordx4 a[108:111], v220, s[24:27], s54 offen offset:3072 sc0 sc1
    v_mul_f32 v84, v84, v206
    v_mfma_f32_16x16x32_bf16 a[220:223], v[136:139], a[12:15], 0
    s_add_u32 s54, s13, 393216
    ds_read_b64_tr_b16 v[158:159], v165 offset:26624
    v_mul_f32 v117, v85, v117
    v_mfma_f32_16x16x32_bf16 a[220:223], v[140:143], a[28:31], a[220:223]
    s_waitcnt lgkmcnt(4)
    v_exp_f32 v70, v70
    v_mfma_f32_16x16x32_bf16 v[224:227], v[144:147], a[0:3], 0
    ds_read_b64_tr_b16 v[128:129], v166 offset:0
    v_mul_f32 v85, v85, v206
    v_mul_f32 v118, v86, v118
    v_mfma_f32_16x16x32_bf16 v[224:227], v[148:151], a[16:19], v[224:227]
    buffer_load_dwordx4 a[112:115], v220, s[24:27], s54 offen offset:0 sc0 sc1
    v_mul_f32 v86, v86, v206
    v_mfma_f32_16x16x32_bf16 v[228:231], v[144:147], a[4:7], 0
    ds_read_b64_tr_b16 v[130:131], v166 offset:2048
    v_mul_f32 v119, v87, v119
    v_mfma_f32_16x16x32_bf16 v[228:231], v[148:151], a[20:23], v[228:231]
    v_exp_f32 v71, v71
    v_mfma_f32_16x16x32_bf16 v[232:235], v[144:147], a[8:11], 0
    ds_read_b64_tr_b16 v[132:133], v166 offset:24576
    v_mul_f32 v87, v87, v206
    v_exp_f32 v84, v84
    v_mfma_f32_16x16x32_bf16 v[232:235], v[148:151], a[24:27], v[232:235]
    buffer_load_dwordx4 a[116:119], v220, s[24:27], s54 offen offset:1024 sc0 sc1
    v_mfma_f32_16x16x32_bf16 v[236:239], v[144:147], a[12:15], 0
    ds_read_b64_tr_b16 v[134:135], v166 offset:26624
    v_fma_f32 v68, v68, v207, v207
    v_mfma_f32_16x16x32_bf16 v[236:239], v[148:151], a[28:31], v[236:239]
    s_waitcnt lgkmcnt(4)
    v_exp_f32 v85, v85
    v_mfma_f32_16x16x32_bf16 a[224:227], v[152:155], a[0:3], 0
    ds_read_b64_tr_b16 v[136:137], v167 offset:0
    v_fma_f32 v69, v69, v207, v207
    v_exp_f32 v86, v86
    v_mfma_f32_16x16x32_bf16 a[224:227], v[156:159], a[16:19], a[224:227]
    buffer_load_dwordx4 a[120:123], v220, s[24:27], s54 offen offset:2048 sc0 sc1
    v_mfma_f32_16x16x32_bf16 a[228:231], v[152:155], a[4:7], 0
    ds_read_b64_tr_b16 v[138:139], v167 offset:2048
    v_fma_f32 v70, v70, v207, v207
    v_mfma_f32_16x16x32_bf16 a[228:231], v[156:159], a[20:23], a[228:231]
    v_exp_f32 v87, v87
    v_mfma_f32_16x16x32_bf16 a[232:235], v[152:155], a[8:11], 0
    s_barrier
    v_fma_f32 v71, v71, v207, v207
    v_fma_f32 v84, v84, v207, v207
    v_mfma_f32_16x16x32_bf16 a[232:235], v[156:159], a[24:27], a[232:235]
    ds_read_b64_tr_b16 v[140:141], v167 offset:24576
    v_fma_f32 v85, v85, v207, v207
    v_mfma_f32_16x16x32_bf16 a[236:239], v[152:155], a[12:15], 0
    ds_read_b64_tr_b16 v[142:143], v167 offset:26624
    v_fma_f32 v86, v86, v207, v207
    v_mfma_f32_16x16x32_bf16 a[236:239], v[156:159], a[28:31], a[236:239]
    s_waitcnt lgkmcnt(4)
    v_rcp_f32 v68, v68
    v_mfma_f32_16x16x32_bf16 v[240:243], v[128:131], a[0:3], 0
    ds_read_b64_tr_b16 v[144:145], v160 offset:24576
    v_fma_f32 v87, v87, v207, v207
    v_rcp_f32 v69, v69
    v_mfma_f32_16x16x32_bf16 v[240:243], v[132:135], a[16:19], v[240:243]
    buffer_load_dwordx4 a[124:127], v220, s[24:27], s54 offen offset:3072 sc0 sc1
    v_mfma_f32_16x16x32_bf16 v[244:247], v[128:131], a[4:7], 0
    s_add_u32 m0, s66, 8192
    ds_read_b64_tr_b16 v[146:147], v160 offset:26624
    s_add_u32 s55, s14, 110720
    v_rcp_f32 v70, v70
    v_mfma_f32_16x16x32_bf16 v[244:247], v[132:135], a[20:23], v[244:247]
    s_sub_u32 s55, s55, s74
    v_rcp_f32 v71, v71
    v_mfma_f32_16x16x32_bf16 v[248:251], v[128:131], a[8:11], 0
    ds_read_b64_tr_b16 v[148:149], v164 offset:8192
    v_mul_f32 v68, v68, v100
    v_rcp_f32 v84, v84
    v_mfma_f32_16x16x32_bf16 v[248:251], v[132:135], a[24:27], v[248:251]
    buffer_load_dwordx4 v172, s[40:43], s55 offen lds
    v_mfma_f32_16x16x32_bf16 v[252:255], v[128:131], a[12:15], 0
    ds_read_b64_tr_b16 v[150:151], v164 offset:10240
    v_mul_f32 v69, v69, v101
    v_mfma_f32_16x16x32_bf16 v[252:255], v[132:135], a[28:31], v[252:255]
    s_waitcnt lgkmcnt(4)
    v_rcp_f32 v85, v85
    v_mfma_f32_16x16x32_bf16 a[240:243], v[136:139], a[0:3], 0
    ds_read_b64_tr_b16 v[152:153], v161 offset:24576
    v_mul_f32 v70, v70, v102
    v_rcp_f32 v86, v86
    v_mfma_f32_16x16x32_bf16 a[240:243], v[140:143], a[16:19], a[240:243]
    buffer_load_dwordx4 v173, s[40:43], s55 offen offset:1024 lds
    v_mfma_f32_16x16x32_bf16 a[244:247], v[136:139], a[4:7], 0
    s_add_u32 m0, s66, 114688
    ds_read_b64_tr_b16 v[154:155], v161 offset:26624
    s_add_u32 s55, s15, 110720
    v_rcp_f32 v87, v87
    v_mfma_f32_16x16x32_bf16 a[244:247], v[140:143], a[20:23], a[244:247]
    s_sub_u32 s55, s55, s74
    v_mul_f32 v71, v71, v103
    v_mul_f32 v84, v84, v116
    v_mfma_f32_16x16x32_bf16 a[248:251], v[136:139], a[8:11], 0
    ds_read_b64_tr_b16 v[156:157], v165 offset:8192
    v_mul_f32 v85, v85, v117
    v_mul_f32 v86, v86, v118
    v_mfma_f32_16x16x32_bf16 a[248:251], v[140:143], a[24:27], a[248:251]
    buffer_load_dwordx4 v172, s[40:43], s55 offen lds
    v_mul_f32 v87, v87, v119
    v_mfma_f32_16x16x32_bf16 a[252:255], v[136:139], a[12:15], 0
    ds_read_b64_tr_b16 v[158:159], v165 offset:10240
    v_cvt_pk_bf16_f32 v100, v68, v69
    v_mfma_f32_16x16x32_bf16 a[252:255], v[140:143], a[28:31], a[252:255]
    s_waitcnt lgkmcnt(4)
    v_cvt_pk_bf16_f32 v101, v70, v71
    v_cvt_pk_bf16_f32 v102, v84, v85
    v_mfma_f32_16x16x32_bf16 v[0:3], v[144:147], a[32:35], v[0:3]
    ds_read_b64_tr_b16 v[128:129], v162 offset:24576
    v_cvt_pk_bf16_f32 v103, v86, v87
    v_mfma_f32_16x16x32_bf16 v[0:3], v[148:151], a[48:51], v[0:3]
    buffer_load_dwordx4 v173, s[40:43], s55 offen offset:1024 lds
    v_mul_f32 v104, v72, v104
    v_mfma_f32_16x16x32_bf16 v[4:7], v[144:147], a[36:39], v[4:7]
    s_add_u32 m0, s66, 139264
    ds_read_b64_tr_b16 v[130:131], v162 offset:26624
    s_add_u32 s55, s14, 110848
    v_mul_f32 v72, v72, v210
    v_mfma_f32_16x16x32_bf16 v[4:7], v[148:151], a[52:55], v[4:7]
    buffer_store_dwordx4 v[100:103], v175, s[24:27], s58 offen offset:1024 sc0 sc1
    v_mul_f32 v105, v73, v105
    v_mfma_f32_16x16x32_bf16 v[8:11], v[144:147], a[40:43], v[8:11]
    ds_read_b64_tr_b16 v[132:133], v166 offset:8192
    v_mul_f32 v73, v73, v210
    v_mfma_f32_16x16x32_bf16 v[8:11], v[148:151], a[56:59], v[8:11]
    buffer_load_dwordx4 v172, s[40:43], s55 offen lds
    v_mfma_f32_16x16x32_bf16 v[12:15], v[144:147], a[44:47], v[12:15]
    ds_read_b64_tr_b16 v[134:135], v166 offset:10240
    v_mul_f32 v106, v74, v106
    v_mfma_f32_16x16x32_bf16 v[12:15], v[148:151], a[60:63], v[12:15]
    s_waitcnt lgkmcnt(4)
    v_exp_f32 v72, v72
    v_mfma_f32_16x16x32_bf16 a[160:163], v[152:155], a[32:35], a[160:163]
    ds_read_b64_tr_b16 v[136:137], v163 offset:24576
    v_mul_f32 v74, v74, v210
    v_mfma_f32_16x16x32_bf16 a[160:163], v[156:159], a[48:51], a[160:163]
    v_exp_f32 v73, v73
    v_mfma_f32_16x16x32_bf16 a[164:167], v[152:155], a[36:39], a[164:167]
    ds_read_b64_tr_b16 v[138:139], v163 offset:26624
    v_mul_f32 v107, v75, v107
    v_mfma_f32_16x16x32_bf16 a[164:167], v[156:159], a[52:55], a[164:167]
    v_exp_f32 v74, v74
    v_mfma_f32_16x16x32_bf16 a[168:171], v[152:155], a[40:43], a[168:171]
    ds_read_b64_tr_b16 v[140:141], v167 offset:8192
    v_mul_f32 v75, v75, v210
    v_mfma_f32_16x16x32_bf16 a[168:171], v[156:159], a[56:59], a[168:171]
    buffer_load_dwordx4 v173, s[40:43], s55 offen offset:1024 lds
    v_mfma_f32_16x16x32_bf16 a[172:175], v[152:155], a[44:47], a[172:175]
    s_add_u32 m0, s66, 16384
    ds_read_b64_tr_b16 v[142:143], v167 offset:10240
    s_add_u32 s55, s15, 110848
    v_mfma_f32_16x16x32_bf16 a[172:175], v[156:159], a[60:63], a[172:175]
    s_waitcnt lgkmcnt(4)
    v_exp_f32 v75, v75
    v_mfma_f32_16x16x32_bf16 v[16:19], v[128:131], a[32:35], v[16:19]
    ds_read_b64_tr_b16 v[144:145], v164 offset:32768
    v_mul_f32 v120, v88, v120
    v_mfma_f32_16x16x32_bf16 v[16:19], v[132:135], a[48:51], v[16:19]
    buffer_load_dwordx4 v172, s[40:43], s55 offen lds
    v_mul_f32 v88, v88, v210
    v_mfma_f32_16x16x32_bf16 v[20:23], v[128:131], a[36:39], v[20:23]
    ds_read_b64_tr_b16 v[146:147], v164 offset:34816
    v_mul_f32 v121, v89, v121
    v_mfma_f32_16x16x32_bf16 v[20:23], v[132:135], a[52:55], v[20:23]
    v_exp_f32 v88, v88
    v_mfma_f32_16x16x32_bf16 v[24:27], v[128:131], a[40:43], v[24:27]
    ds_read_b64_tr_b16 v[148:149], v164 offset:57344
    v_mul_f32 v89, v89, v210
    v_mfma_f32_16x16x32_bf16 v[24:27], v[132:135], a[56:59], v[24:27]
    buffer_load_dwordx4 v173, s[40:43], s55 offen offset:1024 lds
    v_mfma_f32_16x16x32_bf16 v[28:31], v[128:131], a[44:47], v[28:31]
    s_add_u32 s54, s62, 393216
    ds_read_b64_tr_b16 v[150:151], v164 offset:59392
    v_mul_f32 v122, v90, v122
    v_mfma_f32_16x16x32_bf16 v[28:31], v[132:135], a[60:63], v[28:31]
    s_waitcnt lgkmcnt(4)
    v_exp_f32 v89, v89
    v_mfma_f32_16x16x32_bf16 a[176:179], v[136:139], a[32:35], a[176:179]
    ds_read_b64_tr_b16 v[152:153], v165 offset:32768
    v_mul_f32 v90, v90, v210
    v_mfma_f32_16x16x32_bf16 a[176:179], v[140:143], a[48:51], a[176:179]
    buffer_load_dwordx4 a[128:131], v220, s[24:27], s54 offen offset:0 sc0 sc1
    v_mul_f32 v123, v91, v123
    v_mfma_f32_16x16x32_bf16 a[180:183], v[136:139], a[36:39], a[180:183]
    ds_read_b64_tr_b16 v[154:155], v165 offset:34816
    v_mul_f32 v91, v91, v210
    v_mfma_f32_16x16x32_bf16 a[180:183], v[140:143], a[52:55], a[180:183]
    v_exp_f32 v90, v90
    v_mfma_f32_16x16x32_bf16 a[184:187], v[136:139], a[40:43], a[184:187]
    s_barrier
    s_add_u32 s49, s71, 57344
    v_exp_f32 v91, v91
    v_mfma_f32_16x16x32_bf16 a[184:187], v[140:143], a[56:59], a[184:187]
    ds_read_b64_tr_b16 v[156:157], v165 offset:57344
    v_fma_f32 v72, v72, v211, v211
    v_mfma_f32_16x16x32_bf16 a[188:191], v[136:139], a[44:47], a[188:191]
    ds_read_b64_tr_b16 v[158:159], v165 offset:59392
    v_fma_f32 v73, v73, v211, v211
    v_mfma_f32_16x16x32_bf16 a[188:191], v[140:143], a[60:63], a[188:191]
    s_waitcnt lgkmcnt(4)
    buffer_load_dwordx4 a[132:135], v220, s[24:27], s54 offen offset:1024 sc0 sc1
    v_mfma_f32_16x16x32_bf16 v[32:35], v[144:147], a[32:35], v[32:35]
    ds_read_b64_tr_b16 v[128:129], v166 offset:32768
    v_fma_f32 v74, v74, v211, v211
    v_mfma_f32_16x16x32_bf16 v[32:35], v[148:151], a[48:51], v[32:35]
    buffer_load_dwordx4 a[136:139], v220, s[24:27], s54 offen offset:2048 sc0 sc1
    v_fma_f32 v75, v75, v211, v211
    v_mfma_f32_16x16x32_bf16 v[36:39], v[144:147], a[36:39], v[36:39]
    ds_read_b64_tr_b16 v[130:131], v166 offset:34816
    v_fma_f32 v88, v88, v211, v211
    v_mfma_f32_16x16x32_bf16 v[36:39], v[148:151], a[52:55], v[36:39]
    buffer_load_dword v219, v217, s[24:27], s49 offen sc0 sc1
    v_mfma_f32_16x16x32_bf16 v[40:43], v[144:147], a[40:43], v[40:43]
    ds_read_b64_tr_b16 v[132:133], v166 offset:57344
    v_fma_f32 v89, v89, v211, v211
    v_mfma_f32_16x16x32_bf16 v[40:43], v[148:151], a[56:59], v[40:43]
    v_rcp_f32 v72, v72
    v_mfma_f32_16x16x32_bf16 v[44:47], v[144:147], a[44:47], v[44:47]
    ds_read_b64_tr_b16 v[134:135], v166 offset:59392
    v_fma_f32 v90, v90, v211, v211
    v_mfma_f32_16x16x32_bf16 v[44:47], v[148:151], a[60:63], v[44:47]
    s_waitcnt lgkmcnt(4)
    v_rcp_f32 v73, v73
    v_mfma_f32_16x16x32_bf16 a[192:195], v[152:155], a[32:35], a[192:195]
    ds_read_b64_tr_b16 v[136:137], v167 offset:32768
    v_fma_f32 v91, v91, v211, v211
    v_mfma_f32_16x16x32_bf16 a[192:195], v[156:159], a[48:51], a[192:195]
    buffer_load_dwordx4 a[140:143], v220, s[24:27], s54 offen offset:3072 sc0 sc1
    v_rcp_f32 v74, v74
    v_mfma_f32_16x16x32_bf16 a[196:199], v[152:155], a[36:39], a[196:199]
    s_add_u32 m0, s66, 65536
    ds_read_b64_tr_b16 v[138:139], v167 offset:34816
    s_add_u32 s55, s3, 110592
    v_mfma_f32_16x16x32_bf16 a[196:199], v[156:159], a[52:55], a[196:199]
    s_add_u32 s55, s55, s74
    v_rcp_f32 v75, v75
    v_mfma_f32_16x16x32_bf16 a[200:203], v[152:155], a[40:43], a[200:203]
    ds_read_b64_tr_b16 v[140:141], v167 offset:57344
    v_mul_f32 v72, v72, v104
    v_mfma_f32_16x16x32_bf16 a[200:203], v[156:159], a[56:59], a[200:203]
    buffer_load_dwordx4 v172, s[40:43], s55 offen lds
    v_mfma_f32_16x16x32_bf16 a[204:207], v[152:155], a[44:47], a[204:207]
    ds_read_b64_tr_b16 v[142:143], v167 offset:59392
    v_mul_f32 v73, v73, v105
    v_mfma_f32_16x16x32_bf16 a[204:207], v[156:159], a[60:63], a[204:207]
    s_waitcnt lgkmcnt(4)
    v_rcp_f32 v88, v88
    v_mfma_f32_16x16x32_bf16 v[48:51], v[128:131], a[32:35], v[48:51]
    ds_read_b64_tr_b16 v[144:145], v168 offset:16384
    v_mul_f32 v74, v74, v106
    v_mfma_f32_16x16x32_bf16 v[48:51], v[132:135], a[48:51], v[48:51]
    buffer_load_dwordx4 v173, s[40:43], s55 offen offset:1024 lds
    v_rcp_f32 v89, v89
    v_mfma_f32_16x16x32_bf16 v[52:55], v[128:131], a[36:39], v[52:55]
    s_add_u32 m0, s66, 90112
    ds_read_b64_tr_b16 v[146:147], v168 offset:18432
    s_add_u32 s55, s14, 147456
    v_mfma_f32_16x16x32_bf16 v[52:55], v[132:135], a[52:55], v[52:55]
    s_add_u32 s55, s55, s74
    v_rcp_f32 v90, v90
    v_mfma_f32_16x16x32_bf16 v[56:59], v[128:131], a[40:43], v[56:59]
    ds_read_b64_tr_b16 v[148:149], v164 offset:16384
    v_mul_f32 v75, v75, v107
    v_mfma_f32_16x16x32_bf16 v[56:59], v[132:135], a[56:59], v[56:59]
    buffer_load_dwordx4 v172, s[40:43], s55 offen lds
    v_mfma_f32_16x16x32_bf16 v[60:63], v[128:131], a[44:47], v[60:63]
    ds_read_b64_tr_b16 v[150:151], v164 offset:18432
    v_mul_f32 v88, v88, v120
    v_mfma_f32_16x16x32_bf16 v[60:63], v[132:135], a[60:63], v[60:63]
    s_waitcnt lgkmcnt(4)
    v_rcp_f32 v91, v91
    v_mfma_f32_16x16x32_bf16 a[208:211], v[136:139], a[32:35], a[208:211]
    ds_read_b64_tr_b16 v[152:153], v169 offset:16384
    v_mul_f32 v89, v89, v121
    v_mfma_f32_16x16x32_bf16 a[208:211], v[140:143], a[48:51], a[208:211]
    buffer_load_dwordx4 v173, s[40:43], s55 offen offset:1024 lds
    v_mul_f32 v90, v90, v122
    v_mfma_f32_16x16x32_bf16 a[212:215], v[136:139], a[36:39], a[212:215]
    ds_read_b64_tr_b16 v[154:155], v169 offset:18432
    v_mul_f32 v91, v91, v123
    v_mfma_f32_16x16x32_bf16 a[212:215], v[140:143], a[52:55], a[212:215]
    v_cvt_pk_bf16_f32 v104, v72, v73
    v_cvt_pk_bf16_f32 v105, v74, v75
    v_mfma_f32_16x16x32_bf16 a[216:219], v[136:139], a[40:43], a[216:219]
    ds_read_b64_tr_b16 v[156:157], v165 offset:16384
    v_cvt_pk_bf16_f32 v106, v88, v89
    v_mfma_f32_16x16x32_bf16 a[216:219], v[140:143], a[56:59], a[216:219]
    v_cvt_pk_bf16_f32 v107, v90, v91
    v_mul_f32 v108, v76, v108
    v_mfma_f32_16x16x32_bf16 a[220:223], v[136:139], a[44:47], a[220:223]
    ds_read_b64_tr_b16 v[158:159], v165 offset:18432
    v_mul_f32 v76, v76, v214
    v_mfma_f32_16x16x32_bf16 a[220:223], v[140:143], a[60:63], a[220:223]
    s_waitcnt lgkmcnt(4)
    buffer_store_dwordx4 v[104:107], v175, s[24:27], s58 offen offset:2048 sc0 sc1
    v_mul_f32 v109, v77, v109
    v_mfma_f32_16x16x32_bf16 v[224:227], v[144:147], a[32:35], v[224:227]
    ds_read_b64_tr_b16 v[128:129], v170 offset:16384
    v_mul_f32 v77, v77, v214
    v_mfma_f32_16x16x32_bf16 v[224:227], v[148:151], a[48:51], v[224:227]
    v_exp_f32 v76, v76
    v_mfma_f32_16x16x32_bf16 v[228:231], v[144:147], a[36:39], v[228:231]
    ds_read_b64_tr_b16 v[130:131], v170 offset:18432
    v_mul_f32 v110, v78, v110
    v_mfma_f32_16x16x32_bf16 v[228:231], v[148:151], a[52:55], v[228:231]
    v_exp_f32 v77, v77
    v_mfma_f32_16x16x32_bf16 v[232:235], v[144:147], a[40:43], v[232:235]
    ds_read_b64_tr_b16 v[132:133], v166 offset:16384
    v_mul_f32 v78, v78, v214
    v_mfma_f32_16x16x32_bf16 v[232:235], v[148:151], a[56:59], v[232:235]
    v_exp_f32 v78, v78
    v_mfma_f32_16x16x32_bf16 v[236:239], v[144:147], a[44:47], v[236:239]
    ds_read_b64_tr_b16 v[134:135], v166 offset:18432
    v_mul_f32 v111, v79, v111
    v_mfma_f32_16x16x32_bf16 v[236:239], v[148:151], a[60:63], v[236:239]
    s_waitcnt lgkmcnt(4)
    v_mul_f32 v79, v79, v214
    v_mul_f32 v124, v92, v124
    v_mfma_f32_16x16x32_bf16 a[224:227], v[152:155], a[32:35], a[224:227]
    ds_read_b64_tr_b16 v[136:137], v171 offset:16384
    v_mul_f32 v92, v92, v214
    v_mfma_f32_16x16x32_bf16 a[224:227], v[156:159], a[48:51], a[224:227]
    v_exp_f32 v79, v79
    v_mfma_f32_16x16x32_bf16 a[228:231], v[152:155], a[36:39], a[228:231]
    ds_read_b64_tr_b16 v[138:139], v171 offset:18432
    v_mul_f32 v125, v93, v125
    v_mfma_f32_16x16x32_bf16 a[228:231], v[156:159], a[52:55], a[228:231]
    v_exp_f32 v92, v92
    v_mfma_f32_16x16x32_bf16 a[232:235], v[152:155], a[40:43], a[232:235]
    s_waitcnt vmcnt(37)
    s_barrier
    s_add_u32 m0, s66, 24576
    v_mfma_f32_16x16x32_bf16 a[232:235], v[156:159], a[56:59], a[232:235]
    s_add_u32 s55, s3, 110720
    ds_read_b64_tr_b16 v[140:141], v167 offset:16384
    s_sub_u32 s55, s55, s74
    v_mfma_f32_16x16x32_bf16 a[236:239], v[152:155], a[44:47], a[236:239]
    ds_read_b64_tr_b16 v[142:143], v167 offset:18432
    v_mul_f32 v93, v93, v214
    v_mfma_f32_16x16x32_bf16 a[236:239], v[156:159], a[60:63], a[236:239]
    s_waitcnt lgkmcnt(4)
    buffer_load_dwordx4 v172, s[40:43], s55 offen lds
    v_mfma_f32_16x16x32_bf16 v[240:243], v[128:131], a[32:35], v[240:243]
    ds_read_b64_tr_b16 v[144:145], v164 offset:40960
    v_mul_f32 v126, v94, v126
    v_mfma_f32_16x16x32_bf16 v[240:243], v[132:135], a[48:51], v[240:243]
    buffer_load_dwordx4 v173, s[40:43], s55 offen offset:1024 lds
    v_mfma_f32_16x16x32_bf16 v[244:247], v[128:131], a[36:39], v[244:247]
    s_add_u32 m0, s66, 73728
    ds_read_b64_tr_b16 v[146:147], v164 offset:43008
    s_add_u32 s55, s14, 147584
    v_mfma_f32_16x16x32_bf16 v[244:247], v[132:135], a[52:55], v[244:247]
    s_sub_u32 s55, s55, s74
    v_exp_f32 v93, v93
    v_mfma_f32_16x16x32_bf16 v[248:251], v[128:131], a[40:43], v[248:251]
    ds_read_b64_tr_b16 v[148:149], v168 offset:0
    v_mul_f32 v94, v94, v214
    v_mfma_f32_16x16x32_bf16 v[248:251], v[132:135], a[56:59], v[248:251]
    buffer_load_dwordx4 v172, s[40:43], s55 offen lds
    v_mfma_f32_16x16x32_bf16 v[252:255], v[128:131], a[44:47], v[252:255]
    ds_read_b64_tr_b16 v[150:151], v168 offset:2048
    v_mul_f32 v127, v95, v127
    v_mfma_f32_16x16x32_bf16 v[252:255], v[132:135], a[60:63], v[252:255]
    s_waitcnt lgkmcnt(4)
    v_exp_f32 v94, v94
    v_mfma_f32_16x16x32_bf16 a[240:243], v[136:139], a[32:35], a[240:243]
    ds_read_b64_tr_b16 v[152:153], v165 offset:40960
    v_mul_f32 v95, v95, v214
    v_mfma_f32_16x16x32_bf16 a[240:243], v[140:143], a[48:51], a[240:243]
    buffer_load_dwordx4 v173, s[40:43], s55 offen offset:1024 lds
    v_mfma_f32_16x16x32_bf16 a[244:247], v[136:139], a[36:39], a[244:247]
    s_add_u32 m0, s66, 98304
    ds_read_b64_tr_b16 v[154:155], v165 offset:43008
    s_add_u32 s55, s3, 110848
    v_mfma_f32_16x16x32_bf16 a[244:247], v[140:143], a[52:55], a[244:247]
    v_exp_f32 v95, v95
    v_mfma_f32_16x16x32_bf16 a[248:251], v[136:139], a[40:43], a[248:251]
    ds_read_b64_tr_b16 v[156:157], v169 offset:0
    v_fma_f32 v76, v76, v215, v215
    v_mfma_f32_16x16x32_bf16 a[248:251], v[140:143], a[56:59], a[248:251]
    buffer_load_dwordx4 v172, s[40:43], s55 offen lds
    v_mfma_f32_16x16x32_bf16 a[252:255], v[136:139], a[44:47], a[252:255]
    ds_read_b64_tr_b16 v[158:159], v169 offset:2048
    v_fma_f32 v77, v77, v215, v215
    v_mfma_f32_16x16x32_bf16 a[252:255], v[140:143], a[60:63], a[252:255]
    s_waitcnt lgkmcnt(4)
    v_rcp_f32 v76, v76
    v_mfma_f32_16x16x32_bf16 v[0:3], v[144:147], a[64:67], v[0:3]
    ds_read_b64_tr_b16 v[128:129], v166 offset:40960
    v_fma_f32 v78, v78, v215, v215
    v_mfma_f32_16x16x32_bf16 v[0:3], v[148:151], a[80:83], v[0:3]
    buffer_load_dwordx4 v173, s[40:43], s55 offen offset:1024 lds
    v_fma_f32 v79, v79, v215, v215
    v_mfma_f32_16x16x32_bf16 v[4:7], v[144:147], a[68:71], v[4:7]
    s_add_u32 m0, s66, 122880
    ds_read_b64_tr_b16 v[130:131], v166 offset:43008
    s_add_u32 s55, s14, 147712
    v_fma_f32 v92, v92, v215, v215
    v_mfma_f32_16x16x32_bf16 v[4:7], v[148:151], a[84:87], v[4:7]
    v_rcp_f32 v77, v77
    v_mfma_f32_16x16x32_bf16 v[8:11], v[144:147], a[72:75], v[8:11]
    ds_read_b64_tr_b16 v[132:133], v170 offset:0
    v_fma_f32 v93, v93, v215, v215
    v_mfma_f32_16x16x32_bf16 v[8:11], v[148:151], a[88:91], v[8:11]
    buffer_load_dwordx4 v172, s[40:43], s55 offen lds
    v_mfma_f32_16x16x32_bf16 v[12:15], v[144:147], a[76:79], v[12:15]
    ds_read_b64_tr_b16 v[134:135], v170 offset:2048
    v_fma_f32 v94, v94, v215, v215
    v_mfma_f32_16x16x32_bf16 v[12:15], v[148:151], a[92:95], v[12:15]
    s_waitcnt lgkmcnt(4)
    v_rcp_f32 v78, v78
    v_mfma_f32_16x16x32_bf16 a[160:163], v[152:155], a[64:67], a[160:163]
    ds_read_b64_tr_b16 v[136:137], v167 offset:40960
    v_fma_f32 v95, v95, v215, v215
    v_mfma_f32_16x16x32_bf16 a[160:163], v[156:159], a[80:83], a[160:163]
    v_rcp_f32 v79, v79
    v_mfma_f32_16x16x32_bf16 a[164:167], v[152:155], a[68:71], a[164:167]
    ds_read_b64_tr_b16 v[138:139], v167 offset:43008
    v_mul_f32 v76, v76, v108
    v_mfma_f32_16x16x32_bf16 a[164:167], v[156:159], a[84:87], a[164:167]
    v_rcp_f32 v92, v92
    v_mfma_f32_16x16x32_bf16 a[168:171], v[152:155], a[72:75], a[168:171]
    ds_read_b64_tr_b16 v[140:141], v171 offset:0
    v_mul_f32 v77, v77, v109
    v_mfma_f32_16x16x32_bf16 a[168:171], v[156:159], a[88:91], a[168:171]
    buffer_load_dwordx4 v173, s[40:43], s55 offen offset:1024 lds
    v_mfma_f32_16x16x32_bf16 a[172:175], v[152:155], a[76:79], a[172:175]
    ds_read_b64_tr_b16 v[142:143], v171 offset:2048
    v_mul_f32 v78, v78, v110
    v_mfma_f32_16x16x32_bf16 a[172:175], v[156:159], a[92:95], a[172:175]
    s_waitcnt lgkmcnt(4)
    v_rcp_f32 v93, v93
    v_mfma_f32_16x16x32_bf16 v[16:19], v[128:131], a[64:67], v[16:19]
    ds_read_b64_tr_b16 v[144:145], v168 offset:24576
    v_mul_f32 v79, v79, v111
    v_mfma_f32_16x16x32_bf16 v[16:19], v[132:135], a[80:83], v[16:19]
    v_rcp_f32 v94, v94
    v_mfma_f32_16x16x32_bf16 v[20:23], v[128:131], a[68:71], v[20:23]
    ds_read_b64_tr_b16 v[146:147], v168 offset:26624
    v_mul_f32 v92, v92, v124
    v_mfma_f32_16x16x32_bf16 v[20:23], v[132:135], a[84:87], v[20:23]
    v_rcp_f32 v95, v95
    v_mfma_f32_16x16x32_bf16 v[24:27], v[128:131], a[72:75], v[24:27]
    ds_read_b64_tr_b16 v[148:149], v160 offset:32768
    v_mul_f32 v93, v93, v125
    v_mfma_f32_16x16x32_bf16 v[24:27], v[132:135], a[88:91], v[24:27]
    v_mul_f32 v94, v94, v126
    v_mul_f32 v95, v95, v127
    v_mfma_f32_16x16x32_bf16 v[28:31], v[128:131], a[76:79], v[28:31]
    ds_read_b64_tr_b16 v[150:151], v160 offset:34816
    v_cvt_pk_bf16_f32 v108, v76, v77
    v_mfma_f32_16x16x32_bf16 v[28:31], v[132:135], a[92:95], v[28:31]
    s_waitcnt lgkmcnt(4)
    v_cvt_pk_bf16_f32 v109, v78, v79
    v_cvt_pk_bf16_f32 v110, v92, v93
    v_mfma_f32_16x16x32_bf16 a[176:179], v[136:139], a[64:67], a[176:179]
    ds_read_b64_tr_b16 v[152:153], v169 offset:24576
    v_cvt_pk_bf16_f32 v111, v94, v95
    v_mfma_f32_16x16x32_bf16 a[176:179], v[140:143], a[80:83], a[176:179]
    buffer_store_dwordx4 v[108:111], v175, s[24:27], s58 offen offset:3072 sc0 sc1
    v_mfma_f32_16x16x32_bf16 a[180:183], v[136:139], a[68:71], a[180:183]
    ds_read_b64_tr_b16 v[154:155], v169 offset:26624
    v_mfma_f32_16x16x32_bf16 a[180:183], v[140:143], a[84:87], a[180:183]
    v_mfma_f32_16x16x32_bf16 a[184:187], v[136:139], a[72:75], a[184:187]
    s_waitcnt vmcnt(42)
    s_barrier
    s_add_u32 m0, s66, 147456
    v_mfma_f32_16x16x32_bf16 a[184:187], v[140:143], a[88:91], a[184:187]
    s_add_u32 s55, s15, 147456
    ds_read_b64_tr_b16 v[156:157], v161 offset:32768
    s_add_u32 s55, s55, s74
    v_mfma_f32_16x16x32_bf16 a[188:191], v[136:139], a[76:79], a[188:191]
    ds_read_b64_tr_b16 v[158:159], v161 offset:34816
    v_mfma_f32_16x16x32_bf16 a[188:191], v[140:143], a[92:95], a[188:191]
    s_waitcnt lgkmcnt(4)
    buffer_load_dwordx4 v172, s[40:43], s55 offen lds
    v_mfma_f32_16x16x32_bf16 v[32:35], v[144:147], a[64:67], v[32:35]
    ds_read_b64_tr_b16 v[128:129], v170 offset:24576
    v_mfma_f32_16x16x32_bf16 v[32:35], v[148:151], a[80:83], v[32:35]
    buffer_load_dwordx4 v173, s[40:43], s55 offen offset:1024 lds
    v_mfma_f32_16x16x32_bf16 v[36:39], v[144:147], a[68:71], v[36:39]
    s_add_u32 m0, s66, 81920
    ds_read_b64_tr_b16 v[130:131], v170 offset:26624
    s_add_u32 s55, s3, 147456
    v_mfma_f32_16x16x32_bf16 v[36:39], v[148:151], a[84:87], v[36:39]
    s_add_u32 s55, s55, s74
    s_waitcnt vmcnt(17)
    v_cmp_eq_u32 vcc, s79, v219
    v_mfma_f32_16x16x32_bf16 v[40:43], v[144:147], a[72:75], v[40:43]
    ds_read_b64_tr_b16 v[132:133], v162 offset:32768
    v_mfma_f32_16x16x32_bf16 v[40:43], v[148:151], a[88:91], v[40:43]
    buffer_load_dwordx4 v172, s[40:43], s55 offen lds
    v_mfma_f32_16x16x32_bf16 v[44:47], v[144:147], a[76:79], v[44:47]
    ds_read_b64_tr_b16 v[134:135], v162 offset:34816
    v_mfma_f32_16x16x32_bf16 v[44:47], v[148:151], a[92:95], v[44:47]
    s_waitcnt lgkmcnt(4)
    s_andn2_b32 s61, 7, vcc_lo
    s_cbranch_scc1 Lslow_17
Lback_18:
    v_mfma_f32_16x16x32_bf16 a[192:195], v[152:155], a[64:67], a[192:195]
    ds_read_b64_tr_b16 v[136:137], v171 offset:24576
    v_mfma_f32_16x16x32_bf16 a[192:195], v[156:159], a[80:83], a[192:195]
    buffer_load_dwordx4 v173, s[40:43], s55 offen offset:1024 lds
    v_mfma_f32_16x16x32_bf16 a[196:199], v[152:155], a[68:71], a[196:199]
    s_add_u32 s54, s12, 524288
    ds_read_b64_tr_b16 v[138:139], v171 offset:26624
    v_mfma_f32_16x16x32_bf16 a[196:199], v[156:159], a[84:87], a[196:199]
    v_mfma_f32_16x16x32_bf16 a[200:203], v[152:155], a[72:75], a[200:203]
    ds_read_b64_tr_b16 v[140:141], v163 offset:32768
    v_mfma_f32_16x16x32_bf16 a[200:203], v[156:159], a[88:91], a[200:203]
    buffer_load_dwordx4 a[144:147], v220, s[24:27], s54 offen offset:0 sc0 sc1
    v_mfma_f32_16x16x32_bf16 a[204:207], v[152:155], a[76:79], a[204:207]
    ds_read_b64_tr_b16 v[142:143], v163 offset:34816
    v_mfma_f32_16x16x32_bf16 a[204:207], v[156:159], a[92:95], a[204:207]
    s_waitcnt lgkmcnt(4)
    v_mfma_f32_16x16x32_bf16 v[48:51], v[128:131], a[64:67], v[48:51]
    ds_read_b64_tr_b16 v[144:145], v160 offset:40960
    v_mfma_f32_16x16x32_bf16 v[48:51], v[132:135], a[80:83], v[48:51]
    buffer_load_dwordx4 a[148:151], v220, s[24:27], s54 offen offset:1024 sc0 sc1
    v_mfma_f32_16x16x32_bf16 v[52:55], v[128:131], a[68:71], v[52:55]
    ds_read_b64_tr_b16 v[146:147], v160 offset:43008
    v_mfma_f32_16x16x32_bf16 v[52:55], v[132:135], a[84:87], v[52:55]
    v_mfma_f32_16x16x32_bf16 v[56:59], v[128:131], a[72:75], v[56:59]
    ds_read_b64_tr_b16 v[148:149], v160 offset:49152
    v_mfma_f32_16x16x32_bf16 v[56:59], v[132:135], a[88:91], v[56:59]
    buffer_load_dwordx4 a[152:155], v220, s[24:27], s54 offen offset:2048 sc0 sc1
    v_mfma_f32_16x16x32_bf16 v[60:63], v[128:131], a[76:79], v[60:63]
    ds_read_b64_tr_b16 v[150:151], v160 offset:51200
    v_mfma_f32_16x16x32_bf16 v[60:63], v[132:135], a[92:95], v[60:63]
    s_waitcnt lgkmcnt(4)
    v_mfma_f32_16x16x32_bf16 a[208:211], v[136:139], a[64:67], a[208:211]
    ds_read_b64_tr_b16 v[152:153], v161 offset:40960
    v_mfma_f32_16x16x32_bf16 a[208:211], v[140:143], a[80:83], a[208:211]
    v_mfma_f32_16x16x32_bf16 a[212:215], v[136:139], a[68:71], a[212:215]
    ds_read_b64_tr_b16 v[154:155], v161 offset:43008
    v_mfma_f32_16x16x32_bf16 a[212:215], v[140:143], a[84:87], a[212:215]
    v_mfma_f32_16x16x32_bf16 a[216:219], v[136:139], a[72:75], a[216:219]
    ds_read_b64_tr_b16 v[156:157], v161 offset:49152
    v_mfma_f32_16x16x32_bf16 a[216:219], v[140:143], a[88:91], a[216:219]
    buffer_load_dwordx4 a[156:159], v220, s[24:27], s54 offen offset:3072 sc0 sc1
    v_mfma_f32_16x16x32_bf16 a[220:223], v[136:139], a[76:79], a[220:223]
    s_add_u32 s54, s13, 524288
    ds_read_b64_tr_b16 v[158:159], v161 offset:51200
    v_mfma_f32_16x16x32_bf16 a[220:223], v[140:143], a[92:95], a[220:223]
    s_waitcnt lgkmcnt(4)
    v_mfma_f32_16x16x32_bf16 v[224:227], v[144:147], a[64:67], v[224:227]
    ds_read_b64_tr_b16 v[128:129], v162 offset:40960
    v_mfma_f32_16x16x32_bf16 v[224:227], v[148:151], a[80:83], v[224:227]
    buffer_load_dwordx4 a[0:3], v220, s[24:27], s54 offen offset:0 sc0 sc1
    v_mfma_f32_16x16x32_bf16 v[228:231], v[144:147], a[68:71], v[228:231]
    ds_read_b64_tr_b16 v[130:131], v162 offset:43008
    v_mfma_f32_16x16x32_bf16 v[228:231], v[148:151], a[84:87], v[228:231]
    v_mfma_f32_16x16x32_bf16 v[232:235], v[144:147], a[72:75], v[232:235]
    ds_read_b64_tr_b16 v[132:133], v162 offset:49152
    v_mfma_f32_16x16x32_bf16 v[232:235], v[148:151], a[88:91], v[232:235]
    buffer_load_dwordx4 a[4:7], v220, s[24:27], s54 offen offset:1024 sc0 sc1
    v_mfma_f32_16x16x32_bf16 v[236:239], v[144:147], a[76:79], v[236:239]
    ds_read_b64_tr_b16 v[134:135], v162 offset:51200
    v_mfma_f32_16x16x32_bf16 v[236:239], v[148:151], a[92:95], v[236:239]
    s_waitcnt lgkmcnt(4)
    v_mfma_f32_16x16x32_bf16 a[224:227], v[152:155], a[64:67], a[224:227]
    ds_read_b64_tr_b16 v[136:137], v163 offset:40960
    v_mfma_f32_16x16x32_bf16 a[224:227], v[156:159], a[80:83], a[224:227]
    buffer_load_dwordx4 a[8:11], v220, s[24:27], s54 offen offset:2048 sc0 sc1
    v_mfma_f32_16x16x32_bf16 a[228:231], v[152:155], a[68:71], a[228:231]
    ds_read_b64_tr_b16 v[138:139], v163 offset:43008
    v_mfma_f32_16x16x32_bf16 a[228:231], v[156:159], a[84:87], a[228:231]
    v_mfma_f32_16x16x32_bf16 a[232:235], v[152:155], a[72:75], a[232:235]
    s_barrier
    s_add_u32 s49, s71, 24576
    v_mfma_f32_16x16x32_bf16 a[232:235], v[156:159], a[88:91], a[232:235]
    ds_read_b64_tr_b16 v[140:141], v163 offset:49152
    v_mfma_f32_16x16x32_bf16 a[236:239], v[152:155], a[76:79], a[236:239]
    ds_read_b64_tr_b16 v[142:143], v163 offset:51200
    v_mfma_f32_16x16x32_bf16 a[236:239], v[156:159], a[92:95], a[236:239]
    s_waitcnt lgkmcnt(4)
    buffer_load_dwordx4 a[12:15], v220, s[24:27], s54 offen offset:3072 sc0 sc1
    v_mfma_f32_16x16x32_bf16 v[240:243], v[128:131], a[64:67], v[240:243]
    s_add_u32 s54, s62, 524288
    ds_read_b64_tr_b16 v[144:145], v162 offset:57344
    v_mfma_f32_16x16x32_bf16 v[240:243], v[132:135], a[80:83], v[240:243]
    buffer_load_dwordx4 a[16:19], v220, s[24:27], s54 offen offset:0 sc0 sc1
    v_mfma_f32_16x16x32_bf16 v[244:247], v[128:131], a[68:71], v[244:247]
    ds_read_b64_tr_b16 v[146:147], v162 offset:59392
    v_mfma_f32_16x16x32_bf16 v[244:247], v[132:135], a[84:87], v[244:247]
    buffer_load_dword v223, v217, s[24:27], s49 offen sc0 sc1
    v_mfma_f32_16x16x32_bf16 v[248:251], v[128:131], a[72:75], v[248:251]
    ds_read_b64_tr_b16 v[148:149], v162 offset:0
    v_mfma_f32_16x16x32_bf16 v[248:251], v[132:135], a[88:91], v[248:251]
    v_mfma_f32_16x16x32_bf16 v[252:255], v[128:131], a[76:79], v[252:255]
    ds_read_b64_tr_b16 v[150:151], v162 offset:2048
    v_mfma_f32_16x16x32_bf16 v[252:255], v[132:135], a[92:95], v[252:255]
    s_waitcnt lgkmcnt(4)
    v_mfma_f32_16x16x32_bf16 a[240:243], v[136:139], a[64:67], a[240:243]
    ds_read_b64_tr_b16 v[152:153], v163 offset:57344
    v_mfma_f32_16x16x32_bf16 a[240:243], v[140:143], a[80:83], a[240:243]
    buffer_load_dwordx4 a[20:23], v220, s[24:27], s54 offen offset:1024 sc0 sc1
    v_mfma_f32_16x16x32_bf16 a[244:247], v[136:139], a[68:71], a[244:247]
    ds_read_b64_tr_b16 v[154:155], v163 offset:59392
    v_mfma_f32_16x16x32_bf16 a[244:247], v[140:143], a[84:87], a[244:247]
    v_mfma_f32_16x16x32_bf16 a[248:251], v[136:139], a[72:75], a[248:251]
    ds_read_b64_tr_b16 v[156:157], v163 offset:0
    v_mfma_f32_16x16x32_bf16 a[248:251], v[140:143], a[88:91], a[248:251]
    buffer_load_dwordx4 a[24:27], v220, s[24:27], s54 offen offset:2048 sc0 sc1
    v_mfma_f32_16x16x32_bf16 a[252:255], v[136:139], a[76:79], a[252:255]
    ds_read_b64_tr_b16 v[158:159], v163 offset:2048
    v_mfma_f32_16x16x32_bf16 a[252:255], v[140:143], a[92:95], a[252:255]
    s_waitcnt lgkmcnt(4)
    v_mfma_f32_16x16x32_bf16 v[16:19], v[144:147], a[96:99], v[16:19]
    ds_read_b64_tr_b16 v[128:129], v160 offset:8192
    v_mfma_f32_16x16x32_bf16 v[16:19], v[148:151], a[112:115], v[16:19]
    buffer_load_dwordx4 a[28:31], v220, s[24:27], s54 offen offset:3072 sc0 sc1
    v_mfma_f32_16x16x32_bf16 v[20:23], v[144:147], a[100:103], v[20:23]
    s_add_u32 m0, s66, 106496
    ds_read_b64_tr_b16 v[130:131], v160 offset:10240
    s_add_u32 s55, s15, 147584
    v_mfma_f32_16x16x32_bf16 v[20:23], v[148:151], a[116:119], v[20:23]
    s_sub_u32 s55, s55, s74
    v_mfma_f32_16x16x32_bf16 v[24:27], v[144:147], a[104:107], v[24:27]
    ds_read_b64_tr_b16 v[132:133], v164 offset:49152
    v_mfma_f32_16x16x32_bf16 v[24:27], v[148:151], a[120:123], v[24:27]
    buffer_load_dwordx4 v172, s[40:43], s55 offen lds
    v_mfma_f32_16x16x32_bf16 v[28:31], v[144:147], a[108:111], v[28:31]
    ds_read_b64_tr_b16 v[134:135], v164 offset:51200
    v_mfma_f32_16x16x32_bf16 v[28:31], v[148:151], a[124:127], v[28:31]
    s_waitcnt lgkmcnt(4)
    v_mfma_f32_16x16x32_bf16 a[176:179], v[152:155], a[96:99], a[176:179]
    ds_read_b64_tr_b16 v[136:137], v161 offset:8192
    v_mfma_f32_16x16x32_bf16 a[176:179], v[156:159], a[112:115], a[176:179]
    buffer_load_dwordx4 v173, s[40:43], s55 offen offset:1024 lds
    v_mfma_f32_16x16x32_bf16 a[180:183], v[152:155], a[100:103], a[180:183]
    s_add_u32 m0, s66, 131072
    ds_read_b64_tr_b16 v[138:139], v161 offset:10240
    s_add_u32 s55, s3, 147584
    v_mfma_f32_16x16x32_bf16 a[180:183], v[156:159], a[116:119], a[180:183]
    s_sub_u32 s55, s55, s74
    v_mfma_f32_16x16x32_bf16 a[184:187], v[152:155], a[104:107], a[184:187]
    ds_read_b64_tr_b16 v[140:141], v165 offset:49152
    v_mfma_f32_16x16x32_bf16 a[184:187], v[156:159], a[120:123], a[184:187]
    buffer_load_dwordx4 v172, s[40:43], s55 offen lds
    v_mfma_f32_16x16x32_bf16 a[188:191], v[152:155], a[108:111], a[188:191]
    ds_read_b64_tr_b16 v[142:143], v165 offset:51200
    v_mfma_f32_16x16x32_bf16 a[188:191], v[156:159], a[124:127], a[188:191]
    s_waitcnt lgkmcnt(4)
    v_mfma_f32_16x16x32_bf16 v[32:35], v[128:131], a[96:99], v[32:35]
    s_mul_i32 s75, s67, 36
    ds_read_b64_tr_b16 v[144:145], v162 offset:8192
    s_mul_i32 s52, s68, 12
    v_mfma_f32_16x16x32_bf16 v[32:35], v[132:135], a[112:115], v[32:35]
    s_lshr_b32 s60, s48, 1
    s_add_u32 s52, s52, s60
    s_add_u32 s75, s75, s52
    v_mfma_f32_16x16x32_bf16 v[36:39], v[128:131], a[100:103], v[36:39]
    s_lshl_b32 s75, s75, 16
    ds_read_b64_tr_b16 v[146:147], v162 offset:10240
    s_add_u32 s75, s75, 25427968
    v_mfma_f32_16x16x32_bf16 v[36:39], v[132:135], a[116:119], v[36:39]
    s_lshl_b32 s60, s74, 11
    s_and_b32 s61, s67, 1
    s_lshl_b32 s61, s61, 17
    v_mfma_f32_16x16x32_bf16 v[40:43], v[128:131], a[104:107], v[40:43]
    s_waitcnt vmcnt(20)
    s_barrier
    s_add_u32 s4, s75, 0
    v_mfma_f32_16x16x32_bf16 v[40:43], v[132:135], a[120:123], v[40:43]
    s_add_u32 s4, s4, s60
    ds_read_b64_tr_b16 v[148:149], v166 offset:49152
    s_add_u32 s4, s4, s61
    v_mfma_f32_16x16x32_bf16 v[44:47], v[128:131], a[108:111], v[44:47]
    s_add_u32 s5, s75, 131072
    ds_read_b64_tr_b16 v[150:151], v166 offset:51200
    s_add_u32 s5, s5, s60
    v_mfma_f32_16x16x32_bf16 v[44:47], v[132:135], a[124:127], v[44:47]
    s_waitcnt lgkmcnt(4)
    buffer_load_dwordx4 v173, s[40:43], s55 offen offset:1024 lds
    v_mfma_f32_16x16x32_bf16 a[192:195], v[136:139], a[96:99], a[192:195]
    s_add_u32 m0, s66, 155648
    ds_read_b64_tr_b16 v[152:153], v163 offset:8192
    s_add_u32 s55, s15, 147712
    v_mfma_f32_16x16x32_bf16 a[192:195], v[140:143], a[112:115], a[192:195]
    buffer_load_dwordx4 v172, s[40:43], s55 offen lds
    v_mfma_f32_16x16x32_bf16 a[196:199], v[136:139], a[100:103], a[196:199]
    s_sub_u32 s5, s5, s61
    ds_read_b64_tr_b16 v[154:155], v163 offset:10240
    s_add_u32 s6, s75, 262144
    v_mfma_f32_16x16x32_bf16 a[196:199], v[140:143], a[116:119], a[196:199]
    s_sub_u32 s6, s6, s60
    s_add_u32 s6, s6, s61
    s_add_u32 s10, s75, 393216
    v_mfma_f32_16x16x32_bf16 a[200:203], v[136:139], a[104:107], a[200:203]
    s_sub_u32 s10, s10, s60
    ds_read_b64_tr_b16 v[156:157], v167 offset:49152
    s_sub_u32 s10, s10, s61
    v_mfma_f32_16x16x32_bf16 a[200:203], v[140:143], a[120:123], a[200:203]
    buffer_load_dwordx4 v173, s[40:43], s55 offen offset:1024 lds
    v_mfma_f32_16x16x32_bf16 a[204:207], v[136:139], a[108:111], a[204:207]
    s_add_u32 m0, s66, 32768
    ds_read_b64_tr_b16 v[158:159], v167 offset:51200
    s_add_u32 s55, s3, 147712
    v_mfma_f32_16x16x32_bf16 a[204:207], v[140:143], a[124:127], a[204:207]
    s_waitcnt lgkmcnt(4)
    s_add_u32 s11, s75, 524288
    s_add_u32 s11, s11, s61
    v_mfma_f32_16x16x32_bf16 v[48:51], v[144:147], a[96:99], v[48:51]
    s_add_u32 s20, s75, 655360
    ds_read_b64_tr_b16 v[128:129], v168 offset:8192
    s_sub_u32 s20, s20, s61
    v_mfma_f32_16x16x32_bf16 v[48:51], v[148:151], a[112:115], v[48:51]
    buffer_load_dwordx4 v172, s[40:43], s55 offen lds
    v_mfma_f32_16x16x32_bf16 v[52:55], v[144:147], a[100:103], v[52:55]
    s_mul_i32 s60, s67, 2359296
    ds_read_b64_tr_b16 v[130:131], v168 offset:10240
    s_sub_u32 s73, s4, s60
    v_mfma_f32_16x16x32_bf16 v[52:55], v[148:151], a[116:119], v[52:55]
    s_sub_u32 s75, s73, 25427968
    s_lshr_b32 s75, s75, 11
    v_lshlrev_b32 v194, 4, v174
    v_mfma_f32_16x16x32_bf16 v[56:59], v[144:147], a[104:107], v[56:59]
    ds_read_b64_tr_b16 v[132:133], v160 offset:16384
    v_sub_u32 v192, v220, v194
    v_mfma_f32_16x16x32_bf16 v[56:59], v[148:151], a[120:123], v[56:59]
    buffer_load_dwordx4 v173, s[40:43], s55 offen offset:1024 lds
    v_mfma_f32_16x16x32_bf16 v[60:63], v[144:147], a[108:111], v[60:63]
    s_add_u32 m0, s66, 40960
    ds_read_b64_tr_b16 v[134:135], v160 offset:18432
    s_add_u32 s55, s65, 256
    v_mfma_f32_16x16x32_bf16 v[60:63], v[148:151], a[124:127], v[60:63]
    s_waitcnt lgkmcnt(4)
    v_lshrrev_b32 v193, 6, v192
    v_lshrrev_b32 v192, 1, v192
    v_mfma_f32_16x16x32_bf16 a[208:211], v[152:155], a[96:99], a[208:211]
    ds_read_b64_tr_b16 v[136:137], v169 offset:8192
    v_add_u32 v192, v192, v194
    v_mfma_f32_16x16x32_bf16 a[208:211], v[156:159], a[112:115], a[208:211]
    s_lshl_b32 s52, s48, 10
    v_add_u32 v195, s52, v194
    v_xor_b32 v196, 0x800, v195
    v_mfma_f32_16x16x32_bf16 a[212:215], v[152:155], a[100:103], a[212:215]
    ds_read_b64_tr_b16 v[138:139], v169 offset:10240
    v_and_b32 v194, 15, v174
    v_mfma_f32_16x16x32_bf16 a[212:215], v[156:159], a[116:119], a[212:215]
    v_add_u32 v193, v193, v194
    v_mul_u32_u24 v193, 1152, v193
    v_mfma_f32_16x16x32_bf16 a[216:219], v[152:155], a[104:107], a[216:219]
    ds_read_b64_tr_b16 v[140:141], v161 offset:16384
    v_lshrrev_b32 v194, 4, v174
    v_mfma_f32_16x16x32_bf16 a[216:219], v[156:159], a[120:123], a[216:219]
    buffer_load_dwordx4 v172, s[44:47], s55 offen lds
    v_mfma_f32_16x16x32_bf16 a[220:223], v[152:155], a[108:111], a[220:223]
    ds_read_b64_tr_b16 v[142:143], v161 offset:18432
    v_lshl_add_u32 v193, v194, 3, v193
    v_mfma_f32_16x16x32_bf16 a[220:223], v[156:159], a[124:127], a[220:223]
    s_waitcnt lgkmcnt(4)
    s_mov_b32 s76, 0x3f80
    s_mov_b32 s77, 0x3f800000
    v_mfma_f32_16x16x32_bf16 v[224:227], v[128:131], a[96:99], v[224:227]
    s_mov_b32 s28, s18
    ds_read_b64_tr_b16 v[144:145], v170 offset:8192
    s_and_b32 s29, s19, 0xffff
    v_mfma_f32_16x16x32_bf16 v[224:227], v[132:135], a[112:115], v[224:227]
    buffer_load_dwordx4 v173, s[44:47], s55 offen offset:1024 lds
    v_mfma_f32_16x16x32_bf16 v[228:231], v[128:131], a[100:103], v[228:231]
    s_add_u32 m0, s66, 49152
    ds_read_b64_tr_b16 v[146:147], v170 offset:10240
    s_add_u32 s55, s14, 184576
    v_mfma_f32_16x16x32_bf16 v[228:231], v[132:135], a[116:119], v[228:231]
    s_mov_b32 s30, 0x240000
    s_mov_b32 s31, 0x20000
    s_add_u32 s49, s69, 65536
    v_mfma_f32_16x16x32_bf16 v[232:235], v[128:131], a[104:107], v[232:235]
    ds_read_b64_tr_b16 v[148:149], v162 offset:16384
    v_mfma_f32_16x16x32_bf16 v[232:235], v[132:135], a[120:123], v[232:235]
    buffer_load_dwordx4 v172, s[40:43], s55 offen lds
    v_mfma_f32_16x16x32_bf16 v[236:239], v[128:131], a[108:111], v[236:239]
    ds_read_b64_tr_b16 v[150:151], v162 offset:18432
    v_mfma_f32_16x16x32_bf16 v[236:239], v[132:135], a[124:127], v[236:239]
    s_waitcnt lgkmcnt(4)
    buffer_store_dword v218, v216, s[24:27], s49 offen sc0 sc1
    v_mfma_f32_16x16x32_bf16 a[224:227], v[136:139], a[96:99], a[224:227]
    ds_read_b64_tr_b16 v[152:153], v171 offset:8192
    v_mfma_f32_16x16x32_bf16 a[224:227], v[140:143], a[112:115], a[224:227]
    buffer_load_dwordx4 v173, s[40:43], s55 offen offset:1024 lds
    v_mfma_f32_16x16x32_bf16 a[228:231], v[136:139], a[100:103], a[228:231]
    ds_read_b64_tr_b16 v[154:155], v171 offset:10240
    v_mfma_f32_16x16x32_bf16 a[228:231], v[140:143], a[116:119], a[228:231]
    v_mfma_f32_16x16x32_bf16 a[232:235], v[136:139], a[104:107], a[232:235]
    s_barrier
    s_add_u32 m0, s66, 8192
    v_mfma_f32_16x16x32_bf16 a[232:235], v[140:143], a[120:123], a[232:235]
    s_add_u32 s55, s15, 184576
    ds_read_b64_tr_b16 v[156:157], v163 offset:16384
    v_mfma_f32_16x16x32_bf16 a[236:239], v[136:139], a[108:111], a[236:239]
    ds_read_b64_tr_b16 v[158:159], v163 offset:18432
    v_mfma_f32_16x16x32_bf16 a[236:239], v[140:143], a[124:127], a[236:239]
    s_waitcnt lgkmcnt(4)
    buffer_load_dwordx4 v172, s[40:43], s55 offen lds
    v_mfma_f32_16x16x32_bf16 v[240:243], v[144:147], a[96:99], v[240:243]
    ds_read_b64_tr_b16 v[128:129], v166 offset:0
    v_mfma_f32_16x16x32_bf16 v[240:243], v[148:151], a[112:115], v[240:243]
    buffer_load_dwordx4 v173, s[40:43], s55 offen offset:1024 lds
    v_mfma_f32_16x16x32_bf16 v[244:247], v[144:147], a[100:103], v[244:247]
    s_add_u32 m0, s66, 114688
    ds_read_b64_tr_b16 v[130:131], v166 offset:2048
    s_add_u32 s55, s3, 184576
    v_mfma_f32_16x16x32_bf16 v[244:247], v[148:151], a[116:119], v[244:247]
    s_waitcnt vmcnt(18)
    v_cmp_eq_u32 vcc, s79, v223
    v_mfma_f32_16x16x32_bf16 v[248:251], v[144:147], a[104:107], v[248:251]
    ds_read_b64_tr_b16 v[132:133], v166 offset:24576
    v_mfma_f32_16x16x32_bf16 v[248:251], v[148:151], a[120:123], v[248:251]
    s_andn2_b32 s61, 1, vcc_lo
    s_cbranch_scc1 Lslow_20
Lback_21:
    s_add_u32 s52, s75, 0
    v_mfma_f32_16x16x32_bf16 v[252:255], v[144:147], a[108:111], v[252:255]
    ds_read_b64_tr_b16 v[134:135], v166 offset:26624
    v_mfma_f32_16x16x32_bf16 v[252:255], v[148:151], a[124:127], v[252:255]
    s_waitcnt lgkmcnt(4)
    buffer_load_dwordx2 v[176:177], v193, s[36:39], s52 offen offset:0
    v_mfma_f32_16x16x32_bf16 a[240:243], v[152:155], a[96:99], a[240:243]
    ds_read_b64_tr_b16 v[136:137], v167 offset:0
    v_mfma_f32_16x16x32_bf16 a[240:243], v[156:159], a[112:115], a[240:243]
    v_mfma_f32_16x16x32_bf16 a[244:247], v[152:155], a[100:103], a[244:247]
    ds_read_b64_tr_b16 v[138:139], v167 offset:2048
    v_mfma_f32_16x16x32_bf16 a[244:247], v[156:159], a[116:119], a[244:247]
    v_mfma_f32_16x16x32_bf16 a[248:251], v[152:155], a[104:107], a[248:251]
    ds_read_b64_tr_b16 v[140:141], v167 offset:24576
    v_mfma_f32_16x16x32_bf16 a[248:251], v[156:159], a[120:123], a[248:251]
    buffer_load_dwordx4 v172, s[40:43], s55 offen lds
    v_mfma_f32_16x16x32_bf16 a[252:255], v[152:155], a[108:111], a[252:255]
    ds_read_b64_tr_b16 v[142:143], v167 offset:26624
    v_mfma_f32_16x16x32_bf16 a[252:255], v[156:159], a[124:127], a[252:255]
    s_waitcnt lgkmcnt(4)
    v_mfma_f32_16x16x32_bf16 v[16:19], v[128:131], a[128:131], v[16:19]
    ds_read_b64_tr_b16 v[144:145], v160 offset:24576
    v_mfma_f32_16x16x32_bf16 v[16:19], v[132:135], a[144:147], v[16:19]
    buffer_load_dwordx4 v173, s[40:43], s55 offen offset:1024 lds
    v_mfma_f32_16x16x32_bf16 v[20:23], v[128:131], a[132:135], v[20:23]
    s_add_u32 s54, s64, 0
    ds_read_b64_tr_b16 v[146:147], v160 offset:26624
    v_mfma_f32_16x16x32_bf16 v[20:23], v[132:135], a[148:151], v[20:23]
    v_mfma_f32_16x16x32_bf16 v[24:27], v[128:131], a[136:139], v[24:27]
    ds_read_b64_tr_b16 v[148:149], v164 offset:8192
    v_mfma_f32_16x16x32_bf16 v[24:27], v[132:135], a[152:155], v[24:27]
    buffer_load_dwordx4 a[32:35], v220, s[24:27], s54 offen offset:0 sc0 sc1
    v_mfma_f32_16x16x32_bf16 v[28:31], v[128:131], a[140:143], v[28:31]
    ds_read_b64_tr_b16 v[150:151], v164 offset:10240
    v_mfma_f32_16x16x32_bf16 v[28:31], v[132:135], a[156:159], v[28:31]
    s_waitcnt lgkmcnt(4)
    v_mfma_f32_16x16x32_bf16 a[176:179], v[136:139], a[128:131], a[176:179]
    ds_read_b64_tr_b16 v[152:153], v161 offset:24576
    v_mfma_f32_16x16x32_bf16 a[176:179], v[140:143], a[144:147], a[176:179]
    buffer_load_dwordx4 a[36:39], v220, s[24:27], s54 offen offset:1024 sc0 sc1
    v_mfma_f32_16x16x32_bf16 a[180:183], v[136:139], a[132:135], a[180:183]
    ds_read_b64_tr_b16 v[154:155], v161 offset:26624
    v_mfma_f32_16x16x32_bf16 a[180:183], v[140:143], a[148:151], a[180:183]
    v_mfma_f32_16x16x32_bf16 a[184:187], v[136:139], a[136:139], a[184:187]
    ds_read_b64_tr_b16 v[156:157], v165 offset:8192
    v_mfma_f32_16x16x32_bf16 a[184:187], v[140:143], a[152:155], a[184:187]
    buffer_load_dwordx4 a[40:43], v220, s[24:27], s54 offen offset:2048 sc0 sc1
    v_mfma_f32_16x16x32_bf16 a[188:191], v[136:139], a[140:143], a[188:191]
    ds_read_b64_tr_b16 v[158:159], v165 offset:10240
    v_mfma_f32_16x16x32_bf16 a[188:191], v[140:143], a[156:159], a[188:191]
    s_waitcnt lgkmcnt(4)
    v_mfma_f32_16x16x32_bf16 v[32:35], v[144:147], a[128:131], v[32:35]
    ds_read_b64_tr_b16 v[128:129], v162 offset:24576
    v_mfma_f32_16x16x32_bf16 v[32:35], v[148:151], a[144:147], v[32:35]
    v_mfma_f32_16x16x32_bf16 v[36:39], v[144:147], a[132:135], v[36:39]
    ds_read_b64_tr_b16 v[130:131], v162 offset:26624
    v_mfma_f32_16x16x32_bf16 v[36:39], v[148:151], a[148:151], v[36:39]
    v_mfma_f32_16x16x32_bf16 v[40:43], v[144:147], a[136:139], v[40:43]
    s_barrier
    s_add_u32 s49, s71, 65536
    v_mfma_f32_16x16x32_bf16 v[40:43], v[148:151], a[152:155], v[40:43]
    ds_read_b64_tr_b16 v[132:133], v166 offset:8192
    v_mfma_f32_16x16x32_bf16 v[44:47], v[144:147], a[140:143], v[44:47]
    ds_read_b64_tr_b16 v[134:135], v166 offset:10240
    v_mfma_f32_16x16x32_bf16 v[44:47], v[148:151], a[156:159], v[44:47]
    s_waitcnt lgkmcnt(4)
    buffer_load_dwordx4 a[44:47], v220, s[24:27], s54 offen offset:3072 sc0 sc1
    v_mfma_f32_16x16x32_bf16 a[192:195], v[152:155], a[128:131], a[192:195]
    s_add_u32 m0, s66, 139264
    ds_read_b64_tr_b16 v[136:137], v163 offset:24576
    s_add_u32 s55, s65, 128
    v_mfma_f32_16x16x32_bf16 a[192:195], v[156:159], a[144:147], a[192:195]
    buffer_load_dword v219, v217, s[24:27], s49 offen sc0 sc1
    v_mfma_f32_16x16x32_bf16 a[196:199], v[152:155], a[132:135], a[196:199]
    s_sub_u32 s55, s55, s74
    ds_read_b64_tr_b16 v[138:139], v163 offset:26624
    v_mfma_f32_16x16x32_bf16 a[196:199], v[156:159], a[148:151], a[196:199]
    buffer_load_dwordx4 v172, s[44:47], s55 offen lds
    v_mfma_f32_16x16x32_bf16 a[200:203], v[152:155], a[136:139], a[200:203]
    ds_read_b64_tr_b16 v[140:141], v167 offset:8192
    v_mfma_f32_16x16x32_bf16 a[200:203], v[156:159], a[152:155], a[200:203]
    buffer_load_dwordx4 v173, s[44:47], s55 offen offset:1024 lds
    v_mfma_f32_16x16x32_bf16 a[204:207], v[152:155], a[140:143], a[204:207]
    s_add_u32 m0, s66, 16384
    ds_read_b64_tr_b16 v[142:143], v167 offset:10240
    s_add_u32 s55, s14, 184448
    v_mfma_f32_16x16x32_bf16 a[204:207], v[156:159], a[156:159], a[204:207]
    s_waitcnt lgkmcnt(4)
    s_sub_u32 s55, s55, s74
    v_mfma_f32_16x16x32_bf16 v[48:51], v[128:131], a[128:131], v[48:51]
    s_add_u32 s52, s75, 18432
    ds_read_b64_tr_b16 v[144:145], v164 offset:32768
    v_mfma_f32_16x16x32_bf16 v[48:51], v[132:135], a[144:147], v[48:51]
    buffer_load_dwordx4 v172, s[40:43], s55 offen lds
    v_mfma_f32_16x16x32_bf16 v[52:55], v[128:131], a[132:135], v[52:55]
    ds_read_b64_tr_b16 v[146:147], v164 offset:34816
    v_mfma_f32_16x16x32_bf16 v[52:55], v[132:135], a[148:151], v[52:55]
    buffer_load_dwordx2 v[178:179], v193, s[36:39], s52 offen offset:0
    v_mfma_f32_16x16x32_bf16 v[56:59], v[128:131], a[136:139], v[56:59]
    ds_read_b64_tr_b16 v[148:149], v164 offset:57344
    v_mfma_f32_16x16x32_bf16 v[56:59], v[132:135], a[152:155], v[56:59]
    v_mfma_f32_16x16x32_bf16 v[60:63], v[128:131], a[140:143], v[60:63]
    ds_read_b64_tr_b16 v[150:151], v164 offset:59392
    v_mfma_f32_16x16x32_bf16 v[60:63], v[132:135], a[156:159], v[60:63]
    s_waitcnt lgkmcnt(4)
    v_mfma_f32_16x16x32_bf16 a[208:211], v[136:139], a[128:131], a[208:211]
    ds_read_b64_tr_b16 v[152:153], v165 offset:32768
    v_mfma_f32_16x16x32_bf16 a[208:211], v[140:143], a[144:147], a[208:211]
    v_mfma_f32_16x16x32_bf16 a[212:215], v[136:139], a[132:135], a[212:215]
    ds_read_b64_tr_b16 v[154:155], v165 offset:34816
    v_mfma_f32_16x16x32_bf16 a[212:215], v[140:143], a[148:151], a[212:215]
    v_mfma_f32_16x16x32_bf16 a[216:219], v[136:139], a[136:139], a[216:219]
    ds_read_b64_tr_b16 v[156:157], v165 offset:57344
    v_mfma_f32_16x16x32_bf16 a[216:219], v[140:143], a[152:155], a[216:219]
    buffer_load_dwordx4 v173, s[40:43], s55 offen offset:1024 lds
    v_mfma_f32_16x16x32_bf16 a[220:223], v[136:139], a[140:143], a[220:223]
    ds_read_b64_tr_b16 v[158:159], v165 offset:59392
    v_mfma_f32_16x16x32_bf16 a[220:223], v[140:143], a[156:159], a[220:223]
    s_waitcnt lgkmcnt(4)
    v_mfma_f32_16x16x32_bf16 v[224:227], v[144:147], a[128:131], v[224:227]
    ds_read_b64_tr_b16 v[128:129], v166 offset:32768
    v_mfma_f32_16x16x32_bf16 v[224:227], v[148:151], a[144:147], v[224:227]
    v_mfma_f32_16x16x32_bf16 v[228:231], v[144:147], a[132:135], v[228:231]
    ds_read_b64_tr_b16 v[130:131], v166 offset:34816
    v_mfma_f32_16x16x32_bf16 v[228:231], v[148:151], a[148:151], v[228:231]
    v_mfma_f32_16x16x32_bf16 v[232:235], v[144:147], a[136:139], v[232:235]
    ds_read_b64_tr_b16 v[132:133], v166 offset:57344
    v_mfma_f32_16x16x32_bf16 v[232:235], v[148:151], a[152:155], v[232:235]
    v_mfma_f32_16x16x32_bf16 v[236:239], v[144:147], a[140:143], v[236:239]
    ds_read_b64_tr_b16 v[134:135], v166 offset:59392
    v_mfma_f32_16x16x32_bf16 v[236:239], v[148:151], a[156:159], v[236:239]
    s_waitcnt lgkmcnt(4)
    v_mfma_f32_16x16x32_bf16 a[224:227], v[152:155], a[128:131], a[224:227]
    ds_read_b64_tr_b16 v[136:137], v167 offset:32768
    v_mfma_f32_16x16x32_bf16 a[224:227], v[156:159], a[144:147], a[224:227]
    v_mfma_f32_16x16x32_bf16 a[228:231], v[152:155], a[132:135], a[228:231]
    ds_read_b64_tr_b16 v[138:139], v167 offset:34816
    v_mfma_f32_16x16x32_bf16 a[228:231], v[156:159], a[148:151], a[228:231]
    v_mfma_f32_16x16x32_bf16 a[232:235], v[152:155], a[136:139], a[232:235]
    s_waitcnt vmcnt(24)
    s_barrier
    v_mfma_f32_16x16x32_bf16 a[232:235], v[156:159], a[152:155], a[232:235]
    ds_read_b64_tr_b16 v[140:141], v167 offset:57344
    v_mfma_f32_16x16x32_bf16 a[236:239], v[152:155], a[140:143], a[236:239]
    ds_read_b64_tr_b16 v[142:143], v167 offset:59392
    v_mfma_f32_16x16x32_bf16 a[236:239], v[156:159], a[156:159], a[236:239]
    s_waitcnt lgkmcnt(4)
    s_waitcnt vmcnt(5)
    v_cmp_eq_u32 vcc, s79, v219
    v_mfma_f32_16x16x32_bf16 v[240:243], v[128:131], a[128:131], v[240:243]
    ds_read_b64_tr_b16 v[144:145], v170 offset:16384
    v_mfma_f32_16x16x32_bf16 v[240:243], v[132:135], a[144:147], v[240:243]
    s_andn2_b32 s61, 7, vcc_lo
    s_cbranch_scc1 Lslow_23
Lback_24:
    s_add_u32 s54, s12, 655360
    v_mfma_f32_16x16x32_bf16 v[244:247], v[128:131], a[132:135], v[244:247]
    ds_read_b64_tr_b16 v[146:147], v170 offset:18432
    v_mfma_f32_16x16x32_bf16 v[244:247], v[132:135], a[148:151], v[244:247]
    buffer_load_dwordx4 a[48:51], v220, s[24:27], s54 offen offset:0 sc0 sc1
    v_mfma_f32_16x16x32_bf16 v[248:251], v[128:131], a[136:139], v[248:251]
    ds_read_b64_tr_b16 v[148:149], v166 offset:16384
    v_mfma_f32_16x16x32_bf16 v[248:251], v[132:135], a[152:155], v[248:251]
    buffer_load_dwordx4 a[52:55], v220, s[24:27], s54 offen offset:1024 sc0 sc1
    v_mfma_f32_16x16x32_bf16 v[252:255], v[128:131], a[140:143], v[252:255]
    ds_read_b64_tr_b16 v[150:151], v166 offset:18432
    v_mfma_f32_16x16x32_bf16 v[252:255], v[132:135], a[156:159], v[252:255]
    s_waitcnt lgkmcnt(4)
    v_mfma_f32_16x16x32_bf16 a[240:243], v[136:139], a[128:131], a[240:243]
    ds_read_b64_tr_b16 v[152:153], v171 offset:16384
    v_mfma_f32_16x16x32_bf16 a[240:243], v[140:143], a[144:147], a[240:243]
    buffer_load_dwordx4 a[56:59], v220, s[24:27], s54 offen offset:2048 sc0 sc1
    v_mfma_f32_16x16x32_bf16 a[244:247], v[136:139], a[132:135], a[244:247]
    ds_read_b64_tr_b16 v[154:155], v171 offset:18432
    v_mfma_f32_16x16x32_bf16 a[244:247], v[140:143], a[148:151], a[244:247]
    v_mfma_f32_16x16x32_bf16 a[248:251], v[136:139], a[136:139], a[248:251]
    ds_read_b64_tr_b16 v[156:157], v167 offset:16384
    v_mfma_f32_16x16x32_bf16 a[248:251], v[140:143], a[152:155], a[248:251]
    buffer_load_dwordx4 a[60:63], v220, s[24:27], s54 offen offset:3072 sc0 sc1
    v_mfma_f32_16x16x32_bf16 a[252:255], v[136:139], a[140:143], a[252:255]
    s_add_u32 s54, s13, 655360
    ds_read_b64_tr_b16 v[158:159], v167 offset:18432
    v_mfma_f32_16x16x32_bf16 a[252:255], v[140:143], a[156:159], a[252:255]
    s_waitcnt lgkmcnt(4)
    v_mfma_f32_16x16x32_bf16 v[16:19], v[144:147], a[0:3], v[16:19]
    s_add_u32 s52, s75, 36864
    ds_read_b64_tr_b16 v[128:129], v164 offset:40960
    v_mfma_f32_16x16x32_bf16 v[16:19], v[148:151], a[16:19], v[16:19]
    buffer_load_dwordx4 a[64:67], v220, s[24:27], s54 offen offset:0 sc0 sc1
    v_mfma_f32_16x16x32_bf16 v[20:23], v[144:147], a[4:7], v[20:23]
    ds_read_b64_tr_b16 v[130:131], v164 offset:43008
    v_mfma_f32_16x16x32_bf16 v[20:23], v[148:151], a[20:23], v[20:23]
    buffer_load_dwordx2 v[180:181], v193, s[36:39], s52 offen offset:0
    v_mfma_f32_16x16x32_bf16 v[24:27], v[144:147], a[8:11], v[24:27]
    ds_read_b64_tr_b16 v[132:133], v168 offset:0
    v_mfma_f32_16x16x32_bf16 v[24:27], v[148:151], a[24:27], v[24:27]
    v_mfma_f32_16x16x32_bf16 v[28:31], v[144:147], a[12:15], v[28:31]
    ds_read_b64_tr_b16 v[134:135], v168 offset:2048
    v_mfma_f32_16x16x32_bf16 v[28:31], v[148:151], a[28:31], v[28:31]
    s_waitcnt lgkmcnt(4)
    v_mfma_f32_16x16x32_bf16 a[176:179], v[152:155], a[0:3], a[176:179]
    ds_read_b64_tr_b16 v[136:137], v165 offset:40960
    v_mfma_f32_16x16x32_bf16 a[176:179], v[156:159], a[16:19], a[176:179]
    buffer_load_dwordx4 a[68:71], v220, s[24:27], s54 offen offset:1024 sc0 sc1
    v_mfma_f32_16x16x32_bf16 a[180:183], v[152:155], a[4:7], a[180:183]
    ds_read_b64_tr_b16 v[138:139], v165 offset:43008
    v_mfma_f32_16x16x32_bf16 a[180:183], v[156:159], a[20:23], a[180:183]
    v_mfma_f32_16x16x32_bf16 a[184:187], v[152:155], a[8:11], a[184:187]
    ds_read_b64_tr_b16 v[140:141], v169 offset:0
    v_mfma_f32_16x16x32_bf16 a[184:187], v[156:159], a[24:27], a[184:187]
    v_mfma_f32_16x16x32_bf16 a[188:191], v[152:155], a[12:15], a[188:191]
    ds_read_b64_tr_b16 v[142:143], v169 offset:2048
    v_mfma_f32_16x16x32_bf16 a[188:191], v[156:159], a[28:31], a[188:191]
    s_waitcnt lgkmcnt(4)
    v_mfma_f32_16x16x32_bf16 v[32:35], v[128:131], a[0:3], v[32:35]
    ds_read_b64_tr_b16 v[144:145], v166 offset:40960
    v_mfma_f32_16x16x32_bf16 v[32:35], v[132:135], a[16:19], v[32:35]
    buffer_load_dwordx4 a[72:75], v220, s[24:27], s54 offen offset:2048 sc0 sc1
    v_mfma_f32_16x16x32_bf16 v[36:39], v[128:131], a[4:7], v[36:39]
    ds_read_b64_tr_b16 v[146:147], v166 offset:43008
    v_mfma_f32_16x16x32_bf16 v[36:39], v[132:135], a[20:23], v[36:39]
    v_mfma_f32_16x16x32_bf16 v[40:43], v[128:131], a[8:11], v[40:43]
    s_barrier
    v_mfma_f32_16x16x32_bf16 v[40:43], v[132:135], a[24:27], v[40:43]
    ds_read_b64_tr_b16 v[148:149], v170 offset:0
    v_mfma_f32_16x16x32_bf16 v[44:47], v[128:131], a[12:15], v[44:47]
    ds_read_b64_tr_b16 v[150:151], v170 offset:2048
    v_mfma_f32_16x16x32_bf16 v[44:47], v[132:135], a[28:31], v[44:47]
    s_waitcnt lgkmcnt(4)
    buffer_load_dwordx4 a[76:79], v220, s[24:27], s54 offen offset:3072 sc0 sc1
    v_mfma_f32_16x16x32_bf16 a[192:195], v[136:139], a[0:3], a[192:195]
    s_add_u32 s54, s62, 655360
    ds_read_b64_tr_b16 v[152:153], v167 offset:40960
    v_mfma_f32_16x16x32_bf16 a[192:195], v[140:143], a[16:19], a[192:195]
    buffer_load_dwordx4 a[80:83], v220, s[24:27], s54 offen offset:0 sc0 sc1
    v_mfma_f32_16x16x32_bf16 a[196:199], v[136:139], a[4:7], a[196:199]
    ds_read_b64_tr_b16 v[154:155], v167 offset:43008
    v_mfma_f32_16x16x32_bf16 a[196:199], v[140:143], a[20:23], a[196:199]
    v_mfma_f32_16x16x32_bf16 a[200:203], v[136:139], a[8:11], a[200:203]
    ds_read_b64_tr_b16 v[156:157], v171 offset:0
    v_mfma_f32_16x16x32_bf16 a[200:203], v[140:143], a[24:27], a[200:203]
    buffer_load_dwordx4 a[84:87], v220, s[24:27], s54 offen offset:1024 sc0 sc1
    v_mfma_f32_16x16x32_bf16 a[204:207], v[136:139], a[12:15], a[204:207]
    ds_read_b64_tr_b16 v[158:159], v171 offset:2048
    v_mfma_f32_16x16x32_bf16 a[204:207], v[140:143], a[28:31], a[204:207]
    s_waitcnt lgkmcnt(4)
    v_mfma_f32_16x16x32_bf16 v[48:51], v[144:147], a[0:3], v[48:51]
    ds_read_b64_tr_b16 v[128:129], v168 offset:24576
    v_mfma_f32_16x16x32_bf16 v[48:51], v[148:151], a[16:19], v[48:51]
    buffer_load_dwordx4 a[88:91], v220, s[24:27], s54 offen offset:2048 sc0 sc1
    v_mfma_f32_16x16x32_bf16 v[52:55], v[144:147], a[4:7], v[52:55]
    ds_read_b64_tr_b16 v[130:131], v168 offset:26624
    v_mfma_f32_16x16x32_bf16 v[52:55], v[148:151], a[20:23], v[52:55]
    v_mfma_f32_16x16x32_bf16 v[56:59], v[144:147], a[8:11], v[56:59]
    ds_read_b64_tr_b16 v[132:133], v160 offset:32768
    v_mfma_f32_16x16x32_bf16 v[56:59], v[148:151], a[24:27], v[56:59]
    buffer_load_dwordx4 a[92:95], v220, s[24:27], s54 offen offset:3072 sc0 sc1
    v_mfma_f32_16x16x32_bf16 v[60:63], v[144:147], a[12:15], v[60:63]
    ds_read_b64_tr_b16 v[134:135], v160 offset:34816
    v_mfma_f32_16x16x32_bf16 v[60:63], v[148:151], a[28:31], v[60:63]
    s_waitcnt lgkmcnt(4)
    v_mfma_f32_16x16x32_bf16 a[208:211], v[152:155], a[0:3], a[208:211]
    ds_read_b64_tr_b16 v[136:137], v169 offset:24576
    v_mfma_f32_16x16x32_bf16 a[208:211], v[156:159], a[16:19], a[208:211]
    v_mfma_f32_16x16x32_bf16 a[212:215], v[152:155], a[4:7], a[212:215]
    ds_read_b64_tr_b16 v[138:139], v169 offset:26624
    v_mfma_f32_16x16x32_bf16 a[212:215], v[156:159], a[20:23], a[212:215]
    v_mfma_f32_16x16x32_bf16 a[216:219], v[152:155], a[8:11], a[216:219]
    ds_read_b64_tr_b16 v[140:141], v161 offset:32768
    v_mfma_f32_16x16x32_bf16 a[216:219], v[156:159], a[24:27], a[216:219]
    v_mfma_f32_16x16x32_bf16 a[220:223], v[152:155], a[12:15], a[220:223]
    ds_read_b64_tr_b16 v[142:143], v161 offset:34816
    v_mfma_f32_16x16x32_bf16 a[220:223], v[156:159], a[28:31], a[220:223]
    s_waitcnt lgkmcnt(4)
    v_mfma_f32_16x16x32_bf16 v[224:227], v[128:131], a[0:3], v[224:227]
    s_add_u32 s52, s75, 55296
    ds_read_b64_tr_b16 v[144:145], v170 offset:24576
    v_mfma_f32_16x16x32_bf16 v[224:227], v[132:135], a[16:19], v[224:227]
    buffer_load_dwordx2 v[182:183], v193, s[36:39], s52 offen offset:0
    v_mfma_f32_16x16x32_bf16 v[228:231], v[128:131], a[4:7], v[228:231]
    ds_read_b64_tr_b16 v[146:147], v170 offset:26624
    v_mfma_f32_16x16x32_bf16 v[228:231], v[132:135], a[20:23], v[228:231]
    v_mfma_f32_16x16x32_bf16 v[232:235], v[128:131], a[8:11], v[232:235]
    ds_read_b64_tr_b16 v[148:149], v162 offset:32768
    v_mfma_f32_16x16x32_bf16 v[232:235], v[132:135], a[24:27], v[232:235]
    v_mfma_f32_16x16x32_bf16 v[236:239], v[128:131], a[12:15], v[236:239]
    ds_read_b64_tr_b16 v[150:151], v162 offset:34816
    v_mfma_f32_16x16x32_bf16 v[236:239], v[132:135], a[28:31], v[236:239]
    s_waitcnt lgkmcnt(4)
    v_mfma_f32_16x16x32_bf16 a[224:227], v[136:139], a[0:3], a[224:227]
    ds_read_b64_tr_b16 v[152:153], v171 offset:24576
    v_mfma_f32_16x16x32_bf16 a[224:227], v[140:143], a[16:19], a[224:227]
    v_mfma_f32_16x16x32_bf16 a[228:231], v[136:139], a[4:7], a[228:231]
    ds_read_b64_tr_b16 v[154:155], v171 offset:26624
    v_mfma_f32_16x16x32_bf16 a[228:231], v[140:143], a[20:23], a[228:231]
    v_mfma_f32_16x16x32_bf16 a[232:235], v[136:139], a[8:11], a[232:235]
    s_barrier
    s_add_u32 m0, s66, 24576
    v_mfma_f32_16x16x32_bf16 a[232:235], v[140:143], a[24:27], a[232:235]
    s_add_u32 s55, s15, 184448
    ds_read_b64_tr_b16 v[156:157], v163 offset:32768
    s_sub_u32 s55, s55, s74
    v_mfma_f32_16x16x32_bf16 a[236:239], v[136:139], a[12:15], a[236:239]
    ds_read_b64_tr_b16 v[158:159], v163 offset:34816
    v_mfma_f32_16x16x32_bf16 a[236:239], v[140:143], a[28:31], a[236:239]
    s_waitcnt lgkmcnt(4)
    buffer_load_dwordx4 v172, s[40:43], s55 offen lds
    v_mfma_f32_16x16x32_bf16 v[240:243], v[144:147], a[0:3], v[240:243]
    ds_read_b64_tr_b16 v[128:129], v161 offset:40960
    v_mfma_f32_16x16x32_bf16 v[240:243], v[148:151], a[16:19], v[240:243]
    buffer_load_dwordx4 v173, s[40:43], s55 offen offset:1024 lds
    v_mfma_f32_16x16x32_bf16 v[244:247], v[144:147], a[4:7], v[244:247]
    s_add_u32 m0, s66, 73728
    ds_read_b64_tr_b16 v[130:131], v161 offset:43008
    s_add_u32 s55, s3, 184448
    v_mfma_f32_16x16x32_bf16 v[244:247], v[148:151], a[20:23], v[244:247]
    s_sub_u32 s55, s55, s74
    v_mfma_f32_16x16x32_bf16 v[248:251], v[144:147], a[8:11], v[248:251]
    ds_read_b64_tr_b16 v[132:133], v161 offset:49152
    v_mfma_f32_16x16x32_bf16 v[248:251], v[148:151], a[24:27], v[248:251]
    buffer_load_dwordx4 v172, s[40:43], s55 offen lds
    v_mfma_f32_16x16x32_bf16 v[252:255], v[144:147], a[12:15], v[252:255]
    ds_read_b64_tr_b16 v[134:135], v161 offset:51200
    v_mfma_f32_16x16x32_bf16 v[252:255], v[148:151], a[28:31], v[252:255]
    s_waitcnt lgkmcnt(4)
    v_mfma_f32_16x16x32_bf16 a[240:243], v[152:155], a[0:3], a[240:243]
    ds_read_b64_tr_b16 v[136:137], v163 offset:40960
    v_mfma_f32_16x16x32_bf16 a[240:243], v[156:159], a[16:19], a[240:243]
    buffer_load_dwordx4 v173, s[40:43], s55 offen offset:1024 lds
    v_mfma_f32_16x16x32_bf16 a[244:247], v[152:155], a[4:7], a[244:247]
    ds_read_b64_tr_b16 v[138:139], v163 offset:43008
    v_mfma_f32_16x16x32_bf16 a[244:247], v[156:159], a[20:23], a[244:247]
    v_mfma_f32_16x16x32_bf16 a[248:251], v[152:155], a[8:11], a[248:251]
    ds_read_b64_tr_b16 v[140:141], v163 offset:49152
    v_mfma_f32_16x16x32_bf16 a[248:251], v[156:159], a[24:27], a[248:251]
    v_mfma_f32_16x16x32_bf16 a[252:255], v[152:155], a[12:15], a[252:255]
    ds_read_b64_tr_b16 v[142:143], v163 offset:51200
    v_mfma_f32_16x16x32_bf16 a[252:255], v[156:159], a[28:31], a[252:255]
    s_waitcnt lgkmcnt(4)
    s_waitcnt vmcnt(14)
    v_mfma_f32_16x16x32_bf16 a[224:227], v[128:131], a[32:35], a[224:227]
    ds_read_b64_tr_b16 v[144:145], v161 offset:8192
    v_mfma_f32_16x16x32_bf16 a[224:227], v[132:135], a[48:51], a[224:227]
    v_mfma_f32_16x16x32_bf16 a[228:231], v[128:131], a[36:39], a[228:231]
    ds_read_b64_tr_b16 v[146:147], v161 offset:10240
    v_mfma_f32_16x16x32_bf16 a[228:231], v[132:135], a[52:55], a[228:231]
    v_mfma_f32_16x16x32_bf16 a[232:235], v[128:131], a[40:43], a[232:235]
    ds_read_b64_tr_b16 v[148:149], v165 offset:49152
    v_mfma_f32_16x16x32_bf16 a[232:235], v[132:135], a[56:59], a[232:235]
    v_mfma_f32_16x16x32_bf16 a[236:239], v[128:131], a[44:47], a[236:239]
    ds_read_b64_tr_b16 v[150:151], v165 offset:51200
    v_mfma_f32_16x16x32_bf16 a[236:239], v[132:135], a[60:63], a[236:239]
    s_waitcnt lgkmcnt(4)
    v_mfma_f32_16x16x32_bf16 a[240:243], v[136:139], a[32:35], a[240:243]
    s_barrier
    s_add_u32 m0, s66, 98304
    v_mfma_f32_16x16x32_bf16 a[240:243], v[140:143], a[48:51], a[240:243]
    s_add_u32 s55, s65, 0
    ds_read_b64_tr_b16 v[152:153], v163 offset:8192
    s_add_u32 s55, s55, s74
    v_mfma_f32_16x16x32_bf16 a[244:247], v[136:139], a[36:39], a[244:247]
    ds_read_b64_tr_b16 v[154:155], v163 offset:10240
    v_mfma_f32_16x16x32_bf16 a[244:247], v[140:143], a[52:55], a[244:247]
    buffer_load_dwordx4 v172, s[44:47], s55 offen lds
    v_mfma_f32_16x16x32_bf16 a[248:251], v[136:139], a[40:43], a[248:251]
    ds_read_b64_tr_b16 v[156:157], v167 offset:49152
    v_mfma_f32_16x16x32_bf16 a[248:251], v[140:143], a[56:59], a[248:251]
    buffer_load_dwordx4 v173, s[44:47], s55 offen offset:1024 lds
    v_mfma_f32_16x16x32_bf16 a[252:255], v[136:139], a[44:47], a[252:255]
    s_add_u32 m0, s66, 122880
    ds_read_b64_tr_b16 v[158:159], v167 offset:51200
    s_add_u32 s55, s14, 184320
    v_mfma_f32_16x16x32_bf16 a[252:255], v[140:143], a[60:63], a[252:255]
    s_waitcnt lgkmcnt(4)
    s_add_u32 s55, s55, s74
    s_waitcnt vmcnt(11)
    s_waitcnt vmcnt(7)
    v_mfma_f32_16x16x32_bf16 a[224:227], v[144:147], a[64:67], a[224:227]
    ds_read_b64_tr_b16 v[128:129], v160 offset:40960
    v_mfma_f32_16x16x32_bf16 a[224:227], v[148:151], a[80:83], a[224:227]
    buffer_load_dwordx4 v172, s[40:43], s55 offen lds
    v_mfma_f32_16x16x32_bf16 a[228:231], v[144:147], a[68:71], a[228:231]
    ds_read_b64_tr_b16 v[130:131], v160 offset:43008
    v_mfma_f32_16x16x32_bf16 a[228:231], v[148:151], a[84:87], a[228:231]
    v_mfma_f32_16x16x32_bf16 a[232:235], v[144:147], a[72:75], a[232:235]
    ds_read_b64_tr_b16 v[132:133], v160 offset:49152
    v_mfma_f32_16x16x32_bf16 a[232:235], v[148:151], a[88:91], a[232:235]
    buffer_load_dwordx4 v173, s[40:43], s55 offen offset:1024 lds
    v_mfma_f32_16x16x32_bf16 a[236:239], v[144:147], a[76:79], a[236:239]
    ds_read_b64_tr_b16 v[134:135], v160 offset:51200
    v_mfma_f32_16x16x32_bf16 a[236:239], v[148:151], a[92:95], a[236:239]
    s_waitcnt lgkmcnt(4)
    v_mfma_f32_16x16x32_bf16 a[240:243], v[152:155], a[64:67], a[240:243]
    ds_read_b64_tr_b16 v[136:137], v162 offset:40960
    v_mfma_f32_16x16x32_bf16 a[240:243], v[156:159], a[80:83], a[240:243]
    v_mfma_f32_16x16x32_bf16 a[244:247], v[152:155], a[68:71], a[244:247]
    ds_read_b64_tr_b16 v[138:139], v162 offset:43008
    v_mfma_f32_16x16x32_bf16 a[244:247], v[156:159], a[84:87], a[244:247]
    v_mfma_f32_16x16x32_bf16 a[248:251], v[152:155], a[72:75], a[248:251]
    ds_read_b64_tr_b16 v[140:141], v162 offset:49152
    v_mfma_f32_16x16x32_bf16 a[248:251], v[156:159], a[88:91], a[248:251]
    v_mfma_f32_16x16x32_bf16 a[252:255], v[152:155], a[76:79], a[252:255]
    ds_read_b64_tr_b16 v[142:143], v162 offset:51200
    v_mfma_f32_16x16x32_bf16 a[252:255], v[156:159], a[92:95], a[252:255]
    s_waitcnt lgkmcnt(4)
    v_mfma_f32_16x16x32_bf16 v[224:227], v[128:131], a[32:35], v[224:227]
    ds_read_b64_tr_b16 v[144:145], v160 offset:8192
    v_mfma_f32_16x16x32_bf16 v[224:227], v[132:135], a[48:51], v[224:227]
    v_mfma_f32_16x16x32_bf16 v[228:231], v[128:131], a[36:39], v[228:231]
    ds_read_b64_tr_b16 v[146:147], v160 offset:10240
    v_mfma_f32_16x16x32_bf16 v[228:231], v[132:135], a[52:55], v[228:231]
    v_mfma_f32_16x16x32_bf16 v[232:235], v[128:131], a[40:43], v[232:235]
    ds_read_b64_tr_b16 v[148:149], v164 offset:49152
    v_mfma_f32_16x16x32_bf16 v[232:235], v[132:135], a[56:59], v[232:235]
    v_mfma_f32_16x16x32_bf16 v[236:239], v[128:131], a[44:47], v[236:239]
    ds_read_b64_tr_b16 v[150:151], v164 offset:51200
    v_mfma_f32_16x16x32_bf16 v[236:239], v[132:135], a[60:63], v[236:239]
    s_waitcnt lgkmcnt(4)
    v_mfma_f32_16x16x32_bf16 v[240:243], v[136:139], a[32:35], v[240:243]
    s_barrier
    v_mfma_f32_16x16x32_bf16 v[240:243], v[140:143], a[48:51], v[240:243]
    ds_read_b64_tr_b16 v[152:153], v162 offset:8192
    v_mfma_f32_16x16x32_bf16 v[244:247], v[136:139], a[36:39], v[244:247]
    ds_read_b64_tr_b16 v[154:155], v162 offset:10240
    v_mfma_f32_16x16x32_bf16 v[244:247], v[140:143], a[52:55], v[244:247]
    ds_write_b128 v195, a[224:227] offset:32768
    v_mfma_f32_16x16x32_bf16 v[248:251], v[136:139], a[40:43], v[248:251]
    ds_read_b64_tr_b16 v[156:157], v166 offset:49152
    v_mfma_f32_16x16x32_bf16 v[248:251], v[140:143], a[56:59], v[248:251]
    ds_write_b128 v195, a[228:231] offset:36864
    v_mfma_f32_16x16x32_bf16 v[252:255], v[136:139], a[44:47], v[252:255]
    ds_read_b64_tr_b16 v[158:159], v166 offset:51200
    v_add_u32 v195, 0x10000, v195
    v_mfma_f32_16x16x32_bf16 v[252:255], v[140:143], a[60:63], v[252:255]
    s_waitcnt lgkmcnt(6)
    ds_write_b128 v195, a[232:235] offset:40960
    v_mfma_f32_16x16x32_bf16 v[224:227], v[144:147], a[64:67], v[224:227]
    ds_read_b64_tr_b16 v[128:129], v169 offset:8192
    v_mfma_f32_16x16x32_bf16 v[224:227], v[148:151], a[80:83], v[224:227]
    ds_write_b128 v195, a[236:239] offset:45056
    v_mfma_f32_16x16x32_bf16 v[228:231], v[144:147], a[68:71], v[228:231]
    ds_read_b64_tr_b16 v[130:131], v169 offset:10240
    v_add_u32 v195, 0x10000, v195
    v_mfma_f32_16x16x32_bf16 v[228:231], v[148:151], a[84:87], v[228:231]
    ds_write_b128 v195, a[240:243] offset:0
    v_mfma_f32_16x16x32_bf16 v[232:235], v[144:147], a[72:75], v[232:235]
    ds_read_b64_tr_b16 v[132:133], v161 offset:16384
    v_mfma_f32_16x16x32_bf16 v[232:235], v[148:151], a[88:91], v[232:235]
    ds_write_b128 v195, a[244:247] offset:4096
    v_mfma_f32_16x16x32_bf16 v[236:239], v[144:147], a[76:79], v[236:239]
    ds_read_b64_tr_b16 v[134:135], v161 offset:18432
    v_mfma_f32_16x16x32_bf16 v[236:239], v[148:151], a[92:95], v[236:239]
    s_waitcnt lgkmcnt(8)
    ds_write_b128 v195, a[248:251] offset:24576
    v_mfma_f32_16x16x32_bf16 v[240:243], v[152:155], a[64:67], v[240:243]
    ds_read_b64_tr_b16 v[136:137], v171 offset:8192
    v_mfma_f32_16x16x32_bf16 v[240:243], v[156:159], a[80:83], v[240:243]
    ds_write_b128 v195, a[252:255] offset:28672
    v_mfma_f32_16x16x32_bf16 v[244:247], v[152:155], a[68:71], v[244:247]
    ds_read_b64_tr_b16 v[138:139], v171 offset:10240
    v_mfma_f32_16x16x32_bf16 v[244:247], v[156:159], a[84:87], v[244:247]
    v_mfma_f32_16x16x32_bf16 v[248:251], v[152:155], a[72:75], v[248:251]
    s_waitcnt lgkmcnt(1)
    s_waitcnt vmcnt(4)
    s_barrier
    s_add_u32 m0, s66, 40960
    v_mfma_f32_16x16x32_bf16 v[248:251], v[156:159], a[88:91], v[248:251]
    s_add_u32 s55, s15, 184320
    ds_read_b64_tr_b16 v[140:141], v163 offset:16384
    s_add_u32 s55, s55, s74
    v_mfma_f32_16x16x32_bf16 v[252:255], v[152:155], a[76:79], v[252:255]
    ds_read_b64_tr_b16 v[142:143], v163 offset:18432
    v_mfma_f32_16x16x32_bf16 v[252:255], v[156:159], a[92:95], v[252:255]
    buffer_load_dwordx4 v172, s[40:43], s55 offen lds
    v_mfma_f32_16x16x32_bf16 a[192:195], v[128:131], a[32:35], a[192:195]
    ds_read_b64_tr_b16 v[144:145], v161 offset:24576
    v_mfma_f32_16x16x32_bf16 a[192:195], v[132:135], a[48:51], a[192:195]
    buffer_load_dwordx4 v173, s[40:43], s55 offen offset:1024 lds
    v_mfma_f32_16x16x32_bf16 a[196:199], v[128:131], a[36:39], a[196:199]
    s_add_u32 m0, s66, 49152
    ds_read_b64_tr_b16 v[146:147], v161 offset:26624
    s_add_u32 s55, s3, 184320
    v_mfma_f32_16x16x32_bf16 a[196:199], v[132:135], a[52:55], a[196:199]
    s_add_u32 s55, s55, s74
    ds_read_b128 v[64:67], v196 offset:32768
    v_mfma_f32_16x16x32_bf16 a[200:203], v[128:131], a[40:43], a[200:203]
    ds_read_b64_tr_b16 v[148:149], v165 offset:8192
    v_mfma_f32_16x16x32_bf16 a[200:203], v[132:135], a[56:59], a[200:203]
    buffer_load_dwordx4 v172, s[40:43], s55 offen lds
    v_mfma_f32_16x16x32_bf16 a[204:207], v[128:131], a[44:47], a[204:207]
    ds_read_b64_tr_b16 v[150:151], v165 offset:10240
    v_mfma_f32_16x16x32_bf16 a[204:207], v[132:135], a[60:63], a[204:207]
    s_waitcnt lgkmcnt(5)
    ds_read_b128 v[68:71], v196 offset:36864
    v_add_u32 v196, 0x10000, v196
    v_mfma_f32_16x16x32_bf16 a[208:211], v[136:139], a[32:35], a[208:211]
    ds_read_b64_tr_b16 v[152:153], v163 offset:24576
    v_mfma_f32_16x16x32_bf16 a[208:211], v[140:143], a[48:51], a[208:211]
    buffer_load_dwordx4 v173, s[40:43], s55 offen offset:1024 lds
    v_mfma_f32_16x16x32_bf16 a[212:215], v[136:139], a[36:39], a[212:215]
    ds_read_b64_tr_b16 v[154:155], v163 offset:26624
    v_mfma_f32_16x16x32_bf16 a[212:215], v[140:143], a[52:55], a[212:215]
    ds_read_b128 v[72:75], v196 offset:40960
    v_mfma_f32_16x16x32_bf16 a[216:219], v[136:139], a[40:43], a[216:219]
    ds_read_b64_tr_b16 v[156:157], v167 offset:8192
    v_mfma_f32_16x16x32_bf16 a[216:219], v[140:143], a[56:59], a[216:219]
    ds_read_b128 v[76:79], v196 offset:45056
    v_add_u32 v196, 0x10000, v196
    v_mfma_f32_16x16x32_bf16 a[220:223], v[136:139], a[44:47], a[220:223]
    ds_read_b64_tr_b16 v[158:159], v167 offset:10240
    v_mfma_f32_16x16x32_bf16 a[220:223], v[140:143], a[60:63], a[220:223]
    s_waitcnt lgkmcnt(7)
    ds_read_b128 v[80:83], v196 offset:0
    ds_read_b128 v[84:87], v196 offset:4096
    ds_read_b128 v[88:91], v196 offset:24576
    ds_read_b128 v[92:95], v196 offset:28672
    s_waitcnt lgkmcnt(0)
    v_mfma_f32_16x16x32_bf16 a[192:195], v[144:147], a[64:67], a[192:195]
    ds_read_b64_tr_b16 v[128:129], v168 offset:8192
    v_add_f32 v224, v224, v64
    v_add_f32 v225, v225, v65
    v_mfma_f32_16x16x32_bf16 a[192:195], v[148:151], a[80:83], a[192:195]
    v_add_f32 v226, v226, v66
    v_add_f32 v227, v227, v67
    v_mfma_f32_16x16x32_bf16 a[196:199], v[144:147], a[68:71], a[196:199]
    ds_read_b64_tr_b16 v[130:131], v168 offset:10240
    v_add_f32 v228, v228, v68
    v_mfma_f32_16x16x32_bf16 a[196:199], v[148:151], a[84:87], a[196:199]
    v_add_f32 v229, v229, v69
    v_add_f32 v230, v230, v70
    v_mfma_f32_16x16x32_bf16 a[200:203], v[144:147], a[72:75], a[200:203]
    ds_read_b64_tr_b16 v[132:133], v160 offset:16384
    v_add_f32 v231, v231, v71
    v_cvt_pk_bf16_f32 v224, v224, v225
    v_mfma_f32_16x16x32_bf16 a[200:203], v[148:151], a[88:91], a[200:203]
    v_cvt_pk_bf16_f32 v225, v226, v227
    v_add_f32 v232, v232, v72
    v_mfma_f32_16x16x32_bf16 a[204:207], v[144:147], a[76:79], a[204:207]
    ds_read_b64_tr_b16 v[134:135], v160 offset:18432
    v_cvt_pk_bf16_f32 v226, v228, v229
    v_mfma_f32_16x16x32_bf16 a[204:207], v[148:151], a[92:95], a[204:207]
    v_cvt_pk_bf16_f32 v227, v230, v231
    v_add_f32 v233, v233, v73
    v_mfma_f32_16x16x32_bf16 a[208:211], v[152:155], a[64:67], a[208:211]
    ds_read_b64_tr_b16 v[136:137], v170 offset:8192
    v_add_f32 v234, v234, v74
    v_add_f32 v235, v235, v75
    v_mfma_f32_16x16x32_bf16 a[208:211], v[156:159], a[80:83], a[208:211]
    buffer_store_dwordx4 v[224:227], v192, s[24:27], s11 offen offset:0 sc0 sc1
    v_add_f32 v236, v236, v76
    v_mfma_f32_16x16x32_bf16 a[212:215], v[152:155], a[68:71], a[212:215]
    ds_read_b64_tr_b16 v[138:139], v170 offset:10240
    v_add_f32 v237, v237, v77
    v_mfma_f32_16x16x32_bf16 a[212:215], v[156:159], a[84:87], a[212:215]
    v_add_f32 v238, v238, v78
    v_add_f32 v239, v239, v79
    v_mfma_f32_16x16x32_bf16 a[216:219], v[152:155], a[72:75], a[216:219]
    ds_read_b64_tr_b16 v[140:141], v162 offset:16384
    v_cvt_pk_bf16_f32 v232, v232, v233
    v_cvt_pk_bf16_f32 v233, v234, v235
    v_mfma_f32_16x16x32_bf16 a[216:219], v[156:159], a[88:91], a[216:219]
    v_cvt_pk_bf16_f32 v234, v236, v237
    v_cvt_pk_bf16_f32 v235, v238, v239
    v_mfma_f32_16x16x32_bf16 a[220:223], v[152:155], a[76:79], a[220:223]
    ds_read_b64_tr_b16 v[142:143], v162 offset:18432
    v_add_f32 v240, v240, v80
    v_mfma_f32_16x16x32_bf16 a[220:223], v[156:159], a[92:95], a[220:223]
    s_waitcnt lgkmcnt(4)
    buffer_store_dwordx4 v[232:235], v192, s[24:27], s11 offen offset:1024 sc0 sc1
    v_add_f32 v241, v241, v81
    v_mfma_f32_16x16x32_bf16 v[32:35], v[128:131], a[32:35], v[32:35]
    ds_read_b64_tr_b16 v[144:145], v160 offset:24576
    v_add_f32 v242, v242, v82
    v_mfma_f32_16x16x32_bf16 v[32:35], v[132:135], a[48:51], v[32:35]
    v_add_f32 v243, v243, v83
    v_add_f32 v244, v244, v84
    v_mfma_f32_16x16x32_bf16 v[36:39], v[128:131], a[36:39], v[36:39]
    ds_read_b64_tr_b16 v[146:147], v160 offset:26624
    v_add_f32 v245, v245, v85
    v_mfma_f32_16x16x32_bf16 v[36:39], v[132:135], a[52:55], v[36:39]
    v_add_f32 v246, v246, v86
    v_add_f32 v247, v247, v87
    v_mfma_f32_16x16x32_bf16 v[40:43], v[128:131], a[40:43], v[40:43]
    ds_read_b64_tr_b16 v[148:149], v164 offset:8192
    v_cvt_pk_bf16_f32 v240, v240, v241
    v_mfma_f32_16x16x32_bf16 v[40:43], v[132:135], a[56:59], v[40:43]
    v_cvt_pk_bf16_f32 v241, v242, v243
    v_add_f32 v248, v248, v88
    v_mfma_f32_16x16x32_bf16 v[44:47], v[128:131], a[44:47], v[44:47]
    ds_read_b64_tr_b16 v[150:151], v164 offset:10240
    v_cvt_pk_bf16_f32 v242, v244, v245
    v_mfma_f32_16x16x32_bf16 v[44:47], v[132:135], a[60:63], v[44:47]
    s_waitcnt lgkmcnt(4)
    v_cvt_pk_bf16_f32 v243, v246, v247
    v_add_f32 v249, v249, v89
    v_mfma_f32_16x16x32_bf16 v[48:51], v[136:139], a[32:35], v[48:51]
    s_waitcnt vmcnt(4)
    s_barrier
    v_add_u32 v195, 0xfffe0000, v195
    v_add_f32 v250, v250, v90
    v_mfma_f32_16x16x32_bf16 v[48:51], v[140:143], a[48:51], v[48:51]
    ds_read_b64_tr_b16 v[152:153], v162 offset:24576
    v_add_f32 v251, v251, v91
    v_mfma_f32_16x16x32_bf16 v[52:55], v[136:139], a[36:39], v[52:55]
    ds_read_b64_tr_b16 v[154:155], v162 offset:26624
    v_add_f32 v252, v252, v92
    v_mfma_f32_16x16x32_bf16 v[52:55], v[140:143], a[52:55], v[52:55]
    ds_write_b128 v195, a[192:195] offset:32768
    v_mfma_f32_16x16x32_bf16 v[56:59], v[136:139], a[40:43], v[56:59]
    ds_read_b64_tr_b16 v[156:157], v166 offset:8192
    v_add_f32 v253, v253, v93
    v_mfma_f32_16x16x32_bf16 v[56:59], v[140:143], a[56:59], v[56:59]
    ds_write_b128 v195, a[196:199] offset:36864
    v_mfma_f32_16x16x32_bf16 v[60:63], v[136:139], a[44:47], v[60:63]
    ds_read_b64_tr_b16 v[158:159], v166 offset:10240
    v_add_u32 v195, 0x10000, v195
    v_add_f32 v254, v254, v94
    v_mfma_f32_16x16x32_bf16 v[60:63], v[140:143], a[60:63], v[60:63]
    s_waitcnt lgkmcnt(6)
    ds_write_b128 v195, a[200:203] offset:40960
    v_mfma_f32_16x16x32_bf16 v[32:35], v[144:147], a[64:67], v[32:35]
    ds_read_b64_tr_b16 v[128:129], v167 offset:32768
    v_add_f32 v255, v255, v95
    v_cvt_pk_bf16_f32 v248, v248, v249
    v_mfma_f32_16x16x32_bf16 v[32:35], v[148:151], a[80:83], v[32:35]
    ds_write_b128 v195, a[204:207] offset:45056
    v_cvt_pk_bf16_f32 v249, v250, v251
    v_mfma_f32_16x16x32_bf16 v[36:39], v[144:147], a[68:71], v[36:39]
    ds_read_b64_tr_b16 v[130:131], v167 offset:34816
    v_add_u32 v195, 0x10000, v195
    v_cvt_pk_bf16_f32 v250, v252, v253
    v_mfma_f32_16x16x32_bf16 v[36:39], v[148:151], a[84:87], v[36:39]
    ds_write_b128 v195, a[208:211] offset:0
    buffer_store_dwordx4 v[240:243], v192, s[24:27], s20 offen offset:0 sc0 sc1
    v_mfma_f32_16x16x32_bf16 v[40:43], v[144:147], a[72:75], v[40:43]
    ds_read_b64_tr_b16 v[132:133], v167 offset:57344
    v_cvt_pk_bf16_f32 v251, v254, v255
    v_mfma_f32_16x16x32_bf16 v[40:43], v[148:151], a[88:91], v[40:43]
    ds_write_b128 v195, a[212:215] offset:4096
    v_mfma_f32_16x16x32_bf16 v[44:47], v[144:147], a[76:79], v[44:47]
    ds_read_b64_tr_b16 v[134:135], v167 offset:59392
    v_mfma_f32_16x16x32_bf16 v[44:47], v[148:151], a[92:95], v[44:47]
    s_waitcnt lgkmcnt(8)
    ds_write_b128 v195, a[216:219] offset:24576
    buffer_store_dwordx4 v[248:251], v192, s[24:27], s20 offen offset:1024 sc0 sc1
    v_mfma_f32_16x16x32_bf16 v[48:51], v[152:155], a[64:67], v[48:51]
    ds_read_b64_tr_b16 v[136:137], v163 offset:40960
    v_mfma_f32_16x16x32_bf16 v[48:51], v[156:159], a[80:83], v[48:51]
    ds_write_b128 v195, a[220:223] offset:28672
    v_mfma_f32_16x16x32_bf16 v[52:55], v[152:155], a[68:71], v[52:55]
    ds_read_b64_tr_b16 v[138:139], v163 offset:43008
    v_mfma_f32_16x16x32_bf16 v[52:55], v[156:159], a[84:87], v[52:55]
    v_mfma_f32_16x16x32_bf16 v[56:59], v[152:155], a[72:75], v[56:59]
    s_waitcnt lgkmcnt(1)
    s_waitcnt vmcnt(4)
    s_barrier
    v_add_u32 v196, 0xfffe0000, v196
    v_mfma_f32_16x16x32_bf16 v[56:59], v[156:159], a[88:91], v[56:59]
    ds_read_b64_tr_b16 v[140:141], v163 offset:49152
    v_mfma_f32_16x16x32_bf16 v[60:63], v[152:155], a[76:79], v[60:63]
    ds_read_b64_tr_b16 v[142:143], v163 offset:51200
    v_mfma_f32_16x16x32_bf16 v[60:63], v[156:159], a[92:95], v[60:63]
    ds_read_b128 v[96:99], v196 offset:32768
    v_mfma_f32_16x16x32_bf16 a[176:179], v[128:131], a[32:35], a[176:179]
    ds_read_b64_tr_b16 v[144:145], v166 offset:32768
    v_mfma_f32_16x16x32_bf16 a[176:179], v[132:135], a[48:51], a[176:179]
    ds_read_b128 v[100:103], v196 offset:36864
    v_add_u32 v196, 0x10000, v196
    v_mfma_f32_16x16x32_bf16 a[180:183], v[128:131], a[36:39], a[180:183]
    ds_read_b64_tr_b16 v[146:147], v166 offset:34816
    v_mfma_f32_16x16x32_bf16 a[180:183], v[132:135], a[52:55], a[180:183]
    ds_read_b128 v[104:107], v196 offset:40960
    v_mfma_f32_16x16x32_bf16 a[184:187], v[128:131], a[40:43], a[184:187]
    ds_read_b64_tr_b16 v[148:149], v166 offset:57344
    v_mfma_f32_16x16x32_bf16 a[184:187], v[132:135], a[56:59], a[184:187]
    ds_read_b128 v[108:111], v196 offset:45056
    v_add_u32 v196, 0x10000, v196
    v_mfma_f32_16x16x32_bf16 a[188:191], v[128:131], a[44:47], a[188:191]
    ds_read_b64_tr_b16 v[150:151], v166 offset:59392
    v_mfma_f32_16x16x32_bf16 a[188:191], v[132:135], a[60:63], a[188:191]
    s_waitcnt lgkmcnt(8)
    ds_read_b128 v[112:115], v196 offset:0
    v_mfma_f32_16x16x32_bf16 a[176:179], v[136:139], a[64:67], a[176:179]
    ds_read_b64_tr_b16 v[152:153], v162 offset:40960
    v_mfma_f32_16x16x32_bf16 a[176:179], v[140:143], a[80:83], a[176:179]
    ds_read_b128 v[116:119], v196 offset:4096
    v_mfma_f32_16x16x32_bf16 a[180:183], v[136:139], a[68:71], a[180:183]
    ds_read_b64_tr_b16 v[154:155], v162 offset:43008
    v_mfma_f32_16x16x32_bf16 a[180:183], v[140:143], a[84:87], a[180:183]
    ds_read_b128 v[120:123], v196 offset:24576
    v_mfma_f32_16x16x32_bf16 a[184:187], v[136:139], a[72:75], a[184:187]
    ds_read_b64_tr_b16 v[156:157], v162 offset:49152
    v_mfma_f32_16x16x32_bf16 a[184:187], v[140:143], a[88:91], a[184:187]
    ds_read_b128 v[124:127], v196 offset:28672
    v_mfma_f32_16x16x32_bf16 a[188:191], v[136:139], a[76:79], a[188:191]
    ds_read_b64_tr_b16 v[158:159], v162 offset:51200
    v_mfma_f32_16x16x32_bf16 a[188:191], v[140:143], a[92:95], a[188:191]
    s_waitcnt lgkmcnt(8)
    s_waitcnt lgkmcnt(1)
    v_mfma_f32_16x16x32_bf16 v[16:19], v[144:147], a[32:35], v[16:19]
    s_waitcnt vmcnt(0)
    s_barrier
    s_lshl2_add_u32 s49, s67, s9
    v_add_f32 v32, v32, v96
    v_add_f32 v33, v33, v97
    v_mfma_f32_16x16x32_bf16 v[16:19], v[148:151], a[48:51], v[16:19]
    s_add_u32 s49, s49, 0
    ds_read_b64_tr_b16 v[128:129], v161 offset:57344
    v_add_f32 v34, v34, v98
    v_mfma_f32_16x16x32_bf16 v[20:23], v[144:147], a[36:39], v[20:23]
    ds_read_b64_tr_b16 v[130:131], v161 offset:59392
    v_add_f32 v35, v35, v99
    v_add_f32 v36, v36, v100
    v_mfma_f32_16x16x32_bf16 v[20:23], v[148:151], a[52:55], v[20:23]
    buffer_store_dword v218, v216, s[24:27], s49 offen sc0 sc1
    v_add_f32 v37, v37, v101
    v_mfma_f32_16x16x32_bf16 v[24:27], v[144:147], a[40:43], v[24:27]
    ds_read_b64_tr_b16 v[132:133], v161 offset:0
    v_add_f32 v38, v38, v102
    v_add_f32 v39, v39, v103
    v_mfma_f32_16x16x32_bf16 v[24:27], v[148:151], a[56:59], v[24:27]
    v_cvt_pk_bf16_f32 v32, v32, v33
    v_add_f32 v40, v40, v104
    v_mfma_f32_16x16x32_bf16 v[28:31], v[144:147], a[44:47], v[28:31]
    ds_read_b64_tr_b16 v[134:135], v161 offset:2048
    v_cvt_pk_bf16_f32 v33, v34, v35
    v_mfma_f32_16x16x32_bf16 v[28:31], v[148:151], a[60:63], v[28:31]
    s_waitcnt lgkmcnt(4)
    v_cvt_pk_bf16_f32 v34, v36, v37
    v_cvt_pk_bf16_f32 v35, v38, v39
    v_mfma_f32_16x16x32_bf16 v[16:19], v[152:155], a[64:67], v[16:19]
    s_barrier
    v_add_u32 v195, 0xfffe0000, v195
    v_add_f32 v41, v41, v105
    v_add_f32 v42, v42, v106
    v_mfma_f32_16x16x32_bf16 v[16:19], v[156:159], a[80:83], v[16:19]
    ds_read_b64_tr_b16 v[136:137], v165 offset:0
    v_add_f32 v43, v43, v107
    v_mfma_f32_16x16x32_bf16 v[20:23], v[152:155], a[68:71], v[20:23]
    ds_read_b64_tr_b16 v[138:139], v165 offset:2048
    v_add_f32 v44, v44, v108
    v_add_f32 v45, v45, v109
    v_mfma_f32_16x16x32_bf16 v[20:23], v[156:159], a[84:87], v[20:23]
    ds_write_b128 v195, a[176:179] offset:32768
    buffer_store_dwordx4 v[32:35], v192, s[24:27], s6 offen offset:0 sc0 sc1
    v_mfma_f32_16x16x32_bf16 v[24:27], v[152:155], a[72:75], v[24:27]
    ds_read_b64_tr_b16 v[140:141], v165 offset:24576
    v_add_f32 v46, v46, v110
    v_add_f32 v47, v47, v111
    v_mfma_f32_16x16x32_bf16 v[24:27], v[156:159], a[88:91], v[24:27]
    ds_write_b128 v195, a[180:183] offset:36864
    v_cvt_pk_bf16_f32 v40, v40, v41
    v_mfma_f32_16x16x32_bf16 v[28:31], v[152:155], a[76:79], v[28:31]
    ds_read_b64_tr_b16 v[142:143], v165 offset:26624
    v_add_u32 v195, 0x10000, v195
    v_cvt_pk_bf16_f32 v41, v42, v43
    v_cvt_pk_bf16_f32 v42, v44, v45
    v_mfma_f32_16x16x32_bf16 v[28:31], v[156:159], a[92:95], v[28:31]
    s_waitcnt lgkmcnt(6)
    ds_write_b128 v195, a[184:187] offset:40960
    v_cvt_pk_bf16_f32 v43, v46, v47
    v_mfma_f32_16x16x32_bf16 a[160:163], v[128:131], a[96:99], a[160:163]
    ds_read_b64_tr_b16 v[144:145], v169 offset:16384
    v_add_f32 v48, v48, v112
    v_add_f32 v49, v49, v113
    v_mfma_f32_16x16x32_bf16 a[160:163], v[132:135], a[112:115], a[160:163]
    ds_write_b128 v195, a[188:191] offset:45056
    v_add_f32 v50, v50, v114
    v_mfma_f32_16x16x32_bf16 a[164:167], v[128:131], a[100:103], a[164:167]
    ds_read_b64_tr_b16 v[146:147], v169 offset:18432
    v_add_f32 v51, v51, v115
    v_mfma_f32_16x16x32_bf16 a[164:167], v[132:135], a[116:119], a[164:167]
    buffer_store_dwordx4 v[40:43], v192, s[24:27], s6 offen offset:1024 sc0 sc1
    v_add_f32 v52, v52, v116
    v_mfma_f32_16x16x32_bf16 a[168:171], v[128:131], a[104:107], a[168:171]
    s_waitcnt lgkmcnt(1)
    s_barrier
    v_add_u32 v196, 0xfffe0000, v196
    v_add_f32 v53, v53, v117
    v_add_f32 v54, v54, v118
    v_mfma_f32_16x16x32_bf16 a[168:171], v[132:135], a[120:123], a[168:171]
    ds_read_b64_tr_b16 v[148:149], v165 offset:16384
    v_add_f32 v55, v55, v119
    v_mfma_f32_16x16x32_bf16 a[172:175], v[128:131], a[108:111], a[172:175]
    ds_read_b64_tr_b16 v[150:151], v165 offset:18432
    v_cvt_pk_bf16_f32 v48, v48, v49
    v_mfma_f32_16x16x32_bf16 a[172:175], v[132:135], a[124:127], a[172:175]
    ds_read_b128 v[64:67], v196 offset:32768
    v_cvt_pk_bf16_f32 v49, v50, v51
    v_mfma_f32_16x16x32_bf16 a[160:163], v[136:139], a[128:131], a[160:163]
    ds_read_b64_tr_b16 v[152:153], v165 offset:32768
    v_cvt_pk_bf16_f32 v50, v52, v53
    v_cvt_pk_bf16_f32 v51, v54, v55
    v_mfma_f32_16x16x32_bf16 a[160:163], v[140:143], a[144:147], a[160:163]
    buffer_store_dwordx4 v[48:51], v192, s[24:27], s10 offen offset:0 sc0 sc1
    v_add_f32 v56, v56, v120
    v_mfma_f32_16x16x32_bf16 a[164:167], v[136:139], a[132:135], a[164:167]
    ds_read_b64_tr_b16 v[154:155], v165 offset:34816
    v_add_f32 v57, v57, v121
    v_mfma_f32_16x16x32_bf16 a[164:167], v[140:143], a[148:151], a[164:167]
    ds_read_b128 v[68:71], v196 offset:36864
    v_add_u32 v196, 0x10000, v196
    v_mfma_f32_16x16x32_bf16 a[168:171], v[136:139], a[136:139], a[168:171]
    ds_read_b64_tr_b16 v[156:157], v165 offset:57344
    v_add_f32 v58, v58, v122
    v_mfma_f32_16x16x32_bf16 a[168:171], v[140:143], a[152:155], a[168:171]
    ds_read_b128 v[72:75], v196 offset:40960
    v_add_f32 v59, v59, v123
    v_mfma_f32_16x16x32_bf16 a[172:175], v[136:139], a[140:143], a[172:175]
    ds_read_b64_tr_b16 v[158:159], v165 offset:59392
    v_add_f32 v60, v60, v124
    v_mfma_f32_16x16x32_bf16 a[172:175], v[140:143], a[156:159], a[172:175]
    s_waitcnt lgkmcnt(7)
    ds_read_b128 v[76:79], v196 offset:45056
    v_add_f32 v61, v61, v125
    s_waitcnt lgkmcnt(0)
    v_add_f32 v62, v62, v126
    v_add_f32 v63, v63, v127
    v_cvt_pk_bf16_f32 v56, v56, v57
    v_cvt_pk_bf16_f32 v57, v58, v59
    v_cvt_pk_bf16_f32 v58, v60, v61
    v_cvt_pk_bf16_f32 v59, v62, v63
    buffer_store_dwordx4 v[56:59], v192, s[24:27], s10 offen offset:1024 sc0 sc1
    v_mfma_f32_16x16x32_bf16 a[160:163], v[144:147], a[0:3], a[160:163]
    ds_read_b64_tr_b16 v[128:129], v161 offset:40960
    v_add_f32 v16, v16, v64
    v_add_f32 v17, v17, v65
    v_mfma_f32_16x16x32_bf16 a[160:163], v[148:151], a[16:19], a[160:163]
    v_add_f32 v18, v18, v66
    v_add_f32 v19, v19, v67
    v_mfma_f32_16x16x32_bf16 a[164:167], v[144:147], a[4:7], a[164:167]
    ds_read_b64_tr_b16 v[130:131], v161 offset:43008
    v_add_f32 v20, v20, v68
    v_mfma_f32_16x16x32_bf16 a[164:167], v[148:151], a[20:23], a[164:167]
    v_add_f32 v21, v21, v69
    v_add_f32 v22, v22, v70
    v_mfma_f32_16x16x32_bf16 a[168:171], v[144:147], a[8:11], a[168:171]
    ds_read_b64_tr_b16 v[132:133], v161 offset:49152
    v_add_f32 v23, v23, v71
    v_cvt_pk_bf16_f32 v16, v16, v17
    v_mfma_f32_16x16x32_bf16 a[168:171], v[148:151], a[24:27], a[168:171]
    v_cvt_pk_bf16_f32 v17, v18, v19
    v_add_f32 v24, v24, v72
    v_mfma_f32_16x16x32_bf16 a[172:175], v[144:147], a[12:15], a[172:175]
    ds_read_b64_tr_b16 v[134:135], v161 offset:51200
    v_cvt_pk_bf16_f32 v18, v20, v21
    v_mfma_f32_16x16x32_bf16 a[172:175], v[148:151], a[28:31], a[172:175]
    v_cvt_pk_bf16_f32 v19, v22, v23
    v_add_f32 v25, v25, v73
    v_mfma_f32_16x16x32_bf16 a[160:163], v[152:155], a[32:35], a[160:163]
    ds_read_b64_tr_b16 v[136:137], v160 offset:57344
    v_add_f32 v26, v26, v74
    v_add_f32 v27, v27, v75
    v_mfma_f32_16x16x32_bf16 a[160:163], v[156:159], a[48:51], a[160:163]
    buffer_store_dwordx4 v[16:19], v192, s[24:27], s5 offen offset:0 sc0 sc1
    v_add_f32 v28, v28, v76
    v_mfma_f32_16x16x32_bf16 a[164:167], v[152:155], a[36:39], a[164:167]
    ds_read_b64_tr_b16 v[138:139], v160 offset:59392
    v_add_f32 v29, v29, v77
    v_mfma_f32_16x16x32_bf16 a[164:167], v[156:159], a[52:55], a[164:167]
    v_add_f32 v30, v30, v78
    v_add_f32 v31, v31, v79
    v_mfma_f32_16x16x32_bf16 a[168:171], v[152:155], a[40:43], a[168:171]
    ds_read_b64_tr_b16 v[140:141], v160 offset:0
    v_cvt_pk_bf16_f32 v24, v24, v25
    v_mfma_f32_16x16x32_bf16 a[168:171], v[156:159], a[56:59], a[168:171]
    v_cvt_pk_bf16_f32 v25, v26, v27
    v_mfma_f32_16x16x32_bf16 a[172:175], v[152:155], a[44:47], a[172:175]
    ds_read_b64_tr_b16 v[142:143], v160 offset:2048
    v_cvt_pk_bf16_f32 v26, v28, v29
    v_mfma_f32_16x16x32_bf16 a[172:175], v[156:159], a[60:63], a[172:175]
    s_waitcnt lgkmcnt(4)
    v_cvt_pk_bf16_f32 v27, v30, v31
    v_mfma_f32_16x16x32_bf16 a[160:163], v[128:131], a[64:67], a[160:163]
    ds_read_b64_tr_b16 v[144:145], v164 offset:0
    v_mfma_f32_16x16x32_bf16 a[160:163], v[132:135], a[80:83], a[160:163]
    buffer_store_dwordx4 v[24:27], v192, s[24:27], s5 offen offset:1024 sc0 sc1
    v_mfma_f32_16x16x32_bf16 a[164:167], v[128:131], a[68:71], a[164:167]
    ds_read_b64_tr_b16 v[146:147], v164 offset:2048
    v_mfma_f32_16x16x32_bf16 a[164:167], v[132:135], a[84:87], a[164:167]
    v_mfma_f32_16x16x32_bf16 a[168:171], v[128:131], a[72:75], a[168:171]
    ds_read_b64_tr_b16 v[148:149], v164 offset:24576
    v_mfma_f32_16x16x32_bf16 a[168:171], v[132:135], a[88:91], a[168:171]
    v_mfma_f32_16x16x32_bf16 a[172:175], v[128:131], a[76:79], a[172:175]
    ds_read_b64_tr_b16 v[150:151], v164 offset:26624
    v_mfma_f32_16x16x32_bf16 a[172:175], v[132:135], a[92:95], a[172:175]
    s_waitcnt lgkmcnt(4)
    v_mfma_f32_16x16x32_bf16 v[0:3], v[136:139], a[96:99], v[0:3]
    ds_read_b64_tr_b16 v[152:153], v168 offset:16384
    v_mfma_f32_16x16x32_bf16 v[0:3], v[140:143], a[112:115], v[0:3]
    v_mfma_f32_16x16x32_bf16 v[4:7], v[136:139], a[100:103], v[4:7]
    ds_read_b64_tr_b16 v[154:155], v168 offset:18432
    v_mfma_f32_16x16x32_bf16 v[4:7], v[140:143], a[116:119], v[4:7]
    v_mfma_f32_16x16x32_bf16 v[8:11], v[136:139], a[104:107], v[8:11]
    ds_read_b64_tr_b16 v[156:157], v164 offset:16384
    v_mfma_f32_16x16x32_bf16 v[8:11], v[140:143], a[120:123], v[8:11]
    v_mfma_f32_16x16x32_bf16 v[12:15], v[136:139], a[108:111], v[12:15]
    ds_read_b64_tr_b16 v[158:159], v164 offset:18432
    v_mfma_f32_16x16x32_bf16 v[12:15], v[140:143], a[124:127], v[12:15]
    s_waitcnt lgkmcnt(4)
    v_mfma_f32_16x16x32_bf16 v[0:3], v[144:147], a[128:131], v[0:3]
    s_barrier
    v_add_u32 v195, 0xffff0000, v195
    v_mfma_f32_16x16x32_bf16 v[0:3], v[148:151], a[144:147], v[0:3]
    ds_read_b64_tr_b16 v[128:129], v164 offset:32768
    v_mfma_f32_16x16x32_bf16 v[4:7], v[144:147], a[132:135], v[4:7]
    ds_read_b64_tr_b16 v[130:131], v164 offset:34816
    v_mfma_f32_16x16x32_bf16 v[4:7], v[148:151], a[148:151], v[4:7]
    ds_write_b128 v195, a[160:163] offset:32768
    v_mfma_f32_16x16x32_bf16 v[8:11], v[144:147], a[136:139], v[8:11]
    ds_read_b64_tr_b16 v[132:133], v164 offset:57344
    v_mfma_f32_16x16x32_bf16 v[8:11], v[148:151], a[152:155], v[8:11]
    ds_write_b128 v195, a[164:167] offset:36864
    v_mfma_f32_16x16x32_bf16 v[12:15], v[144:147], a[140:143], v[12:15]
    ds_read_b64_tr_b16 v[134:135], v164 offset:59392
    v_add_u32 v195, 0x10000, v195
    v_mfma_f32_16x16x32_bf16 v[12:15], v[148:151], a[156:159], v[12:15]
    s_waitcnt lgkmcnt(6)
    ds_write_b128 v195, a[168:171] offset:40960
    v_mfma_f32_16x16x32_bf16 v[0:3], v[152:155], a[0:3], v[0:3]
    ds_read_b64_tr_b16 v[136:137], v160 offset:40960
    v_mfma_f32_16x16x32_bf16 v[0:3], v[156:159], a[16:19], v[0:3]
    ds_write_b128 v195, a[172:175] offset:45056
    v_mfma_f32_16x16x32_bf16 v[4:7], v[152:155], a[4:7], v[4:7]
    ds_read_b64_tr_b16 v[138:139], v160 offset:43008
    v_mfma_f32_16x16x32_bf16 v[4:7], v[156:159], a[20:23], v[4:7]
    v_mfma_f32_16x16x32_bf16 v[8:11], v[152:155], a[8:11], v[8:11]
    s_waitcnt lgkmcnt(1)
    s_barrier
    v_add_u32 v196, 0xffff0000, v196
    v_mfma_f32_16x16x32_bf16 v[8:11], v[156:159], a[24:27], v[8:11]
    ds_read_b64_tr_b16 v[140:141], v160 offset:49152
    v_mfma_f32_16x16x32_bf16 v[12:15], v[152:155], a[12:15], v[12:15]
    ds_read_b64_tr_b16 v[142:143], v160 offset:51200
    v_mfma_f32_16x16x32_bf16 v[12:15], v[156:159], a[28:31], v[12:15]
    ds_read_b128 v[80:83], v196 offset:32768
    v_mfma_f32_16x16x32_bf16 v[0:3], v[128:131], a[32:35], v[0:3]
    ds_read_b128 v[84:87], v196 offset:36864
    v_add_u32 v196, 0x10000, v196
    v_mfma_f32_16x16x32_bf16 v[0:3], v[132:135], a[48:51], v[0:3]
    ds_read_b128 v[88:91], v196 offset:40960
    v_mfma_f32_16x16x32_bf16 v[4:7], v[128:131], a[36:39], v[4:7]
    ds_read_b128 v[92:95], v196 offset:45056
    v_mfma_f32_16x16x32_bf16 v[4:7], v[132:135], a[52:55], v[4:7]
    v_mfma_f32_16x16x32_bf16 v[8:11], v[128:131], a[40:43], v[8:11]
    v_mfma_f32_16x16x32_bf16 v[8:11], v[132:135], a[56:59], v[8:11]
    v_mfma_f32_16x16x32_bf16 v[12:15], v[128:131], a[44:47], v[12:15]
    v_mfma_f32_16x16x32_bf16 v[12:15], v[132:135], a[60:63], v[12:15]
    s_waitcnt lgkmcnt(4)
    v_mfma_f32_16x16x32_bf16 v[0:3], v[136:139], a[64:67], v[0:3]
    v_mfma_f32_16x16x32_bf16 v[0:3], v[140:143], a[80:83], v[0:3]
    v_mfma_f32_16x16x32_bf16 v[4:7], v[136:139], a[68:71], v[4:7]
    v_mfma_f32_16x16x32_bf16 v[4:7], v[140:143], a[84:87], v[4:7]
    v_mfma_f32_16x16x32_bf16 v[8:11], v[136:139], a[72:75], v[8:11]
    v_mfma_f32_16x16x32_bf16 v[8:11], v[140:143], a[88:91], v[8:11]
    v_mfma_f32_16x16x32_bf16 v[12:15], v[136:139], a[76:79], v[12:15]
    v_mfma_f32_16x16x32_bf16 v[12:15], v[140:143], a[92:95], v[12:15]
    s_waitcnt vmcnt(0)
    s_barrier
    s_lshl2_add_u32 s49, s67, s9
    s_add_u32 s49, s49, 32
    buffer_store_dword v218, v216, s[24:27], s49 offen sc0 sc1
    s_cmp_lg_u32 s48, 3
    s_cbranch_scc1 Lfw_26
    s_lshl_b32 s52, 0x100, s67
    s_andn2_b32 s52, 0x1f00, s52
    s_mov_b32 s49, s9
    s_mov_b32 s59, 40000
Lw_27:
    buffer_load_dword v219, v217, s[24:27], s49 offen sc0 sc1
    s_waitcnt vmcnt(0)
    v_cmp_eq_u32 vcc, s79, v219
    s_andn2_b32 s61, s52, vcc_lo
    s_cbranch_scc0 Lw_28
    s_sleep 2
    s_sub_u32 s59, s59, 1
    s_cmp_lg_u32 s59, 0
    s_cbranch_scc1 Lw_27
Lw_28:
    s_cmp_lg_u32 s2, 64
    s_cbranch_scc1 Lfw_26
    s_mov_b32 s49, 0x80000
    buffer_store_dword v218, v216, s[24:27], s49 offen
Lfw_26:
    s_barrier
    s_add_u32 s58, s73, 9437184
    buffer_load_dwordx4 v[96:99], v192, s[24:27], s58 offen offset:0 sc0 sc1
    buffer_load_dwordx4 v[100:103], v192, s[24:27], s58 offen offset:1024 sc0 sc1
    s_xor_b32 s52, s67, 3
    s_mul_i32 s52, s52, 2359296
    s_add_u32 s58, s73, s52
    buffer_load_dwordx4 v[104:107], v192, s[24:27], s58 offen offset:0 sc0 sc1
    buffer_load_dwordx4 v[108:111], v192, s[24:27], s58 offen offset:1024 sc0 sc1
    s_xor_b32 s52, s67, 2
    s_mul_i32 s52, s52, 2359296
    s_add_u32 s58, s73, s52
    buffer_load_dwordx4 v[112:115], v192, s[24:27], s58 offen offset:0 sc0 sc1
    buffer_load_dwordx4 v[116:119], v192, s[24:27], s58 offen offset:1024 sc0 sc1
    s_xor_b32 s52, s67, 1
    s_mul_i32 s52, s52, 2359296
    s_add_u32 s58, s73, s52
    buffer_load_dwordx4 v[120:123], v192, s[24:27], s58 offen offset:0 sc0 sc1
    buffer_load_dwordx4 v[124:127], v192, s[24:27], s58 offen offset:1024 sc0 sc1
    s_waitcnt lgkmcnt(0)
    v_pk_add_f32 v[0:1], v[0:1], v[80:81]
    v_pk_add_f32 v[2:3], v[2:3], v[82:83]
    v_pk_add_f32 v[4:5], v[4:5], v[84:85]
    v_pk_add_f32 v[6:7], v[6:7], v[86:87]
    v_pk_add_f32 v[8:9], v[8:9], v[88:89]
    v_pk_add_f32 v[10:11], v[10:11], v[90:91]
    v_pk_add_f32 v[12:13], v[12:13], v[92:93]
    v_pk_add_f32 v[14:15], v[14:15], v[94:95]
    v_dot2_f32_bf16 v0, v176, s76, v0
    v_dot2_f32_bf16 v1, v176, s77, v1
    v_dot2_f32_bf16 v2, v177, s76, v2
    v_dot2_f32_bf16 v3, v177, s77, v3
    v_dot2_f32_bf16 v4, v178, s76, v4
    v_dot2_f32_bf16 v5, v178, s77, v5
    v_dot2_f32_bf16 v6, v179, s76, v6
    v_dot2_f32_bf16 v7, v179, s77, v7
    v_dot2_f32_bf16 v8, v180, s76, v8
    v_dot2_f32_bf16 v9, v180, s77, v9
    v_dot2_f32_bf16 v10, v181, s76, v10
    v_dot2_f32_bf16 v11, v181, s77, v11
    v_dot2_f32_bf16 v12, v182, s76, v12
    v_dot2_f32_bf16 v13, v182, s77, v13
    v_dot2_f32_bf16 v14, v183, s76, v14
    v_dot2_f32_bf16 v15, v183, s77, v15
    s_waitcnt vmcnt(6)
    v_dot2_f32_bf16 v0, v96, s76, v0
    v_dot2_f32_bf16 v1, v96, s77, v1
    v_dot2_f32_bf16 v2, v97, s76, v2
    v_dot2_f32_bf16 v3, v97, s77, v3
    v_dot2_f32_bf16 v4, v98, s76, v4
    v_dot2_f32_bf16 v5, v98, s77, v5
    v_dot2_f32_bf16 v6, v99, s76, v6
    v_dot2_f32_bf16 v7, v99, s77, v7
    v_dot2_f32_bf16 v8, v100, s76, v8
    v_dot2_f32_bf16 v9, v100, s77, v9
    v_dot2_f32_bf16 v10, v101, s76, v10
    v_dot2_f32_bf16 v11, v101, s77, v11
    v_dot2_f32_bf16 v12, v102, s76, v12
    v_dot2_f32_bf16 v13, v102, s77, v13
    v_dot2_f32_bf16 v14, v103, s76, v14
    v_dot2_f32_bf16 v15, v103, s77, v15
    s_waitcnt vmcnt(4)
    v_dot2_f32_bf16 v0, v104, s76, v0
    v_dot2_f32_bf16 v1, v104, s77, v1
    v_dot2_f32_bf16 v2, v105, s76, v2
    v_dot2_f32_bf16 v3, v105, s77, v3
    v_dot2_f32_bf16 v4, v106, s76, v4
    v_dot2_f32_bf16 v5, v106, s77, v5
    v_dot2_f32_bf16 v6, v107, s76, v6
    v_dot2_f32_bf16 v7, v107, s77, v7
    v_dot2_f32_bf16 v8, v108, s76, v8
    v_dot2_f32_bf16 v9, v108, s77, v9
    v_dot2_f32_bf16 v10, v109, s76, v10
    v_dot2_f32_bf16 v11, v109, s77, v11
    v_dot2_f32_bf16 v12, v110, s76, v12
    v_dot2_f32_bf16 v13, v110, s77, v13
    v_dot2_f32_bf16 v14, v111, s76, v14
    v_dot2_f32_bf16 v15, v111, s77, v15
    s_waitcnt vmcnt(2)
    v_dot2_f32_bf16 v0, v112, s76, v0
    v_dot2_f32_bf16 v1, v112, s77, v1
    v_dot2_f32_bf16 v2, v113, s76, v2
    v_dot2_f32_bf16 v3, v113, s77, v3
    v_dot2_f32_bf16 v4, v114, s76, v4
    v_dot2_f32_bf16 v5, v114, s77, v5
    v_dot2_f32_bf16 v6, v115, s76, v6
    v_dot2_f32_bf16 v7, v115, s77, v7
    v_dot2_f32_bf16 v8, v116, s76, v8
    v_dot2_f32_bf16 v9, v116, s77, v9
    v_dot2_f32_bf16 v10, v117, s76, v10
    v_dot2_f32_bf16 v11, v117, s77, v11
    v_dot2_f32_bf16 v12, v118, s76, v12
    v_dot2_f32_bf16 v13, v118, s77, v13
    v_dot2_f32_bf16 v14, v119, s76, v14
    v_dot2_f32_bf16 v15, v119, s77, v15
    s_waitcnt vmcnt(0)
    v_dot2_f32_bf16 v0, v120, s76, v0
    v_dot2_f32_bf16 v1, v120, s77, v1
    v_dot2_f32_bf16 v2, v121, s76, v2
    v_dot2_f32_bf16 v3, v121, s77, v3
    v_dot2_f32_bf16 v4, v122, s76, v4
    v_dot2_f32_bf16 v5, v122, s77, v5
    v_dot2_f32_bf16 v6, v123, s76, v6
    v_dot2_f32_bf16 v7, v123, s77, v7
    v_dot2_f32_bf16 v8, v124, s76, v8
    v_dot2_f32_bf16 v9, v124, s77, v9
    v_dot2_f32_bf16 v10, v125, s76, v10
    v_dot2_f32_bf16 v11, v125, s77, v11
    v_dot2_f32_bf16 v12, v126, s76, v12
    v_dot2_f32_bf16 v13, v126, s77, v13
    v_dot2_f32_bf16 v14, v127, s76, v14
    v_dot2_f32_bf16 v15, v127, s77, v15
    s_nop 2
    v_cvt_pk_bf16_f32 v0, v0, v1
    v_cvt_pk_bf16_f32 v1, v2, v3
    v_cvt_pk_bf16_f32 v2, v4, v5
    v_cvt_pk_bf16_f32 v3, v6, v7
    v_cvt_pk_bf16_f32 v4, v8, v9
    v_cvt_pk_bf16_f32 v5, v10, v11
    v_cvt_pk_bf16_f32 v6, v12, v13
    v_cvt_pk_bf16_f32 v7, v14, v15
    s_add_u32 s52, s75, 0
    buffer_store_dwordx2 v[0:1], v193, s[28:31], s52 offen offset:0
    s_add_u32 s52, s75, 18432
    buffer_store_dwordx2 v[2:3], v193, s[28:31], s52 offen offset:0
    s_add_u32 s52, s75, 36864
    buffer_store_dwordx2 v[4:5], v193, s[28:31], s52 offen offset:0
    s_add_u32 s52, s75, 55296
    buffer_store_dwordx2 v[6:7], v193, s[28:31], s52 offen offset:0
L_final:
L_end:
    s_endpgm
L_attn:
    v_mov_b32 v244, v174
    v_mov_b32 v245, v175
    v_mov_b32 v246, v216
    v_mov_b32 v247, v217
    v_lshrrev_b32 v64, 3, v244
    v_lshrrev_b32 v65, 1, v64
    v_xor_b32 v65, v65, v244
    v_and_b32 v65, 7, v65
    s_lshl_b32 s52, s50, 8
    s_lshl_b32 s49, s48, 6
    s_add_u32 s52, s52, s49
    v_add_u32 v64, s52, v64
    v_mul_u32_u24 v64, 1152, v64
    v_lshl_add_u32 v236, v65, 4, v64
    v_xor_b32 v237, 64, v236
    v_add_u32 v238, 16384, v236
    v_add_u32 v239, 24576, v237
    v_add_u32 v237, 8192, v237
    s_mul_i32 s34, s48, 16384
    s_add_u32 s34, s34, 98304
    s_lshl_b32 s32, s81, 7
    s_add_u32 m0, s34, 0
    s_add_u32 s54, s32, 0
    buffer_load_dwordx4 v236, s[36:39], s54 offen offset:0 lds
    buffer_load_dwordx4 v237, s[36:39], s54 offen offset:1024 lds
    buffer_load_dwordx4 v238, s[36:39], s54 offen offset:2048 lds
    buffer_load_dwordx4 v239, s[36:39], s54 offen offset:3072 lds
    s_add_u32 m0, s34, 4096
    s_add_u32 s54, s32, 36864
    buffer_load_dwordx4 v236, s[36:39], s54 offen offset:0 lds
    buffer_load_dwordx4 v237, s[36:39], s54 offen offset:1024 lds
    buffer_load_dwordx4 v238, s[36:39], s54 offen offset:2048 lds
    buffer_load_dwordx4 v239, s[36:39], s54 offen offset:3072 lds
    s_add_u32 s32, s32, 128
    s_cmp_ge_u32 s32, 1152
    s_cmov_b32 s32, 0
    s_mov_b32 s28, s6
    s_and_b32 s29, s7, 0xffff
    s_mov_b32 s30, 0x1e6000
    s_mov_b32 s31, 0x20000
    v_lshrrev_b32 v64, 3, v244
    v_and_b32 v65, 6, v64
    v_xor_b32 v65, v65, v244
    v_and_b32 v65, 7, v65
    v_and_b32 v230, 4, v64
    v_add_u32 v64, v64, v230
    v_mul_u32_u24 v64, 3456, v64
    v_lshl_add_u32 v230, v65, 4, v64
    s_lshr_b32 s52, s48, 1
    s_add_u32 s52, s52, s51
    s_lshl_b32 s52, s52, 7
    s_and_b32 s49, s48, 1
    s_mul_i32 s49, s49, 13824
    s_add_u32 s52, s52, s49
    v_add_u32 v230, s52, v230
    v_add_u32 v231, 54272, v230
    s_lshl_b32 s53, s48, 11
    s_mul_i32 s33, s81, 221184
    s_add_u32 m0, s53, 0
    s_add_u32 s55, s33, 0
    buffer_load_dwordx4 v230, s[28:31], s55 offen lds
    buffer_load_dwordx4 v231, s[28:31], s55 offen offset:1024 lds
    s_add_u32 m0, s53, 24576
    s_add_u32 s55, s33, 110592
    buffer_load_dwordx4 v230, s[28:31], s55 offen lds
    buffer_load_dwordx4 v231, s[28:31], s55 offen offset:1024 lds
    v_and_b32 v64, 15, v244
    v_lshrrev_b32 v65, 1, v64
    v_lshrrev_b32 v66, 4, v244
    v_xor_b32 v65, v65, v66
    v_lshlrev_b32 v64, 7, v64
    v_lshl_add_u32 v64, v65, 4, v64
    v_add_u32 v240, s34, v64
    v_xor_b32 v241, 64, v240
    v_lshrrev_b32 v64, 4, v244
    v_bfe_u32 v65, v244, 2, 3
    v_and_b32 v66, 3, v244
    v_lshrrev_b32 v64, 1, v64
    v_lshlrev_b32 v64, 10, v64
    v_lshl_add_u32 v64, v65, 7, v64
    v_lshrrev_b32 v65, 1, v65
    s_lshl_b32 s52, s51, 1
    v_add_u32 v67, 0, v66
    v_add_u32 v67, s52, v67
    v_lshrrev_b32 v68, 4, v67
    v_lshl_add_u32 v224, v68, 12, v64
    v_bfe_u32 v68, v67, 2, 2
    v_xor_b32 v68, v68, v65
    v_lshl_add_u32 v224, v68, 5, v224
    v_and_b32 v68, 3, v67
    v_lshl_add_u32 v224, v68, 3, v224
    v_add_u32 v67, 4, v66
    v_add_u32 v67, s52, v67
    v_lshrrev_b32 v68, 4, v67
    v_lshl_add_u32 v225, v68, 12, v64
    v_bfe_u32 v68, v67, 2, 2
    v_xor_b32 v68, v68, v65
    v_lshl_add_u32 v225, v68, 5, v225
    v_and_b32 v68, 3, v67
    v_lshl_add_u32 v225, v68, 3, v225
    v_add_u32 v67, 9, v66
    v_add_u32 v67, s52, v67
    v_lshrrev_b32 v68, 4, v67
    v_lshl_add_u32 v226, v68, 12, v64
    v_bfe_u32 v68, v67, 2, 2
    v_xor_b32 v68, v68, v65
    v_lshl_add_u32 v226, v68, 5, v226
    v_and_b32 v68, 3, v67
    v_lshl_add_u32 v226, v68, 3, v226
    v_add_u32 v67, 13, v66
    v_add_u32 v67, s52, v67
    v_lshrrev_b32 v68, 4, v67
    v_lshl_add_u32 v227, v68, 12, v64
    v_bfe_u32 v68, v67, 2, 2
    v_xor_b32 v68, v68, v65
    v_lshl_add_u32 v227, v68, 5, v227
    v_and_b32 v68, 3, v67
    v_lshl_add_u32 v227, v68, 3, v227
    v_lshrrev_b32 v67, 1, v66
    v_lshl_add_u32 v67, v66, 2, v67
    v_add_u32 v67, 4, v67
    v_add_u32 v67, s52, v67
    v_lshrrev_b32 v68, 4, v67
    v_lshl_add_u32 v228, v68, 12, v64
    v_bfe_u32 v68, v67, 2, 2
    v_xor_b32 v68, v68, v65
    v_lshl_add_u32 v228, v68, 5, v228
    v_and_b32 v68, 3, v67
    v_lshl_add_u32 v228, v68, 3, v228
    v_and_b32 v67, 1, v66
    v_mul_u32_u24 v67, 9, v67
    v_add_u32 v67, 8, v67
    v_add_u32 v67, s52, v67
    v_lshrrev_b32 v68, 4, v67
    v_lshl_add_u32 v229, v68, 12, v64
    v_bfe_u32 v68, v67, 2, 2
    v_xor_b32 v68, v68, v65
    v_lshl_add_u32 v229, v68, 5, v229
    v_and_b32 v68, 3, v67
    v_lshl_add_u32 v229, v68, 3, v229
    v_lshrrev_b32 v68, 1, v66
    v_add_u32 v68, 1, v68
    v_lshl_add_u32 v229, v68, 13, v229
    s_bitcmp1_b32 s48, 0
    s_cselect_b64 vcc, -1, 0
    v_cndmask_b32 v67, v224, v225, vcc
    v_cndmask_b32 v68, v226, v227, vcc
    v_cndmask_b32 v251, v228, v229, vcc
    s_bitcmp1_b32 s48, 1
    s_cselect_b64 vcc, -1, 0
    v_cndmask_b32 v250, v67, v68, vcc
    v_mov_b32 v67, 0x3f803f80
    v_accvgpr_write_b32 a32, v67
    v_accvgpr_write_b32 a33, v67
    v_accvgpr_write_b32 a34, v67
    v_accvgpr_write_b32 a35, v67
    s_cmp_ge_u32 s50, 3
    s_cselect_b32 s4, 1, 0
    s_mul_i32 s52, s4, 3
    s_sub_u32 s68, s50, s52
    s_lshr_b32 s70, s48, 1
    s_lshl_b32 s72, s51, 10
    s_lshl_b32 s52, s70, 9
    s_add_u32 s72, s72, s52
    s_add_u32 s72, s72, 0x80000
    s_mov_b32 s40, s16
    s_and_b32 s41, s17, 0xffff
    s_mov_b32 s42, 0x510000
    s_mov_b32 s43, 0x20000
    s_mov_b32 s44, s8
    s_and_b32 s45, s9, 0xffff
    s_mov_b32 s46, 0xa2000
    s_mov_b32 s47, 0x20000
    s_lshl_b32 s66, s48, 11
    s_mul_i32 s62, s70, 9437184
    s_add_u32 s62, s62, 2359296
    s_mul_i32 s63, s70, 2654208
    s_mul_i32 s64, s70, 262144
    s_add_u32 s64, s64, 23330816
    s_mul_i32 s65, s70, 331776
    s_mul_i32 s7, s70, 1048576
    s_add_u32 s7, s7, 21233664
    s_mov_b32 s67, 4
    s_add_u32 s52, s51, 24
    s_lshl_b32 s83, s52, 7
    s_add_u32 s83, s83, 0x83000
    s_mov_b32 s71, 0x07070707
    s_cmp_ge_u32 s50, 6
    s_cmov_b32 s62, 0x7f000000
    s_cmov_b32 s63, 0x7f000000
    s_cmov_b32 s71, 0
    s_lshl_b32 s82, s51, 13
    s_add_u32 s82, s82, 360448
    s_cmp_eq_u32 s50, 7
    s_cselect_b32 s35, 0x3f803f80, 0
    s_add_u32 m0, s53, 8192
    s_add_u32 s55, s33, 1152
    buffer_load_dwordx4 v230, s[28:31], s55 offen lds
    buffer_load_dwordx4 v231, s[28:31], s55 offen offset:1024 lds
    s_add_u32 m0, s53, 32768
    s_add_u32 s55, s33, 111744
    buffer_load_dwordx4 v230, s[28:31], s55 offen lds
    buffer_load_dwordx4 v231, s[28:31], s55 offen offset:1024 lds
    s_add_u32 m0, s53, 16384
    s_add_u32 s55, s33, 2304
    buffer_load_dwordx4 v230, s[28:31], s55 offen lds
    buffer_load_dwordx4 v231, s[28:31], s55 offen offset:1024 lds
    s_add_u32 m0, s53, 40960
    s_add_u32 s55, s33, 112896
    buffer_load_dwordx4 v230, s[28:31], s55 offen lds
    buffer_load_dwordx4 v231, s[28:31], s55 offen offset:1024 lds
    s_add_u32 s33, s33, 221184
    s_cmp_ge_u32 s33, 1990656
    s_cmov_b32 s33, 0
    s_mov_b32 s49, 0x3f803f80
    s_waitcnt lgkmcnt(0)
    s_add_u32 s79, s79, 1
    v_mov_b32 v248, s79
    v_mov_b32 v17, s79
    v_mov_b32 v19, s79
    s_waitcnt vmcnt(20)
    v_dot2_f32_bf16 v12, v0, s49, 0
    v_dot2_f32_bf16 v13, v0, v0, 0
    v_dot2_f32_bf16 v12, v1, s49, v12
    v_dot2_f32_bf16 v13, v1, v1, v13
    v_dot2_f32_bf16 v12, v2, s49, v12
    v_dot2_f32_bf16 v13, v2, v2, v13
    v_dot2_f32_bf16 v12, v3, s49, v12
    v_dot2_f32_bf16 v13, v3, v3, v13
    v_dot2_f32_bf16 v12, v4, s49, v12
    v_dot2_f32_bf16 v13, v4, v4, v13
    v_dot2_f32_bf16 v12, v5, s49, v12
    v_dot2_f32_bf16 v13, v5, v5, v13
    v_dot2_f32_bf16 v12, v6, s49, v12
    v_dot2_f32_bf16 v13, v6, v6, v13
    v_dot2_f32_bf16 v12, v7, s49, v12
    v_dot2_f32_bf16 v13, v7, v7, v13
    v_dot2_f32_bf16 v12, v8, s49, v12
    v_dot2_f32_bf16 v13, v8, v8, v13
    v_dot2_f32_bf16 v12, v9, s49, v12
    v_dot2_f32_bf16 v13, v9, v9, v13
    v_dot2_f32_bf16 v12, v10, s49, v12
    v_dot2_f32_bf16 v13, v10, v10, v13
    v_dot2_f32_bf16 v12, v11, s49, v12
    v_dot2_f32_bf16 v13, v11, v11, v13
    s_mov_b32 s49, 0
    s_nop 1
    v_add_f32_dpp v12, v12, v12 row_ror:1 row_mask:0xf bank_mask:0xf
    v_add_f32_dpp v13, v13, v13 row_ror:1 row_mask:0xf bank_mask:0xf
    s_nop 0
    v_add_f32_dpp v12, v12, v12 row_ror:2 row_mask:0xf bank_mask:0xf
    v_add_f32_dpp v13, v13, v13 row_ror:2 row_mask:0xf bank_mask:0xf
    s_nop 0
    v_add_f32_dpp v12, v12, v12 row_ror:4 row_mask:0xf bank_mask:0xf
    v_add_f32_dpp v13, v13, v13 row_ror:4 row_mask:0xf bank_mask:0xf
    s_nop 0
    v_add_f32_dpp v12, v12, v12 row_ror:8 row_mask:0xf bank_mask:0xf
    v_add_f32_dpp v13, v13, v13 row_ror:8 row_mask:0xf bank_mask:0xf
    s_nop 0
    v_mov_b32 v14, v12
    v_mov_b32 v15, v13
    s_nop 1
    v_permlane16_swap_b32 v12, v14
    v_permlane16_swap_b32 v13, v15
    s_nop 0
    v_add_f32 v12, v12, v14
    v_add_f32 v13, v13, v15
    v_mul_f32 v12, 0x3ae38e39, v12
    v_mul_f32 v13, 0x3ae38e39, v13
    v_fma_f32 v13, -v12, v12, v13
    v_max_f32 v13, 0, v13
    v_cvt_pk_bf16_f32 v13, v13, v13
    v_cvt_pk_bf16_f32 v16, -v12, -v12
    v_and_b32 v13, 0xffff0000, v13
    v_add_f32 v13, 0x3727c5ac, v13
    v_cvt_pk_bf16_f32 v13, v13, v13
    v_and_b32 v13, 0xffff0000, v13
    v_sqrt_f32 v13, v13
    s_nop 0
    v_cvt_pk_bf16_f32 v13, v13, v13
    v_and_b32 v18, 0xffff0000, v13
    buffer_store_dwordx4 v[16:19], v40, s[24:27], s49 offen sc0 sc1
    s_waitcnt vmcnt(13)
    ds_read_b128 a[96:99], v240 offset:0
    ds_read_b128 a[100:103], v240 offset:2048
    ds_read_b128 a[104:107], v240 offset:4096
    ds_read_b128 a[108:111], v240 offset:6144
    ds_read_b128 a[112:115], v241 offset:0
    ds_read_b128 a[116:119], v241 offset:2048
    ds_read_b128 a[120:123], v241 offset:4096
    ds_read_b128 a[124:127], v241 offset:6144
    s_waitcnt vmcnt(9)
    s_barrier
    ds_read_b64_tr_b16 a[0:1], v224 offset:0
    ds_read_b64_tr_b16 a[2:3], v224 offset:2048
    ds_read_b64_tr_b16 a[4:5], v224 offset:24576
    ds_read_b64_tr_b16 a[6:7], v224 offset:26624
    ds_read_b64_tr_b16 a[8:9], v250 offset:0
    ds_read_b64_tr_b16 a[10:11], v250 offset:2048
    ds_read_b64_tr_b16 a[12:13], v225 offset:0
    ds_read_b64_tr_b16 a[14:15], v225 offset:2048
    s_waitcnt lgkmcnt(8)
    s_waitcnt lgkmcnt(4)
    v_mfma_f32_16x16x32_bf16 v[0:3], a[0:3], a[96:99], 0
    s_add_u32 m0, s34, 8192
    ds_read_b64_tr_b16 a[16:17], v225 offset:24576
    s_add_u32 s54, s32, 0
    v_mfma_f32_16x16x32_bf16 v[0:3], a[4:7], a[112:115], v[0:3]
    buffer_load_dwordx4 v236, s[36:39], s54 offen offset:0 lds
    v_mfma_f32_16x16x32_bf16 v[4:7], a[0:3], a[100:103], 0
    ds_read_b64_tr_b16 a[18:19], v225 offset:26624
    v_mfma_f32_16x16x32_bf16 v[4:7], a[4:7], a[116:119], v[4:7]
    v_mfma_f32_16x16x32_bf16 v[8:11], a[0:3], a[104:107], 0
    ds_read_b64_tr_b16 a[20:21], v250 offset:24576
    v_mfma_f32_16x16x32_bf16 v[8:11], a[4:7], a[120:123], v[8:11]
    buffer_load_dwordx4 v237, s[36:39], s54 offen offset:1024 lds
    v_mfma_f32_16x16x32_bf16 v[12:15], a[0:3], a[108:111], 0
    ds_read_b64_tr_b16 a[22:23], v250 offset:26624
    v_mfma_f32_16x16x32_bf16 v[12:15], a[4:7], a[124:127], v[12:15]
    s_waitcnt lgkmcnt(4)
    v_mfma_f32_16x16x32_bf16 a[36:39], a[32:35], a[8:11], 0
    s_waitcnt lgkmcnt(2)
    v_mfma_f32_16x16x32_bf16 v[16:19], a[12:15], a[96:99], 0
    s_waitcnt vmcnt(7)
    s_barrier
    v_lshrrev_b32 v254, 4, v244
    v_mfma_f32_16x16x32_bf16 v[16:19], a[16:19], a[112:115], v[16:19]
    ds_read_b64_tr_b16 a[24:25], v226 offset:0
    v_mul_u32_u24 v252, 9, v254
    v_mfma_f32_16x16x32_bf16 v[20:23], a[12:15], a[100:103], 0
    ds_read_b64_tr_b16 a[26:27], v226 offset:2048
    v_add_u32 v252, 1, v252
    v_mfma_f32_16x16x32_bf16 v[20:23], a[16:19], a[116:119], v[20:23]
    ds_read_b64_tr_b16 a[28:29], v226 offset:24576
    v_lshrrev_b32 v252, 1, v252
    ds_read_b64_tr_b16 a[30:31], v226 offset:26624
    v_mfma_f32_16x16x32_bf16 v[24:27], a[12:15], a[104:107], 0
    ds_read_b64_tr_b16 a[0:1], v227 offset:0
    v_add_u32 v252, s48, v252
    v_mfma_f32_16x16x32_bf16 v[24:27], a[16:19], a[120:123], v[24:27]
    buffer_load_dwordx4 v238, s[36:39], s54 offen offset:2048 lds
    v_mfma_f32_16x16x32_bf16 v[28:31], a[12:15], a[108:111], 0
    s_mul_i32 s52, s48, 9
    ds_read_b64_tr_b16 a[2:3], v227 offset:2048
    s_add_u32 s52, s52, 4
    v_mfma_f32_16x16x32_bf16 v[28:31], a[16:19], a[124:127], v[28:31]
    s_waitcnt lgkmcnt(4)
    buffer_load_dwordx4 v239, s[36:39], s54 offen offset:3072 lds
    v_mfma_f32_16x16x32_bf16 a[36:39], a[32:35], a[20:23], a[36:39]
    s_add_u32 m0, s34, 12288
    s_add_u32 s54, s32, 36864
    s_waitcnt lgkmcnt(2)
    v_mfma_f32_16x16x32_bf16 v[32:35], a[24:27], a[96:99], 0
    ds_read_b64_tr_b16 a[4:5], v227 offset:24576
    v_mfma_f32_16x16x32_bf16 v[32:35], a[28:31], a[112:115], v[32:35]
    ds_read_b64_tr_b16 a[6:7], v227 offset:26624
    v_mfma_f32_16x16x32_bf16 v[36:39], a[24:27], a[100:103], 0
    ds_read_b64_tr_b16 a[8:9], v228 offset:0
    v_mfma_f32_16x16x32_bf16 v[36:39], a[28:31], a[116:119], v[36:39]
    ds_read_b64_tr_b16 a[10:11], v228 offset:2048
    v_mfma_f32_16x16x32_bf16 v[40:43], a[24:27], a[104:107], 0
    ds_read_b64_tr_b16 a[12:13], v228 offset:24576
    v_mfma_f32_16x16x32_bf16 v[40:43], a[28:31], a[120:123], v[40:43]
    buffer_load_dwordx4 v236, s[36:39], s54 offen offset:0 lds
    v_mfma_f32_16x16x32_bf16 v[44:47], a[24:27], a[108:111], 0
    ds_read_b64_tr_b16 a[14:15], v228 offset:26624
    v_mfma_f32_16x16x32_bf16 v[44:47], a[28:31], a[124:127], v[44:47]
    s_waitcnt lgkmcnt(4)
    s_cmp_ge_u32 s48, 2
    s_cmov_b32 s52, 0x3f8000
    v_mfma_f32_16x16x32_bf16 v[48:51], a[0:3], a[96:99], 0
    ds_read_b64_tr_b16 a[16:17], v224 offset:8192
    v_mov_b32 v255, s52
    v_mfma_f32_16x16x32_bf16 v[48:51], a[4:7], a[112:115], v[48:51]
    buffer_load_dwordx4 v237, s[36:39], s54 offen offset:1024 lds
    v_mfma_f32_16x16x32_bf16 v[52:55], a[0:3], a[100:103], 0
    ds_read_b64_tr_b16 a[18:19], v224 offset:10240
    v_cmp_eq_u32 vcc, 3, v254
    v_mfma_f32_16x16x32_bf16 v[52:55], a[4:7], a[116:119], v[52:55]
    s_nop 1
    v_cndmask_b32 v252, v252, v255, vcc
    v_and_b32 v254, 15, v244
    v_mfma_f32_16x16x32_bf16 v[56:59], a[0:3], a[104:107], 0
    ds_read_b64_tr_b16 a[20:21], v224 offset:32768
    v_lshlrev_b32 v254, 4, v254
    v_mfma_f32_16x16x32_bf16 v[56:59], a[4:7], a[120:123], v[56:59]
    buffer_load_dwordx4 v238, s[36:39], s54 offen offset:2048 lds
    v_mfma_f32_16x16x32_bf16 v[60:63], a[0:3], a[108:111], 0
    ds_read_b64_tr_b16 a[22:23], v224 offset:34816
    v_and_b32 v255, 1, v252
    v_mfma_f32_16x16x32_bf16 v[60:63], a[4:7], a[124:127], v[60:63]
    s_waitcnt lgkmcnt(4)
    v_lshl_add_u32 v254, v255, 3, v254
    v_lshrrev_b32 v252, 1, v252
    v_mfma_f32_16x16x32_bf16 v[64:67], a[8:11], a[96:99], 0
    ds_read_b64_tr_b16 a[24:25], v250 offset:8192
    v_lshl_add_u32 v252, v252, 10, v254
    v_mfma_f32_16x16x32_bf16 v[64:67], a[12:15], a[112:115], v[64:67]
    buffer_load_dwordx4 v239, s[36:39], s54 offen offset:3072 lds
    v_mfma_f32_16x16x32_bf16 v[68:71], a[8:11], a[100:103], 0
    s_add_u32 s32, s32, 128
    ds_read_b64_tr_b16 a[26:27], v250 offset:10240
    s_lshr_b32 s52, s50, 1
    v_mfma_f32_16x16x32_bf16 v[68:71], a[12:15], a[116:119], v[68:71]
    s_cmp_ge_u32 s32, 1152
    s_cmov_b32 s32, 0
    s_add_u32 m0, s53, 49152
    v_mfma_f32_16x16x32_bf16 v[72:75], a[8:11], a[104:107], 0
    s_add_u32 s55, s33, 0
    ds_read_b64_tr_b16 a[28:29], v225 offset:8192
    s_lshl_b32 s52, s52, 8
    v_mfma_f32_16x16x32_bf16 v[72:75], a[12:15], a[120:123], v[72:75]
    buffer_load_dwordx4 v230, s[28:31], s55 offen lds
    v_mfma_f32_16x16x32_bf16 v[76:79], a[8:11], a[108:111], 0
    s_and_b32 s60, s50, 1
    ds_read_b64_tr_b16 a[30:31], v225 offset:10240
    s_lshl2_add_u32 s52, s60, s52
    v_mfma_f32_16x16x32_bf16 v[76:79], a[12:15], a[124:127], v[76:79]
    s_waitcnt lgkmcnt(4)
    v_add_u32 v252, s52, v252
    v_mfma_f32_16x16x32_bf16 v[80:83], a[16:19], a[96:99], 0
    ds_read_b64_tr_b16 a[0:1], v225 offset:32768
    v_mfma_f32_16x16x32_bf16 v[80:83], a[20:23], a[112:115], v[80:83]
    v_mfma_f32_16x16x32_bf16 v[84:87], a[16:19], a[100:103], 0
    ds_read_b64_tr_b16 a[2:3], v225 offset:34816
    v_mfma_f32_16x16x32_bf16 v[84:87], a[20:23], a[116:119], v[84:87]
    v_mfma_f32_16x16x32_bf16 v[88:91], a[16:19], a[104:107], 0
    ds_read_b64_tr_b16 a[4:5], v250 offset:32768
    v_mfma_f32_16x16x32_bf16 v[88:91], a[20:23], a[120:123], v[88:91]
    buffer_load_dwordx4 v231, s[28:31], s55 offen offset:1024 lds
    v_mfma_f32_16x16x32_bf16 v[92:95], a[16:19], a[108:111], 0
    s_add_u32 m0, s53, 73728
    ds_read_b64_tr_b16 a[6:7], v250 offset:34816
    s_add_u32 s55, s33, 110592
    v_mfma_f32_16x16x32_bf16 v[92:95], a[20:23], a[124:127], v[92:95]
    s_waitcnt lgkmcnt(4)
    v_mfma_f32_16x16x32_bf16 a[40:43], a[32:35], a[24:27], 0
    s_waitcnt lgkmcnt(2)
    v_mfma_f32_16x16x32_bf16 v[96:99], a[28:31], a[96:99], 0
    s_waitcnt vmcnt(11)
    s_barrier
    s_waitcnt vmcnt(2)
    v_mfma_f32_16x16x32_bf16 v[96:99], a[0:3], a[112:115], v[96:99]
    ds_read_b64_tr_b16 a[8:9], v226 offset:8192
    v_mfma_f32_16x16x32_bf16 v[100:103], a[28:31], a[100:103], 0
    ds_read_b64_tr_b16 a[10:11], v226 offset:10240
    v_mfma_f32_16x16x32_bf16 v[100:103], a[0:3], a[116:119], v[100:103]
    ds_read_b64_tr_b16 a[12:13], v226 offset:32768
    ds_read_b64_tr_b16 a[14:15], v226 offset:34816
    v_mfma_f32_16x16x32_bf16 v[104:107], a[28:31], a[104:107], 0
    ds_read_b64_tr_b16 a[16:17], v227 offset:8192
    v_mfma_f32_16x16x32_bf16 v[104:107], a[0:3], a[120:123], v[104:107]
    buffer_load_dwordx4 v230, s[28:31], s55 offen lds
    v_mfma_f32_16x16x32_bf16 v[108:111], a[28:31], a[108:111], 0
    ds_read_b64_tr_b16 a[18:19], v227 offset:10240
    v_mfma_f32_16x16x32_bf16 v[108:111], a[0:3], a[124:127], v[108:111]
    s_waitcnt lgkmcnt(4)
    buffer_load_dwordx4 v231, s[28:31], s55 offen offset:1024 lds
    v_mfma_f32_16x16x32_bf16 a[40:43], a[32:35], a[4:7], a[40:43]
    s_add_u32 m0, s53, 57344
    ds_read_b128 a[128:131], v240 offset:8192
    s_add_u32 s55, s33, 1152
    s_waitcnt lgkmcnt(3)
    v_mfma_f32_16x16x32_bf16 v[112:115], a[8:11], a[96:99], 0
    ds_read_b64_tr_b16 a[20:21], v227 offset:32768
    v_mfma_f32_16x16x32_bf16 v[112:115], a[12:15], a[112:115], v[112:115]
    ds_read_b64_tr_b16 a[22:23], v227 offset:34816
    v_mfma_f32_16x16x32_bf16 v[116:119], a[8:11], a[100:103], 0
    ds_read_b64_tr_b16 a[24:25], v251 offset:0
    v_mfma_f32_16x16x32_bf16 v[116:119], a[12:15], a[116:119], v[116:119]
    ds_read_b64_tr_b16 a[26:27], v251 offset:2048
    v_mfma_f32_16x16x32_bf16 v[120:123], a[8:11], a[104:107], 0
    ds_read_b64_tr_b16 a[28:29], v229 offset:0
    v_mfma_f32_16x16x32_bf16 v[120:123], a[12:15], a[120:123], v[120:123]
    buffer_load_dwordx4 v230, s[28:31], s55 offen lds
    v_mfma_f32_16x16x32_bf16 v[124:127], a[8:11], a[108:111], 0
    ds_read_b64_tr_b16 a[30:31], v229 offset:2048
    v_mfma_f32_16x16x32_bf16 v[124:127], a[12:15], a[124:127], v[124:127]
    s_waitcnt lgkmcnt(4)
    ds_read_b128 a[132:135], v240 offset:10240
    v_mfma_f32_16x16x32_bf16 v[128:131], a[16:19], a[96:99], 0
    ds_read_b64_tr_b16 a[0:1], v229 offset:24576
    v_mfma_f32_16x16x32_bf16 v[128:131], a[20:23], a[112:115], v[128:131]
    buffer_load_dwordx4 v231, s[28:31], s55 offen offset:1024 lds
    v_mfma_f32_16x16x32_bf16 v[132:135], a[16:19], a[100:103], 0
    s_add_u32 m0, s53, 81920
    ds_read_b64_tr_b16 a[2:3], v229 offset:26624
    s_add_u32 s55, s33, 111744
    v_mfma_f32_16x16x32_bf16 v[132:135], a[20:23], a[116:119], v[132:135]
    ds_read_b128 a[136:139], v240 offset:12288
    v_mfma_f32_16x16x32_bf16 v[136:139], a[16:19], a[104:107], 0
    ds_read_b64_tr_b16 a[4:5], v251 offset:24576
    v_mfma_f32_16x16x32_bf16 v[136:139], a[20:23], a[120:123], v[136:139]
    buffer_load_dwordx4 v230, s[28:31], s55 offen lds
    v_mfma_f32_16x16x32_bf16 v[140:143], a[16:19], a[108:111], 0
    ds_read_b64_tr_b16 a[6:7], v251 offset:26624
    v_mfma_f32_16x16x32_bf16 v[140:143], a[20:23], a[124:127], v[140:143]
    s_waitcnt lgkmcnt(6)
    ds_read_b128 a[140:143], v240 offset:14336
    v_mfma_f32_16x16x32_bf16 a[48:51], a[32:35], a[24:27], 0
    ds_read_b128 a[144:147], v241 offset:8192
    s_waitcnt lgkmcnt(5)
    v_mfma_f32_16x16x32_bf16 v[208:211], a[28:31], a[96:99], 0
    ds_read_b64_tr_b16 a[8:9], v224 offset:16384
    v_mfma_f32_16x16x32_bf16 v[208:211], a[0:3], a[112:115], v[208:211]
    ds_read_b64_tr_b16 a[10:11], v224 offset:18432
    v_mfma_f32_16x16x32_bf16 v[212:215], a[28:31], a[100:103], 0
    ds_read_b64_tr_b16 a[12:13], v224 offset:40960
    v_mfma_f32_16x16x32_bf16 v[212:215], a[0:3], a[116:119], v[212:215]
    ds_read_b64_tr_b16 a[14:15], v224 offset:43008
    v_mfma_f32_16x16x32_bf16 v[216:219], a[28:31], a[104:107], 0
    ds_read_b64_tr_b16 a[16:17], v250 offset:16384
    v_mfma_f32_16x16x32_bf16 v[216:219], a[0:3], a[120:123], v[216:219]
    buffer_load_dwordx4 v231, s[28:31], s55 offen offset:1024 lds
    v_mfma_f32_16x16x32_bf16 v[220:223], a[28:31], a[108:111], 0
    s_add_u32 m0, s53, 65536
    ds_read_b64_tr_b16 a[18:19], v250 offset:18432
    s_add_u32 s55, s33, 2304
    v_mfma_f32_16x16x32_bf16 v[220:223], a[0:3], a[124:127], v[220:223]
    s_waitcnt lgkmcnt(4)
    buffer_load_dwordx4 v230, s[28:31], s55 offen lds
    v_mfma_f32_16x16x32_bf16 a[48:51], a[32:35], a[4:7], a[48:51]
    ds_read_b128 a[148:151], v241 offset:10240
    s_waitcnt lgkmcnt(3)
    v_mfma_f32_16x16x32_bf16 v[144:147], a[8:11], a[96:99], 0
    ds_read_b64_tr_b16 a[20:21], v225 offset:16384
    v_mfma_f32_16x16x32_bf16 v[144:147], a[12:15], a[112:115], v[144:147]
    ds_read_b64_tr_b16 a[22:23], v225 offset:18432
    v_mfma_f32_16x16x32_bf16 v[148:151], a[8:11], a[100:103], 0
    ds_read_b64_tr_b16 a[24:25], v225 offset:40960
    v_mfma_f32_16x16x32_bf16 v[148:151], a[12:15], a[116:119], v[148:151]
    ds_read_b64_tr_b16 a[26:27], v225 offset:43008
    v_mfma_f32_16x16x32_bf16 v[152:155], a[8:11], a[104:107], 0
    ds_read_b64_tr_b16 a[28:29], v250 offset:40960
    v_mfma_f32_16x16x32_bf16 v[152:155], a[12:15], a[120:123], v[152:155]
    buffer_load_dwordx4 v231, s[28:31], s55 offen offset:1024 lds
    v_mfma_f32_16x16x32_bf16 v[156:159], a[8:11], a[108:111], 0
    s_add_u32 m0, s53, 90112
    ds_read_b64_tr_b16 a[30:31], v250 offset:43008
    s_add_u32 s55, s33, 112896
    v_mfma_f32_16x16x32_bf16 v[156:159], a[12:15], a[124:127], v[156:159]
    s_waitcnt lgkmcnt(4)
    ds_read_b128 a[152:155], v241 offset:12288
    v_mfma_f32_16x16x32_bf16 a[44:47], a[32:35], a[16:19], 0
    ds_read_b128 a[156:159], v241 offset:14336
    s_waitcnt lgkmcnt(4)
    v_mfma_f32_16x16x32_bf16 v[160:163], a[20:23], a[96:99], 0
    s_waitcnt vmcnt(6)
    s_barrier
    v_mfma_f32_16x16x32_bf16 v[160:163], a[24:27], a[112:115], v[160:163]
    ds_read_b64_tr_b16 a[0:1], v226 offset:16384
    v_mfma_f32_16x16x32_bf16 v[164:167], a[20:23], a[100:103], 0
    ds_read_b64_tr_b16 a[2:3], v226 offset:18432
    v_mfma_f32_16x16x32_bf16 v[164:167], a[24:27], a[116:119], v[164:167]
    ds_read_b64_tr_b16 a[4:5], v226 offset:40960
    ds_read_b64_tr_b16 a[6:7], v226 offset:43008
    v_mfma_f32_16x16x32_bf16 v[168:171], a[20:23], a[104:107], 0
    ds_read_b64_tr_b16 a[8:9], v227 offset:16384
    v_mfma_f32_16x16x32_bf16 v[168:171], a[24:27], a[120:123], v[168:171]
    buffer_load_dwordx4 v230, s[28:31], s55 offen lds
    v_mfma_f32_16x16x32_bf16 v[172:175], a[20:23], a[108:111], 0
    ds_read_b64_tr_b16 a[10:11], v227 offset:18432
    v_mfma_f32_16x16x32_bf16 v[172:175], a[24:27], a[124:127], v[172:175]
    s_waitcnt lgkmcnt(4)
    buffer_load_dwordx4 v231, s[28:31], s55 offen offset:1024 lds
    v_mfma_f32_16x16x32_bf16 a[44:47], a[32:35], a[28:31], a[44:47]
    s_add_u32 s33, s33, 221184
    s_cmp_ge_u32 s33, 1990656
    s_cmov_b32 s33, 0
    s_waitcnt lgkmcnt(2)
    v_mfma_f32_16x16x32_bf16 v[176:179], a[0:3], a[96:99], 0
    ds_read_b64_tr_b16 a[12:13], v227 offset:40960
    s_add_u32 m0, s34, 0
    v_mfma_f32_16x16x32_bf16 v[176:179], a[4:7], a[112:115], v[176:179]
    s_add_u32 s54, s32, 0
    ds_read_b64_tr_b16 a[14:15], v227 offset:43008
    v_add_u32 v224, 0xc000, v224
    v_mfma_f32_16x16x32_bf16 v[180:183], a[0:3], a[100:103], 0
    ds_read_b64_tr_b16 a[16:17], v224 offset:0
    v_mfma_f32_16x16x32_bf16 v[180:183], a[4:7], a[116:119], v[180:183]
    ds_read_b64_tr_b16 a[18:19], v224 offset:2048
    v_mfma_f32_16x16x32_bf16 v[184:187], a[0:3], a[104:107], 0
    ds_read_b64_tr_b16 a[20:21], v224 offset:24576
    v_mfma_f32_16x16x32_bf16 v[184:187], a[4:7], a[120:123], v[184:187]
    buffer_load_dwordx4 v236, s[36:39], s54 offen offset:0 lds
    v_mfma_f32_16x16x32_bf16 v[188:191], a[0:3], a[108:111], 0
    ds_read_b64_tr_b16 a[22:23], v224 offset:26624
    v_mfma_f32_16x16x32_bf16 v[188:191], a[4:7], a[124:127], v[188:191]
    s_waitcnt lgkmcnt(4)
    v_mfma_f32_16x16x32_bf16 v[192:195], a[8:11], a[96:99], 0
    v_add_u32 v250, 49152, v250
    v_add_u32 v251, 49152, v251
    v_mfma_f32_16x16x32_bf16 v[192:195], a[12:15], a[112:115], v[192:195]
    ds_read_b64_tr_b16 a[24:25], v250 offset:0
    v_mfma_f32_16x16x32_bf16 v[196:199], a[8:11], a[100:103], 0
    ds_read_b64_tr_b16 a[26:27], v250 offset:2048
    v_mfma_f32_16x16x32_bf16 v[196:199], a[12:15], a[116:119], v[196:199]
    buffer_load_dwordx4 v237, s[36:39], s54 offen offset:1024 lds
    v_mfma_f32_16x16x32_bf16 v[200:203], a[8:11], a[104:107], 0
    v_add_u32 v225, 0xc000, v225
    v_mfma_f32_16x16x32_bf16 v[200:203], a[12:15], a[120:123], v[200:203]
    ds_read_b64_tr_b16 a[28:29], v225 offset:0
    v_mfma_f32_16x16x32_bf16 v[204:207], a[8:11], a[108:111], 0
    ds_read_b64_tr_b16 a[30:31], v225 offset:2048
    v_mfma_f32_16x16x32_bf16 v[204:207], a[12:15], a[124:127], v[204:207]
    s_waitcnt lgkmcnt(4)
    buffer_load_dwordx4 v238, s[36:39], s54 offen offset:2048 lds
    v_mfma_f32_16x16x32_bf16 v[0:3], a[16:19], a[128:131], v[0:3]
    ds_read_b64_tr_b16 a[0:1], v225 offset:24576
    v_mfma_f32_16x16x32_bf16 v[0:3], a[20:23], a[144:147], v[0:3]
    buffer_load_dwordx4 v239, s[36:39], s54 offen offset:3072 lds
    v_mfma_f32_16x16x32_bf16 v[4:7], a[16:19], a[132:135], v[4:7]
    s_add_u32 m0, s34, 4096
    ds_read_b64_tr_b16 a[2:3], v225 offset:26624
    s_add_u32 s54, s32, 36864
    v_mfma_f32_16x16x32_bf16 v[4:7], a[20:23], a[148:151], v[4:7]
    v_mfma_f32_16x16x32_bf16 v[8:11], a[16:19], a[136:139], v[8:11]
    ds_read_b64_tr_b16 a[4:5], v250 offset:24576
    v_mfma_f32_16x16x32_bf16 v[8:11], a[20:23], a[152:155], v[8:11]
    buffer_load_dwordx4 v236, s[36:39], s54 offen offset:0 lds
    v_mfma_f32_16x16x32_bf16 v[12:15], a[16:19], a[140:143], v[12:15]
    ds_read_b64_tr_b16 a[6:7], v250 offset:26624
    v_mfma_f32_16x16x32_bf16 v[12:15], a[20:23], a[156:159], v[12:15]
    s_waitcnt lgkmcnt(4)
    v_mov_b32 v253, s35
    v_accvgpr_write_b32 a32, v253
    v_accvgpr_write_b32 a33, v253
    v_accvgpr_write_b32 a34, v253
    v_accvgpr_write_b32 a35, v253
    s_nop 1
    v_mfma_f32_16x16x32_bf16 a[36:39], a[32:35], a[24:27], a[36:39]
    s_waitcnt lgkmcnt(2)
    v_mfma_f32_16x16x32_bf16 v[16:19], a[28:31], a[128:131], v[16:19]
    s_waitcnt vmcnt(9)
    s_barrier
    v_add_u32 v226, 0xc000, v226
    v_mfma_f32_16x16x32_bf16 v[16:19], a[0:3], a[144:147], v[16:19]
    ds_read_b64_tr_b16 a[8:9], v226 offset:0
    v_mfma_f32_16x16x32_bf16 v[20:23], a[28:31], a[132:135], v[20:23]
    ds_read_b64_tr_b16 a[10:11], v226 offset:2048
    v_mfma_f32_16x16x32_bf16 v[20:23], a[0:3], a[148:151], v[20:23]
    ds_read_b64_tr_b16 a[12:13], v226 offset:24576
    ds_read_b64_tr_b16 a[14:15], v226 offset:26624
    v_mfma_f32_16x16x32_bf16 v[24:27], a[28:31], a[136:139], v[24:27]
    v_add_u32 v227, 0xc000, v227
    v_mfma_f32_16x16x32_bf16 v[24:27], a[0:3], a[152:155], v[24:27]
    ds_read_b64_tr_b16 a[16:17], v227 offset:0
    v_mfma_f32_16x16x32_bf16 v[28:31], a[28:31], a[140:143], v[28:31]
    ds_read_b64_tr_b16 a[18:19], v227 offset:2048
    v_mfma_f32_16x16x32_bf16 v[28:31], a[0:3], a[156:159], v[28:31]
    s_waitcnt lgkmcnt(4)
    buffer_load_dwordx4 v237, s[36:39], s54 offen offset:1024 lds
    v_mfma_f32_16x16x32_bf16 a[36:39], a[32:35], a[4:7], a[36:39]
    s_waitcnt lgkmcnt(2)
    v_mfma_f32_16x16x32_bf16 v[32:35], a[8:11], a[128:131], v[32:35]
    ds_read_b64_tr_b16 a[20:21], v227 offset:24576
    v_mfma_f32_16x16x32_bf16 v[32:35], a[12:15], a[144:147], v[32:35]
    ds_read_b64_tr_b16 a[22:23], v227 offset:26624
    v_add_u32 v228, 0xc000, v228
    v_mfma_f32_16x16x32_bf16 v[36:39], a[8:11], a[132:135], v[36:39]
    ds_read_b64_tr_b16 a[24:25], v228 offset:0
    v_mfma_f32_16x16x32_bf16 v[36:39], a[12:15], a[148:151], v[36:39]
    ds_read_b64_tr_b16 a[26:27], v228 offset:2048
    v_mfma_f32_16x16x32_bf16 v[40:43], a[8:11], a[136:139], v[40:43]
    ds_read_b64_tr_b16 a[28:29], v228 offset:24576
    v_mfma_f32_16x16x32_bf16 v[40:43], a[12:15], a[152:155], v[40:43]
    buffer_load_dwordx4 v238, s[36:39], s54 offen offset:2048 lds
    v_mfma_f32_16x16x32_bf16 v[44:47], a[8:11], a[140:143], v[44:47]
    ds_read_b64_tr_b16 a[30:31], v228 offset:26624
    v_mfma_f32_16x16x32_bf16 v[44:47], a[12:15], a[156:159], v[44:47]
    s_waitcnt lgkmcnt(4)
    buffer_load_dwordx4 v239, s[36:39], s54 offen offset:3072 lds
    v_mfma_f32_16x16x32_bf16 v[48:51], a[16:19], a[128:131], v[48:51]
    s_add_u32 s32, s32, 128
    ds_read_b64_tr_b16 a[0:1], v224 offset:8192
    v_mfma_f32_16x16x32_bf16 v[48:51], a[20:23], a[144:147], v[48:51]
    s_cmp_ge_u32 s32, 1152
    s_cmov_b32 s32, 0
    s_add_u32 m0, s53, 0
    v_mfma_f32_16x16x32_bf16 v[52:55], a[16:19], a[132:135], v[52:55]
    s_add_u32 s55, s33, 0
    ds_read_b64_tr_b16 a[2:3], v224 offset:10240
    v_mfma_f32_16x16x32_bf16 v[52:55], a[20:23], a[148:151], v[52:55]
    v_mfma_f32_16x16x32_bf16 v[56:59], a[16:19], a[136:139], v[56:59]
    ds_read_b64_tr_b16 a[4:5], v224 offset:32768
    v_mfma_f32_16x16x32_bf16 v[56:59], a[20:23], a[152:155], v[56:59]
    buffer_load_dwordx4 v230, s[28:31], s55 offen lds
    v_mfma_f32_16x16x32_bf16 v[60:63], a[16:19], a[140:143], v[60:63]
    ds_read_b64_tr_b16 a[6:7], v224 offset:34816
    v_mfma_f32_16x16x32_bf16 v[60:63], a[20:23], a[156:159], v[60:63]
    s_waitcnt lgkmcnt(4)
    v_mfma_f32_16x16x32_bf16 v[64:67], a[24:27], a[128:131], v[64:67]
    ds_read_b64_tr_b16 a[8:9], v250 offset:8192
    v_mfma_f32_16x16x32_bf16 v[64:67], a[28:31], a[144:147], v[64:67]
    buffer_load_dwordx4 v231, s[28:31], s55 offen offset:1024 lds
    v_mfma_f32_16x16x32_bf16 v[68:71], a[24:27], a[132:135], v[68:71]
    s_add_u32 m0, s53, 24576
    ds_read_b64_tr_b16 a[10:11], v250 offset:10240
    s_add_u32 s55, s33, 110592
    v_mfma_f32_16x16x32_bf16 v[68:71], a[28:31], a[148:151], v[68:71]
    v_mfma_f32_16x16x32_bf16 v[72:75], a[24:27], a[136:139], v[72:75]
    ds_read_b64_tr_b16 a[12:13], v225 offset:8192
    v_mfma_f32_16x16x32_bf16 v[72:75], a[28:31], a[152:155], v[72:75]
    buffer_load_dwordx4 v230, s[28:31], s55 offen lds
    v_mfma_f32_16x16x32_bf16 v[76:79], a[24:27], a[140:143], v[76:79]
    ds_read_b64_tr_b16 a[14:15], v225 offset:10240
    v_mfma_f32_16x16x32_bf16 v[76:79], a[28:31], a[156:159], v[76:79]
    s_waitcnt lgkmcnt(4)
    v_mfma_f32_16x16x32_bf16 v[80:83], a[0:3], a[128:131], v[80:83]
    ds_read_b64_tr_b16 a[16:17], v225 offset:32768
    v_mfma_f32_16x16x32_bf16 v[80:83], a[4:7], a[144:147], v[80:83]
    buffer_load_dwordx4 v231, s[28:31], s55 offen offset:1024 lds
    v_mfma_f32_16x16x32_bf16 v[84:87], a[0:3], a[132:135], v[84:87]
    s_add_u32 m0, s53, 8192
    ds_read_b64_tr_b16 a[18:19], v225 offset:34816
    s_add_u32 s55, s33, 1152
    v_mfma_f32_16x16x32_bf16 v[84:87], a[4:7], a[148:151], v[84:87]
    v_mfma_f32_16x16x32_bf16 v[88:91], a[0:3], a[136:139], v[88:91]
    ds_read_b64_tr_b16 a[20:21], v250 offset:32768
    v_mfma_f32_16x16x32_bf16 v[88:91], a[4:7], a[152:155], v[88:91]
    buffer_load_dwordx4 v230, s[28:31], s55 offen lds
    v_mfma_f32_16x16x32_bf16 v[92:95], a[0:3], a[140:143], v[92:95]
    ds_read_b64_tr_b16 a[22:23], v250 offset:34816
    v_mfma_f32_16x16x32_bf16 v[92:95], a[4:7], a[156:159], v[92:95]
    s_waitcnt lgkmcnt(4)
    v_mfma_f32_16x16x32_bf16 a[40:43], a[32:35], a[8:11], a[40:43]
    s_waitcnt lgkmcnt(2)
    v_mfma_f32_16x16x32_bf16 v[96:99], a[12:15], a[128:131], v[96:99]
    s_waitcnt vmcnt(13)
    s_barrier
    s_waitcnt vmcnt(5)
    v_mfma_f32_16x16x32_bf16 v[96:99], a[16:19], a[144:147], v[96:99]
    ds_read_b64_tr_b16 a[24:25], v226 offset:8192
    v_mfma_f32_16x16x32_bf16 v[100:103], a[12:15], a[132:135], v[100:103]
    ds_read_b64_tr_b16 a[26:27], v226 offset:10240
    v_mfma_f32_16x16x32_bf16 v[100:103], a[16:19], a[148:151], v[100:103]
    ds_read_b64_tr_b16 a[28:29], v226 offset:32768
    ds_read_b64_tr_b16 a[30:31], v226 offset:34816
    v_mfma_f32_16x16x32_bf16 v[104:107], a[12:15], a[136:139], v[104:107]
    ds_read_b64_tr_b16 a[0:1], v227 offset:8192
    v_mfma_f32_16x16x32_bf16 v[104:107], a[16:19], a[152:155], v[104:107]
    buffer_load_dwordx4 v231, s[28:31], s55 offen offset:1024 lds
    v_mfma_f32_16x16x32_bf16 v[108:111], a[12:15], a[140:143], v[108:111]
    s_add_u32 m0, s53, 32768
    ds_read_b64_tr_b16 a[2:3], v227 offset:10240
    s_add_u32 s55, s33, 111744
    v_mfma_f32_16x16x32_bf16 v[108:111], a[16:19], a[156:159], v[108:111]
    s_waitcnt lgkmcnt(4)
    ds_read_b128 a[160:163], v240 offset:0
    v_mfma_f32_16x16x32_bf16 a[40:43], a[32:35], a[20:23], a[40:43]
    ds_read_b128 a[164:167], v240 offset:2048
    s_waitcnt lgkmcnt(4)
    v_mfma_f32_16x16x32_bf16 v[112:115], a[24:27], a[128:131], v[112:115]
    ds_read_b64_tr_b16 a[4:5], v227 offset:32768
    v_mfma_f32_16x16x32_bf16 v[112:115], a[28:31], a[144:147], v[112:115]
    ds_read_b64_tr_b16 a[6:7], v227 offset:34816
    v_mfma_f32_16x16x32_bf16 v[116:119], a[24:27], a[132:135], v[116:119]
    ds_read_b64_tr_b16 a[8:9], v251 offset:0
    v_mfma_f32_16x16x32_bf16 v[116:119], a[28:31], a[148:151], v[116:119]
    ds_read_b64_tr_b16 a[10:11], v251 offset:2048
    v_mfma_f32_16x16x32_bf16 v[120:123], a[24:27], a[136:139], v[120:123]
    v_add_u32 v229, 0xc000, v229
    v_mfma_f32_16x16x32_bf16 v[120:123], a[28:31], a[152:155], v[120:123]
    ds_read_b64_tr_b16 a[12:13], v229 offset:0
    v_mfma_f32_16x16x32_bf16 v[124:127], a[24:27], a[140:143], v[124:127]
    ds_read_b64_tr_b16 a[14:15], v229 offset:2048
    v_mfma_f32_16x16x32_bf16 v[124:127], a[28:31], a[156:159], v[124:127]
    s_waitcnt lgkmcnt(4)
    buffer_load_dwordx4 v230, s[28:31], s55 offen lds
    v_mfma_f32_16x16x32_bf16 v[128:131], a[0:3], a[128:131], v[128:131]
    ds_read_b64_tr_b16 a[16:17], v229 offset:24576
    v_mfma_f32_16x16x32_bf16 v[128:131], a[4:7], a[144:147], v[128:131]
    buffer_load_dwordx4 v231, s[28:31], s55 offen offset:1024 lds
    v_mfma_f32_16x16x32_bf16 v[132:135], a[0:3], a[132:135], v[132:135]
    s_add_u32 m0, s53, 16384
    ds_read_b64_tr_b16 a[18:19], v229 offset:26624
    s_add_u32 s55, s33, 2304
    v_mfma_f32_16x16x32_bf16 v[132:135], a[4:7], a[148:151], v[132:135]
    ds_read_b128 a[168:171], v240 offset:4096
    v_mfma_f32_16x16x32_bf16 v[136:139], a[0:3], a[136:139], v[136:139]
    ds_read_b64_tr_b16 a[20:21], v251 offset:24576
    v_mfma_f32_16x16x32_bf16 v[136:139], a[4:7], a[152:155], v[136:139]
    buffer_load_dwordx4 v230, s[28:31], s55 offen lds
    v_mfma_f32_16x16x32_bf16 v[140:143], a[0:3], a[140:143], v[140:143]
    ds_read_b64_tr_b16 a[22:23], v251 offset:26624
    v_mfma_f32_16x16x32_bf16 v[140:143], a[4:7], a[156:159], v[140:143]
    s_waitcnt lgkmcnt(5)
    ds_read_b128 a[172:175], v240 offset:6144
    v_mfma_f32_16x16x32_bf16 a[48:51], a[32:35], a[8:11], a[48:51]
    ds_read_b128 a[176:179], v241 offset:0
    s_waitcnt lgkmcnt(5)
    v_mfma_f32_16x16x32_bf16 v[208:211], a[12:15], a[128:131], v[208:211]
    ds_read_b64_tr_b16 a[24:25], v224 offset:16384
    v_mfma_f32_16x16x32_bf16 v[208:211], a[16:19], a[144:147], v[208:211]
    ds_read_b64_tr_b16 a[26:27], v224 offset:18432
    v_mfma_f32_16x16x32_bf16 v[212:215], a[12:15], a[132:135], v[212:215]
    ds_read_b64_tr_b16 a[28:29], v224 offset:40960
    v_mfma_f32_16x16x32_bf16 v[212:215], a[16:19], a[148:151], v[212:215]
    ds_read_b64_tr_b16 a[30:31], v224 offset:43008
    v_mfma_f32_16x16x32_bf16 v[216:219], a[12:15], a[136:139], v[216:219]
    ds_read_b64_tr_b16 a[0:1], v250 offset:16384
    v_mfma_f32_16x16x32_bf16 v[216:219], a[16:19], a[152:155], v[216:219]
    buffer_load_dwordx4 v231, s[28:31], s55 offen offset:1024 lds
    v_mfma_f32_16x16x32_bf16 v[220:223], a[12:15], a[140:143], v[220:223]
    s_add_u32 m0, s53, 40960
    ds_read_b64_tr_b16 a[2:3], v250 offset:18432
    s_add_u32 s55, s33, 112896
    v_mfma_f32_16x16x32_bf16 v[220:223], a[16:19], a[156:159], v[220:223]
    s_waitcnt lgkmcnt(4)
    buffer_load_dwordx4 v230, s[28:31], s55 offen lds
    v_mfma_f32_16x16x32_bf16 a[48:51], a[32:35], a[20:23], a[48:51]
    ds_read_b128 a[180:183], v241 offset:2048
    s_waitcnt lgkmcnt(3)
    v_mfma_f32_16x16x32_bf16 v[144:147], a[24:27], a[128:131], v[144:147]
    ds_read_b64_tr_b16 a[4:5], v225 offset:16384
    v_mfma_f32_16x16x32_bf16 v[144:147], a[28:31], a[144:147], v[144:147]
    ds_read_b64_tr_b16 a[6:7], v225 offset:18432
    v_mfma_f32_16x16x32_bf16 v[148:151], a[24:27], a[132:135], v[148:151]
    ds_read_b64_tr_b16 a[8:9], v225 offset:40960
    v_mfma_f32_16x16x32_bf16 v[148:151], a[28:31], a[148:151], v[148:151]
    ds_read_b64_tr_b16 a[10:11], v225 offset:43008
    v_mfma_f32_16x16x32_bf16 v[152:155], a[24:27], a[136:139], v[152:155]
    ds_read_b64_tr_b16 a[12:13], v250 offset:40960
    v_mfma_f32_16x16x32_bf16 v[152:155], a[28:31], a[152:155], v[152:155]
    buffer_load_dwordx4 v231, s[28:31], s55 offen offset:1024 lds
    v_mfma_f32_16x16x32_bf16 v[156:159], a[24:27], a[140:143], v[156:159]
    s_add_u32 s33, s33, 221184
    ds_read_b64_tr_b16 a[14:15], v250 offset:43008
    v_mfma_f32_16x16x32_bf16 v[156:159], a[28:31], a[156:159], v[156:159]
    s_waitcnt lgkmcnt(4)
    ds_read_b128 a[184:187], v241 offset:4096
    v_mfma_f32_16x16x32_bf16 a[44:47], a[32:35], a[0:3], a[44:47]
    s_cmp_ge_u32 s33, 1990656
    s_cmov_b32 s33, 0
    ds_read_b128 a[188:191], v241 offset:6144
    s_waitcnt lgkmcnt(4)
    v_mfma_f32_16x16x32_bf16 v[160:163], a[4:7], a[128:131], v[160:163]
    s_waitcnt vmcnt(8)
    s_barrier
    v_mfma_f32_16x16x32_bf16 v[160:163], a[8:11], a[144:147], v[160:163]
    s_add_u32 m0, s34, 8192
    ds_read_b64_tr_b16 a[16:17], v226 offset:16384
    s_add_u32 s54, s32, 0
    v_mfma_f32_16x16x32_bf16 v[164:167], a[4:7], a[132:135], v[164:167]
    ds_read_b64_tr_b16 a[18:19], v226 offset:18432
    v_mfma_f32_16x16x32_bf16 v[164:167], a[8:11], a[148:151], v[164:167]
    ds_read_b64_tr_b16 a[20:21], v226 offset:40960
    ds_read_b64_tr_b16 a[22:23], v226 offset:43008
    v_mfma_f32_16x16x32_bf16 v[168:171], a[4:7], a[136:139], v[168:171]
    ds_read_b64_tr_b16 a[24:25], v227 offset:16384
    v_mfma_f32_16x16x32_bf16 v[168:171], a[8:11], a[152:155], v[168:171]
    buffer_load_dwordx4 v236, s[36:39], s54 offen offset:0 lds
    v_mfma_f32_16x16x32_bf16 v[172:175], a[4:7], a[140:143], v[172:175]
    ds_read_b64_tr_b16 a[26:27], v227 offset:18432
    v_mfma_f32_16x16x32_bf16 v[172:175], a[8:11], a[156:159], v[172:175]
    s_waitcnt lgkmcnt(4)
    buffer_load_dwordx4 v237, s[36:39], s54 offen offset:1024 lds
    v_mfma_f32_16x16x32_bf16 a[44:47], a[32:35], a[12:15], a[44:47]
    s_waitcnt lgkmcnt(2)
    v_mfma_f32_16x16x32_bf16 v[176:179], a[16:19], a[128:131], v[176:179]
    ds_read_b64_tr_b16 a[28:29], v227 offset:40960
    v_mfma_f32_16x16x32_bf16 v[176:179], a[20:23], a[144:147], v[176:179]
    ds_read_b64_tr_b16 a[30:31], v227 offset:43008
    v_add_u32 v224, 0xffff4000, v224
    v_mfma_f32_16x16x32_bf16 v[180:183], a[16:19], a[132:135], v[180:183]
    ds_read_b64_tr_b16 a[0:1], v224 offset:0
    v_mfma_f32_16x16x32_bf16 v[180:183], a[20:23], a[148:151], v[180:183]
    ds_read_b64_tr_b16 a[2:3], v224 offset:2048
    v_mfma_f32_16x16x32_bf16 v[184:187], a[16:19], a[136:139], v[184:187]
    ds_read_b64_tr_b16 a[4:5], v224 offset:24576
    v_mfma_f32_16x16x32_bf16 v[184:187], a[20:23], a[152:155], v[184:187]
    buffer_load_dwordx4 v238, s[36:39], s54 offen offset:2048 lds
    v_mfma_f32_16x16x32_bf16 v[188:191], a[16:19], a[140:143], v[188:191]
    ds_read_b64_tr_b16 a[6:7], v224 offset:26624
    v_mfma_f32_16x16x32_bf16 v[188:191], a[20:23], a[156:159], v[188:191]
    s_waitcnt lgkmcnt(4)
    v_mfma_f32_16x16x32_bf16 v[192:195], a[24:27], a[128:131], v[192:195]
    v_add_u32 v225, 0xffff4000, v225
    v_mfma_f32_16x16x32_bf16 v[192:195], a[28:31], a[144:147], v[192:195]
    ds_read_b64_tr_b16 a[8:9], v225 offset:0
    v_mfma_f32_16x16x32_bf16 v[196:199], a[24:27], a[132:135], v[196:199]
    ds_read_b64_tr_b16 a[10:11], v225 offset:2048
    v_mfma_f32_16x16x32_bf16 v[196:199], a[28:31], a[148:151], v[196:199]
    buffer_load_dwordx4 v239, s[36:39], s54 offen offset:3072 lds
    v_mfma_f32_16x16x32_bf16 v[200:203], a[24:27], a[136:139], v[200:203]
    s_add_u32 m0, s34, 12288
    ds_read_b64_tr_b16 a[12:13], v225 offset:24576
    s_add_u32 s54, s32, 36864
    v_mfma_f32_16x16x32_bf16 v[200:203], a[28:31], a[152:155], v[200:203]
    buffer_load_dwordx4 v236, s[36:39], s54 offen offset:0 lds
    v_mfma_f32_16x16x32_bf16 v[204:207], a[24:27], a[140:143], v[204:207]
    ds_read_b64_tr_b16 a[14:15], v225 offset:26624
    v_mfma_f32_16x16x32_bf16 v[204:207], a[28:31], a[156:159], v[204:207]
    s_waitcnt lgkmcnt(4)
    v_mfma_f32_16x16x32_bf16 v[0:3], a[0:3], a[160:163], v[0:3]
    v_add_u32 v226, 0xffff4000, v226
    v_mfma_f32_16x16x32_bf16 v[0:3], a[4:7], a[176:179], v[0:3]
    ds_read_b64_tr_b16 a[16:17], v226 offset:0
    v_mfma_f32_16x16x32_bf16 v[4:7], a[0:3], a[164:167], v[4:7]
    ds_read_b64_tr_b16 a[18:19], v226 offset:2048
    v_mfma_f32_16x16x32_bf16 v[4:7], a[4:7], a[180:183], v[4:7]
    buffer_load_dwordx4 v237, s[36:39], s54 offen offset:1024 lds
    v_mfma_f32_16x16x32_bf16 v[8:11], a[0:3], a[168:171], v[8:11]
    ds_read_b64_tr_b16 a[20:21], v226 offset:24576
    v_mfma_f32_16x16x32_bf16 v[8:11], a[4:7], a[184:187], v[8:11]
    buffer_load_dwordx4 v238, s[36:39], s54 offen offset:2048 lds
    v_mfma_f32_16x16x32_bf16 v[12:15], a[0:3], a[172:175], v[12:15]
    ds_read_b64_tr_b16 a[22:23], v226 offset:26624
    v_mfma_f32_16x16x32_bf16 v[12:15], a[4:7], a[188:191], v[12:15]
    s_waitcnt lgkmcnt(4)
    v_mfma_f32_16x16x32_bf16 v[16:19], a[8:11], a[160:163], v[16:19]
    s_waitcnt vmcnt(11)
    s_barrier
    v_add_u32 v227, 0xffff4000, v227
    v_mfma_f32_16x16x32_bf16 v[16:19], a[12:15], a[176:179], v[16:19]
    ds_read_b64_tr_b16 a[24:25], v227 offset:0
    v_accvgpr_read_b32 v254, a36
    v_mfma_f32_16x16x32_bf16 v[20:23], a[8:11], a[164:167], v[20:23]
    ds_read_b64_tr_b16 a[26:27], v227 offset:2048
    v_accvgpr_read_b32 v255, a40
    v_mfma_f32_16x16x32_bf16 v[20:23], a[12:15], a[180:183], v[20:23]
    s_mov_b32 vcc_lo, 0xffff0000
    s_mov_b32 vcc_hi, 0
    v_cndmask_b32 v254, v254, v255, vcc
    v_mfma_f32_16x16x32_bf16 v[24:27], a[8:11], a[168:171], v[24:27]
    ds_read_b64_tr_b16 a[28:29], v227 offset:24576
    v_accvgpr_read_b32 v255, a44
    v_mfma_f32_16x16x32_bf16 v[24:27], a[12:15], a[184:187], v[24:27]
    buffer_load_dwordx4 v239, s[36:39], s54 offen offset:3072 lds
    v_mfma_f32_16x16x32_bf16 v[28:31], a[8:11], a[172:175], v[28:31]
    s_add_u32 s32, s32, 128
    ds_read_b64_tr_b16 a[30:31], v227 offset:26624
    s_mov_b32 vcc_lo, 0
    v_mfma_f32_16x16x32_bf16 v[28:31], a[12:15], a[188:191], v[28:31]
    s_waitcnt lgkmcnt(4)
    s_cmp_ge_u32 s32, 1152
    s_cmov_b32 s32, 0
    v_mfma_f32_16x16x32_bf16 v[32:35], a[16:19], a[160:163], v[32:35]
    s_add_u32 m0, s53, 49152
    v_add_u32 v228, 0xffff4000, v228
    s_add_u32 s55, s33, 0
    v_mfma_f32_16x16x32_bf16 v[32:35], a[20:23], a[176:179], v[32:35]
    s_mov_b32 vcc_hi, 0xffff
    ds_read_b64_tr_b16 a[0:1], v228 offset:0
    v_cndmask_b32 v254, v254, v255, vcc
    v_mfma_f32_16x16x32_bf16 v[36:39], a[16:19], a[164:167], v[36:39]
    ds_read_b64_tr_b16 a[2:3], v228 offset:2048
    v_accvgpr_read_b32 v255, a48
    v_mfma_f32_16x16x32_bf16 v[36:39], a[20:23], a[180:183], v[36:39]
    buffer_load_dwordx4 v230, s[28:31], s55 offen lds
    v_mfma_f32_16x16x32_bf16 v[40:43], a[16:19], a[168:171], v[40:43]
    s_mov_b32 vcc_lo, 0
    ds_read_b64_tr_b16 a[4:5], v228 offset:24576
    s_mov_b32 vcc_hi, 0xffff0000
    v_mfma_f32_16x16x32_bf16 v[40:43], a[20:23], a[184:187], v[40:43]
    buffer_load_dwordx4 v231, s[28:31], s55 offen offset:1024 lds
    v_mfma_f32_16x16x32_bf16 v[44:47], a[16:19], a[172:175], v[44:47]
    s_add_u32 m0, s53, 73728
    ds_read_b64_tr_b16 a[6:7], v228 offset:26624
    s_add_u32 s55, s33, 110592
    v_mfma_f32_16x16x32_bf16 v[44:47], a[20:23], a[188:191], v[44:47]
    s_waitcnt lgkmcnt(4)
    v_cndmask_b32 v254, v254, v255, vcc
    v_cvt_pk_bf16_f32 v255, v254, v254
    v_mfma_f32_16x16x32_bf16 v[48:51], a[24:27], a[160:163], v[48:51]
    ds_read_b64_tr_b16 a[8:9], v224 offset:8192
    v_and_b32 v255, 0xffff0000, v255
    v_mfma_f32_16x16x32_bf16 v[48:51], a[28:31], a[176:179], v[48:51]
    buffer_load_dwordx4 v230, s[28:31], s55 offen lds
    v_mfma_f32_16x16x32_bf16 v[52:55], a[24:27], a[164:167], v[52:55]
    ds_read_b64_tr_b16 a[10:11], v224 offset:10240
    v_sub_f32 v250, v254, v255
    v_mfma_f32_16x16x32_bf16 v[52:55], a[28:31], a[180:183], v[52:55]
    v_cvt_pk_bf16_f32 v254, v255, v250
    v_mfma_f32_16x16x32_bf16 v[56:59], a[24:27], a[168:171], v[56:59]
    ds_read_b64_tr_b16 a[12:13], v224 offset:32768
    v_mfma_f32_16x16x32_bf16 v[56:59], a[28:31], a[184:187], v[56:59]
    buffer_load_dwordx4 v231, s[28:31], s55 offen offset:1024 lds
    v_mfma_f32_16x16x32_bf16 v[60:63], a[24:27], a[172:175], v[60:63]
    s_add_u32 m0, s53, 57344
    ds_read_b64_tr_b16 a[14:15], v224 offset:34816
    s_add_u32 s55, s33, 1152
    v_mfma_f32_16x16x32_bf16 v[60:63], a[28:31], a[188:191], v[60:63]
    s_waitcnt lgkmcnt(4)
    buffer_store_dword v254, v252, s[24:27], s82 offen sc0 sc1
    v_mfma_f32_16x16x32_bf16 v[64:67], a[0:3], a[160:163], v[64:67]
    ds_read_b64_tr_b16 a[16:17], v225 offset:8192
    v_mfma_f32_16x16x32_bf16 v[64:67], a[4:7], a[176:179], v[64:67]
    buffer_load_dwordx4 v230, s[28:31], s55 offen lds
    v_mfma_f32_16x16x32_bf16 v[68:71], a[0:3], a[164:167], v[68:71]
    ds_read_b64_tr_b16 a[18:19], v225 offset:10240
    v_mfma_f32_16x16x32_bf16 v[68:71], a[4:7], a[180:183], v[68:71]
    v_mfma_f32_16x16x32_bf16 v[72:75], a[0:3], a[168:171], v[72:75]
    ds_read_b64_tr_b16 a[20:21], v225 offset:32768
    v_mfma_f32_16x16x32_bf16 v[72:75], a[4:7], a[184:187], v[72:75]
    v_mfma_f32_16x16x32_bf16 v[76:79], a[0:3], a[172:175], v[76:79]
    ds_read_b64_tr_b16 a[22:23], v225 offset:34816
    v_mfma_f32_16x16x32_bf16 v[76:79], a[4:7], a[188:191], v[76:79]
    s_waitcnt lgkmcnt(4)
    v_mfma_f32_16x16x32_bf16 v[80:83], a[8:11], a[160:163], v[80:83]
    ds_read_b64_tr_b16 a[24:25], v226 offset:8192
    v_mfma_f32_16x16x32_bf16 v[80:83], a[12:15], a[176:179], v[80:83]
    buffer_load_dwordx4 v231, s[28:31], s55 offen offset:1024 lds
    v_mfma_f32_16x16x32_bf16 v[84:87], a[8:11], a[164:167], v[84:87]
    s_add_u32 m0, s53, 81920
    ds_read_b64_tr_b16 a[26:27], v226 offset:10240
    s_add_u32 s55, s33, 111744
    v_mfma_f32_16x16x32_bf16 v[84:87], a[12:15], a[180:183], v[84:87]
    v_mfma_f32_16x16x32_bf16 v[88:91], a[8:11], a[168:171], v[88:91]
    ds_read_b64_tr_b16 a[28:29], v226 offset:32768
    v_mfma_f32_16x16x32_bf16 v[88:91], a[12:15], a[184:187], v[88:91]
    buffer_load_dwordx4 v230, s[28:31], s55 offen lds
    v_mfma_f32_16x16x32_bf16 v[92:95], a[8:11], a[172:175], v[92:95]
    ds_read_b64_tr_b16 a[30:31], v226 offset:34816
    v_mfma_f32_16x16x32_bf16 v[92:95], a[12:15], a[188:191], v[92:95]
    s_waitcnt lgkmcnt(4)
    v_mfma_f32_16x16x32_bf16 v[96:99], a[16:19], a[160:163], v[96:99]
    s_waitcnt vmcnt(16)
    s_barrier
    s_waitcnt vmcnt(8)
    v_mfma_f32_16x16x32_bf16 v[96:99], a[20:23], a[176:179], v[96:99]
    ds_read_b64_tr_b16 a[0:1], v227 offset:8192
    v_mfma_f32_16x16x32_bf16 v[100:103], a[16:19], a[164:167], v[100:103]
    ds_read_b64_tr_b16 a[2:3], v227 offset:10240
    v_mfma_f32_16x16x32_bf16 v[100:103], a[20:23], a[180:183], v[100:103]
    buffer_load_dwordx4 v231, s[28:31], s55 offen offset:1024 lds
    v_mfma_f32_16x16x32_bf16 v[104:107], a[16:19], a[168:171], v[104:107]
    s_add_u32 m0, s53, 65536
    ds_read_b64_tr_b16 a[4:5], v227 offset:32768
    s_add_u32 s55, s33, 2304
    v_mfma_f32_16x16x32_bf16 v[104:107], a[20:23], a[184:187], v[104:107]
    buffer_load_dwordx4 v230, s[28:31], s55 offen lds
    v_mfma_f32_16x16x32_bf16 v[108:111], a[16:19], a[172:175], v[108:111]
    ds_read_b64_tr_b16 a[6:7], v227 offset:34816
    v_mfma_f32_16x16x32_bf16 v[108:111], a[20:23], a[188:191], v[108:111]
    s_waitcnt lgkmcnt(4)
    ds_read_b128 a[192:195], v240 offset:8192
    v_mfma_f32_16x16x32_bf16 v[112:115], a[24:27], a[160:163], v[112:115]
    v_add_u32 v229, 0xffff4000, v229
    v_mfma_f32_16x16x32_bf16 v[112:115], a[28:31], a[176:179], v[112:115]
    ds_read_b64_tr_b16 a[8:9], v229 offset:0
    v_mfma_f32_16x16x32_bf16 v[116:119], a[24:27], a[164:167], v[116:119]
    ds_read_b64_tr_b16 a[10:11], v229 offset:2048
    v_mfma_f32_16x16x32_bf16 v[116:119], a[28:31], a[180:183], v[116:119]
    buffer_load_dwordx4 v231, s[28:31], s55 offen offset:1024 lds
    v_mfma_f32_16x16x32_bf16 v[120:123], a[24:27], a[168:171], v[120:123]
    s_add_u32 m0, s53, 90112
    ds_read_b64_tr_b16 a[12:13], v229 offset:24576
    s_add_u32 s55, s33, 112896
    v_mfma_f32_16x16x32_bf16 v[120:123], a[28:31], a[184:187], v[120:123]
    buffer_load_dwordx4 v230, s[28:31], s55 offen lds
    v_mfma_f32_16x16x32_bf16 v[124:127], a[24:27], a[172:175], v[124:127]
    ds_read_b64_tr_b16 a[14:15], v229 offset:26624
    v_mfma_f32_16x16x32_bf16 v[124:127], a[28:31], a[188:191], v[124:127]
    s_waitcnt lgkmcnt(5)
    ds_read_b128 a[196:199], v240 offset:10240
    v_mfma_f32_16x16x32_bf16 v[128:131], a[0:3], a[160:163], v[128:131]
    ds_read_b64_tr_b16 a[16:17], v224 offset:16384
    v_mfma_f32_16x16x32_bf16 v[128:131], a[4:7], a[176:179], v[128:131]
    ds_read_b128 a[200:203], v240 offset:12288
    v_mfma_f32_16x16x32_bf16 v[132:135], a[0:3], a[164:167], v[132:135]
    ds_read_b64_tr_b16 a[18:19], v224 offset:18432
    v_mfma_f32_16x16x32_bf16 v[132:135], a[4:7], a[180:183], v[132:135]
    ds_read_b128 a[204:207], v240 offset:14336
    v_mfma_f32_16x16x32_bf16 v[136:139], a[0:3], a[168:171], v[136:139]
    ds_read_b64_tr_b16 a[20:21], v224 offset:40960
    v_mfma_f32_16x16x32_bf16 v[136:139], a[4:7], a[184:187], v[136:139]
    buffer_load_dwordx4 v231, s[28:31], s55 offen offset:1024 lds
    v_mfma_f32_16x16x32_bf16 v[140:143], a[0:3], a[172:175], v[140:143]
    s_add_u32 s33, s33, 221184
    ds_read_b64_tr_b16 a[22:23], v224 offset:43008
    v_mfma_f32_16x16x32_bf16 v[140:143], a[4:7], a[188:191], v[140:143]
    s_waitcnt lgkmcnt(7)
    ds_read_b128 a[208:211], v241 offset:8192
    v_mfma_f32_16x16x32_bf16 v[208:211], a[8:11], a[160:163], v[208:211]
    ds_read_b64_tr_b16 a[24:25], v225 offset:16384
    v_mfma_f32_16x16x32_bf16 v[208:211], a[12:15], a[176:179], v[208:211]
    s_cmp_ge_u32 s33, 1990656
    s_cmov_b32 s33, 0
    ds_read_b128 a[212:215], v241 offset:10240
    v_mfma_f32_16x16x32_bf16 v[212:215], a[8:11], a[164:167], v[212:215]
    ds_read_b64_tr_b16 a[26:27], v225 offset:18432
    s_add_u32 m0, s34, 0
    v_mfma_f32_16x16x32_bf16 v[212:215], a[12:15], a[180:183], v[212:215]
    s_add_u32 s54, s32, 0
    ds_read_b128 a[216:219], v241 offset:12288
    v_mfma_f32_16x16x32_bf16 v[216:219], a[8:11], a[168:171], v[216:219]
    ds_read_b64_tr_b16 a[28:29], v225 offset:40960
    v_mfma_f32_16x16x32_bf16 v[216:219], a[12:15], a[184:187], v[216:219]
    buffer_load_dwordx4 v236, s[36:39], s54 offen offset:0 lds
    v_mfma_f32_16x16x32_bf16 v[220:223], a[8:11], a[172:175], v[220:223]
    ds_read_b64_tr_b16 a[30:31], v225 offset:43008
    v_mfma_f32_16x16x32_bf16 v[220:223], a[12:15], a[188:191], v[220:223]
    s_waitcnt lgkmcnt(7)
    buffer_load_dwordx4 v237, s[36:39], s54 offen offset:1024 lds
    v_mfma_f32_16x16x32_bf16 v[144:147], a[16:19], a[160:163], v[144:147]
    ds_read_b64_tr_b16 a[0:1], v226 offset:16384
    v_mfma_f32_16x16x32_bf16 v[144:147], a[20:23], a[176:179], v[144:147]
    ds_read_b128 a[220:223], v241 offset:14336
    v_mfma_f32_16x16x32_bf16 v[148:151], a[16:19], a[164:167], v[148:151]
    ds_read_b64_tr_b16 a[2:3], v226 offset:18432
    v_mfma_f32_16x16x32_bf16 v[148:151], a[20:23], a[180:183], v[148:151]
    v_mfma_f32_16x16x32_bf16 v[152:155], a[16:19], a[168:171], v[152:155]
    ds_read_b64_tr_b16 a[4:5], v226 offset:40960
    v_mfma_f32_16x16x32_bf16 v[152:155], a[20:23], a[184:187], v[152:155]
    buffer_load_dwordx4 v238, s[36:39], s54 offen offset:2048 lds
    v_mfma_f32_16x16x32_bf16 v[156:159], a[16:19], a[172:175], v[156:159]
    ds_read_b64_tr_b16 a[6:7], v226 offset:43008
    v_mfma_f32_16x16x32_bf16 v[156:159], a[20:23], a[188:191], v[156:159]
    s_waitcnt lgkmcnt(5)
    v_mfma_f32_16x16x32_bf16 v[160:163], a[24:27], a[160:163], v[160:163]
    s_waitcnt vmcnt(12)
    s_barrier
    v_mfma_f32_16x16x32_bf16 v[160:163], a[28:31], a[176:179], v[160:163]
    ds_read_b64_tr_b16 a[8:9], v227 offset:16384
    v_mfma_f32_16x16x32_bf16 v[164:167], a[24:27], a[164:167], v[164:167]
    ds_read_b64_tr_b16 a[10:11], v227 offset:18432
    v_mfma_f32_16x16x32_bf16 v[164:167], a[28:31], a[180:183], v[164:167]
    buffer_load_dwordx4 v239, s[36:39], s54 offen offset:3072 lds
    v_mfma_f32_16x16x32_bf16 v[168:171], a[24:27], a[168:171], v[168:171]
    s_add_u32 m0, s34, 4096
    ds_read_b64_tr_b16 a[12:13], v227 offset:40960
    s_add_u32 s54, s32, 36864
    v_mfma_f32_16x16x32_bf16 v[168:171], a[28:31], a[184:187], v[168:171]
    buffer_load_dwordx4 v236, s[36:39], s54 offen offset:0 lds
    v_mfma_f32_16x16x32_bf16 v[172:175], a[24:27], a[172:175], v[172:175]
    ds_read_b64_tr_b16 a[14:15], v227 offset:43008
    v_mfma_f32_16x16x32_bf16 v[172:175], a[28:31], a[188:191], v[172:175]
    s_waitcnt lgkmcnt(4)
    v_mfma_f32_16x16x32_bf16 v[176:179], a[0:3], a[160:163], v[176:179]
    v_add_u32 v224, 0xc000, v224
    v_mfma_f32_16x16x32_bf16 v[176:179], a[4:7], a[176:179], v[176:179]
    ds_read_b64_tr_b16 a[16:17], v224 offset:0
    v_mfma_f32_16x16x32_bf16 v[180:183], a[0:3], a[164:167], v[180:183]
    ds_read_b64_tr_b16 a[18:19], v224 offset:2048
    v_mfma_f32_16x16x32_bf16 v[180:183], a[4:7], a[180:183], v[180:183]
    buffer_load_dwordx4 v237, s[36:39], s54 offen offset:1024 lds
    v_mfma_f32_16x16x32_bf16 v[184:187], a[0:3], a[168:171], v[184:187]
    ds_read_b64_tr_b16 a[20:21], v224 offset:24576
    v_mfma_f32_16x16x32_bf16 v[184:187], a[4:7], a[184:187], v[184:187]
    buffer_load_dwordx4 v238, s[36:39], s54 offen offset:2048 lds
    v_mfma_f32_16x16x32_bf16 v[188:191], a[0:3], a[172:175], v[188:191]
    ds_read_b64_tr_b16 a[22:23], v224 offset:26624
    v_mfma_f32_16x16x32_bf16 v[188:191], a[4:7], a[188:191], v[188:191]
    s_waitcnt lgkmcnt(4)
    v_mfma_f32_16x16x32_bf16 v[192:195], a[8:11], a[160:163], v[192:195]
    v_add_u32 v225, 0xc000, v225
    v_mfma_f32_16x16x32_bf16 v[192:195], a[12:15], a[176:179], v[192:195]
    ds_read_b64_tr_b16 a[24:25], v225 offset:0
    v_mfma_f32_16x16x32_bf16 v[196:199], a[8:11], a[164:167], v[196:199]
    ds_read_b64_tr_b16 a[26:27], v225 offset:2048
    v_mfma_f32_16x16x32_bf16 v[196:199], a[12:15], a[180:183], v[196:199]
    v_mfma_f32_16x16x32_bf16 v[200:203], a[8:11], a[168:171], v[200:203]
    ds_read_b64_tr_b16 a[28:29], v225 offset:24576
    v_mfma_f32_16x16x32_bf16 v[200:203], a[12:15], a[184:187], v[200:203]
    buffer_load_dwordx4 v239, s[36:39], s54 offen offset:3072 lds
    v_mfma_f32_16x16x32_bf16 v[204:207], a[8:11], a[172:175], v[204:207]
    s_add_u32 s32, s32, 128
    ds_read_b64_tr_b16 a[30:31], v225 offset:26624
    v_mfma_f32_16x16x32_bf16 v[204:207], a[12:15], a[188:191], v[204:207]
    s_waitcnt lgkmcnt(4)
    s_cmp_ge_u32 s32, 1152
    s_cmov_b32 s32, 0
    v_mfma_f32_16x16x32_bf16 v[0:3], a[16:19], a[192:195], v[0:3]
    s_add_u32 m0, s53, 0
    v_add_u32 v226, 0xc000, v226
    s_add_u32 s55, s33, 0
    v_mfma_f32_16x16x32_bf16 v[0:3], a[20:23], a[208:211], v[0:3]
    ds_read_b64_tr_b16 a[0:1], v226 offset:0
    v_mfma_f32_16x16x32_bf16 v[4:7], a[16:19], a[196:199], v[4:7]
    ds_read_b64_tr_b16 a[2:3], v226 offset:2048
    v_mfma_f32_16x16x32_bf16 v[4:7], a[20:23], a[212:215], v[4:7]
    buffer_load_dwordx4 v230, s[28:31], s55 offen lds
    v_mfma_f32_16x16x32_bf16 v[8:11], a[16:19], a[200:203], v[8:11]
    ds_read_b64_tr_b16 a[4:5], v226 offset:24576
    v_mfma_f32_16x16x32_bf16 v[8:11], a[20:23], a[216:219], v[8:11]
    buffer_load_dwordx4 v231, s[28:31], s55 offen offset:1024 lds
    v_mfma_f32_16x16x32_bf16 v[12:15], a[16:19], a[204:207], v[12:15]
    s_add_u32 m0, s53, 24576
    ds_read_b64_tr_b16 a[6:7], v226 offset:26624
    s_add_u32 s55, s33, 110592
    v_mfma_f32_16x16x32_bf16 v[12:15], a[20:23], a[220:223], v[12:15]
    s_waitcnt lgkmcnt(4)
    v_mfma_f32_16x16x32_bf16 v[16:19], a[24:27], a[192:195], v[16:19]
    s_waitcnt vmcnt(14)
    s_barrier
    v_add_u32 v227, 0xc000, v227
    v_mfma_f32_16x16x32_bf16 v[16:19], a[28:31], a[208:211], v[16:19]
    s_lshl2_add_u32 s49, s50, s83
    ds_read_b64_tr_b16 a[8:9], v227 offset:0
    v_mfma_f32_16x16x32_bf16 v[20:23], a[24:27], a[196:199], v[20:23]
    ds_read_b64_tr_b16 a[10:11], v227 offset:2048
    v_mfma_f32_16x16x32_bf16 v[20:23], a[28:31], a[212:215], v[20:23]
    buffer_load_dwordx4 v230, s[28:31], s55 offen lds
    v_mfma_f32_16x16x32_bf16 v[24:27], a[24:27], a[200:203], v[24:27]
    ds_read_b64_tr_b16 a[12:13], v227 offset:24576
    v_mfma_f32_16x16x32_bf16 v[24:27], a[28:31], a[216:219], v[24:27]
    buffer_load_dwordx4 v231, s[28:31], s55 offen offset:1024 lds
    v_mfma_f32_16x16x32_bf16 v[28:31], a[24:27], a[204:207], v[28:31]
    s_add_u32 m0, s53, 8192
    ds_read_b64_tr_b16 a[14:15], v227 offset:26624
    s_add_u32 s55, s33, 1152
    v_mfma_f32_16x16x32_bf16 v[28:31], a[28:31], a[220:223], v[28:31]
    s_waitcnt lgkmcnt(4)
    buffer_store_dword v248, v246, s[24:27], s49 offen sc0 sc1
    v_mfma_f32_16x16x32_bf16 v[32:35], a[0:3], a[192:195], v[32:35]
    v_add_u32 v228, 0xc000, v228
    v_mfma_f32_16x16x32_bf16 v[32:35], a[4:7], a[208:211], v[32:35]
    ds_read_b64_tr_b16 a[16:17], v228 offset:0
    v_mfma_f32_16x16x32_bf16 v[36:39], a[0:3], a[196:199], v[36:39]
    ds_read_b64_tr_b16 a[18:19], v228 offset:2048
    v_mfma_f32_16x16x32_bf16 v[36:39], a[4:7], a[212:215], v[36:39]
    buffer_load_dwordx4 v230, s[28:31], s55 offen lds
    v_mfma_f32_16x16x32_bf16 v[40:43], a[0:3], a[200:203], v[40:43]
    ds_read_b64_tr_b16 a[20:21], v228 offset:24576
    v_mfma_f32_16x16x32_bf16 v[40:43], a[4:7], a[216:219], v[40:43]
    v_mfma_f32_16x16x32_bf16 v[44:47], a[0:3], a[204:207], v[44:47]
    ds_read_b64_tr_b16 a[22:23], v228 offset:26624
    v_mfma_f32_16x16x32_bf16 v[44:47], a[4:7], a[220:223], v[44:47]
    s_waitcnt lgkmcnt(4)
    v_mfma_f32_16x16x32_bf16 v[48:51], a[8:11], a[192:195], v[48:51]
    ds_read_b64_tr_b16 a[24:25], v224 offset:8192
    v_mfma_f32_16x16x32_bf16 v[48:51], a[12:15], a[208:211], v[48:51]
    buffer_load_dwordx4 v231, s[28:31], s55 offen offset:1024 lds
    v_mfma_f32_16x16x32_bf16 v[52:55], a[8:11], a[196:199], v[52:55]
    s_add_u32 m0, s53, 32768
    ds_read_b64_tr_b16 a[26:27], v224 offset:10240
    s_add_u32 s55, s33, 111744
    v_mfma_f32_16x16x32_bf16 v[52:55], a[12:15], a[212:215], v[52:55]
    v_mfma_f32_16x16x32_bf16 v[56:59], a[8:11], a[200:203], v[56:59]
    ds_read_b64_tr_b16 a[28:29], v224 offset:32768
    v_mfma_f32_16x16x32_bf16 v[56:59], a[12:15], a[216:219], v[56:59]
    buffer_load_dwordx4 v230, s[28:31], s55 offen lds
    v_mfma_f32_16x16x32_bf16 v[60:63], a[8:11], a[204:207], v[60:63]
    ds_read_b64_tr_b16 a[30:31], v224 offset:34816
    v_mfma_f32_16x16x32_bf16 v[60:63], a[12:15], a[220:223], v[60:63]
    s_waitcnt lgkmcnt(4)
    v_mfma_f32_16x16x32_bf16 v[64:67], a[16:19], a[192:195], v[64:67]
    ds_read_b64_tr_b16 a[0:1], v225 offset:8192
    v_mfma_f32_16x16x32_bf16 v[64:67], a[20:23], a[208:211], v[64:67]
    buffer_load_dwordx4 v231, s[28:31], s55 offen offset:1024 lds
    v_mfma_f32_16x16x32_bf16 v[68:71], a[16:19], a[196:199], v[68:71]
    s_add_u32 m0, s53, 16384
    ds_read_b64_tr_b16 a[2:3], v225 offset:10240
    s_add_u32 s55, s33, 2304
    v_mfma_f32_16x16x32_bf16 v[68:71], a[20:23], a[212:215], v[68:71]
    v_mfma_f32_16x16x32_bf16 v[72:75], a[16:19], a[200:203], v[72:75]
    ds_read_b64_tr_b16 a[4:5], v225 offset:32768
    v_mfma_f32_16x16x32_bf16 v[72:75], a[20:23], a[216:219], v[72:75]
    buffer_load_dwordx4 v230, s[28:31], s55 offen lds
    v_mfma_f32_16x16x32_bf16 v[76:79], a[16:19], a[204:207], v[76:79]
    ds_read_b64_tr_b16 a[6:7], v225 offset:34816
    v_mfma_f32_16x16x32_bf16 v[76:79], a[20:23], a[220:223], v[76:79]
    s_waitcnt lgkmcnt(4)
    v_mfma_f32_16x16x32_bf16 v[80:83], a[24:27], a[192:195], v[80:83]
    ds_read_b64_tr_b16 a[8:9], v226 offset:8192
    v_mfma_f32_16x16x32_bf16 v[80:83], a[28:31], a[208:211], v[80:83]
    buffer_load_dwordx4 v231, s[28:31], s55 offen offset:1024 lds
    v_mfma_f32_16x16x32_bf16 v[84:87], a[24:27], a[196:199], v[84:87]
    s_add_u32 m0, s53, 40960
    ds_read_b64_tr_b16 a[10:11], v226 offset:10240
    s_add_u32 s55, s33, 112896
    v_mfma_f32_16x16x32_bf16 v[84:87], a[28:31], a[212:215], v[84:87]
    v_mfma_f32_16x16x32_bf16 v[88:91], a[24:27], a[200:203], v[88:91]
    ds_read_b64_tr_b16 a[12:13], v226 offset:32768
    v_mfma_f32_16x16x32_bf16 v[88:91], a[28:31], a[216:219], v[88:91]
    buffer_load_dwordx4 v230, s[28:31], s55 offen lds
    v_mfma_f32_16x16x32_bf16 v[92:95], a[24:27], a[204:207], v[92:95]
    ds_read_b64_tr_b16 a[14:15], v226 offset:34816
    v_mfma_f32_16x16x32_bf16 v[92:95], a[28:31], a[220:223], v[92:95]
    s_waitcnt lgkmcnt(4)
    v_mfma_f32_16x16x32_bf16 v[96:99], a[0:3], a[192:195], v[96:99]
    s_waitcnt vmcnt(20)
    s_barrier
    s_waitcnt vmcnt(12)
    v_mfma_f32_16x16x32_bf16 v[96:99], a[4:7], a[208:211], v[96:99]
    ds_read_b64_tr_b16 a[16:17], v227 offset:8192
    v_mfma_f32_16x16x32_bf16 v[100:103], a[0:3], a[196:199], v[100:103]
    ds_read_b64_tr_b16 a[18:19], v227 offset:10240
    v_mfma_f32_16x16x32_bf16 v[100:103], a[4:7], a[212:215], v[100:103]
    ds_read_b128 a[224:227], v240 offset:0
    v_mfma_f32_16x16x32_bf16 v[104:107], a[0:3], a[200:203], v[104:107]
    ds_read_b64_tr_b16 a[20:21], v227 offset:32768
    v_mfma_f32_16x16x32_bf16 v[104:107], a[4:7], a[216:219], v[104:107]
    buffer_load_dwordx4 v231, s[28:31], s55 offen offset:1024 lds
    v_mfma_f32_16x16x32_bf16 v[108:111], a[0:3], a[204:207], v[108:111]
    s_add_u32 s33, s33, 221184
    ds_read_b64_tr_b16 a[22:23], v227 offset:34816
    v_mfma_f32_16x16x32_bf16 v[108:111], a[4:7], a[220:223], v[108:111]
    s_waitcnt lgkmcnt(5)
    ds_read_b128 a[228:231], v240 offset:2048
    v_mfma_f32_16x16x32_bf16 v[112:115], a[8:11], a[192:195], v[112:115]
    v_add_u32 v229, 0xc000, v229
    v_mfma_f32_16x16x32_bf16 v[112:115], a[12:15], a[208:211], v[112:115]
    ds_read_b64_tr_b16 a[24:25], v229 offset:0
    v_mfma_f32_16x16x32_bf16 v[116:119], a[8:11], a[196:199], v[116:119]
    ds_read_b64_tr_b16 a[26:27], v229 offset:2048
    v_mfma_f32_16x16x32_bf16 v[116:119], a[12:15], a[212:215], v[116:119]
    s_cmp_ge_u32 s33, 1990656
    s_cmov_b32 s33, 0
    ds_read_b128 a[232:235], v240 offset:4096
    v_mfma_f32_16x16x32_bf16 v[120:123], a[8:11], a[200:203], v[120:123]
    ds_read_b64_tr_b16 a[28:29], v229 offset:24576
    s_add_u32 m0, s34, 8192
    v_mfma_f32_16x16x32_bf16 v[120:123], a[12:15], a[216:219], v[120:123]
    s_add_u32 s54, s32, 0
    ds_read_b128 a[236:239], v240 offset:6144
    v_mfma_f32_16x16x32_bf16 v[124:127], a[8:11], a[204:207], v[124:127]
    ds_read_b64_tr_b16 a[30:31], v229 offset:26624
    v_mfma_f32_16x16x32_bf16 v[124:127], a[12:15], a[220:223], v[124:127]
    s_waitcnt lgkmcnt(7)
    buffer_load_dwordx4 v236, s[36:39], s54 offen offset:0 lds
    v_mfma_f32_16x16x32_bf16 v[128:131], a[16:19], a[192:195], v[128:131]
    ds_read_b64_tr_b16 a[0:1], v224 offset:16384
    v_mfma_f32_16x16x32_bf16 v[128:131], a[20:23], a[208:211], v[128:131]
    buffer_load_dwordx4 v237, s[36:39], s54 offen offset:1024 lds
    v_mfma_f32_16x16x32_bf16 v[132:135], a[16:19], a[196:199], v[132:135]
    ds_read_b64_tr_b16 a[2:3], v224 offset:18432
    v_mfma_f32_16x16x32_bf16 v[132:135], a[20:23], a[212:215], v[132:135]
    ds_read_b128 a[240:243], v241 offset:0
    v_mfma_f32_16x16x32_bf16 v[136:139], a[16:19], a[200:203], v[136:139]
    ds_read_b64_tr_b16 a[4:5], v224 offset:40960
    v_mfma_f32_16x16x32_bf16 v[136:139], a[20:23], a[216:219], v[136:139]
    buffer_load_dwordx4 v238, s[36:39], s54 offen offset:2048 lds
    v_mfma_f32_16x16x32_bf16 v[140:143], a[16:19], a[204:207], v[140:143]
    ds_read_b64_tr_b16 a[6:7], v224 offset:43008
    v_mfma_f32_16x16x32_bf16 v[140:143], a[20:23], a[220:223], v[140:143]
    s_waitcnt lgkmcnt(5)
    ds_read_b128 a[244:247], v241 offset:2048
    v_mfma_f32_16x16x32_bf16 v[208:211], a[24:27], a[192:195], v[208:211]
    ds_read_b64_tr_b16 a[8:9], v225 offset:16384
    v_mfma_f32_16x16x32_bf16 v[208:211], a[28:31], a[208:211], v[208:211]
    buffer_load_dwordx4 v239, s[36:39], s54 offen offset:3072 lds
    v_mfma_f32_16x16x32_bf16 v[212:215], a[24:27], a[196:199], v[212:215]
    s_add_u32 m0, s34, 12288
    ds_read_b64_tr_b16 a[10:11], v225 offset:18432
    s_add_u32 s54, s32, 36864
    v_mfma_f32_16x16x32_bf16 v[212:215], a[28:31], a[212:215], v[212:215]
    ds_read_b128 a[248:251], v241 offset:4096
    v_mfma_f32_16x16x32_bf16 v[216:219], a[24:27], a[200:203], v[216:219]
    ds_read_b64_tr_b16 a[12:13], v225 offset:40960
    v_mfma_f32_16x16x32_bf16 v[216:219], a[28:31], a[216:219], v[216:219]
    buffer_load_dwordx4 v236, s[36:39], s54 offen offset:0 lds
    v_mfma_f32_16x16x32_bf16 v[220:223], a[24:27], a[204:207], v[220:223]
    ds_read_b64_tr_b16 a[14:15], v225 offset:43008
    v_mfma_f32_16x16x32_bf16 v[220:223], a[28:31], a[220:223], v[220:223]
    s_waitcnt lgkmcnt(6)
    ds_read_b128 a[252:255], v241 offset:6144
    s_add_u32 s61, s68, s4
    v_mfma_f32_16x16x32_bf16 v[144:147], a[0:3], a[192:195], v[144:147]
    s_mul_i32 s60, s61, 43
    ds_read_b64_tr_b16 a[16:17], v226 offset:16384
    s_lshr_b32 s60, s60, 7
    v_mfma_f32_16x16x32_bf16 v[144:147], a[4:7], a[208:211], v[144:147]
    buffer_load_dwordx4 v237, s[36:39], s54 offen offset:1024 lds
    v_mfma_f32_16x16x32_bf16 v[148:151], a[0:3], a[196:199], v[148:151]
    s_mul_i32 s60, s60, 3
    ds_read_b64_tr_b16 a[18:19], v226 offset:18432
    s_sub_u32 s61, s61, s60
    v_mfma_f32_16x16x32_bf16 v[148:151], a[4:7], a[212:215], v[148:151]
    s_add_u32 s52, s61, 0
    s_cmp_ge_u32 s52, 3
    s_cselect_b32 s60, 3, 0
    v_mfma_f32_16x16x32_bf16 v[152:155], a[0:3], a[200:203], v[152:155]
    s_sub_u32 s52, s52, s60
    ds_read_b64_tr_b16 a[20:21], v226 offset:40960
    s_mul_i32 s60, s52, 221184
    v_mfma_f32_16x16x32_bf16 v[152:155], a[4:7], a[216:219], v[152:155]
    buffer_load_dwordx4 v238, s[36:39], s54 offen offset:2048 lds
    v_mfma_f32_16x16x32_bf16 v[156:159], a[0:3], a[204:207], v[156:159]
    s_add_u32 s14, s63, s60
    ds_read_b64_tr_b16 a[22:23], v226 offset:43008
    s_mul_i32 s60, s52, 786432
    v_mfma_f32_16x16x32_bf16 v[156:159], a[4:7], a[220:223], v[156:159]
    s_waitcnt lgkmcnt(5)
    s_add_u32 s12, s62, s60
    s_add_u32 s52, s61, 1
    v_mfma_f32_16x16x32_bf16 v[160:163], a[8:11], a[192:195], v[160:163]
    s_waitcnt vmcnt(16)
    s_barrier
    v_mfma_f32_16x16x32_bf16 v[160:163], a[12:15], a[208:211], v[160:163]
    ds_read_b64_tr_b16 a[24:25], v227 offset:16384
    v_mfma_f32_16x16x32_bf16 v[164:167], a[8:11], a[196:199], v[164:167]
    ds_read_b64_tr_b16 a[26:27], v227 offset:18432
    v_mfma_f32_16x16x32_bf16 v[164:167], a[12:15], a[212:215], v[164:167]
    s_cmp_ge_u32 s52, 3
    s_cselect_b32 s60, 3, 0
    s_sub_u32 s52, s52, s60
    v_mfma_f32_16x16x32_bf16 v[168:171], a[8:11], a[200:203], v[168:171]
    s_mul_i32 s60, s52, 221184
    ds_read_b64_tr_b16 a[28:29], v227 offset:40960
    s_add_u32 s15, s63, s60
    v_mfma_f32_16x16x32_bf16 v[168:171], a[12:15], a[216:219], v[168:171]
    buffer_load_dwordx4 v239, s[36:39], s54 offen offset:3072 lds
    v_mfma_f32_16x16x32_bf16 v[172:175], a[8:11], a[204:207], v[172:175]
    s_add_u32 s32, s32, 128
    ds_read_b64_tr_b16 a[30:31], v227 offset:43008
    s_mul_i32 s60, s52, 786432
    v_mfma_f32_16x16x32_bf16 v[172:175], a[12:15], a[220:223], v[172:175]
    s_waitcnt lgkmcnt(4)
    s_cmp_ge_u32 s32, 1152
    s_cmov_b32 s32, 0
    v_mfma_f32_16x16x32_bf16 v[176:179], a[16:19], a[192:195], v[176:179]
    s_add_u32 m0, s53, 49152
    v_add_u32 v224, 0xffff4000, v224
    s_add_u32 s55, s33, 0
    v_mfma_f32_16x16x32_bf16 v[176:179], a[20:23], a[208:211], v[176:179]
    s_add_u32 s13, s62, s60
    ds_read_b64_tr_b16 a[0:1], v224 offset:0
    s_add_u32 s52, s61, 2
    v_mfma_f32_16x16x32_bf16 v[180:183], a[16:19], a[196:199], v[180:183]
    ds_read_b64_tr_b16 a[2:3], v224 offset:2048
    v_mfma_f32_16x16x32_bf16 v[180:183], a[20:23], a[212:215], v[180:183]
    buffer_load_dwordx4 v230, s[28:31], s55 offen lds
    v_mfma_f32_16x16x32_bf16 v[184:187], a[16:19], a[200:203], v[184:187]
    ds_read_b64_tr_b16 a[4:5], v224 offset:24576
    v_mfma_f32_16x16x32_bf16 v[184:187], a[20:23], a[216:219], v[184:187]
    buffer_load_dwordx4 v231, s[28:31], s55 offen offset:1024 lds
    v_mfma_f32_16x16x32_bf16 v[188:191], a[16:19], a[204:207], v[188:191]
    s_add_u32 m0, s53, 73728
    ds_read_b64_tr_b16 a[6:7], v224 offset:26624
    s_add_u32 s55, s33, 110592
    v_mfma_f32_16x16x32_bf16 v[188:191], a[20:23], a[220:223], v[188:191]
    s_waitcnt lgkmcnt(4)
    s_cmp_ge_u32 s52, 3
    s_cselect_b32 s60, 3, 0
    v_mfma_f32_16x16x32_bf16 v[192:195], a[24:27], a[192:195], v[192:195]
    s_sub_u32 s52, s52, s60
    v_add_u32 v225, 0xffff4000, v225
    s_mul_i32 s60, s52, 221184
    v_mfma_f32_16x16x32_bf16 v[192:195], a[28:31], a[208:211], v[192:195]
    s_add_u32 s3, s63, s60
    ds_read_b64_tr_b16 a[8:9], v225 offset:0
    s_mul_i32 s60, s52, 786432
    v_mfma_f32_16x16x32_bf16 v[196:199], a[24:27], a[196:199], v[196:199]
    s_add_u32 s62, s62, s60
    ds_read_b64_tr_b16 a[10:11], v225 offset:2048
    v_mfma_f32_16x16x32_bf16 v[196:199], a[28:31], a[212:215], v[196:199]
    buffer_load_dwordx4 v230, s[28:31], s55 offen lds
    v_mfma_f32_16x16x32_bf16 v[200:203], a[24:27], a[200:203], v[200:203]
    ds_read_b64_tr_b16 a[12:13], v225 offset:24576
    v_mfma_f32_16x16x32_bf16 v[200:203], a[28:31], a[216:219], v[200:203]
    buffer_load_dwordx4 v231, s[28:31], s55 offen offset:1024 lds
    v_mfma_f32_16x16x32_bf16 v[204:207], a[24:27], a[204:207], v[204:207]
    s_add_u32 m0, s53, 57344
    ds_read_b64_tr_b16 a[14:15], v225 offset:26624
    s_add_u32 s55, s33, 1152
    v_mfma_f32_16x16x32_bf16 v[204:207], a[28:31], a[220:223], v[204:207]
    s_waitcnt lgkmcnt(4)
    v_mfma_f32_16x16x32_bf16 v[0:3], a[0:3], a[224:227], v[0:3]
    v_add_u32 v226, 0xffff4000, v226
    v_mfma_f32_16x16x32_bf16 v[0:3], a[4:7], a[240:243], v[0:3]
    ds_read_b64_tr_b16 a[16:17], v226 offset:0
    v_mfma_f32_16x16x32_bf16 v[4:7], a[0:3], a[228:231], v[4:7]
    ds_read_b64_tr_b16 a[18:19], v226 offset:2048
    v_mfma_f32_16x16x32_bf16 v[4:7], a[4:7], a[244:247], v[4:7]
    buffer_load_dwordx4 v230, s[28:31], s55 offen lds
    v_mfma_f32_16x16x32_bf16 v[8:11], a[0:3], a[232:235], v[8:11]
    ds_read_b64_tr_b16 a[20:21], v226 offset:24576
    v_mfma_f32_16x16x32_bf16 v[8:11], a[4:7], a[248:251], v[8:11]
    v_mfma_f32_16x16x32_bf16 v[12:15], a[0:3], a[236:239], v[12:15]
    ds_read_b64_tr_b16 a[22:23], v226 offset:26624
    v_mfma_f32_16x16x32_bf16 v[12:15], a[4:7], a[252:255], v[12:15]
    s_waitcnt lgkmcnt(4)
    v_mfma_f32_16x16x32_bf16 v[16:19], a[8:11], a[224:227], v[16:19]
    s_waitcnt vmcnt(17)
    s_barrier
    v_add_u32 v227, 0xffff4000, v227
    v_mfma_f32_16x16x32_bf16 v[16:19], a[12:15], a[240:243], v[16:19]
    ds_read_b64_tr_b16 a[24:25], v227 offset:0
    v_mfma_f32_16x16x32_bf16 v[20:23], a[8:11], a[228:231], v[20:23]
    ds_read_b64_tr_b16 a[26:27], v227 offset:2048
    v_mfma_f32_16x16x32_bf16 v[20:23], a[12:15], a[244:247], v[20:23]
    buffer_load_dwordx4 v231, s[28:31], s55 offen offset:1024 lds
    v_mfma_f32_16x16x32_bf16 v[24:27], a[8:11], a[232:235], v[24:27]
    s_add_u32 m0, s53, 81920
    ds_read_b64_tr_b16 a[28:29], v227 offset:24576
    s_add_u32 s55, s33, 111744
    v_mfma_f32_16x16x32_bf16 v[24:27], a[12:15], a[248:251], v[24:27]
    buffer_load_dwordx4 v230, s[28:31], s55 offen lds
    v_mfma_f32_16x16x32_bf16 v[28:31], a[8:11], a[236:239], v[28:31]
    ds_read_b64_tr_b16 a[30:31], v227 offset:26624
    v_mfma_f32_16x16x32_bf16 v[28:31], a[12:15], a[252:255], v[28:31]
    s_waitcnt lgkmcnt(4)
    v_mfma_f32_16x16x32_bf16 v[32:35], a[16:19], a[224:227], v[32:35]
    v_add_u32 v228, 0xffff4000, v228
    v_mfma_f32_16x16x32_bf16 v[32:35], a[20:23], a[240:243], v[32:35]
    ds_read_b64_tr_b16 a[0:1], v228 offset:0
    v_mfma_f32_16x16x32_bf16 v[36:39], a[16:19], a[228:231], v[36:39]
    ds_read_b64_tr_b16 a[2:3], v228 offset:2048
    v_mfma_f32_16x16x32_bf16 v[36:39], a[20:23], a[244:247], v[36:39]
    buffer_load_dwordx4 v231, s[28:31], s55 offen offset:1024 lds
    v_mfma_f32_16x16x32_bf16 v[40:43], a[16:19], a[232:235], v[40:43]
    s_add_u32 m0, s53, 65536
    ds_read_b64_tr_b16 a[4:5], v228 offset:24576
    s_add_u32 s55, s33, 2304
    v_mfma_f32_16x16x32_bf16 v[40:43], a[20:23], a[248:251], v[40:43]
    buffer_load_dwordx4 v230, s[28:31], s55 offen lds
    v_mfma_f32_16x16x32_bf16 v[44:47], a[16:19], a[236:239], v[44:47]
    ds_read_b64_tr_b16 a[6:7], v228 offset:26624
    v_mfma_f32_16x16x32_bf16 v[44:47], a[20:23], a[252:255], v[44:47]
    s_waitcnt lgkmcnt(4)
    v_mfma_f32_16x16x32_bf16 v[48:51], a[24:27], a[224:227], v[48:51]
    ds_read_b64_tr_b16 a[8:9], v224 offset:8192
    v_mfma_f32_16x16x32_bf16 v[48:51], a[28:31], a[240:243], v[48:51]
    buffer_load_dwordx4 v231, s[28:31], s55 offen offset:1024 lds
    v_mfma_f32_16x16x32_bf16 v[52:55], a[24:27], a[228:231], v[52:55]
    s_add_u32 m0, s53, 90112
    ds_read_b64_tr_b16 a[10:11], v224 offset:10240
    s_add_u32 s55, s33, 112896
    v_mfma_f32_16x16x32_bf16 v[52:55], a[28:31], a[244:247], v[52:55]
    v_mfma_f32_16x16x32_bf16 v[56:59], a[24:27], a[232:235], v[56:59]
    ds_read_b64_tr_b16 a[12:13], v224 offset:32768
    v_mfma_f32_16x16x32_bf16 v[56:59], a[28:31], a[248:251], v[56:59]
    buffer_load_dwordx4 v230, s[28:31], s55 offen lds
    v_mfma_f32_16x16x32_bf16 v[60:63], a[24:27], a[236:239], v[60:63]
    ds_read_b64_tr_b16 a[14:15], v224 offset:34816
    v_mfma_f32_16x16x32_bf16 v[60:63], a[28:31], a[252:255], v[60:63]
    s_waitcnt lgkmcnt(4)
    v_mfma_f32_16x16x32_bf16 v[64:67], a[0:3], a[224:227], v[64:67]
    ds_read_b64_tr_b16 a[16:17], v225 offset:8192
    v_mfma_f32_16x16x32_bf16 v[64:67], a[4:7], a[240:243], v[64:67]
    v_mfma_f32_16x16x32_bf16 v[68:71], a[0:3], a[228:231], v[68:71]
    ds_read_b64_tr_b16 a[18:19], v225 offset:10240
    v_mfma_f32_16x16x32_bf16 v[68:71], a[4:7], a[244:247], v[68:71]
    v_mfma_f32_16x16x32_bf16 v[72:75], a[0:3], a[232:235], v[72:75]
    ds_read_b64_tr_b16 a[20:21], v225 offset:32768
    v_mfma_f32_16x16x32_bf16 v[72:75], a[4:7], a[248:251], v[72:75]
    buffer_load_dwordx4 v231, s[28:31], s55 offen offset:1024 lds
    v_mfma_f32_16x16x32_bf16 v[76:79], a[0:3], a[236:239], v[76:79]
    s_add_u32 s33, s33, 221184
    ds_read_b64_tr_b16 a[22:23], v225 offset:34816
    v_mfma_f32_16x16x32_bf16 v[76:79], a[4:7], a[252:255], v[76:79]
    s_waitcnt lgkmcnt(4)
    s_cmp_ge_u32 s33, 1990656
    s_cmov_b32 s33, 0
    v_mfma_f32_16x16x32_bf16 v[80:83], a[8:11], a[224:227], v[80:83]
    ds_read_b64_tr_b16 a[24:25], v226 offset:8192
    s_add_u32 m0, s34, 0
    v_mfma_f32_16x16x32_bf16 v[80:83], a[12:15], a[240:243], v[80:83]
    s_add_u32 s54, s32, 0
    v_mfma_f32_16x16x32_bf16 v[84:87], a[8:11], a[228:231], v[84:87]
    ds_read_b64_tr_b16 a[26:27], v226 offset:10240
    v_mfma_f32_16x16x32_bf16 v[84:87], a[12:15], a[244:247], v[84:87]
    buffer_load_dwordx4 v236, s[36:39], s54 offen offset:0 lds
    v_mfma_f32_16x16x32_bf16 v[88:91], a[8:11], a[232:235], v[88:91]
    ds_read_b64_tr_b16 a[28:29], v226 offset:32768
    v_mfma_f32_16x16x32_bf16 v[88:91], a[12:15], a[248:251], v[88:91]
    buffer_load_dwordx4 v237, s[36:39], s54 offen offset:1024 lds
    v_mfma_f32_16x16x32_bf16 v[92:95], a[8:11], a[236:239], v[92:95]
    ds_read_b64_tr_b16 a[30:31], v226 offset:34816
    v_mfma_f32_16x16x32_bf16 v[92:95], a[12:15], a[252:255], v[92:95]
    s_waitcnt lgkmcnt(4)
    v_mfma_f32_16x16x32_bf16 v[96:99], a[16:19], a[224:227], v[96:99]
    s_waitcnt vmcnt(22)
    s_barrier
    s_waitcnt vmcnt(14)
    v_mfma_f32_16x16x32_bf16 v[96:99], a[20:23], a[240:243], v[96:99]
    ds_read_b64_tr_b16 a[0:1], v227 offset:8192
    v_mfma_f32_16x16x32_bf16 v[100:103], a[16:19], a[228:231], v[100:103]
    ds_read_b64_tr_b16 a[2:3], v227 offset:10240
    v_mfma_f32_16x16x32_bf16 v[100:103], a[20:23], a[244:247], v[100:103]
    buffer_load_dwordx4 v238, s[36:39], s54 offen offset:2048 lds
    v_mfma_f32_16x16x32_bf16 v[104:107], a[16:19], a[232:235], v[104:107]
    ds_read_b64_tr_b16 a[4:5], v227 offset:32768
    v_mfma_f32_16x16x32_bf16 v[104:107], a[20:23], a[248:251], v[104:107]
    buffer_load_dwordx4 v239, s[36:39], s54 offen offset:3072 lds
    v_mfma_f32_16x16x32_bf16 v[108:111], a[16:19], a[236:239], v[108:111]
    s_add_u32 m0, s34, 4096
    ds_read_b64_tr_b16 a[6:7], v227 offset:34816
    s_add_u32 s54, s32, 36864
    v_mfma_f32_16x16x32_bf16 v[108:111], a[20:23], a[252:255], v[108:111]
    s_waitcnt lgkmcnt(4)
    ds_read_b128 a[96:99], v240 offset:8192
    v_mfma_f32_16x16x32_bf16 v[112:115], a[24:27], a[224:227], v[112:115]
    v_add_u32 v229, 0xffff4000, v229
    v_mfma_f32_16x16x32_bf16 v[112:115], a[28:31], a[240:243], v[112:115]
    ds_read_b64_tr_b16 a[8:9], v229 offset:0
    v_mfma_f32_16x16x32_bf16 v[116:119], a[24:27], a[228:231], v[116:119]
    ds_read_b64_tr_b16 a[10:11], v229 offset:2048
    v_mfma_f32_16x16x32_bf16 v[116:119], a[28:31], a[244:247], v[116:119]
    ds_read_b128 a[100:103], v240 offset:10240
    v_mfma_f32_16x16x32_bf16 v[120:123], a[24:27], a[232:235], v[120:123]
    ds_read_b64_tr_b16 a[12:13], v229 offset:24576
    v_mfma_f32_16x16x32_bf16 v[120:123], a[28:31], a[248:251], v[120:123]
    buffer_load_dwordx4 v236, s[36:39], s54 offen offset:0 lds
    v_mfma_f32_16x16x32_bf16 v[124:127], a[24:27], a[236:239], v[124:127]
    ds_read_b64_tr_b16 a[14:15], v229 offset:26624
    v_mfma_f32_16x16x32_bf16 v[124:127], a[28:31], a[252:255], v[124:127]
    s_waitcnt lgkmcnt(6)
    ds_read_b128 a[104:107], v240 offset:12288
    v_mfma_f32_16x16x32_bf16 v[128:131], a[0:3], a[224:227], v[128:131]
    ds_read_b64_tr_b16 a[16:17], v224 offset:16384
    v_mfma_f32_16x16x32_bf16 v[128:131], a[4:7], a[240:243], v[128:131]
    buffer_load_dwordx4 v237, s[36:39], s54 offen offset:1024 lds
    v_mfma_f32_16x16x32_bf16 v[132:135], a[0:3], a[228:231], v[132:135]
    ds_read_b64_tr_b16 a[18:19], v224 offset:18432
    v_mfma_f32_16x16x32_bf16 v[132:135], a[4:7], a[244:247], v[132:135]
    ds_read_b128 a[108:111], v240 offset:14336
    v_mfma_f32_16x16x32_bf16 v[136:139], a[0:3], a[232:235], v[136:139]
    ds_read_b64_tr_b16 a[20:21], v224 offset:40960
    v_mfma_f32_16x16x32_bf16 v[136:139], a[4:7], a[248:251], v[136:139]
    buffer_load_dwordx4 v238, s[36:39], s54 offen offset:2048 lds
    v_mfma_f32_16x16x32_bf16 v[140:143], a[0:3], a[236:239], v[140:143]
    ds_read_b64_tr_b16 a[22:23], v224 offset:43008
    v_mfma_f32_16x16x32_bf16 v[140:143], a[4:7], a[252:255], v[140:143]
    s_waitcnt lgkmcnt(6)
    ds_read_b128 a[112:115], v241 offset:8192
    v_mfma_f32_16x16x32_bf16 v[208:211], a[8:11], a[224:227], v[208:211]
    ds_read_b64_tr_b16 a[24:25], v225 offset:16384
    v_mfma_f32_16x16x32_bf16 v[208:211], a[12:15], a[240:243], v[208:211]
    buffer_load_dwordx4 v239, s[36:39], s54 offen offset:3072 lds
    v_mfma_f32_16x16x32_bf16 v[212:215], a[8:11], a[228:231], v[212:215]
    s_add_u32 s32, s32, 128
    ds_read_b64_tr_b16 a[26:27], v225 offset:18432
    v_mfma_f32_16x16x32_bf16 v[212:215], a[12:15], a[244:247], v[212:215]
    s_cmp_ge_u32 s32, 1152
    s_cmov_b32 s32, 0
    ds_read_b128 a[116:119], v241 offset:10240
    v_mfma_f32_16x16x32_bf16 v[216:219], a[8:11], a[232:235], v[216:219]
    s_add_u32 m0, s53, 0
    ds_read_b64_tr_b16 a[28:29], v225 offset:40960
    s_add_u32 s55, s33, 0
    v_mfma_f32_16x16x32_bf16 v[216:219], a[12:15], a[248:251], v[216:219]
    buffer_load_dwordx4 v230, s[28:31], s55 offen lds
    v_mfma_f32_16x16x32_bf16 v[220:223], a[8:11], a[236:239], v[220:223]
    ds_read_b64_tr_b16 a[30:31], v225 offset:43008
    v_mfma_f32_16x16x32_bf16 v[220:223], a[12:15], a[252:255], v[220:223]
    s_waitcnt lgkmcnt(6)
    ds_read_b128 a[120:123], v241 offset:12288
    v_mfma_f32_16x16x32_bf16 v[144:147], a[16:19], a[224:227], v[144:147]
    ds_read_b64_tr_b16 a[0:1], v226 offset:16384
    v_mfma_f32_16x16x32_bf16 v[144:147], a[20:23], a[240:243], v[144:147]
    buffer_load_dwordx4 v231, s[28:31], s55 offen offset:1024 lds
    v_mfma_f32_16x16x32_bf16 v[148:151], a[16:19], a[228:231], v[148:151]
    s_add_u32 m0, s53, 24576
    ds_read_b64_tr_b16 a[2:3], v226 offset:18432
    s_add_u32 s55, s33, 110592
    v_mfma_f32_16x16x32_bf16 v[148:151], a[20:23], a[244:247], v[148:151]
    ds_read_b128 a[124:127], v241 offset:14336
    v_mfma_f32_16x16x32_bf16 v[152:155], a[16:19], a[232:235], v[152:155]
    ds_read_b64_tr_b16 a[4:5], v226 offset:40960
    v_mfma_f32_16x16x32_bf16 v[152:155], a[20:23], a[248:251], v[152:155]
    v_mfma_f32_16x16x32_bf16 v[156:159], a[16:19], a[236:239], v[156:159]
    ds_read_b64_tr_b16 a[6:7], v226 offset:43008
    v_mfma_f32_16x16x32_bf16 v[156:159], a[20:23], a[252:255], v[156:159]
    s_waitcnt lgkmcnt(6)
    v_mfma_f32_16x16x32_bf16 v[160:163], a[24:27], a[224:227], v[160:163]
    s_waitcnt vmcnt(18)
    s_barrier
    v_mfma_f32_16x16x32_bf16 v[160:163], a[28:31], a[240:243], v[160:163]
    ds_read_b64_tr_b16 a[8:9], v227 offset:16384
    v_mfma_f32_16x16x32_bf16 v[164:167], a[24:27], a[228:231], v[164:167]
    ds_read_b64_tr_b16 a[10:11], v227 offset:18432
    v_mfma_f32_16x16x32_bf16 v[164:167], a[28:31], a[244:247], v[164:167]
    buffer_load_dwordx4 v230, s[28:31], s55 offen lds
    v_mfma_f32_16x16x32_bf16 v[168:171], a[24:27], a[232:235], v[168:171]
    ds_read_b64_tr_b16 a[12:13], v227 offset:40960
    v_mfma_f32_16x16x32_bf16 v[168:171], a[28:31], a[248:251], v[168:171]
    buffer_load_dwordx4 v231, s[28:31], s55 offen offset:1024 lds
    v_mfma_f32_16x16x32_bf16 v[172:175], a[24:27], a[236:239], v[172:175]
    s_add_u32 m0, s53, 8192
    ds_read_b64_tr_b16 a[14:15], v227 offset:43008
    s_add_u32 s55, s33, 1152
    v_mfma_f32_16x16x32_bf16 v[172:175], a[28:31], a[252:255], v[172:175]
    s_waitcnt lgkmcnt(4)
    v_mfma_f32_16x16x32_bf16 v[176:179], a[0:3], a[224:227], v[176:179]
    v_add_u32 v224, 0xc000, v224
    v_mfma_f32_16x16x32_bf16 v[176:179], a[4:7], a[240:243], v[176:179]
    ds_read_b64_tr_b16 a[16:17], v224 offset:0
    v_mfma_f32_16x16x32_bf16 v[180:183], a[0:3], a[228:231], v[180:183]
    ds_read_b64_tr_b16 a[18:19], v224 offset:2048
    v_mfma_f32_16x16x32_bf16 v[180:183], a[4:7], a[244:247], v[180:183]
    buffer_load_dwordx4 v230, s[28:31], s55 offen lds
    v_mfma_f32_16x16x32_bf16 v[184:187], a[0:3], a[232:235], v[184:187]
    ds_read_b64_tr_b16 a[20:21], v224 offset:24576
    v_mfma_f32_16x16x32_bf16 v[184:187], a[4:7], a[248:251], v[184:187]
    buffer_load_dwordx4 v231, s[28:31], s55 offen offset:1024 lds
    v_mfma_f32_16x16x32_bf16 v[188:191], a[0:3], a[236:239], v[188:191]
    s_add_u32 m0, s53, 32768
    ds_read_b64_tr_b16 a[22:23], v224 offset:26624
    s_add_u32 s55, s33, 111744
    v_mfma_f32_16x16x32_bf16 v[188:191], a[4:7], a[252:255], v[188:191]
    s_waitcnt lgkmcnt(4)
    v_mfma_f32_16x16x32_bf16 v[192:195], a[8:11], a[224:227], v[192:195]
    v_add_u32 v225, 0xc000, v225
    v_mfma_f32_16x16x32_bf16 v[192:195], a[12:15], a[240:243], v[192:195]
    ds_read_b64_tr_b16 a[24:25], v225 offset:0
    v_mfma_f32_16x16x32_bf16 v[196:199], a[8:11], a[228:231], v[196:199]
    ds_read_b64_tr_b16 a[26:27], v225 offset:2048
    v_mfma_f32_16x16x32_bf16 v[196:199], a[12:15], a[244:247], v[196:199]
    buffer_load_dwordx4 v230, s[28:31], s55 offen lds
    v_mfma_f32_16x16x32_bf16 v[200:203], a[8:11], a[232:235], v[200:203]
    ds_read_b64_tr_b16 a[28:29], v225 offset:24576
    v_mfma_f32_16x16x32_bf16 v[200:203], a[12:15], a[248:251], v[200:203]
    buffer_load_dwordx4 v231, s[28:31], s55 offen offset:1024 lds
    v_mfma_f32_16x16x32_bf16 v[204:207], a[8:11], a[236:239], v[204:207]
    ds_read_b64_tr_b16 a[30:31], v225 offset:26624
    s_add_u32 m0, s34, 8192
    v_mfma_f32_16x16x32_bf16 v[204:207], a[12:15], a[252:255], v[204:207]
    s_waitcnt lgkmcnt(4)
    s_add_u32 s54, s32, 0
    v_mfma_f32_16x16x32_bf16 v[0:3], a[16:19], a[96:99], v[0:3]
    v_add_u32 v226, 0xc000, v226
    v_mfma_f32_16x16x32_bf16 v[0:3], a[20:23], a[112:115], v[0:3]
    ds_read_b64_tr_b16 a[0:1], v226 offset:0
    v_mfma_f32_16x16x32_bf16 v[4:7], a[16:19], a[100:103], v[4:7]
    ds_read_b64_tr_b16 a[2:3], v226 offset:2048
    v_mfma_f32_16x16x32_bf16 v[4:7], a[20:23], a[116:119], v[4:7]
    v_mfma_f32_16x16x32_bf16 v[8:11], a[16:19], a[104:107], v[8:11]
    ds_read_b64_tr_b16 a[4:5], v226 offset:24576
    v_mfma_f32_16x16x32_bf16 v[8:11], a[20:23], a[120:123], v[8:11]
    buffer_load_dwordx4 v236, s[36:39], s54 offen offset:0 lds
    v_mfma_f32_16x16x32_bf16 v[12:15], a[16:19], a[108:111], v[12:15]
    ds_read_b64_tr_b16 a[6:7], v226 offset:26624
    v_mfma_f32_16x16x32_bf16 v[12:15], a[20:23], a[124:127], v[12:15]
    s_waitcnt lgkmcnt(4)
    v_mfma_f32_16x16x32_bf16 v[16:19], a[24:27], a[96:99], v[16:19]
    s_waitcnt vmcnt(21)
    s_barrier
    v_add_u32 v227, 0xc000, v227
    v_mfma_f32_16x16x32_bf16 v[16:19], a[28:31], a[112:115], v[16:19]
    ds_read_b64_tr_b16 a[8:9], v227 offset:0
    v_mfma_f32_16x16x32_bf16 v[20:23], a[24:27], a[100:103], v[20:23]
    ds_read_b64_tr_b16 a[10:11], v227 offset:2048
    v_mfma_f32_16x16x32_bf16 v[20:23], a[28:31], a[116:119], v[20:23]
    buffer_load_dwordx4 v237, s[36:39], s54 offen offset:1024 lds
    v_mfma_f32_16x16x32_bf16 v[24:27], a[24:27], a[104:107], v[24:27]
    ds_read_b64_tr_b16 a[12:13], v227 offset:24576
    v_mfma_f32_16x16x32_bf16 v[24:27], a[28:31], a[120:123], v[24:27]
    buffer_load_dwordx4 v238, s[36:39], s54 offen offset:2048 lds
    v_mfma_f32_16x16x32_bf16 v[28:31], a[24:27], a[108:111], v[28:31]
    ds_read_b64_tr_b16 a[14:15], v227 offset:26624
    v_mfma_f32_16x16x32_bf16 v[28:31], a[28:31], a[124:127], v[28:31]
    s_waitcnt lgkmcnt(4)
    v_mfma_f32_16x16x32_bf16 v[32:35], a[0:3], a[96:99], v[32:35]
    v_add_u32 v228, 0xc000, v228
    v_mfma_f32_16x16x32_bf16 v[32:35], a[4:7], a[112:115], v[32:35]
    ds_read_b64_tr_b16 a[16:17], v228 offset:0
    v_mfma_f32_16x16x32_bf16 v[36:39], a[0:3], a[100:103], v[36:39]
    ds_read_b64_tr_b16 a[18:19], v228 offset:2048
    v_mfma_f32_16x16x32_bf16 v[36:39], a[4:7], a[116:119], v[36:39]
    buffer_load_dwordx4 v239, s[36:39], s54 offen offset:3072 lds
    v_mfma_f32_16x16x32_bf16 v[40:43], a[0:3], a[104:107], v[40:43]
    s_add_u32 m0, s34, 12288
    ds_read_b64_tr_b16 a[20:21], v228 offset:24576
    s_add_u32 s54, s32, 36864
    v_mfma_f32_16x16x32_bf16 v[40:43], a[4:7], a[120:123], v[40:43]
    buffer_load_dwordx4 v236, s[36:39], s54 offen offset:0 lds
    v_mfma_f32_16x16x32_bf16 v[44:47], a[0:3], a[108:111], v[44:47]
    ds_read_b64_tr_b16 a[22:23], v228 offset:26624
    v_mfma_f32_16x16x32_bf16 v[44:47], a[4:7], a[124:127], v[44:47]
    s_waitcnt lgkmcnt(4)
    v_mfma_f32_16x16x32_bf16 v[48:51], a[8:11], a[96:99], v[48:51]
    ds_read_b64_tr_b16 a[24:25], v224 offset:8192
    v_mfma_f32_16x16x32_bf16 v[48:51], a[12:15], a[112:115], v[48:51]
    v_mfma_f32_16x16x32_bf16 v[52:55], a[8:11], a[100:103], v[52:55]
    ds_read_b64_tr_b16 a[26:27], v224 offset:10240
    v_mfma_f32_16x16x32_bf16 v[52:55], a[12:15], a[116:119], v[52:55]
    v_mfma_f32_16x16x32_bf16 v[56:59], a[8:11], a[104:107], v[56:59]
    ds_read_b64_tr_b16 a[28:29], v224 offset:32768
    v_mfma_f32_16x16x32_bf16 v[56:59], a[12:15], a[120:123], v[56:59]
    buffer_load_dwordx4 v237, s[36:39], s54 offen offset:1024 lds
    v_mfma_f32_16x16x32_bf16 v[60:63], a[8:11], a[108:111], v[60:63]
    ds_read_b64_tr_b16 a[30:31], v224 offset:34816
    v_mfma_f32_16x16x32_bf16 v[60:63], a[12:15], a[124:127], v[60:63]
    s_waitcnt lgkmcnt(4)
    v_mfma_f32_16x16x32_bf16 v[64:67], a[16:19], a[96:99], v[64:67]
    ds_read_b64_tr_b16 a[0:1], v225 offset:8192
    v_mfma_f32_16x16x32_bf16 v[64:67], a[20:23], a[112:115], v[64:67]
    buffer_load_dwordx4 v238, s[36:39], s54 offen offset:2048 lds
    v_mfma_f32_16x16x32_bf16 v[68:71], a[16:19], a[100:103], v[68:71]
    ds_read_b64_tr_b16 a[2:3], v225 offset:10240
    v_mfma_f32_16x16x32_bf16 v[68:71], a[20:23], a[116:119], v[68:71]
    v_mfma_f32_16x16x32_bf16 v[72:75], a[16:19], a[104:107], v[72:75]
    ds_read_b64_tr_b16 a[4:5], v225 offset:32768
    v_mfma_f32_16x16x32_bf16 v[72:75], a[20:23], a[120:123], v[72:75]
    buffer_load_dwordx4 v239, s[36:39], s54 offen offset:3072 lds
    v_mfma_f32_16x16x32_bf16 v[76:79], a[16:19], a[108:111], v[76:79]
    s_add_u32 s32, s32, 128
    ds_read_b64_tr_b16 a[6:7], v225 offset:34816
    v_mfma_f32_16x16x32_bf16 v[76:79], a[20:23], a[124:127], v[76:79]
    s_waitcnt lgkmcnt(4)
    s_cmp_ge_u32 s32, 1152
    s_cmov_b32 s32, 0
    v_mfma_f32_16x16x32_bf16 v[80:83], a[24:27], a[96:99], v[80:83]
    s_add_u32 m0, s53, 16384
    ds_read_b64_tr_b16 a[8:9], v226 offset:8192
    s_add_u32 s55, s33, 2304
    v_mfma_f32_16x16x32_bf16 v[80:83], a[28:31], a[112:115], v[80:83]
    buffer_load_dwordx4 v230, s[28:31], s55 offen lds
    v_mfma_f32_16x16x32_bf16 v[84:87], a[24:27], a[100:103], v[84:87]
    ds_read_b64_tr_b16 a[10:11], v226 offset:10240
    v_mfma_f32_16x16x32_bf16 v[84:87], a[28:31], a[116:119], v[84:87]
    v_mfma_f32_16x16x32_bf16 v[88:91], a[24:27], a[104:107], v[88:91]
    ds_read_b64_tr_b16 a[12:13], v226 offset:32768
    v_mfma_f32_16x16x32_bf16 v[88:91], a[28:31], a[120:123], v[88:91]
    buffer_load_dwordx4 v231, s[28:31], s55 offen offset:1024 lds
    v_mfma_f32_16x16x32_bf16 v[92:95], a[24:27], a[108:111], v[92:95]
    s_add_u32 m0, s53, 40960
    ds_read_b64_tr_b16 a[14:15], v226 offset:34816
    s_add_u32 s55, s33, 112896
    v_mfma_f32_16x16x32_bf16 v[92:95], a[28:31], a[124:127], v[92:95]
    s_waitcnt lgkmcnt(4)
    v_mfma_f32_16x16x32_bf16 v[96:99], a[0:3], a[96:99], v[96:99]
    s_waitcnt vmcnt(26)
    s_barrier
    s_waitcnt vmcnt(18)
    v_mfma_f32_16x16x32_bf16 v[96:99], a[4:7], a[112:115], v[96:99]
    ds_read_b64_tr_b16 a[16:17], v227 offset:8192
    v_mfma_f32_16x16x32_bf16 v[100:103], a[0:3], a[100:103], v[100:103]
    ds_read_b64_tr_b16 a[18:19], v227 offset:10240
    v_mfma_f32_16x16x32_bf16 v[100:103], a[4:7], a[116:119], v[100:103]
    buffer_load_dwordx4 v230, s[28:31], s55 offen lds
    v_mfma_f32_16x16x32_bf16 v[104:107], a[0:3], a[104:107], v[104:107]
    ds_read_b64_tr_b16 a[20:21], v227 offset:32768
    v_mfma_f32_16x16x32_bf16 v[104:107], a[4:7], a[120:123], v[104:107]
    ds_read_b128 a[128:131], v240 offset:0
    v_mfma_f32_16x16x32_bf16 v[108:111], a[0:3], a[108:111], v[108:111]
    ds_read_b64_tr_b16 a[22:23], v227 offset:34816
    v_mfma_f32_16x16x32_bf16 v[108:111], a[4:7], a[124:127], v[108:111]
    s_waitcnt lgkmcnt(5)
    ds_read_b128 a[132:135], v240 offset:2048
    v_mfma_f32_16x16x32_bf16 v[112:115], a[8:11], a[96:99], v[112:115]
    v_add_u32 v229, 0xc000, v229
    v_mfma_f32_16x16x32_bf16 v[112:115], a[12:15], a[112:115], v[112:115]
    ds_read_b64_tr_b16 a[24:25], v229 offset:0
    v_mfma_f32_16x16x32_bf16 v[116:119], a[8:11], a[100:103], v[116:119]
    ds_read_b64_tr_b16 a[26:27], v229 offset:2048
    v_mfma_f32_16x16x32_bf16 v[116:119], a[12:15], a[116:119], v[116:119]
    buffer_load_dwordx4 v231, s[28:31], s55 offen offset:1024 lds
    v_mfma_f32_16x16x32_bf16 v[120:123], a[8:11], a[104:107], v[120:123]
    s_add_u32 s33, s33, 221184
    ds_read_b64_tr_b16 a[28:29], v229 offset:24576
    v_mfma_f32_16x16x32_bf16 v[120:123], a[12:15], a[120:123], v[120:123]
    s_cmp_ge_u32 s33, 1990656
    s_cmov_b32 s33, 0
    ds_read_b128 a[136:139], v240 offset:4096
    v_mfma_f32_16x16x32_bf16 v[124:127], a[8:11], a[108:111], v[124:127]
    s_add_u32 m0, s53, 49152
    ds_read_b64_tr_b16 a[30:31], v229 offset:26624
    s_add_u32 s55, s33, 0
    v_mfma_f32_16x16x32_bf16 v[124:127], a[12:15], a[124:127], v[124:127]
    s_waitcnt lgkmcnt(6)
    buffer_load_dwordx4 v230, s[28:31], s55 offen lds
    v_mfma_f32_16x16x32_bf16 v[128:131], a[16:19], a[96:99], v[128:131]
    ds_read_b64_tr_b16 a[0:1], v224 offset:16384
    v_mfma_f32_16x16x32_bf16 v[128:131], a[20:23], a[112:115], v[128:131]
    buffer_load_dwordx4 v231, s[28:31], s55 offen offset:1024 lds
    v_mfma_f32_16x16x32_bf16 v[132:135], a[16:19], a[100:103], v[132:135]
    s_add_u32 m0, s53, 73728
    ds_read_b64_tr_b16 a[2:3], v224 offset:18432
    s_add_u32 s55, s33, 110592
    v_mfma_f32_16x16x32_bf16 v[132:135], a[20:23], a[116:119], v[132:135]
    ds_read_b128 a[140:143], v240 offset:6144
    v_mfma_f32_16x16x32_bf16 v[136:139], a[16:19], a[104:107], v[136:139]
    ds_read_b64_tr_b16 a[4:5], v224 offset:40960
    v_mfma_f32_16x16x32_bf16 v[136:139], a[20:23], a[120:123], v[136:139]
    buffer_load_dwordx4 v230, s[28:31], s55 offen lds
    v_mfma_f32_16x16x32_bf16 v[140:143], a[16:19], a[108:111], v[140:143]
    ds_read_b64_tr_b16 a[6:7], v224 offset:43008
    v_mfma_f32_16x16x32_bf16 v[140:143], a[20:23], a[124:127], v[140:143]
    s_waitcnt lgkmcnt(5)
    ds_read_b128 a[144:147], v241 offset:0
    v_mfma_f32_16x16x32_bf16 v[208:211], a[24:27], a[96:99], v[208:211]
    ds_read_b64_tr_b16 a[8:9], v225 offset:16384
    v_mfma_f32_16x16x32_bf16 v[208:211], a[28:31], a[112:115], v[208:211]
    buffer_load_dwordx4 v231, s[28:31], s55 offen offset:1024 lds
    v_mfma_f32_16x16x32_bf16 v[212:215], a[24:27], a[100:103], v[212:215]
    ds_read_b64_tr_b16 a[10:11], v225 offset:18432
    v_mfma_f32_16x16x32_bf16 v[212:215], a[28:31], a[116:119], v[212:215]
    ds_read_b128 a[148:151], v241 offset:2048
    v_mfma_f32_16x16x32_bf16 v[216:219], a[24:27], a[104:107], v[216:219]
    ds_read_b64_tr_b16 a[12:13], v225 offset:40960
    v_mfma_f32_16x16x32_bf16 v[216:219], a[28:31], a[120:123], v[216:219]
    ds_read_b128 a[152:155], v241 offset:4096
    v_mfma_f32_16x16x32_bf16 v[220:223], a[24:27], a[108:111], v[220:223]
    ds_read_b64_tr_b16 a[14:15], v225 offset:43008
    v_mfma_f32_16x16x32_bf16 v[220:223], a[28:31], a[124:127], v[220:223]
    s_waitcnt lgkmcnt(7)
    ds_read_b128 a[156:159], v241 offset:6144
    s_waitcnt lgkmcnt(0)
    v_mfma_f32_16x16x32_bf16 v[144:147], a[0:3], a[96:99], v[144:147]
    s_add_u32 m0, s34, 0
    ds_read_b64_tr_b16 a[16:17], v226 offset:16384
    s_add_u32 s54, s32, 0
    v_mfma_f32_16x16x32_bf16 v[144:147], a[4:7], a[112:115], v[144:147]
    buffer_load_dwordx4 v236, s[36:39], s54 offen offset:0 lds
    v_mfma_f32_16x16x32_bf16 v[148:151], a[0:3], a[100:103], v[148:151]
    s_mov_b32 s49, s83
    ds_read_b64_tr_b16 a[18:19], v226 offset:18432
    v_mfma_f32_16x16x32_bf16 v[148:151], a[4:7], a[116:119], v[148:151]
    buffer_load_dword v249, v247, s[24:27], s49 offen sc0 sc1
    v_mfma_f32_16x16x32_bf16 v[152:155], a[0:3], a[104:107], v[152:155]
    ds_read_b64_tr_b16 a[20:21], v226 offset:40960
    v_and_b32 v250, 15, v244
    v_mfma_f32_16x16x32_bf16 v[152:155], a[4:7], a[120:123], v[152:155]
    buffer_load_dwordx4 v237, s[36:39], s54 offen offset:1024 lds
    v_mfma_f32_16x16x32_bf16 v[156:159], a[0:3], a[108:111], v[156:159]
    s_lshl_b32 s52, s50, 12
    ds_read_b64_tr_b16 a[22:23], v226 offset:43008
    s_lshl_b32 s60, s48, 10
    v_mfma_f32_16x16x32_bf16 v[156:159], a[4:7], a[124:127], v[156:159]
    s_add_u32 s52, s52, s60
    v_lshl_add_u32 v250, v250, 4, s52
    s_mov_b32 s49, 0
    v_mfma_f32_16x16x32_bf16 v[160:163], a[8:11], a[96:99], v[160:163]
    s_waitcnt vmcnt(23)
    s_barrier
    v_mfma_f32_16x16x32_bf16 v[160:163], a[12:15], a[112:115], v[160:163]
    ds_read_b64_tr_b16 a[24:25], v227 offset:16384
    v_mfma_f32_16x16x32_bf16 v[164:167], a[8:11], a[100:103], v[164:167]
    ds_read_b64_tr_b16 a[26:27], v227 offset:18432
    v_mfma_f32_16x16x32_bf16 v[164:167], a[12:15], a[116:119], v[164:167]
    buffer_load_dwordx4 v238, s[36:39], s54 offen offset:2048 lds
    v_mfma_f32_16x16x32_bf16 v[168:171], a[8:11], a[104:107], v[168:171]
    ds_read_b64_tr_b16 a[28:29], v227 offset:40960
    v_mfma_f32_16x16x32_bf16 v[168:171], a[12:15], a[120:123], v[168:171]
    buffer_load_dwordx4 v239, s[36:39], s54 offen offset:3072 lds
    v_mfma_f32_16x16x32_bf16 v[172:175], a[8:11], a[108:111], v[172:175]
    s_add_u32 m0, s34, 4096
    ds_read_b64_tr_b16 a[30:31], v227 offset:43008
    s_add_u32 s54, s32, 36864
    v_mfma_f32_16x16x32_bf16 v[172:175], a[12:15], a[124:127], v[172:175]
    s_waitcnt lgkmcnt(4)
    buffer_load_dwordx4 a[52:55], v250, s[24:27], s49 offen offset:0 sc0 sc1
    v_mfma_f32_16x16x32_bf16 v[176:179], a[16:19], a[96:99], v[176:179]
    v_add_u32 v224, 0xffff4000, v224
    v_mfma_f32_16x16x32_bf16 v[176:179], a[20:23], a[112:115], v[176:179]
    ds_read_b64_tr_b16 a[0:1], v224 offset:0
    v_mfma_f32_16x16x32_bf16 v[180:183], a[16:19], a[100:103], v[180:183]
    ds_read_b64_tr_b16 a[2:3], v224 offset:2048
    v_mfma_f32_16x16x32_bf16 v[180:183], a[20:23], a[116:119], v[180:183]
    buffer_load_dwordx4 v236, s[36:39], s54 offen offset:0 lds
    v_mfma_f32_16x16x32_bf16 v[184:187], a[16:19], a[104:107], v[184:187]
    ds_read_b64_tr_b16 a[4:5], v224 offset:24576
    v_mfma_f32_16x16x32_bf16 v[184:187], a[20:23], a[120:123], v[184:187]
    buffer_load_dwordx4 v237, s[36:39], s54 offen offset:1024 lds
    v_mfma_f32_16x16x32_bf16 v[188:191], a[16:19], a[108:111], v[188:191]
    ds_read_b64_tr_b16 a[6:7], v224 offset:26624
    v_mfma_f32_16x16x32_bf16 v[188:191], a[20:23], a[124:127], v[188:191]
    s_waitcnt lgkmcnt(4)
    buffer_load_dwordx4 a[56:59], v250, s[24:27], s49 offen offset:256 sc0 sc1
    v_mfma_f32_16x16x32_bf16 v[192:195], a[24:27], a[96:99], v[192:195]
    v_add_u32 v225, 0xffff4000, v225
    v_mfma_f32_16x16x32_bf16 v[192:195], a[28:31], a[112:115], v[192:195]
    ds_read_b64_tr_b16 a[8:9], v225 offset:0
    v_mfma_f32_16x16x32_bf16 v[196:199], a[24:27], a[100:103], v[196:199]
    ds_read_b64_tr_b16 a[10:11], v225 offset:2048
    v_mfma_f32_16x16x32_bf16 v[196:199], a[28:31], a[116:119], v[196:199]
    buffer_load_dwordx4 a[60:63], v250, s[24:27], s49 offen offset:512 sc0 sc1
    v_mfma_f32_16x16x32_bf16 v[200:203], a[24:27], a[104:107], v[200:203]
    ds_read_b64_tr_b16 a[12:13], v225 offset:24576
    v_mfma_f32_16x16x32_bf16 v[200:203], a[28:31], a[120:123], v[200:203]
    buffer_load_dwordx4 v238, s[36:39], s54 offen offset:2048 lds
    v_mfma_f32_16x16x32_bf16 v[204:207], a[24:27], a[108:111], v[204:207]
    ds_read_b64_tr_b16 a[14:15], v225 offset:26624
    v_mfma_f32_16x16x32_bf16 v[204:207], a[28:31], a[124:127], v[204:207]
    s_waitcnt lgkmcnt(4)
    buffer_load_dwordx4 a[64:67], v250, s[24:27], s49 offen offset:768 sc0 sc1
    v_mfma_f32_16x16x32_bf16 v[0:3], a[0:3], a[128:131], v[0:3]
    v_add_u32 v226, 0xffff4000, v226
    v_mfma_f32_16x16x32_bf16 v[0:3], a[4:7], a[144:147], v[0:3]
    ds_read_b64_tr_b16 a[16:17], v226 offset:0
    v_mfma_f32_16x16x32_bf16 v[4:7], a[0:3], a[132:135], v[4:7]
    ds_read_b64_tr_b16 a[18:19], v226 offset:2048
    v_mfma_f32_16x16x32_bf16 v[4:7], a[4:7], a[148:151], v[4:7]
    buffer_load_dwordx4 v239, s[36:39], s54 offen offset:3072 lds
    v_mfma_f32_16x16x32_bf16 v[8:11], a[0:3], a[136:139], v[8:11]
    s_add_u32 s32, s32, 128
    ds_read_b64_tr_b16 a[20:21], v226 offset:24576
    v_mfma_f32_16x16x32_bf16 v[8:11], a[4:7], a[152:155], v[8:11]
    s_cmp_ge_u32 s32, 1152
    s_cmov_b32 s32, 0
    s_add_u32 m0, s53, 57344
    v_mfma_f32_16x16x32_bf16 v[12:15], a[0:3], a[140:143], v[12:15]
    s_add_u32 s55, s33, 1152
    ds_read_b64_tr_b16 a[22:23], v226 offset:26624
    v_mfma_f32_16x16x32_bf16 v[12:15], a[4:7], a[156:159], v[12:15]
    s_waitcnt lgkmcnt(4)
    buffer_load_dwordx4 v230, s[28:31], s55 offen lds
    v_mfma_f32_16x16x32_bf16 v[16:19], a[8:11], a[128:131], v[16:19]
    s_waitcnt vmcnt(30)
    s_barrier
    v_add_u32 v227, 0xffff4000, v227
    v_mfma_f32_16x16x32_bf16 v[16:19], a[12:15], a[144:147], v[16:19]
    ds_read_b64_tr_b16 a[24:25], v227 offset:0
    v_mfma_f32_16x16x32_bf16 v[20:23], a[8:11], a[132:135], v[20:23]
    ds_read_b64_tr_b16 a[26:27], v227 offset:2048
    v_mfma_f32_16x16x32_bf16 v[20:23], a[12:15], a[148:151], v[20:23]
    buffer_load_dwordx4 v231, s[28:31], s55 offen offset:1024 lds
    v_mfma_f32_16x16x32_bf16 v[24:27], a[8:11], a[136:139], v[24:27]
    s_add_u32 m0, s53, 81920
    ds_read_b64_tr_b16 a[28:29], v227 offset:24576
    s_add_u32 s55, s33, 111744
    v_mfma_f32_16x16x32_bf16 v[24:27], a[12:15], a[152:155], v[24:27]
    buffer_load_dwordx4 v230, s[28:31], s55 offen lds
    v_mfma_f32_16x16x32_bf16 v[28:31], a[8:11], a[140:143], v[28:31]
    ds_read_b64_tr_b16 a[30:31], v227 offset:26624
    v_mfma_f32_16x16x32_bf16 v[28:31], a[12:15], a[156:159], v[28:31]
    s_waitcnt lgkmcnt(4)
    v_mfma_f32_16x16x32_bf16 v[32:35], a[16:19], a[128:131], v[32:35]
    v_add_u32 v228, 0xffff4000, v228
    v_mfma_f32_16x16x32_bf16 v[32:35], a[20:23], a[144:147], v[32:35]
    ds_read_b64_tr_b16 a[0:1], v228 offset:0
    v_mfma_f32_16x16x32_bf16 v[36:39], a[16:19], a[132:135], v[36:39]
    ds_read_b64_tr_b16 a[2:3], v228 offset:2048
    v_mfma_f32_16x16x32_bf16 v[36:39], a[20:23], a[148:151], v[36:39]
    buffer_load_dwordx4 v231, s[28:31], s55 offen offset:1024 lds
    v_mfma_f32_16x16x32_bf16 v[40:43], a[16:19], a[136:139], v[40:43]
    s_add_u32 m0, s53, 65536
    ds_read_b64_tr_b16 a[4:5], v228 offset:24576
    s_add_u32 s55, s33, 2304
    v_mfma_f32_16x16x32_bf16 v[40:43], a[20:23], a[152:155], v[40:43]
    v_mfma_f32_16x16x32_bf16 v[44:47], a[16:19], a[140:143], v[44:47]
    ds_read_b64_tr_b16 a[6:7], v228 offset:26624
    v_mfma_f32_16x16x32_bf16 v[44:47], a[20:23], a[156:159], v[44:47]
    s_waitcnt lgkmcnt(4)
    v_mfma_f32_16x16x32_bf16 v[48:51], a[24:27], a[128:131], v[48:51]
    ds_read_b64_tr_b16 a[8:9], v224 offset:8192
    v_mfma_f32_16x16x32_bf16 v[48:51], a[28:31], a[144:147], v[48:51]
    buffer_load_dwordx4 v230, s[28:31], s55 offen lds
    v_mfma_f32_16x16x32_bf16 v[52:55], a[24:27], a[132:135], v[52:55]
    ds_read_b64_tr_b16 a[10:11], v224 offset:10240
    v_mfma_f32_16x16x32_bf16 v[52:55], a[28:31], a[148:151], v[52:55]
    v_mfma_f32_16x16x32_bf16 v[56:59], a[24:27], a[136:139], v[56:59]
    ds_read_b64_tr_b16 a[12:13], v224 offset:32768
    v_mfma_f32_16x16x32_bf16 v[56:59], a[28:31], a[152:155], v[56:59]
    buffer_load_dwordx4 v231, s[28:31], s55 offen offset:1024 lds
    v_mfma_f32_16x16x32_bf16 v[60:63], a[24:27], a[140:143], v[60:63]
    s_add_u32 m0, s53, 90112
    ds_read_b64_tr_b16 a[14:15], v224 offset:34816
    s_add_u32 s55, s33, 112896
    v_mfma_f32_16x16x32_bf16 v[60:63], a[28:31], a[156:159], v[60:63]
    s_waitcnt lgkmcnt(4)
    v_mfma_f32_16x16x32_bf16 v[64:67], a[0:3], a[128:131], v[64:67]
    ds_read_b64_tr_b16 a[16:17], v225 offset:8192
    v_mfma_f32_16x16x32_bf16 v[64:67], a[4:7], a[144:147], v[64:67]
    buffer_load_dwordx4 v230, s[28:31], s55 offen lds
    v_mfma_f32_16x16x32_bf16 v[68:71], a[0:3], a[132:135], v[68:71]
    ds_read_b64_tr_b16 a[18:19], v225 offset:10240
    v_mfma_f32_16x16x32_bf16 v[68:71], a[4:7], a[148:151], v[68:71]
    v_mfma_f32_16x16x32_bf16 v[72:75], a[0:3], a[136:139], v[72:75]
    ds_read_b64_tr_b16 a[20:21], v225 offset:32768
    v_mfma_f32_16x16x32_bf16 v[72:75], a[4:7], a[152:155], v[72:75]
    buffer_load_dwordx4 v231, s[28:31], s55 offen offset:1024 lds
    v_mfma_f32_16x16x32_bf16 v[76:79], a[0:3], a[140:143], v[76:79]
    s_add_u32 s33, s33, 221184
    ds_read_b64_tr_b16 a[22:23], v225 offset:34816
    v_mfma_f32_16x16x32_bf16 v[76:79], a[4:7], a[156:159], v[76:79]
    s_waitcnt lgkmcnt(4)
    s_cmp_ge_u32 s33, 1990656
    s_cmov_b32 s33, 0
    v_mfma_f32_16x16x32_bf16 v[80:83], a[8:11], a[128:131], v[80:83]
    ds_read_b64_tr_b16 a[24:25], v226 offset:8192
    v_mfma_f32_16x16x32_bf16 v[80:83], a[12:15], a[144:147], v[80:83]
    v_mfma_f32_16x16x32_bf16 v[84:87], a[8:11], a[132:135], v[84:87]
    ds_read_b64_tr_b16 a[26:27], v226 offset:10240
    v_mfma_f32_16x16x32_bf16 v[84:87], a[12:15], a[148:151], v[84:87]
    v_mfma_f32_16x16x32_bf16 v[88:91], a[8:11], a[136:139], v[88:91]
    ds_read_b64_tr_b16 a[28:29], v226 offset:32768
    v_mfma_f32_16x16x32_bf16 v[88:91], a[12:15], a[152:155], v[88:91]
    v_mfma_f32_16x16x32_bf16 v[92:95], a[8:11], a[140:143], v[92:95]
    ds_read_b64_tr_b16 a[30:31], v226 offset:34816
    v_mfma_f32_16x16x32_bf16 v[92:95], a[12:15], a[156:159], v[92:95]
    s_waitcnt lgkmcnt(4)
    v_mfma_f32_16x16x32_bf16 v[96:99], a[16:19], a[128:131], v[96:99]
    s_waitcnt vmcnt(25)
    s_barrier
    s_add_u32 m0, s53, 0
    v_mfma_f32_16x16x32_bf16 v[96:99], a[20:23], a[144:147], v[96:99]
    s_add_u32 s55, s33, 0
    ds_read_b64_tr_b16 a[0:1], v227 offset:8192
    v_mfma_f32_16x16x32_bf16 v[100:103], a[16:19], a[132:135], v[100:103]
    ds_read_b64_tr_b16 a[2:3], v227 offset:10240
    v_mfma_f32_16x16x32_bf16 v[100:103], a[20:23], a[148:151], v[100:103]
    buffer_load_dwordx4 v230, s[28:31], s55 offen lds
    v_mfma_f32_16x16x32_bf16 v[104:107], a[16:19], a[136:139], v[104:107]
    ds_read_b64_tr_b16 a[4:5], v227 offset:32768
    v_mfma_f32_16x16x32_bf16 v[104:107], a[20:23], a[152:155], v[104:107]
    buffer_load_dwordx4 v231, s[28:31], s55 offen offset:1024 lds
    v_mfma_f32_16x16x32_bf16 v[108:111], a[16:19], a[140:143], v[108:111]
    s_add_u32 m0, s53, 24576
    ds_read_b64_tr_b16 a[6:7], v227 offset:34816
    s_add_u32 s55, s33, 110592
    v_mfma_f32_16x16x32_bf16 v[108:111], a[20:23], a[156:159], v[108:111]
    s_waitcnt lgkmcnt(4)
    ds_read_b128 a[160:163], v240 offset:8192
    v_mfma_f32_16x16x32_bf16 v[112:115], a[24:27], a[128:131], v[112:115]
    v_add_u32 v229, 0xffff4000, v229
    v_mfma_f32_16x16x32_bf16 v[112:115], a[28:31], a[144:147], v[112:115]
    ds_read_b64_tr_b16 a[8:9], v229 offset:0
    v_mfma_f32_16x16x32_bf16 v[116:119], a[24:27], a[132:135], v[116:119]
    ds_read_b64_tr_b16 a[10:11], v229 offset:2048
    v_mfma_f32_16x16x32_bf16 v[116:119], a[28:31], a[148:151], v[116:119]
    buffer_load_dwordx4 v230, s[28:31], s55 offen lds
    v_mfma_f32_16x16x32_bf16 v[120:123], a[24:27], a[136:139], v[120:123]
    ds_read_b64_tr_b16 a[12:13], v229 offset:24576
    v_mfma_f32_16x16x32_bf16 v[120:123], a[28:31], a[152:155], v[120:123]
    buffer_load_dwordx4 v231, s[28:31], s55 offen offset:1024 lds
    v_mfma_f32_16x16x32_bf16 v[124:127], a[24:27], a[140:143], v[124:127]
    ds_read_b64_tr_b16 a[14:15], v229 offset:26624
    v_mfma_f32_16x16x32_bf16 v[124:127], a[28:31], a[156:159], v[124:127]
    s_waitcnt lgkmcnt(5)
    ds_read_b128 a[164:167], v240 offset:10240
    v_mfma_f32_16x16x32_bf16 v[128:131], a[0:3], a[128:131], v[128:131]
    ds_read_b64_tr_b16 a[16:17], v224 offset:16384
    v_mfma_f32_16x16x32_bf16 v[128:131], a[4:7], a[144:147], v[128:131]
    ds_read_b128 a[168:171], v240 offset:12288
    v_mfma_f32_16x16x32_bf16 v[132:135], a[0:3], a[132:135], v[132:135]
    ds_read_b64_tr_b16 a[18:19], v224 offset:18432
    v_mfma_f32_16x16x32_bf16 v[132:135], a[4:7], a[148:151], v[132:135]
    ds_read_b128 a[172:175], v240 offset:14336
    v_mfma_f32_16x16x32_bf16 v[136:139], a[0:3], a[136:139], v[136:139]
    ds_read_b64_tr_b16 a[20:21], v224 offset:40960
    v_mfma_f32_16x16x32_bf16 v[136:139], a[4:7], a[152:155], v[136:139]
    ds_read_b128 a[176:179], v241 offset:8192
    v_mfma_f32_16x16x32_bf16 v[140:143], a[0:3], a[140:143], v[140:143]
    ds_read_b64_tr_b16 a[22:23], v224 offset:43008
    v_mfma_f32_16x16x32_bf16 v[140:143], a[4:7], a[156:159], v[140:143]
    s_waitcnt lgkmcnt(8)
    ds_read_b128 a[180:183], v241 offset:10240
    v_mfma_f32_16x16x32_bf16 v[208:211], a[8:11], a[128:131], v[208:211]
    ds_read_b64_tr_b16 a[24:25], v225 offset:16384
    v_mfma_f32_16x16x32_bf16 v[208:211], a[12:15], a[144:147], v[208:211]
    ds_read_b128 a[184:187], v241 offset:12288
    v_mfma_f32_16x16x32_bf16 v[212:215], a[8:11], a[132:135], v[212:215]
    ds_read_b64_tr_b16 a[26:27], v225 offset:18432
    v_mfma_f32_16x16x32_bf16 v[212:215], a[12:15], a[148:151], v[212:215]
    ds_read_b128 a[188:191], v241 offset:14336
    v_mfma_f32_16x16x32_bf16 v[216:219], a[8:11], a[136:139], v[216:219]
    ds_read_b64_tr_b16 a[28:29], v225 offset:40960
    v_mfma_f32_16x16x32_bf16 v[216:219], a[12:15], a[152:155], v[216:219]
    v_mfma_f32_16x16x32_bf16 v[220:223], a[8:11], a[140:143], v[220:223]
    ds_read_b64_tr_b16 a[30:31], v225 offset:43008
    v_mfma_f32_16x16x32_bf16 v[220:223], a[12:15], a[156:159], v[220:223]
    s_waitcnt lgkmcnt(7)
    v_mfma_f32_16x16x32_bf16 v[144:147], a[16:19], a[128:131], v[144:147]
    ds_read_b64_tr_b16 a[0:1], v226 offset:16384
    v_mfma_f32_16x16x32_bf16 v[144:147], a[20:23], a[144:147], v[144:147]
    v_mfma_f32_16x16x32_bf16 v[148:151], a[16:19], a[132:135], v[148:151]
    ds_read_b64_tr_b16 a[2:3], v226 offset:18432
    v_mfma_f32_16x16x32_bf16 v[148:151], a[20:23], a[148:151], v[148:151]
    v_mfma_f32_16x16x32_bf16 v[152:155], a[16:19], a[136:139], v[152:155]
    ds_read_b64_tr_b16 a[4:5], v226 offset:40960
    v_mfma_f32_16x16x32_bf16 v[152:155], a[20:23], a[152:155], v[152:155]
    v_mfma_f32_16x16x32_bf16 v[156:159], a[16:19], a[140:143], v[156:159]
    ds_read_b64_tr_b16 a[6:7], v226 offset:43008
    v_mfma_f32_16x16x32_bf16 v[156:159], a[20:23], a[156:159], v[156:159]
    s_waitcnt lgkmcnt(4)
    v_mfma_f32_16x16x32_bf16 v[160:163], a[24:27], a[128:131], v[160:163]
    s_waitcnt vmcnt(25)
    s_barrier
    s_add_u32 m0, s53, 8192
    v_mfma_f32_16x16x32_bf16 v[160:163], a[28:31], a[144:147], v[160:163]
    s_add_u32 s55, s33, 1152
    ds_read_b64_tr_b16 a[8:9], v227 offset:16384
    v_mfma_f32_16x16x32_bf16 v[164:167], a[24:27], a[132:135], v[164:167]
    ds_read_b64_tr_b16 a[10:11], v227 offset:18432
    v_mfma_f32_16x16x32_bf16 v[164:167], a[28:31], a[148:151], v[164:167]
    buffer_load_dwordx4 v230, s[28:31], s55 offen lds
    v_mfma_f32_16x16x32_bf16 v[168:171], a[24:27], a[136:139], v[168:171]
    ds_read_b64_tr_b16 a[12:13], v227 offset:40960
    v_mfma_f32_16x16x32_bf16 v[168:171], a[28:31], a[152:155], v[168:171]
    buffer_load_dwordx4 v231, s[28:31], s55 offen offset:1024 lds
    v_mfma_f32_16x16x32_bf16 v[172:175], a[24:27], a[140:143], v[172:175]
    s_add_u32 m0, s53, 32768
    ds_read_b64_tr_b16 a[14:15], v227 offset:43008
    s_add_u32 s55, s33, 111744
    v_mfma_f32_16x16x32_bf16 v[172:175], a[28:31], a[156:159], v[172:175]
    s_waitcnt lgkmcnt(4)
    s_waitcnt vmcnt(25)
    v_cmp_eq_u32 vcc, s79, v249
    v_mfma_f32_16x16x32_bf16 v[176:179], a[0:3], a[128:131], v[176:179]
    v_add_u32 v224, 0xc000, v224
    v_mfma_f32_16x16x32_bf16 v[176:179], a[4:7], a[144:147], v[176:179]
    ds_read_b64_tr_b16 a[16:17], v224 offset:0
    v_mfma_f32_16x16x32_bf16 v[180:183], a[0:3], a[132:135], v[180:183]
    ds_read_b64_tr_b16 a[18:19], v224 offset:2048
    v_mfma_f32_16x16x32_bf16 v[180:183], a[4:7], a[148:151], v[180:183]
    buffer_load_dwordx4 v230, s[28:31], s55 offen lds
    v_mfma_f32_16x16x32_bf16 v[184:187], a[0:3], a[136:139], v[184:187]
    ds_read_b64_tr_b16 a[20:21], v224 offset:24576
    v_mfma_f32_16x16x32_bf16 v[184:187], a[4:7], a[152:155], v[184:187]
    buffer_load_dwordx4 v231, s[28:31], s55 offen offset:1024 lds
    v_mfma_f32_16x16x32_bf16 v[188:191], a[0:3], a[140:143], v[188:191]
    ds_read_b64_tr_b16 a[22:23], v224 offset:26624
    v_mfma_f32_16x16x32_bf16 v[188:191], a[4:7], a[156:159], v[188:191]
    s_waitcnt lgkmcnt(4)
    s_andn2_b32 s61, 0xff, vcc_lo
    s_cbranch_scc1 Lslow_29
Lback_30:
    v_mfma_f32_16x16x32_bf16 v[192:195], a[8:11], a[128:131], v[192:195]
    v_add_u32 v225, 0xc000, v225
    v_lshlrev_b32 v254, 4, v244
    v_mfma_f32_16x16x32_bf16 v[192:195], a[12:15], a[144:147], v[192:195]
    ds_read_b64_tr_b16 a[24:25], v225 offset:0
    v_mfma_f32_16x16x32_bf16 v[196:199], a[8:11], a[132:135], v[196:199]
    ds_read_b64_tr_b16 a[26:27], v225 offset:2048
    v_mfma_f32_16x16x32_bf16 v[196:199], a[12:15], a[148:151], v[196:199]
    buffer_load_dwordx4 a[68:71], v254, s[24:27], s82 offen offset:0 sc0 sc1
    v_mfma_f32_16x16x32_bf16 v[200:203], a[8:11], a[136:139], v[200:203]
    ds_read_b64_tr_b16 a[28:29], v225 offset:24576
    v_mfma_f32_16x16x32_bf16 v[200:203], a[12:15], a[152:155], v[200:203]
    buffer_load_dwordx4 a[72:75], v254, s[24:27], s82 offen offset:1024 sc0 sc1
    v_mfma_f32_16x16x32_bf16 v[204:207], a[8:11], a[140:143], v[204:207]
    ds_read_b64_tr_b16 a[30:31], v225 offset:26624
    v_mfma_f32_16x16x32_bf16 v[204:207], a[12:15], a[156:159], v[204:207]
    s_waitcnt lgkmcnt(4)
    buffer_load_dwordx4 a[76:79], v254, s[24:27], s82 offen offset:2048 sc0 sc1
    v_mfma_f32_16x16x32_bf16 v[0:3], a[16:19], a[160:163], v[0:3]
    v_add_u32 v226, 0xc000, v226
    v_mfma_f32_16x16x32_bf16 v[0:3], a[20:23], a[176:179], v[0:3]
    ds_read_b64_tr_b16 a[0:1], v226 offset:0
    v_mfma_f32_16x16x32_bf16 v[4:7], a[16:19], a[164:167], v[4:7]
    ds_read_b64_tr_b16 a[2:3], v226 offset:2048
    v_mfma_f32_16x16x32_bf16 v[4:7], a[20:23], a[180:183], v[4:7]
    buffer_load_dwordx4 a[80:83], v254, s[24:27], s82 offen offset:3072 sc0 sc1
    v_mfma_f32_16x16x32_bf16 v[8:11], a[16:19], a[168:171], v[8:11]
    s_add_u32 s82, s82, 4096
    ds_read_b64_tr_b16 a[4:5], v226 offset:24576
    v_mfma_f32_16x16x32_bf16 v[8:11], a[20:23], a[184:187], v[8:11]
    buffer_load_dwordx4 a[84:87], v254, s[24:27], s82 offen offset:0 sc0 sc1
    v_mfma_f32_16x16x32_bf16 v[12:15], a[16:19], a[172:175], v[12:15]
    ds_read_b64_tr_b16 a[6:7], v226 offset:26624
    v_mfma_f32_16x16x32_bf16 v[12:15], a[20:23], a[188:191], v[12:15]
    s_waitcnt lgkmcnt(4)
    buffer_load_dwordx4 a[88:91], v254, s[24:27], s82 offen offset:1024 sc0 sc1
    v_mfma_f32_16x16x32_bf16 v[16:19], a[24:27], a[160:163], v[16:19]
    s_waitcnt vmcnt(18)
    s_barrier
    v_add_u32 v227, 0xc000, v227
    v_mfma_f32_16x16x32_bf16 v[16:19], a[28:31], a[176:179], v[16:19]
    s_add_u32 m0, s53, 16384
    ds_read_b64_tr_b16 a[8:9], v227 offset:0
    s_add_u32 s55, s33, 2304
    v_mfma_f32_16x16x32_bf16 v[20:23], a[24:27], a[164:167], v[20:23]
    ds_read_b64_tr_b16 a[10:11], v227 offset:2048
    v_mfma_f32_16x16x32_bf16 v[20:23], a[28:31], a[180:183], v[20:23]
    buffer_load_dwordx4 v230, s[28:31], s55 offen lds
    v_mfma_f32_16x16x32_bf16 v[24:27], a[24:27], a[168:171], v[24:27]
    ds_read_b64_tr_b16 a[12:13], v227 offset:24576
    v_mfma_f32_16x16x32_bf16 v[24:27], a[28:31], a[184:187], v[24:27]
    buffer_load_dwordx4 v231, s[28:31], s55 offen offset:1024 lds
    v_mfma_f32_16x16x32_bf16 v[28:31], a[24:27], a[172:175], v[28:31]
    s_add_u32 m0, s53, 40960
    ds_read_b64_tr_b16 a[14:15], v227 offset:26624
    s_add_u32 s55, s33, 112896
    v_mfma_f32_16x16x32_bf16 v[28:31], a[28:31], a[188:191], v[28:31]
    s_waitcnt lgkmcnt(4)
    buffer_load_dwordx4 a[92:95], v254, s[24:27], s82 offen offset:2048 sc0 sc1
    v_mfma_f32_16x16x32_bf16 v[32:35], a[0:3], a[160:163], v[32:35]
    v_add_u32 v228, 0xc000, v228
    v_accvgpr_read_b32 v255, a53
    v_mfma_f32_16x16x32_bf16 v[32:35], a[4:7], a[176:179], v[32:35]
    ds_read_b64_tr_b16 a[16:17], v228 offset:0
    v_cmp_eq_u32 s[60:61], s79, v255
    v_mfma_f32_16x16x32_bf16 v[36:39], a[0:3], a[164:167], v[36:39]
    ds_read_b64_tr_b16 a[18:19], v228 offset:2048
    v_accvgpr_read_b32 v255, a55
    v_mfma_f32_16x16x32_bf16 v[36:39], a[4:7], a[180:183], v[36:39]
    buffer_load_dwordx4 v230, s[28:31], s55 offen lds
    v_mfma_f32_16x16x32_bf16 v[40:43], a[0:3], a[168:171], v[40:43]
    ds_read_b64_tr_b16 a[20:21], v228 offset:24576
    v_cmp_eq_u32 vcc, s79, v255
    v_mfma_f32_16x16x32_bf16 v[40:43], a[4:7], a[184:187], v[40:43]
    buffer_load_dwordx4 v231, s[28:31], s55 offen offset:1024 lds
    v_mfma_f32_16x16x32_bf16 v[44:47], a[0:3], a[172:175], v[44:47]
    s_add_u32 s33, s33, 221184
    ds_read_b64_tr_b16 a[22:23], v228 offset:26624
    s_and_b64 s[60:61], s[60:61], vcc
    v_mfma_f32_16x16x32_bf16 v[44:47], a[4:7], a[188:191], v[44:47]
    s_waitcnt lgkmcnt(4)
    s_cmp_ge_u32 s33, 1990656
    s_cmov_b32 s33, 0
    v_mfma_f32_16x16x32_bf16 v[48:51], a[8:11], a[160:163], v[48:51]
    ds_read_b64_tr_b16 a[24:25], v224 offset:8192
    v_accvgpr_read_b32 v255, a57
    v_mfma_f32_16x16x32_bf16 v[48:51], a[12:15], a[176:179], v[48:51]
    v_cmp_eq_u32 vcc, s79, v255
    s_and_b64 s[60:61], s[60:61], vcc
    v_mfma_f32_16x16x32_bf16 v[52:55], a[8:11], a[164:167], v[52:55]
    ds_read_b64_tr_b16 a[26:27], v224 offset:10240
    v_accvgpr_read_b32 v255, a59
    v_mfma_f32_16x16x32_bf16 v[52:55], a[12:15], a[180:183], v[52:55]
    v_cmp_eq_u32 vcc, s79, v255
    s_and_b64 s[60:61], s[60:61], vcc
    v_mfma_f32_16x16x32_bf16 v[56:59], a[8:11], a[168:171], v[56:59]
    ds_read_b64_tr_b16 a[28:29], v224 offset:32768
    v_accvgpr_read_b32 v255, a61
    v_mfma_f32_16x16x32_bf16 v[56:59], a[12:15], a[184:187], v[56:59]
    v_cmp_eq_u32 vcc, s79, v255
    s_and_b64 s[60:61], s[60:61], vcc
    v_mfma_f32_16x16x32_bf16 v[60:63], a[8:11], a[172:175], v[60:63]
    ds_read_b64_tr_b16 a[30:31], v224 offset:34816
    v_accvgpr_read_b32 v255, a63
    v_mfma_f32_16x16x32_bf16 v[60:63], a[12:15], a[188:191], v[60:63]
    s_waitcnt lgkmcnt(4)
    v_cmp_eq_u32 vcc, s79, v255
    s_and_b64 s[60:61], s[60:61], vcc
    v_mfma_f32_16x16x32_bf16 v[64:67], a[16:19], a[160:163], v[64:67]
    ds_read_b64_tr_b16 a[0:1], v225 offset:8192
    v_accvgpr_read_b32 v255, a65
    v_mfma_f32_16x16x32_bf16 v[64:67], a[20:23], a[176:179], v[64:67]
    v_cmp_eq_u32 vcc, s79, v255
    s_and_b64 s[60:61], s[60:61], vcc
    v_mfma_f32_16x16x32_bf16 v[68:71], a[16:19], a[164:167], v[68:71]
    ds_read_b64_tr_b16 a[2:3], v225 offset:10240
    v_accvgpr_read_b32 v255, a67
    v_mfma_f32_16x16x32_bf16 v[68:71], a[20:23], a[180:183], v[68:71]
    v_cmp_eq_u32 vcc, s79, v255
    s_and_b64 s[60:61], s[60:61], vcc
    v_mfma_f32_16x16x32_bf16 v[72:75], a[16:19], a[168:171], v[72:75]
    ds_read_b64_tr_b16 a[4:5], v225 offset:32768
    v_mfma_f32_16x16x32_bf16 v[72:75], a[20:23], a[184:187], v[72:75]
    s_cmp_lg_u64 s[60:61], -1
    s_cbranch_scc1 Lslow_32
Lback_33:
    v_accvgpr_mov_b32 a53, a52
    v_mfma_f32_16x16x32_bf16 v[76:79], a[16:19], a[172:175], v[76:79]
    ds_read_b64_tr_b16 a[6:7], v225 offset:34816
    v_accvgpr_mov_b32 a57, a56
    v_mfma_f32_16x16x32_bf16 v[76:79], a[20:23], a[188:191], v[76:79]
    s_waitcnt lgkmcnt(4)
    v_accvgpr_mov_b32 a61, a60
    v_accvgpr_mov_b32 a65, a64
    v_mfma_f32_16x16x32_bf16 v[80:83], a[24:27], a[160:163], v[80:83]
    ds_read_b64_tr_b16 a[8:9], v226 offset:8192
    v_mfma_f32_16x16x32_bf16 v[80:83], a[28:31], a[176:179], v[80:83]
    v_mfma_f32_16x16x32_bf16 v[84:87], a[24:27], a[164:167], v[84:87]
    ds_read_b64_tr_b16 a[10:11], v226 offset:10240
    v_mfma_f32_16x16x32_bf16 v[84:87], a[28:31], a[180:183], v[84:87]
    v_mfma_f32_16x16x32_bf16 v[88:91], a[24:27], a[168:171], v[88:91]
    ds_read_b64_tr_b16 a[12:13], v226 offset:32768
    v_mfma_f32_16x16x32_bf16 v[88:91], a[28:31], a[184:187], v[88:91]
    v_mfma_f32_16x16x32_bf16 v[92:95], a[24:27], a[172:175], v[92:95]
    ds_read_b64_tr_b16 a[14:15], v226 offset:34816
    v_mfma_f32_16x16x32_bf16 v[92:95], a[28:31], a[188:191], v[92:95]
    s_waitcnt lgkmcnt(4)
    v_mfma_f32_16x16x32_bf16 v[96:99], a[0:3], a[160:163], v[96:99]
    s_waitcnt vmcnt(19)
    s_barrier
    v_mfma_f32_16x16x32_bf16 v[96:99], a[4:7], a[176:179], v[96:99]
    ds_read_b64_tr_b16 a[16:17], v227 offset:8192
    v_mfma_f32_16x16x32_bf16 v[100:103], a[0:3], a[164:167], v[100:103]
    ds_read_b64_tr_b16 a[18:19], v227 offset:10240
    v_mfma_f32_16x16x32_bf16 v[100:103], a[4:7], a[180:183], v[100:103]
    ds_read_b128 a[192:195], v240 offset:0
    v_mfma_f32_16x16x32_bf16 v[104:107], a[0:3], a[168:171], v[104:107]
    ds_read_b64_tr_b16 a[20:21], v227 offset:32768
    v_mfma_f32_16x16x32_bf16 v[104:107], a[4:7], a[184:187], v[104:107]
    ds_read_b128 a[196:199], v240 offset:2048
    v_mfma_f32_16x16x32_bf16 v[108:111], a[0:3], a[172:175], v[108:111]
    ds_read_b64_tr_b16 a[22:23], v227 offset:34816
    v_mfma_f32_16x16x32_bf16 v[108:111], a[4:7], a[188:191], v[108:111]
    s_waitcnt lgkmcnt(6)
    ds_read_b128 a[200:203], v240 offset:4096
    v_mfma_f32_16x16x32_bf16 v[112:115], a[8:11], a[160:163], v[112:115]
    v_add_u32 v229, 0xc000, v229
    v_mfma_f32_16x16x32_bf16 v[112:115], a[12:15], a[176:179], v[112:115]
    ds_read_b64_tr_b16 a[24:25], v229 offset:0
    v_mfma_f32_16x16x32_bf16 v[116:119], a[8:11], a[164:167], v[116:119]
    ds_read_b64_tr_b16 a[26:27], v229 offset:2048
    v_mfma_f32_16x16x32_bf16 v[116:119], a[12:15], a[180:183], v[116:119]
    ds_read_b128 a[204:207], v240 offset:6144
    v_mfma_f32_16x16x32_bf16 v[120:123], a[8:11], a[168:171], v[120:123]
    ds_read_b64_tr_b16 a[28:29], v229 offset:24576
    v_mfma_f32_16x16x32_bf16 v[120:123], a[12:15], a[184:187], v[120:123]
    ds_read_b128 a[208:211], v241 offset:0
    v_mfma_f32_16x16x32_bf16 v[124:127], a[8:11], a[172:175], v[124:127]
    ds_read_b64_tr_b16 a[30:31], v229 offset:26624
    v_mfma_f32_16x16x32_bf16 v[124:127], a[12:15], a[188:191], v[124:127]
    s_waitcnt lgkmcnt(7)
    ds_read_b128 a[212:215], v241 offset:2048
    v_mfma_f32_16x16x32_bf16 v[128:131], a[16:19], a[160:163], v[128:131]
    ds_read_b64_tr_b16 a[0:1], v224 offset:16384
    v_mfma_f32_16x16x32_bf16 v[128:131], a[20:23], a[176:179], v[128:131]
    ds_read_b128 a[216:219], v241 offset:4096
    v_mfma_f32_16x16x32_bf16 v[132:135], a[16:19], a[164:167], v[132:135]
    ds_read_b64_tr_b16 a[2:3], v224 offset:18432
    v_mfma_f32_16x16x32_bf16 v[132:135], a[20:23], a[180:183], v[132:135]
    ds_read_b128 a[220:223], v241 offset:6144
    v_mfma_f32_16x16x32_bf16 v[136:139], a[16:19], a[168:171], v[136:139]
    ds_read_b64_tr_b16 a[4:5], v224 offset:40960
    v_mfma_f32_16x16x32_bf16 v[136:139], a[20:23], a[184:187], v[136:139]
    v_mfma_f32_16x16x32_bf16 v[140:143], a[16:19], a[172:175], v[140:143]
    ds_read_b64_tr_b16 a[6:7], v224 offset:43008
    v_mfma_f32_16x16x32_bf16 v[140:143], a[20:23], a[188:191], v[140:143]
    s_waitcnt lgkmcnt(7)
    v_mfma_f32_16x16x32_bf16 v[208:211], a[24:27], a[160:163], v[208:211]
    ds_read_b64_tr_b16 a[8:9], v225 offset:16384
    v_mfma_f32_16x16x32_bf16 v[208:211], a[28:31], a[176:179], v[208:211]
    v_mfma_f32_16x16x32_bf16 v[212:215], a[24:27], a[164:167], v[212:215]
    ds_read_b64_tr_b16 a[10:11], v225 offset:18432
    v_mfma_f32_16x16x32_bf16 v[212:215], a[28:31], a[180:183], v[212:215]
    v_mfma_f32_16x16x32_bf16 v[216:219], a[24:27], a[168:171], v[216:219]
    ds_read_b64_tr_b16 a[12:13], v225 offset:40960
    v_mfma_f32_16x16x32_bf16 v[216:219], a[28:31], a[184:187], v[216:219]
    v_mfma_f32_16x16x32_bf16 v[220:223], a[24:27], a[172:175], v[220:223]
    ds_read_b64_tr_b16 a[14:15], v225 offset:43008
    v_mfma_f32_16x16x32_bf16 v[220:223], a[28:31], a[188:191], v[220:223]
    s_waitcnt lgkmcnt(4)
    v_mfma_f32_16x16x32_bf16 v[144:147], a[0:3], a[160:163], v[144:147]
    ds_read_b64_tr_b16 a[16:17], v226 offset:16384
    v_mfma_f32_16x16x32_bf16 v[144:147], a[4:7], a[176:179], v[144:147]
    v_mfma_f32_16x16x32_bf16 v[148:151], a[0:3], a[164:167], v[148:151]
    ds_read_b64_tr_b16 a[18:19], v226 offset:18432
    v_mfma_f32_16x16x32_bf16 v[148:151], a[4:7], a[180:183], v[148:151]
    v_mfma_f32_16x16x32_bf16 v[152:155], a[0:3], a[168:171], v[152:155]
    ds_read_b64_tr_b16 a[20:21], v226 offset:40960
    v_mfma_f32_16x16x32_bf16 v[152:155], a[4:7], a[184:187], v[152:155]
    v_mfma_f32_16x16x32_bf16 v[156:159], a[0:3], a[172:175], v[156:159]
    ds_read_b64_tr_b16 a[22:23], v226 offset:43008
    v_mfma_f32_16x16x32_bf16 v[156:159], a[4:7], a[188:191], v[156:159]
    s_waitcnt lgkmcnt(4)
    v_mfma_f32_16x16x32_bf16 v[160:163], a[8:11], a[160:163], v[160:163]
    s_waitcnt vmcnt(15)
    s_barrier
    v_mfma_f32_16x16x32_bf16 v[160:163], a[12:15], a[176:179], v[160:163]
    ds_read_b64_tr_b16 a[24:25], v227 offset:16384
    v_mfma_f32_16x16x32_bf16 v[164:167], a[8:11], a[164:167], v[164:167]
    ds_read_b64_tr_b16 a[26:27], v227 offset:18432
    v_mfma_f32_16x16x32_bf16 v[164:167], a[12:15], a[180:183], v[164:167]
    v_mfma_f32_16x16x32_bf16 v[168:171], a[8:11], a[168:171], v[168:171]
    ds_read_b64_tr_b16 a[28:29], v227 offset:40960
    v_mfma_f32_16x16x32_bf16 v[168:171], a[12:15], a[184:187], v[168:171]
    v_mfma_f32_16x16x32_bf16 v[172:175], a[8:11], a[172:175], v[172:175]
    ds_read_b64_tr_b16 a[30:31], v227 offset:43008
    v_mfma_f32_16x16x32_bf16 v[172:175], a[12:15], a[188:191], v[172:175]
    s_waitcnt lgkmcnt(4)
    v_mfma_f32_16x16x32_bf16 v[176:179], a[16:19], a[160:163], v[176:179]
    v_add_u32 v224, 0xffff4000, v224
    v_mfma_f32_16x16x32_bf16 v[176:179], a[20:23], a[176:179], v[176:179]
    ds_read_b64_tr_b16 a[0:1], v224 offset:0
    v_mfma_f32_16x16x32_bf16 v[180:183], a[16:19], a[164:167], v[180:183]
    ds_read_b64_tr_b16 a[2:3], v224 offset:2048
    v_mfma_f32_16x16x32_bf16 v[180:183], a[20:23], a[180:183], v[180:183]
    v_mfma_f32_16x16x32_bf16 v[184:187], a[16:19], a[168:171], v[184:187]
    ds_read_b64_tr_b16 a[4:5], v224 offset:24576
    v_mfma_f32_16x16x32_bf16 v[184:187], a[20:23], a[184:187], v[184:187]
    v_mfma_f32_16x16x32_bf16 v[188:191], a[16:19], a[172:175], v[188:191]
    ds_read_b64_tr_b16 a[6:7], v224 offset:26624
    v_mfma_f32_16x16x32_bf16 v[188:191], a[20:23], a[188:191], v[188:191]
    s_waitcnt lgkmcnt(4)
    v_mfma_f32_16x16x32_bf16 v[192:195], a[24:27], a[160:163], v[192:195]
    v_add_u32 v225, 0xffff4000, v225
    v_mfma_f32_16x16x32_bf16 v[192:195], a[28:31], a[176:179], v[192:195]
    ds_read_b64_tr_b16 a[8:9], v225 offset:0
    v_mfma_f32_16x16x32_bf16 v[196:199], a[24:27], a[164:167], v[196:199]
    ds_read_b64_tr_b16 a[10:11], v225 offset:2048
    v_mfma_f32_16x16x32_bf16 v[196:199], a[28:31], a[180:183], v[196:199]
    v_mfma_f32_16x16x32_bf16 v[200:203], a[24:27], a[168:171], v[200:203]
    ds_read_b64_tr_b16 a[12:13], v225 offset:24576
    v_mfma_f32_16x16x32_bf16 v[200:203], a[28:31], a[184:187], v[200:203]
    v_mfma_f32_16x16x32_bf16 v[204:207], a[24:27], a[172:175], v[204:207]
    ds_read_b64_tr_b16 a[14:15], v225 offset:26624
    v_mfma_f32_16x16x32_bf16 v[204:207], a[28:31], a[188:191], v[204:207]
    s_waitcnt lgkmcnt(4)
    v_mfma_f32_16x16x32_bf16 v[0:3], a[0:3], a[192:195], v[0:3]
    v_add_u32 v226, 0xffff4000, v226
    v_mfma_f32_16x16x32_bf16 v[0:3], a[4:7], a[208:211], v[0:3]
    ds_read_b64_tr_b16 a[16:17], v226 offset:0
    v_mfma_f32_16x16x32_bf16 v[4:7], a[0:3], a[196:199], v[4:7]
    ds_read_b64_tr_b16 a[18:19], v226 offset:2048
    v_mfma_f32_16x16x32_bf16 v[4:7], a[4:7], a[212:215], v[4:7]
    v_mfma_f32_16x16x32_bf16 v[8:11], a[0:3], a[200:203], v[8:11]
    ds_read_b64_tr_b16 a[20:21], v226 offset:24576
    v_mfma_f32_16x16x32_bf16 v[8:11], a[4:7], a[216:219], v[8:11]
    v_mfma_f32_16x16x32_bf16 v[12:15], a[0:3], a[204:207], v[12:15]
    ds_read_b64_tr_b16 a[22:23], v226 offset:26624
    v_mfma_f32_16x16x32_bf16 v[12:15], a[4:7], a[220:223], v[12:15]
    s_waitcnt lgkmcnt(4)
    v_mfma_f32_16x16x32_bf16 v[16:19], a[8:11], a[192:195], v[16:19]
    s_waitcnt vmcnt(11)
    s_barrier
    v_add_u32 v227, 0xffff4000, v227
    v_mfma_f32_16x16x32_bf16 v[16:19], a[12:15], a[208:211], v[16:19]
    ds_read_b64_tr_b16 a[24:25], v227 offset:0
    v_mfma_f32_16x16x32_bf16 v[20:23], a[8:11], a[196:199], v[20:23]
    ds_read_b64_tr_b16 a[26:27], v227 offset:2048
    v_mfma_f32_16x16x32_bf16 v[20:23], a[12:15], a[212:215], v[20:23]
    v_mfma_f32_16x16x32_bf16 v[24:27], a[8:11], a[200:203], v[24:27]
    ds_read_b64_tr_b16 a[28:29], v227 offset:24576
    v_mfma_f32_16x16x32_bf16 v[24:27], a[12:15], a[216:219], v[24:27]
    v_mfma_f32_16x16x32_bf16 v[28:31], a[8:11], a[204:207], v[28:31]
    ds_read_b64_tr_b16 a[30:31], v227 offset:26624
    v_mfma_f32_16x16x32_bf16 v[28:31], a[12:15], a[220:223], v[28:31]
    s_waitcnt lgkmcnt(4)
    v_mfma_f32_16x16x32_bf16 v[32:35], a[16:19], a[192:195], v[32:35]
    v_add_u32 v228, 0xffff4000, v228
    v_mfma_f32_16x16x32_bf16 v[32:35], a[20:23], a[208:211], v[32:35]
    ds_read_b64_tr_b16 a[0:1], v228 offset:0
    v_mfma_f32_16x16x32_bf16 v[36:39], a[16:19], a[196:199], v[36:39]
    ds_read_b64_tr_b16 a[2:3], v228 offset:2048
    v_mfma_f32_16x16x32_bf16 v[36:39], a[20:23], a[212:215], v[36:39]
    v_mfma_f32_16x16x32_bf16 v[40:43], a[16:19], a[200:203], v[40:43]
    ds_read_b64_tr_b16 a[4:5], v228 offset:24576
    v_mfma_f32_16x16x32_bf16 v[40:43], a[20:23], a[216:219], v[40:43]
    v_mfma_f32_16x16x32_bf16 v[44:47], a[16:19], a[204:207], v[44:47]
    ds_read_b64_tr_b16 a[6:7], v228 offset:26624
    v_mfma_f32_16x16x32_bf16 v[44:47], a[20:23], a[220:223], v[44:47]
    s_waitcnt lgkmcnt(4)
    v_mfma_f32_16x16x32_bf16 v[48:51], a[24:27], a[192:195], v[48:51]
    ds_read_b64_tr_b16 a[8:9], v224 offset:8192
    v_mfma_f32_16x16x32_bf16 v[48:51], a[28:31], a[208:211], v[48:51]
    v_mfma_f32_16x16x32_bf16 v[52:55], a[24:27], a[196:199], v[52:55]
    ds_read_b64_tr_b16 a[10:11], v224 offset:10240
    v_mfma_f32_16x16x32_bf16 v[52:55], a[28:31], a[212:215], v[52:55]
    v_mfma_f32_16x16x32_bf16 v[56:59], a[24:27], a[200:203], v[56:59]
    ds_read_b64_tr_b16 a[12:13], v224 offset:32768
    v_mfma_f32_16x16x32_bf16 v[56:59], a[28:31], a[216:219], v[56:59]
    v_mfma_f32_16x16x32_bf16 v[60:63], a[24:27], a[204:207], v[60:63]
    ds_read_b64_tr_b16 a[14:15], v224 offset:34816
    v_mfma_f32_16x16x32_bf16 v[60:63], a[28:31], a[220:223], v[60:63]
    s_waitcnt lgkmcnt(4)
    v_mfma_f32_16x16x32_bf16 v[64:67], a[0:3], a[192:195], v[64:67]
    ds_read_b64_tr_b16 a[16:17], v225 offset:8192
    v_mfma_f32_16x16x32_bf16 v[64:67], a[4:7], a[208:211], v[64:67]
    v_mfma_f32_16x16x32_bf16 v[68:71], a[0:3], a[196:199], v[68:71]
    ds_read_b64_tr_b16 a[18:19], v225 offset:10240
    v_mfma_f32_16x16x32_bf16 v[68:71], a[4:7], a[212:215], v[68:71]
    v_mfma_f32_16x16x32_bf16 v[72:75], a[0:3], a[200:203], v[72:75]
    ds_read_b64_tr_b16 a[20:21], v225 offset:32768
    v_mfma_f32_16x16x32_bf16 v[72:75], a[4:7], a[216:219], v[72:75]
    v_mfma_f32_16x16x32_bf16 v[76:79], a[0:3], a[204:207], v[76:79]
    ds_read_b64_tr_b16 a[22:23], v225 offset:34816
    v_mfma_f32_16x16x32_bf16 v[76:79], a[4:7], a[220:223], v[76:79]
    s_waitcnt lgkmcnt(4)
    v_mfma_f32_16x16x32_bf16 v[80:83], a[8:11], a[192:195], v[80:83]
    ds_read_b64_tr_b16 a[24:25], v226 offset:8192
    v_mfma_f32_16x16x32_bf16 v[80:83], a[12:15], a[208:211], v[80:83]
    v_mfma_f32_16x16x32_bf16 v[84:87], a[8:11], a[196:199], v[84:87]
    ds_read_b64_tr_b16 a[26:27], v226 offset:10240
    v_mfma_f32_16x16x32_bf16 v[84:87], a[12:15], a[212:215], v[84:87]
    v_mfma_f32_16x16x32_bf16 v[88:91], a[8:11], a[200:203], v[88:91]
    ds_read_b64_tr_b16 a[28:29], v226 offset:32768
    v_mfma_f32_16x16x32_bf16 v[88:91], a[12:15], a[216:219], v[88:91]
    v_mfma_f32_16x16x32_bf16 v[92:95], a[8:11], a[204:207], v[92:95]
    ds_read_b64_tr_b16 a[30:31], v226 offset:34816
    v_mfma_f32_16x16x32_bf16 v[92:95], a[12:15], a[220:223], v[92:95]
    s_waitcnt lgkmcnt(4)
    v_mfma_f32_16x16x32_bf16 v[96:99], a[16:19], a[192:195], v[96:99]
    s_waitcnt vmcnt(0)
    s_barrier
    v_mfma_f32_16x16x32_bf16 v[96:99], a[20:23], a[208:211], v[96:99]
    ds_read_b64_tr_b16 a[0:1], v227 offset:8192
    v_mfma_f32_16x16x32_bf16 v[100:103], a[16:19], a[196:199], v[100:103]
    ds_read_b64_tr_b16 a[2:3], v227 offset:10240
    v_mfma_f32_16x16x32_bf16 v[100:103], a[20:23], a[212:215], v[100:103]
    v_mfma_f32_16x16x32_bf16 v[104:107], a[16:19], a[200:203], v[104:107]
    ds_read_b64_tr_b16 a[4:5], v227 offset:32768
    v_mfma_f32_16x16x32_bf16 v[104:107], a[20:23], a[216:219], v[104:107]
    v_mfma_f32_16x16x32_bf16 v[108:111], a[16:19], a[204:207], v[108:111]
    ds_read_b64_tr_b16 a[6:7], v227 offset:34816
    v_mfma_f32_16x16x32_bf16 v[108:111], a[20:23], a[220:223], v[108:111]
    s_waitcnt lgkmcnt(4)
    v_mfma_f32_16x16x32_bf16 v[112:115], a[24:27], a[192:195], v[112:115]
    v_add_u32 v229, 0xffff4000, v229
    v_mfma_f32_16x16x32_bf16 v[112:115], a[28:31], a[208:211], v[112:115]
    ds_read_b64_tr_b16 a[8:9], v229 offset:0
    v_mfma_f32_16x16x32_bf16 v[116:119], a[24:27], a[196:199], v[116:119]
    ds_read_b64_tr_b16 a[10:11], v229 offset:2048
    v_mfma_f32_16x16x32_bf16 v[116:119], a[28:31], a[212:215], v[116:119]
    v_mfma_f32_16x16x32_bf16 v[120:123], a[24:27], a[200:203], v[120:123]
    ds_read_b64_tr_b16 a[12:13], v229 offset:24576
    v_mfma_f32_16x16x32_bf16 v[120:123], a[28:31], a[216:219], v[120:123]
    v_mfma_f32_16x16x32_bf16 v[124:127], a[24:27], a[204:207], v[124:127]
    ds_read_b64_tr_b16 a[14:15], v229 offset:26624
    v_mfma_f32_16x16x32_bf16 v[124:127], a[28:31], a[220:223], v[124:127]
    s_waitcnt lgkmcnt(4)
    v_mfma_f32_16x16x32_bf16 v[128:131], a[0:3], a[192:195], v[128:131]
    ds_read_b64_tr_b16 a[16:17], v224 offset:16384
    v_mfma_f32_16x16x32_bf16 v[128:131], a[4:7], a[208:211], v[128:131]
    v_mfma_f32_16x16x32_bf16 v[132:135], a[0:3], a[196:199], v[132:135]
    ds_read_b64_tr_b16 a[18:19], v224 offset:18432
    v_mfma_f32_16x16x32_bf16 v[132:135], a[4:7], a[212:215], v[132:135]
    v_mfma_f32_16x16x32_bf16 v[136:139], a[0:3], a[200:203], v[136:139]
    ds_read_b64_tr_b16 a[20:21], v224 offset:40960
    v_mfma_f32_16x16x32_bf16 v[136:139], a[4:7], a[216:219], v[136:139]
    v_mfma_f32_16x16x32_bf16 v[140:143], a[0:3], a[204:207], v[140:143]
    ds_read_b64_tr_b16 a[22:23], v224 offset:43008
    v_mfma_f32_16x16x32_bf16 v[140:143], a[4:7], a[220:223], v[140:143]
    s_waitcnt lgkmcnt(4)
    v_mfma_f32_16x16x32_bf16 v[208:211], a[8:11], a[192:195], v[208:211]
    ds_read_b64_tr_b16 a[24:25], v225 offset:16384
    v_mfma_f32_16x16x32_bf16 v[208:211], a[12:15], a[208:211], v[208:211]
    v_mfma_f32_16x16x32_bf16 v[212:215], a[8:11], a[196:199], v[212:215]
    ds_read_b64_tr_b16 a[26:27], v225 offset:18432
    v_mfma_f32_16x16x32_bf16 v[212:215], a[12:15], a[212:215], v[212:215]
    v_mfma_f32_16x16x32_bf16 v[216:219], a[8:11], a[200:203], v[216:219]
    ds_read_b64_tr_b16 a[28:29], v225 offset:40960
    v_mfma_f32_16x16x32_bf16 v[216:219], a[12:15], a[216:219], v[216:219]
    v_mfma_f32_16x16x32_bf16 v[220:223], a[8:11], a[204:207], v[220:223]
    ds_read_b64_tr_b16 a[30:31], v225 offset:43008
    v_mfma_f32_16x16x32_bf16 v[220:223], a[12:15], a[220:223], v[220:223]
    s_waitcnt lgkmcnt(4)
    v_mfma_f32_16x16x32_bf16 v[144:147], a[16:19], a[192:195], v[144:147]
    ds_read_b64_tr_b16 a[0:1], v226 offset:16384
    v_mfma_f32_16x16x32_bf16 v[144:147], a[20:23], a[208:211], v[144:147]
    v_mfma_f32_16x16x32_bf16 v[148:151], a[16:19], a[196:199], v[148:151]
    ds_read_b64_tr_b16 a[2:3], v226 offset:18432
    v_mfma_f32_16x16x32_bf16 v[148:151], a[20:23], a[212:215], v[148:151]
    v_mfma_f32_16x16x32_bf16 v[152:155], a[16:19], a[200:203], v[152:155]
    ds_read_b64_tr_b16 a[4:5], v226 offset:40960
    v_mfma_f32_16x16x32_bf16 v[152:155], a[20:23], a[216:219], v[152:155]
    v_mfma_f32_16x16x32_bf16 v[156:159], a[16:19], a[204:207], v[156:159]
    ds_read_b64_tr_b16 a[6:7], v226 offset:43008
    v_mfma_f32_16x16x32_bf16 v[156:159], a[20:23], a[220:223], v[156:159]
    s_waitcnt lgkmcnt(4)
    v_mfma_f32_16x16x32_bf16 v[160:163], a[24:27], a[192:195], v[160:163]
    s_barrier
    v_mfma_f32_16x16x32_bf16 v[160:163], a[28:31], a[208:211], v[160:163]
    ds_read_b64_tr_b16 a[8:9], v227 offset:16384
    v_mfma_f32_16x16x32_bf16 v[164:167], a[24:27], a[196:199], v[164:167]
    ds_read_b64_tr_b16 a[10:11], v227 offset:18432
    v_mfma_f32_16x16x32_bf16 v[164:167], a[28:31], a[212:215], v[164:167]
    v_mfma_f32_16x16x32_bf16 v[168:171], a[24:27], a[200:203], v[168:171]
    ds_read_b64_tr_b16 a[12:13], v227 offset:40960
    v_mfma_f32_16x16x32_bf16 v[168:171], a[28:31], a[216:219], v[168:171]
    v_mfma_f32_16x16x32_bf16 v[172:175], a[24:27], a[204:207], v[172:175]
    ds_read_b64_tr_b16 a[14:15], v227 offset:43008
    v_mfma_f32_16x16x32_bf16 v[172:175], a[28:31], a[220:223], v[172:175]
    s_waitcnt lgkmcnt(4)
    v_mfma_f32_16x16x32_bf16 v[176:179], a[0:3], a[192:195], v[176:179]
    v_mfma_f32_16x16x32_bf16 v[176:179], a[4:7], a[208:211], v[176:179]
    v_mfma_f32_16x16x32_bf16 v[180:183], a[0:3], a[196:199], v[180:183]
    v_mfma_f32_16x16x32_bf16 v[180:183], a[4:7], a[212:215], v[180:183]
    v_mfma_f32_16x16x32_bf16 v[184:187], a[0:3], a[200:203], v[184:187]
    v_mfma_f32_16x16x32_bf16 v[184:187], a[4:7], a[216:219], v[184:187]
    v_mfma_f32_16x16x32_bf16 v[188:191], a[0:3], a[204:207], v[188:191]
    v_mfma_f32_16x16x32_bf16 v[188:191], a[4:7], a[220:223], v[188:191]
    s_waitcnt lgkmcnt(0)
    v_mfma_f32_16x16x32_bf16 v[192:195], a[8:11], a[192:195], v[192:195]
    v_mfma_f32_16x16x32_bf16 v[192:195], a[12:15], a[208:211], v[192:195]
    v_mfma_f32_16x16x32_bf16 v[196:199], a[8:11], a[196:199], v[196:199]
    v_mfma_f32_16x16x32_bf16 v[196:199], a[12:15], a[212:215], v[196:199]
    v_mfma_f32_16x16x32_bf16 v[200:203], a[8:11], a[200:203], v[200:203]
    v_mfma_f32_16x16x32_bf16 v[200:203], a[12:15], a[216:219], v[200:203]
    v_mfma_f32_16x16x32_bf16 v[204:207], a[8:11], a[204:207], v[204:207]
    v_mfma_f32_16x16x32_bf16 v[204:207], a[12:15], a[220:223], v[204:207]
    s_nop 1
    v_mfma_f32_16x16x16_bf16 v[144:147], a[86:87], a[52:53], v[144:147]
    v_mfma_f32_16x16x16_bf16 v[148:151], a[86:87], a[56:57], v[148:151]
    v_mfma_f32_16x16x16_bf16 v[152:155], a[86:87], a[60:61], v[152:155]
    v_mfma_f32_16x16x16_bf16 v[156:159], a[86:87], a[64:65], v[156:159]
    v_mfma_f32_16x16x16_bf16 v[160:163], a[88:89], a[52:53], v[160:163]
    v_mfma_f32_16x16x16_bf16 v[164:167], a[88:89], a[56:57], v[164:167]
    v_mfma_f32_16x16x16_bf16 v[168:171], a[88:89], a[60:61], v[168:171]
    v_mfma_f32_16x16x16_bf16 v[172:175], a[88:89], a[64:65], v[172:175]
    v_mfma_f32_16x16x16_bf16 v[176:179], a[90:91], a[52:53], v[176:179]
    v_mfma_f32_16x16x16_bf16 v[180:183], a[90:91], a[56:57], v[180:183]
    v_mfma_f32_16x16x16_bf16 v[184:187], a[90:91], a[60:61], v[184:187]
    v_mfma_f32_16x16x16_bf16 v[188:191], a[90:91], a[64:65], v[188:191]
    v_mfma_f32_16x16x16_bf16 v[192:195], a[92:93], a[52:53], v[192:195]
    v_mfma_f32_16x16x16_bf16 v[196:199], a[92:93], a[56:57], v[196:199]
    v_mfma_f32_16x16x16_bf16 v[200:203], a[92:93], a[60:61], v[200:203]
    v_mfma_f32_16x16x16_bf16 v[204:207], a[92:93], a[64:65], v[204:207]
    v_mfma_f32_16x16x16_bf16 v[80:83], a[78:79], a[52:53], v[80:83]
    v_mfma_f32_16x16x16_bf16 v[84:87], a[78:79], a[56:57], v[84:87]
    v_mfma_f32_16x16x16_bf16 v[88:91], a[78:79], a[60:61], v[88:91]
    v_mfma_f32_16x16x16_bf16 v[92:95], a[78:79], a[64:65], v[92:95]
    v_mfma_f32_16x16x16_bf16 v[96:99], a[80:81], a[52:53], v[96:99]
    v_mfma_f32_16x16x16_bf16 v[100:103], a[80:81], a[56:57], v[100:103]
    v_mfma_f32_16x16x16_bf16 v[104:107], a[80:81], a[60:61], v[104:107]
    v_mfma_f32_16x16x16_bf16 v[108:111], a[80:81], a[64:65], v[108:111]
    v_mfma_f32_16x16x16_bf16 v[112:115], a[82:83], a[52:53], v[112:115]
    v_mfma_f32_16x16x16_bf16 v[116:119], a[82:83], a[56:57], v[116:119]
    v_mfma_f32_16x16x16_bf16 v[120:123], a[82:83], a[60:61], v[120:123]
    v_mfma_f32_16x16x16_bf16 v[124:127], a[82:83], a[64:65], v[124:127]
    v_mfma_f32_16x16x16_bf16 v[128:131], a[84:85], a[52:53], v[128:131]
    v_mfma_f32_16x16x16_bf16 v[132:135], a[84:85], a[56:57], v[132:135]
    v_mfma_f32_16x16x16_bf16 v[136:139], a[84:85], a[60:61], v[136:139]
    v_mfma_f32_16x16x16_bf16 v[140:143], a[84:85], a[64:65], v[140:143]
    v_mfma_f32_16x16x16_bf16 v[208:211], a[94:95], a[52:53], v[208:211]
    v_mfma_f32_16x16x16_bf16 v[212:215], a[94:95], a[56:57], v[212:215]
    v_mfma_f32_16x16x16_bf16 v[216:219], a[94:95], a[60:61], v[216:219]
    v_mfma_f32_16x16x16_bf16 v[220:223], a[94:95], a[64:65], v[220:223]
    v_mfma_f32_16x16x16_bf16 v[0:3], a[68:69], a[52:53], v[0:3]
    v_mfma_f32_16x16x16_bf16 v[4:7], a[68:69], a[56:57], v[4:7]
    v_mfma_f32_16x16x16_bf16 v[8:11], a[68:69], a[60:61], v[8:11]
    v_mfma_f32_16x16x16_bf16 v[12:15], a[68:69], a[64:65], v[12:15]
    v_mfma_f32_16x16x16_bf16 v[16:19], a[70:71], a[52:53], v[16:19]
    v_mfma_f32_16x16x16_bf16 v[20:23], a[70:71], a[56:57], v[20:23]
    v_mfma_f32_16x16x16_bf16 v[24:27], a[70:71], a[60:61], v[24:27]
    v_mfma_f32_16x16x16_bf16 v[28:31], a[70:71], a[64:65], v[28:31]
    v_mfma_f32_16x16x16_bf16 v[32:35], a[72:73], a[52:53], v[32:35]
    v_mfma_f32_16x16x16_bf16 v[36:39], a[72:73], a[56:57], v[36:39]
    v_mfma_f32_16x16x16_bf16 v[40:43], a[72:73], a[60:61], v[40:43]
    v_mfma_f32_16x16x16_bf16 v[44:47], a[72:73], a[64:65], v[44:47]
    v_mfma_f32_16x16x16_bf16 v[48:51], a[74:75], a[52:53], v[48:51]
    v_mfma_f32_16x16x16_bf16 v[52:55], a[74:75], a[56:57], v[52:55]
    v_mfma_f32_16x16x16_bf16 v[56:59], a[74:75], a[60:61], v[56:59]
    v_mfma_f32_16x16x16_bf16 v[60:63], a[74:75], a[64:65], v[60:63]
    v_mfma_f32_16x16x16_bf16 v[64:67], a[76:77], a[52:53], v[64:67]
    v_mfma_f32_16x16x16_bf16 v[68:71], a[76:77], a[56:57], v[68:71]
    v_mfma_f32_16x16x16_bf16 v[72:75], a[76:77], a[60:61], v[72:75]
    v_mfma_f32_16x16x16_bf16 v[76:79], a[76:77], a[64:65], v[76:79]
    s_barrier
    v_accvgpr_read_b32 v250, a54
    v_accvgpr_read_b32 v251, a58
    v_accvgpr_read_b32 v252, a62
    v_accvgpr_read_b32 v253, a66
    v_lshrrev_b32 v224, 4, v244
    v_and_b32 v225, 15, v244
    v_rcp_f32 v250, v250
    v_rcp_f32 v251, v251
    v_rcp_f32 v252, v252
    v_rcp_f32 v253, v253
    s_lshl_b32 s52, s48, 6
    v_add_u32 v242, s52, v225
    v_mul_u32_u24 v242, 296, v242
    v_lshl_add_u32 v226, v224, 3, v242
    v_mul_u32_u24 v243, 72, v224
    v_add3_u32 v227, v242, v243, 64
    v_mul_f32 v250, 0x3fb8aa3b, v250
    v_mul_f32 v251, 0x3fb8aa3b, v251
    v_mul_f32 v252, 0x3fb8aa3b, v252
    v_mul_f32 v253, 0x3fb8aa3b, v253
    s_mov_b32 s56, 0x3f317218
    s_mov_b32 s57, s56
    v_mov_b32 v228, 0x35c1a2a0
    v_cmp_gt_u32 s[32:33], 2, v224
    v_mov_b32 v254, 0x3f803f80
    v_mov_b32 v255, 0x3f803f80
    ds_write_b64 v242, v[254:255] offset:288
    ds_write_b64 v242, v[254:255] offset:5024
    ds_write_b64 v242, v[254:255] offset:9760
    ds_write_b64 v242, v[254:255] offset:14496
    v_pk_mul_f32 v[220:221], v[220:221], v[252:253] op_sel:[0,1] op_sel_hi:[1,1]
    v_pk_mul_f32 v[222:223], v[222:223], v[252:253] op_sel:[0,1] op_sel_hi:[1,1]
    v_exp_f32_e64 v232, v220 clamp
    v_exp_f32_e64 v233, v221 clamp
    v_exp_f32_e64 v234, v222 clamp
    v_exp_f32_e64 v235, v223 clamp
    v_max_f32 v236, v220, v228
    v_max_f32 v237, v221, v228
    v_max_f32 v238, v222, v228
    v_max_f32 v239, v223, v228
    v_pk_fma_f32 v[232:233], v[236:237], s[56:57], v[232:233]
    v_pk_fma_f32 v[234:235], v[238:239], s[56:57], v[234:235]
    v_cndmask_b32 v220, v220, v232, s[32:33]
    v_cndmask_b32 v221, v221, v233, s[32:33]
    v_cndmask_b32 v222, v222, v234, s[32:33]
    v_cndmask_b32 v223, v223, v235, s[32:33]
    v_cvt_pk_bf16_f32 v220, v220, v221
    v_cvt_pk_bf16_f32 v221, v222, v223
    ds_write_b64 v227, v[220:221] offset:14208
    v_pk_mul_f32 v[216:217], v[216:217], v[252:253] op_sel:[0,0] op_sel_hi:[1,0]
    v_pk_mul_f32 v[218:219], v[218:219], v[252:253] op_sel:[0,0] op_sel_hi:[1,0]
    v_exp_f32_e64 v232, v216 clamp
    v_exp_f32_e64 v233, v217 clamp
    v_exp_f32_e64 v234, v218 clamp
    v_exp_f32_e64 v235, v219 clamp
    v_max_f32 v236, v216, v228
    v_max_f32 v237, v217, v228
    v_max_f32 v238, v218, v228
    v_max_f32 v239, v219, v228
    v_pk_fma_f32 v[232:233], v[236:237], s[56:57], v[232:233]
    v_pk_fma_f32 v[234:235], v[238:239], s[56:57], v[234:235]
    v_cndmask_b32 v216, v216, v232, s[32:33]
    v_cndmask_b32 v217, v217, v233, s[32:33]
    v_cndmask_b32 v218, v218, v234, s[32:33]
    v_cndmask_b32 v219, v219, v235, s[32:33]
    v_cvt_pk_bf16_f32 v216, v216, v217
    v_cvt_pk_bf16_f32 v217, v218, v219
    ds_write_b64 v227, v[216:217] offset:9472
    v_pk_mul_f32 v[212:213], v[212:213], v[250:251] op_sel:[0,1] op_sel_hi:[1,1]
    v_pk_mul_f32 v[214:215], v[214:215], v[250:251] op_sel:[0,1] op_sel_hi:[1,1]
    v_exp_f32_e64 v232, v212 clamp
    v_exp_f32_e64 v233, v213 clamp
    v_exp_f32_e64 v234, v214 clamp
    v_exp_f32_e64 v235, v215 clamp
    v_max_f32 v236, v212, v228
    v_max_f32 v237, v213, v228
    v_max_f32 v238, v214, v228
    v_max_f32 v239, v215, v228
    v_pk_fma_f32 v[232:233], v[236:237], s[56:57], v[232:233]
    v_pk_fma_f32 v[234:235], v[238:239], s[56:57], v[234:235]
    v_cndmask_b32 v212, v212, v232, s[32:33]
    v_cndmask_b32 v213, v213, v233, s[32:33]
    v_cndmask_b32 v214, v214, v234, s[32:33]
    v_cndmask_b32 v215, v215, v235, s[32:33]
    v_cvt_pk_bf16_f32 v212, v212, v213
    v_cvt_pk_bf16_f32 v213, v214, v215
    ds_write_b64 v227, v[212:213] offset:4736
    v_pk_mul_f32 v[208:209], v[208:209], v[250:251] op_sel:[0,0] op_sel_hi:[1,0]
    v_pk_mul_f32 v[210:211], v[210:211], v[250:251] op_sel:[0,0] op_sel_hi:[1,0]
    v_exp_f32_e64 v232, v208 clamp
    v_exp_f32_e64 v233, v209 clamp
    v_exp_f32_e64 v234, v210 clamp
    v_exp_f32_e64 v235, v211 clamp
    v_max_f32 v236, v208, v228
    v_max_f32 v237, v209, v228
    v_max_f32 v238, v210, v228
    v_max_f32 v239, v211, v228
    v_pk_fma_f32 v[232:233], v[236:237], s[56:57], v[232:233]
    v_pk_fma_f32 v[234:235], v[238:239], s[56:57], v[234:235]
    v_cndmask_b32 v208, v208, v232, s[32:33]
    v_cndmask_b32 v209, v209, v233, s[32:33]
    v_cndmask_b32 v210, v210, v234, s[32:33]
    v_cndmask_b32 v211, v211, v235, s[32:33]
    v_cvt_pk_bf16_f32 v208, v208, v209
    v_cvt_pk_bf16_f32 v209, v210, v211
    ds_write_b64 v227, v[208:209] offset:0
    v_lshrrev_b32 v240, 3, v244
    v_and_b32 v241, 6, v240
    v_xor_b32 v241, v241, v244
    v_and_b32 v241, 7, v241
    v_mul_u32_u24 v240, 1152, v240
    v_lshl_add_u32 v220, v241, 4, v240
    s_mul_i32 s52, s68, 384
    s_and_b32 s60, s48, 1
    s_mul_i32 s60, s60, 18432
    s_add_u32 s52, s52, s60
    v_add_u32 v220, s52, v220
    v_add_u32 v221, 8192, v220
    s_mov_b32 s52, s4
    s_lshl1_add_u32 s52, s51, s52
    s_mul_i32 s9, s52, 3
    s_add_u32 s9, s9, s68
    s_lshl_b32 s9, s9, 7
    s_add_u32 s9, s9, 540672
    s_and_b32 s60, s48, 1
    s_lshl1_add_u32 s52, s52, s60
    s_lshl_b32 s52, s52, 12
    v_lshl_add_u32 v222, v244, 4, s52
    v_bfe_u32 v223, v244, 3, 2
    v_and_b32 v240, 7, v244
    v_lshlrev_b32 v240, 2, v240
    v_lshl_add_u32 v223, v223, 7, v240
    v_pk_mul_f32 v[156:157], v[156:157], v[252:253] op_sel:[0,1] op_sel_hi:[1,1]
    v_pk_mul_f32 v[158:159], v[158:159], v[252:253] op_sel:[0,1] op_sel_hi:[1,1]
    v_cvt_pk_bf16_f32 v156, v156, v157
    v_cvt_pk_bf16_f32 v157, v158, v159
    ds_write_b64 v226, v[156:157] offset:14352
    s_add_u32 m0, s66, 81920
    s_add_u32 s55, s14, 256
    buffer_load_dwordx4 v220, s[40:43], s55 offen lds
    v_pk_mul_f32 v[152:153], v[152:153], v[252:253] op_sel:[0,0] op_sel_hi:[1,0]
    v_pk_mul_f32 v[154:155], v[154:155], v[252:253] op_sel:[0,0] op_sel_hi:[1,0]
    v_cvt_pk_bf16_f32 v152, v152, v153
    v_cvt_pk_bf16_f32 v153, v154, v155
    ds_write_b64 v226, v[152:153] offset:9616
    v_pk_mul_f32 v[148:149], v[148:149], v[250:251] op_sel:[0,1] op_sel_hi:[1,1]
    v_pk_mul_f32 v[150:151], v[150:151], v[250:251] op_sel:[0,1] op_sel_hi:[1,1]
    v_cvt_pk_bf16_f32 v148, v148, v149
    v_cvt_pk_bf16_f32 v149, v150, v151
    ds_write_b64 v226, v[148:149] offset:4880
    buffer_load_dwordx4 v221, s[40:43], s55 offen offset:1024 lds
    v_pk_mul_f32 v[144:145], v[144:145], v[250:251] op_sel:[0,0] op_sel_hi:[1,0]
    v_pk_mul_f32 v[146:147], v[146:147], v[250:251] op_sel:[0,0] op_sel_hi:[1,0]
    v_cvt_pk_bf16_f32 v144, v144, v145
    v_cvt_pk_bf16_f32 v145, v146, v147
    ds_write_b64 v226, v[144:145] offset:144
    v_pk_mul_f32 v[172:173], v[172:173], v[252:253] op_sel:[0,1] op_sel_hi:[1,1]
    v_pk_mul_f32 v[174:175], v[174:175], v[252:253] op_sel:[0,1] op_sel_hi:[1,1]
    v_cvt_pk_bf16_f32 v172, v172, v173
    v_cvt_pk_bf16_f32 v173, v174, v175
    ds_write_b64 v226, v[172:173] offset:14384
    s_add_u32 m0, s66, 90112
    s_add_u32 s55, s15, 256
    buffer_load_dwordx4 v220, s[40:43], s55 offen lds
    v_pk_mul_f32 v[168:169], v[168:169], v[252:253] op_sel:[0,0] op_sel_hi:[1,0]
    v_pk_mul_f32 v[170:171], v[170:171], v[252:253] op_sel:[0,0] op_sel_hi:[1,0]
    v_cvt_pk_bf16_f32 v168, v168, v169
    v_cvt_pk_bf16_f32 v169, v170, v171
    ds_write_b64 v226, v[168:169] offset:9648
    v_pk_mul_f32 v[164:165], v[164:165], v[250:251] op_sel:[0,1] op_sel_hi:[1,1]
    v_pk_mul_f32 v[166:167], v[166:167], v[250:251] op_sel:[0,1] op_sel_hi:[1,1]
    v_cvt_pk_bf16_f32 v164, v164, v165
    v_cvt_pk_bf16_f32 v165, v166, v167
    ds_write_b64 v226, v[164:165] offset:4912
    buffer_load_dwordx4 v221, s[40:43], s55 offen offset:1024 lds
    v_pk_mul_f32 v[160:161], v[160:161], v[250:251] op_sel:[0,0] op_sel_hi:[1,0]
    v_pk_mul_f32 v[162:163], v[162:163], v[250:251] op_sel:[0,0] op_sel_hi:[1,0]
    v_cvt_pk_bf16_f32 v160, v160, v161
    v_cvt_pk_bf16_f32 v161, v162, v163
    ds_write_b64 v226, v[160:161] offset:176
    v_pk_mul_f32 v[188:189], v[188:189], v[252:253] op_sel:[0,1] op_sel_hi:[1,1]
    v_pk_mul_f32 v[190:191], v[190:191], v[252:253] op_sel:[0,1] op_sel_hi:[1,1]
    v_cvt_pk_bf16_f32 v188, v188, v189
    v_cvt_pk_bf16_f32 v189, v190, v191
    ds_write_b64 v226, v[188:189] offset:14424
    s_add_u32 m0, s66, 98304
    s_add_u32 s55, s14, 0
    buffer_load_dwordx4 v220, s[40:43], s55 offen lds
    v_pk_mul_f32 v[184:185], v[184:185], v[252:253] op_sel:[0,0] op_sel_hi:[1,0]
    v_pk_mul_f32 v[186:187], v[186:187], v[252:253] op_sel:[0,0] op_sel_hi:[1,0]
    v_cvt_pk_bf16_f32 v184, v184, v185
    v_cvt_pk_bf16_f32 v185, v186, v187
    ds_write_b64 v226, v[184:185] offset:9688
    v_pk_mul_f32 v[180:181], v[180:181], v[250:251] op_sel:[0,1] op_sel_hi:[1,1]
    v_pk_mul_f32 v[182:183], v[182:183], v[250:251] op_sel:[0,1] op_sel_hi:[1,1]
    v_cvt_pk_bf16_f32 v180, v180, v181
    v_cvt_pk_bf16_f32 v181, v182, v183
    ds_write_b64 v226, v[180:181] offset:4952
    buffer_load_dwordx4 v221, s[40:43], s55 offen offset:1024 lds
    v_pk_mul_f32 v[176:177], v[176:177], v[250:251] op_sel:[0,0] op_sel_hi:[1,0]
    v_pk_mul_f32 v[178:179], v[178:179], v[250:251] op_sel:[0,0] op_sel_hi:[1,0]
    v_cvt_pk_bf16_f32 v176, v176, v177
    v_cvt_pk_bf16_f32 v177, v178, v179
    ds_write_b64 v226, v[176:177] offset:216
    v_pk_mul_f32 v[204:205], v[204:205], v[252:253] op_sel:[0,1] op_sel_hi:[1,1]
    v_pk_mul_f32 v[206:207], v[206:207], v[252:253] op_sel:[0,1] op_sel_hi:[1,1]
    v_cvt_pk_bf16_f32 v204, v204, v205
    v_cvt_pk_bf16_f32 v205, v206, v207
    ds_write_b64 v226, v[204:205] offset:14456
    s_add_u32 m0, s66, 106496
    s_add_u32 s55, s15, 0
    buffer_load_dwordx4 v220, s[40:43], s55 offen lds
    v_pk_mul_f32 v[200:201], v[200:201], v[252:253] op_sel:[0,0] op_sel_hi:[1,0]
    v_pk_mul_f32 v[202:203], v[202:203], v[252:253] op_sel:[0,0] op_sel_hi:[1,0]
    v_cvt_pk_bf16_f32 v200, v200, v201
    v_cvt_pk_bf16_f32 v201, v202, v203
    ds_write_b64 v226, v[200:201] offset:9720
    v_pk_mul_f32 v[196:197], v[196:197], v[250:251] op_sel:[0,1] op_sel_hi:[1,1]
    v_pk_mul_f32 v[198:199], v[198:199], v[250:251] op_sel:[0,1] op_sel_hi:[1,1]
    v_cvt_pk_bf16_f32 v196, v196, v197
    v_cvt_pk_bf16_f32 v197, v198, v199
    ds_write_b64 v226, v[196:197] offset:4984
    buffer_load_dwordx4 v221, s[40:43], s55 offen offset:1024 lds
    v_pk_mul_f32 v[192:193], v[192:193], v[250:251] op_sel:[0,0] op_sel_hi:[1,0]
    v_pk_mul_f32 v[194:195], v[194:195], v[250:251] op_sel:[0,0] op_sel_hi:[1,0]
    v_cvt_pk_bf16_f32 v192, v192, v193
    v_cvt_pk_bf16_f32 v193, v194, v195
    ds_write_b64 v226, v[192:193] offset:248
    s_add_u32 m0, s66, 114688
    s_add_u32 s55, s14, 128
    buffer_load_dwordx4 v220, s[40:43], s55 offen lds
    v_pk_mul_f32 v[92:93], v[92:93], v[252:253] op_sel:[0,1] op_sel_hi:[1,1]
    v_pk_mul_f32 v[94:95], v[94:95], v[252:253] op_sel:[0,1] op_sel_hi:[1,1]
    v_exp_f32_e64 v232, v92 clamp
    v_exp_f32_e64 v233, v93 clamp
    v_exp_f32_e64 v234, v94 clamp
    v_exp_f32_e64 v235, v95 clamp
    v_max_f32 v236, v92, v228
    v_max_f32 v237, v93, v228
    v_max_f32 v238, v94, v228
    v_max_f32 v239, v95, v228
    v_pk_fma_f32 v[92:93], v[236:237], s[56:57], v[232:233]
    v_pk_fma_f32 v[94:95], v[238:239], s[56:57], v[234:235]
    v_cvt_pk_bf16_f32 v92, v92, v93
    v_cvt_pk_bf16_f32 v93, v94, v95
    ds_write_b64 v226, v[92:93] offset:14208
    buffer_load_dwordx4 v221, s[40:43], s55 offen offset:1024 lds
    v_pk_mul_f32 v[88:89], v[88:89], v[252:253] op_sel:[0,0] op_sel_hi:[1,0]
    v_pk_mul_f32 v[90:91], v[90:91], v[252:253] op_sel:[0,0] op_sel_hi:[1,0]
    v_exp_f32_e64 v232, v88 clamp
    v_exp_f32_e64 v233, v89 clamp
    v_exp_f32_e64 v234, v90 clamp
    v_exp_f32_e64 v235, v91 clamp
    v_max_f32 v236, v88, v228
    v_max_f32 v237, v89, v228
    v_max_f32 v238, v90, v228
    v_max_f32 v239, v91, v228
    v_pk_fma_f32 v[88:89], v[236:237], s[56:57], v[232:233]
    v_pk_fma_f32 v[90:91], v[238:239], s[56:57], v[234:235]
    v_cvt_pk_bf16_f32 v88, v88, v89
    v_cvt_pk_bf16_f32 v89, v90, v91
    ds_write_b64 v226, v[88:89] offset:9472
    s_add_u32 m0, s66, 122880
    s_add_u32 s55, s15, 128
    buffer_load_dwordx4 v220, s[40:43], s55 offen lds
    v_pk_mul_f32 v[84:85], v[84:85], v[250:251] op_sel:[0,1] op_sel_hi:[1,1]
    v_pk_mul_f32 v[86:87], v[86:87], v[250:251] op_sel:[0,1] op_sel_hi:[1,1]
    v_exp_f32_e64 v232, v84 clamp
    v_exp_f32_e64 v233, v85 clamp
    v_exp_f32_e64 v234, v86 clamp
    v_exp_f32_e64 v235, v87 clamp
    v_max_f32 v236, v84, v228
    v_max_f32 v237, v85, v228
    v_max_f32 v238, v86, v228
    v_max_f32 v239, v87, v228
    v_pk_fma_f32 v[84:85], v[236:237], s[56:57], v[232:233]
    v_pk_fma_f32 v[86:87], v[238:239], s[56:57], v[234:235]
    v_cvt_pk_bf16_f32 v84, v84, v85
    v_cvt_pk_bf16_f32 v85, v86, v87
    ds_write_b64 v226, v[84:85] offset:4736
    buffer_load_dwordx4 v221, s[40:43], s55 offen offset:1024 lds
    v_pk_mul_f32 v[80:81], v[80:81], v[250:251] op_sel:[0,0] op_sel_hi:[1,0]
    v_pk_mul_f32 v[82:83], v[82:83], v[250:251] op_sel:[0,0] op_sel_hi:[1,0]
    v_exp_f32_e64 v232, v80 clamp
    v_exp_f32_e64 v233, v81 clamp
    v_exp_f32_e64 v234, v82 clamp
    v_exp_f32_e64 v235, v83 clamp
    v_max_f32 v236, v80, v228
    v_max_f32 v237, v81, v228
    v_max_f32 v238, v82, v228
    v_max_f32 v239, v83, v228
    v_pk_fma_f32 v[80:81], v[236:237], s[56:57], v[232:233]
    v_pk_fma_f32 v[82:83], v[238:239], s[56:57], v[234:235]
    v_cvt_pk_bf16_f32 v80, v80, v81
    v_cvt_pk_bf16_f32 v81, v82, v83
    ds_write_b64 v226, v[80:81] offset:0
    s_add_u32 m0, s66, 131072
    s_add_u32 s55, s3, 256
    buffer_load_dwordx4 v220, s[40:43], s55 offen lds
    v_pk_mul_f32 v[108:109], v[108:109], v[252:253] op_sel:[0,1] op_sel_hi:[1,1]
    v_pk_mul_f32 v[110:111], v[110:111], v[252:253] op_sel:[0,1] op_sel_hi:[1,1]
    v_exp_f32_e64 v232, v108 clamp
    v_exp_f32_e64 v233, v109 clamp
    v_exp_f32_e64 v234, v110 clamp
    v_exp_f32_e64 v235, v111 clamp
    v_max_f32 v236, v108, v228
    v_max_f32 v237, v109, v228
    v_max_f32 v238, v110, v228
    v_max_f32 v239, v111, v228
    v_pk_fma_f32 v[108:109], v[236:237], s[56:57], v[232:233]
    v_pk_fma_f32 v[110:111], v[238:239], s[56:57], v[234:235]
    v_cvt_pk_bf16_f32 v108, v108, v109
    v_cvt_pk_bf16_f32 v109, v110, v111
    ds_write_b64 v226, v[108:109] offset:14240
    buffer_load_dwordx4 v221, s[40:43], s55 offen offset:1024 lds
    v_pk_mul_f32 v[104:105], v[104:105], v[252:253] op_sel:[0,0] op_sel_hi:[1,0]
    v_pk_mul_f32 v[106:107], v[106:107], v[252:253] op_sel:[0,0] op_sel_hi:[1,0]
    v_exp_f32_e64 v232, v104 clamp
    v_exp_f32_e64 v233, v105 clamp
    v_exp_f32_e64 v234, v106 clamp
    v_exp_f32_e64 v235, v107 clamp
    v_max_f32 v236, v104, v228
    v_max_f32 v237, v105, v228
    v_max_f32 v238, v106, v228
    v_max_f32 v239, v107, v228
    v_pk_fma_f32 v[104:105], v[236:237], s[56:57], v[232:233]
    v_pk_fma_f32 v[106:107], v[238:239], s[56:57], v[234:235]
    v_cvt_pk_bf16_f32 v104, v104, v105
    v_cvt_pk_bf16_f32 v105, v106, v107
    ds_write_b64 v226, v[104:105] offset:9504
    s_add_u32 m0, s66, 139264
    s_add_u32 s55, s14, 663808
    buffer_load_dwordx4 v220, s[40:43], s55 offen lds
    v_pk_mul_f32 v[100:101], v[100:101], v[250:251] op_sel:[0,1] op_sel_hi:[1,1]
    v_pk_mul_f32 v[102:103], v[102:103], v[250:251] op_sel:[0,1] op_sel_hi:[1,1]
    v_exp_f32_e64 v232, v100 clamp
    v_exp_f32_e64 v233, v101 clamp
    v_exp_f32_e64 v234, v102 clamp
    v_exp_f32_e64 v235, v103 clamp
    v_max_f32 v236, v100, v228
    v_max_f32 v237, v101, v228
    v_max_f32 v238, v102, v228
    v_max_f32 v239, v103, v228
    v_pk_fma_f32 v[100:101], v[236:237], s[56:57], v[232:233]
    v_pk_fma_f32 v[102:103], v[238:239], s[56:57], v[234:235]
    v_cvt_pk_bf16_f32 v100, v100, v101
    v_cvt_pk_bf16_f32 v101, v102, v103
    ds_write_b64 v226, v[100:101] offset:4768
    buffer_load_dwordx4 v221, s[40:43], s55 offen offset:1024 lds
    v_pk_mul_f32 v[96:97], v[96:97], v[250:251] op_sel:[0,0] op_sel_hi:[1,0]
    v_pk_mul_f32 v[98:99], v[98:99], v[250:251] op_sel:[0,0] op_sel_hi:[1,0]
    v_exp_f32_e64 v232, v96 clamp
    v_exp_f32_e64 v233, v97 clamp
    v_exp_f32_e64 v234, v98 clamp
    v_exp_f32_e64 v235, v99 clamp
    v_max_f32 v236, v96, v228
    v_max_f32 v237, v97, v228
    v_max_f32 v238, v98, v228
    v_max_f32 v239, v99, v228
    v_pk_fma_f32 v[96:97], v[236:237], s[56:57], v[232:233]
    v_pk_fma_f32 v[98:99], v[238:239], s[56:57], v[234:235]
    v_cvt_pk_bf16_f32 v96, v96, v97
    v_cvt_pk_bf16_f32 v97, v98, v99
    ds_write_b64 v226, v[96:97] offset:32
    s_add_u32 s49, s72, 32768
    buffer_load_dword v231, v223, s[24:27], s49 offen sc0 sc1
    v_pk_mul_f32 v[124:125], v[124:125], v[252:253] op_sel:[0,1] op_sel_hi:[1,1]
    v_pk_mul_f32 v[126:127], v[126:127], v[252:253] op_sel:[0,1] op_sel_hi:[1,1]
    v_exp_f32_e64 v232, v124 clamp
    v_exp_f32_e64 v233, v125 clamp
    v_exp_f32_e64 v234, v126 clamp
    v_exp_f32_e64 v235, v127 clamp
    v_max_f32 v236, v124, v228
    v_max_f32 v237, v125, v228
    v_max_f32 v238, v126, v228
    v_max_f32 v239, v127, v228
    v_pk_fma_f32 v[124:125], v[236:237], s[56:57], v[232:233]
    v_pk_fma_f32 v[126:127], v[238:239], s[56:57], v[234:235]
    v_cvt_pk_bf16_f32 v124, v124, v125
    v_cvt_pk_bf16_f32 v125, v126, v127
    ds_write_b64 v226, v[124:125] offset:14280
    v_pk_mul_f32 v[120:121], v[120:121], v[252:253] op_sel:[0,0] op_sel_hi:[1,0]
    v_pk_mul_f32 v[122:123], v[122:123], v[252:253] op_sel:[0,0] op_sel_hi:[1,0]
    v_exp_f32_e64 v232, v120 clamp
    v_exp_f32_e64 v233, v121 clamp
    v_exp_f32_e64 v234, v122 clamp
    v_exp_f32_e64 v235, v123 clamp
    v_max_f32 v236, v120, v228
    v_max_f32 v237, v121, v228
    v_max_f32 v238, v122, v228
    v_max_f32 v239, v123, v228
    v_pk_fma_f32 v[120:121], v[236:237], s[56:57], v[232:233]
    v_pk_fma_f32 v[122:123], v[238:239], s[56:57], v[234:235]
    v_cvt_pk_bf16_f32 v120, v120, v121
    v_cvt_pk_bf16_f32 v121, v122, v123
    ds_write_b64 v226, v[120:121] offset:9544
    v_pk_mul_f32 v[116:117], v[116:117], v[250:251] op_sel:[0,1] op_sel_hi:[1,1]
    v_pk_mul_f32 v[118:119], v[118:119], v[250:251] op_sel:[0,1] op_sel_hi:[1,1]
    v_exp_f32_e64 v232, v116 clamp
    v_exp_f32_e64 v233, v117 clamp
    v_exp_f32_e64 v234, v118 clamp
    v_exp_f32_e64 v235, v119 clamp
    v_max_f32 v236, v116, v228
    v_max_f32 v237, v117, v228
    v_max_f32 v238, v118, v228
    v_max_f32 v239, v119, v228
    v_pk_fma_f32 v[116:117], v[236:237], s[56:57], v[232:233]
    v_pk_fma_f32 v[118:119], v[238:239], s[56:57], v[234:235]
    v_cvt_pk_bf16_f32 v116, v116, v117
    v_cvt_pk_bf16_f32 v117, v118, v119
    ds_write_b64 v226, v[116:117] offset:4808
    v_pk_mul_f32 v[112:113], v[112:113], v[250:251] op_sel:[0,0] op_sel_hi:[1,0]
    v_pk_mul_f32 v[114:115], v[114:115], v[250:251] op_sel:[0,0] op_sel_hi:[1,0]
    v_exp_f32_e64 v232, v112 clamp
    v_exp_f32_e64 v233, v113 clamp
    v_exp_f32_e64 v234, v114 clamp
    v_exp_f32_e64 v235, v115 clamp
    v_max_f32 v236, v112, v228
    v_max_f32 v237, v113, v228
    v_max_f32 v238, v114, v228
    v_max_f32 v239, v115, v228
    v_pk_fma_f32 v[112:113], v[236:237], s[56:57], v[232:233]
    v_pk_fma_f32 v[114:115], v[238:239], s[56:57], v[234:235]
    v_cvt_pk_bf16_f32 v112, v112, v113
    v_cvt_pk_bf16_f32 v113, v114, v115
    ds_write_b64 v226, v[112:113] offset:72
    v_pk_mul_f32 v[140:141], v[140:141], v[252:253] op_sel:[0,1] op_sel_hi:[1,1]
    v_pk_mul_f32 v[142:143], v[142:143], v[252:253] op_sel:[0,1] op_sel_hi:[1,1]
    v_exp_f32_e64 v232, v140 clamp
    v_exp_f32_e64 v233, v141 clamp
    v_exp_f32_e64 v234, v142 clamp
    v_exp_f32_e64 v235, v143 clamp
    v_max_f32 v236, v140, v228
    v_max_f32 v237, v141, v228
    v_max_f32 v238, v142, v228
    v_max_f32 v239, v143, v228
    v_pk_fma_f32 v[140:141], v[236:237], s[56:57], v[232:233]
    v_pk_fma_f32 v[142:143], v[238:239], s[56:57], v[234:235]
    v_cvt_pk_bf16_f32 v140, v140, v141
    v_cvt_pk_bf16_f32 v141, v142, v143
    ds_write_b64 v226, v[140:141] offset:14312
    v_pk_mul_f32 v[136:137], v[136:137], v[252:253] op_sel:[0,0] op_sel_hi:[1,0]
    v_pk_mul_f32 v[138:139], v[138:139], v[252:253] op_sel:[0,0] op_sel_hi:[1,0]
    v_exp_f32_e64 v232, v136 clamp
    v_exp_f32_e64 v233, v137 clamp
    v_exp_f32_e64 v234, v138 clamp
    v_exp_f32_e64 v235, v139 clamp
    v_max_f32 v236, v136, v228
    v_max_f32 v237, v137, v228
    v_max_f32 v238, v138, v228
    v_max_f32 v239, v139, v228
    v_pk_fma_f32 v[136:137], v[236:237], s[56:57], v[232:233]
    v_pk_fma_f32 v[138:139], v[238:239], s[56:57], v[234:235]
    v_cvt_pk_bf16_f32 v136, v136, v137
    v_cvt_pk_bf16_f32 v137, v138, v139
    ds_write_b64 v226, v[136:137] offset:9576
    v_pk_mul_f32 v[132:133], v[132:133], v[250:251] op_sel:[0,1] op_sel_hi:[1,1]
    v_pk_mul_f32 v[134:135], v[134:135], v[250:251] op_sel:[0,1] op_sel_hi:[1,1]
    v_exp_f32_e64 v232, v132 clamp
    v_exp_f32_e64 v233, v133 clamp
    v_exp_f32_e64 v234, v134 clamp
    v_exp_f32_e64 v235, v135 clamp
    v_max_f32 v236, v132, v228
    v_max_f32 v237, v133, v228
    v_max_f32 v238, v134, v228
    v_max_f32 v239, v135, v228
    v_pk_fma_f32 v[132:133], v[236:237], s[56:57], v[232:233]
    v_pk_fma_f32 v[134:135], v[238:239], s[56:57], v[234:235]
    v_cvt_pk_bf16_f32 v132, v132, v133
    v_cvt_pk_bf16_f32 v133, v134, v135
    ds_write_b64 v226, v[132:133] offset:4840
    v_pk_mul_f32 v[128:129], v[128:129], v[250:251] op_sel:[0,0] op_sel_hi:[1,0]
    v_pk_mul_f32 v[130:131], v[130:131], v[250:251] op_sel:[0,0] op_sel_hi:[1,0]
    v_exp_f32_e64 v232, v128 clamp
    v_exp_f32_e64 v233, v129 clamp
    v_exp_f32_e64 v234, v130 clamp
    v_exp_f32_e64 v235, v131 clamp
    v_max_f32 v236, v128, v228
    v_max_f32 v237, v129, v228
    v_max_f32 v238, v130, v228
    v_max_f32 v239, v131, v228
    v_pk_fma_f32 v[128:129], v[236:237], s[56:57], v[232:233]
    v_pk_fma_f32 v[130:131], v[238:239], s[56:57], v[234:235]
    v_cvt_pk_bf16_f32 v128, v128, v129
    v_cvt_pk_bf16_f32 v129, v130, v131
    ds_write_b64 v226, v[128:129] offset:104
    v_bfe_u32 v242, v244, 2, 4
    v_mul_u32_u24 v242, 296, v242
    v_and_b32 v254, 3, v244
    s_lshl_b32 s52, s48, 2
    s_lshr_b32 s49, s48, 1
    s_add_u32 s52, s52, s49
    v_cmp_eq_u32 vcc, s48, v254
    v_add_u32 v255, s52, v254
    v_lshl_add_u32 v229, v255, 3, v242
    s_lshl_b32 s52, s52, 3
    s_add_u32 s52, s52, 32
    v_add_u32 v230, s52, v242
    v_add_u32 v255, 144, v242
    v_cndmask_b32 v226, v255, v230, vcc
    v_cmp_eq_u32 s[34:35], s48, v224
    s_waitcnt lgkmcnt(0)
    s_barrier
    ds_read_b64_tr_b16 v[96:97], v229 offset:0
    ds_read_b64_tr_b16 v[98:99], v229 offset:4736
    ds_read_b64_tr_b16 v[100:101], v230 offset:0
    ds_read_b64_tr_b16 v[102:103], v230 offset:4736
    ds_read_b64_tr_b16 v[104:105], v229 offset:144
    ds_read_b64_tr_b16 v[106:107], v229 offset:4880
    ds_read_b64_tr_b16 v[108:109], v226 offset:144
    ds_read_b64_tr_b16 v[110:111], v226 offset:4880
    ds_read_b64_tr_b16 v[112:113], v229 offset:9472
    ds_read_b64_tr_b16 v[114:115], v229 offset:14208
    ds_read_b64_tr_b16 v[116:117], v230 offset:9472
    ds_read_b64_tr_b16 v[118:119], v230 offset:14208
    ds_read_b64_tr_b16 v[120:121], v229 offset:9616
    ds_read_b64_tr_b16 v[122:123], v229 offset:14352
    ds_read_b64_tr_b16 v[124:125], v226 offset:9616
    ds_read_b64_tr_b16 v[126:127], v226 offset:14352
    s_waitcnt lgkmcnt(8)
    v_mfma_f32_16x16x32_bf16 v[80:83], v[96:99], v[104:107], 0
    v_mfma_f32_16x16x32_bf16 v[84:87], v[96:99], v[108:111], 0
    v_mfma_f32_16x16x32_bf16 v[88:91], v[100:103], v[104:107], 0
    v_mfma_f32_16x16x32_bf16 v[92:95], v[100:103], v[108:111], 0
    ds_read_b64_tr_b16 v[128:129], v229 offset:18944
    ds_read_b64_tr_b16 v[130:131], v229 offset:23680
    ds_read_b64_tr_b16 v[132:133], v230 offset:18944
    ds_read_b64_tr_b16 v[134:135], v230 offset:23680
    ds_read_b64_tr_b16 v[136:137], v229 offset:19088
    ds_read_b64_tr_b16 v[138:139], v229 offset:23824
    ds_read_b64_tr_b16 v[140:141], v226 offset:19088
    ds_read_b64_tr_b16 v[142:143], v226 offset:23824
    s_waitcnt lgkmcnt(8)
    v_mfma_f32_16x16x32_bf16 v[80:83], v[112:115], v[120:123], v[80:83]
    v_mfma_f32_16x16x32_bf16 v[84:87], v[112:115], v[124:127], v[84:87]
    v_mfma_f32_16x16x32_bf16 v[88:91], v[116:119], v[120:123], v[88:91]
    v_mfma_f32_16x16x32_bf16 v[92:95], v[116:119], v[124:127], v[92:95]
    ds_read_b64_tr_b16 v[144:145], v229 offset:28416
    ds_read_b64_tr_b16 v[146:147], v229 offset:33152
    ds_read_b64_tr_b16 v[148:149], v230 offset:28416
    ds_read_b64_tr_b16 v[150:151], v230 offset:33152
    ds_read_b64_tr_b16 v[152:153], v229 offset:28560
    ds_read_b64_tr_b16 v[154:155], v229 offset:33296
    ds_read_b64_tr_b16 v[156:157], v226 offset:28560
    ds_read_b64_tr_b16 v[158:159], v226 offset:33296
    s_waitcnt lgkmcnt(8)
    v_mfma_f32_16x16x32_bf16 v[80:83], v[128:131], v[136:139], v[80:83]
    v_mfma_f32_16x16x32_bf16 v[84:87], v[128:131], v[140:143], v[84:87]
    v_mfma_f32_16x16x32_bf16 v[88:91], v[132:135], v[136:139], v[88:91]
    v_mfma_f32_16x16x32_bf16 v[92:95], v[132:135], v[140:143], v[92:95]
    v_add_u32 v229, 37888, v229
    v_add_u32 v230, 37888, v230
    v_add_u32 v226, 37888, v226
    ds_read_b64_tr_b16 v[160:161], v229 offset:0
    ds_read_b64_tr_b16 v[162:163], v229 offset:4736
    ds_read_b64_tr_b16 v[164:165], v230 offset:0
    ds_read_b64_tr_b16 v[166:167], v230 offset:4736
    ds_read_b64_tr_b16 v[168:169], v229 offset:144
    ds_read_b64_tr_b16 v[170:171], v229 offset:4880
    ds_read_b64_tr_b16 v[172:173], v226 offset:144
    ds_read_b64_tr_b16 v[174:175], v226 offset:4880
    s_waitcnt lgkmcnt(8)
    v_mfma_f32_16x16x32_bf16 v[80:83], v[144:147], v[152:155], v[80:83]
    v_mfma_f32_16x16x32_bf16 v[84:87], v[144:147], v[156:159], v[84:87]
    v_mfma_f32_16x16x32_bf16 v[88:91], v[148:151], v[152:155], v[88:91]
    v_mfma_f32_16x16x32_bf16 v[92:95], v[148:151], v[156:159], v[92:95]
    ds_read_b64_tr_b16 v[176:177], v229 offset:9472
    ds_read_b64_tr_b16 v[178:179], v229 offset:14208
    ds_read_b64_tr_b16 v[180:181], v230 offset:9472
    ds_read_b64_tr_b16 v[182:183], v230 offset:14208
    ds_read_b64_tr_b16 v[184:185], v229 offset:9616
    ds_read_b64_tr_b16 v[186:187], v229 offset:14352
    ds_read_b64_tr_b16 v[188:189], v226 offset:9616
    ds_read_b64_tr_b16 v[190:191], v226 offset:14352
    s_waitcnt lgkmcnt(8)
    v_mfma_f32_16x16x32_bf16 v[80:83], v[160:163], v[168:171], v[80:83]
    v_mfma_f32_16x16x32_bf16 v[84:87], v[160:163], v[172:175], v[84:87]
    v_mfma_f32_16x16x32_bf16 v[88:91], v[164:167], v[168:171], v[88:91]
    v_mfma_f32_16x16x32_bf16 v[92:95], v[164:167], v[172:175], v[92:95]
    ds_read_b64_tr_b16 v[192:193], v229 offset:18944
    ds_read_b64_tr_b16 v[194:195], v229 offset:23680
    ds_read_b64_tr_b16 v[196:197], v230 offset:18944
    ds_read_b64_tr_b16 v[198:199], v230 offset:23680
    ds_read_b64_tr_b16 v[200:201], v229 offset:19088
    ds_read_b64_tr_b16 v[202:203], v229 offset:23824
    ds_read_b64_tr_b16 v[204:205], v226 offset:19088
    ds_read_b64_tr_b16 v[206:207], v226 offset:23824
    s_waitcnt lgkmcnt(8)
    v_mfma_f32_16x16x32_bf16 v[80:83], v[176:179], v[184:187], v[80:83]
    v_mfma_f32_16x16x32_bf16 v[84:87], v[176:179], v[188:191], v[84:87]
    v_mfma_f32_16x16x32_bf16 v[88:91], v[180:183], v[184:187], v[88:91]
    v_mfma_f32_16x16x32_bf16 v[92:95], v[180:183], v[188:191], v[92:95]
    ds_read_b64_tr_b16 v[96:97], v229 offset:28416
    ds_read_b64_tr_b16 v[98:99], v229 offset:33152
    ds_read_b64_tr_b16 v[100:101], v230 offset:28416
    ds_read_b64_tr_b16 v[102:103], v230 offset:33152
    ds_read_b64_tr_b16 v[104:105], v229 offset:28560
    ds_read_b64_tr_b16 v[106:107], v229 offset:33296
    ds_read_b64_tr_b16 v[108:109], v226 offset:28560
    ds_read_b64_tr_b16 v[110:111], v226 offset:33296
    s_waitcnt lgkmcnt(8)
    v_mfma_f32_16x16x32_bf16 v[80:83], v[192:195], v[200:203], v[80:83]
    v_mfma_f32_16x16x32_bf16 v[84:87], v[192:195], v[204:207], v[84:87]
    v_mfma_f32_16x16x32_bf16 v[88:91], v[196:199], v[200:203], v[88:91]
    v_mfma_f32_16x16x32_bf16 v[92:95], v[196:199], v[204:207], v[92:95]
    s_waitcnt lgkmcnt(0)
    v_mfma_f32_16x16x32_bf16 v[80:83], v[96:99], v[104:107], v[80:83]
    v_mfma_f32_16x16x32_bf16 v[84:87], v[96:99], v[108:111], v[84:87]
    v_mfma_f32_16x16x32_bf16 v[88:91], v[100:103], v[104:107], v[88:91]
    v_mfma_f32_16x16x32_bf16 v[92:95], v[100:103], v[108:111], v[92:95]
    s_lshl_b32 s52, s51, 5
    s_add_u32 s52, s52, s48
    s_mul_i32 s6, s52, 3072
    s_add_u32 s6, s6, 23855104
    s_mul_i32 s52, s50, 12288
    s_add_u32 s58, s6, s52
    v_lshlrev_b32 v242, 4, v244
    s_lshl_b32 s81, s51, 7
    s_add_u32 s81, s81, 531456
    v_cndmask_b32 v88, v92, v88, s[34:35]
    v_cndmask_b32 v89, v93, v89, s[34:35]
    v_cndmask_b32 v90, v94, v90, s[34:35]
    v_cndmask_b32 v91, v95, v91, s[34:35]
    buffer_store_dwordx4 v[80:83], v242, s[24:27], s58 offen offset:0 sc0 sc1
    buffer_store_dwordx4 v[84:87], v242, s[24:27], s58 offen offset:1024 sc0 sc1
    buffer_store_dwordx4 v[88:91], v242, s[24:27], s58 offen offset:2048 sc0 sc1
    s_waitcnt vmcnt(3)
    v_cmp_eq_u32 vcc, s79, v231
    s_andn2_b32 s61, s71, vcc_lo
    s_cbranch_scc1 Lslow_35
Lback_36:
    s_add_u32 s54, s12, 0
    buffer_load_dwordx4 a[0:3], v222, s[24:27], s54 offen offset:0 sc0 sc1
    v_pk_mul_f32 v[0:1], v[0:1], v[250:251] op_sel:[0,0] op_sel_hi:[1,0]
    v_pk_mul_f32 v[2:3], v[2:3], v[250:251] op_sel:[0,0] op_sel_hi:[1,0]
    v_exp_f32_e64 v232, v0 clamp
    v_exp_f32_e64 v233, v1 clamp
    v_exp_f32_e64 v234, v2 clamp
    v_exp_f32_e64 v235, v3 clamp
    v_max_f32 v236, v0, v228
    v_max_f32 v237, v1, v228
    v_max_f32 v238, v2, v228
    v_max_f32 v239, v3, v228
    v_pk_fma_f32 v[0:1], v[236:237], s[56:57], v[232:233]
    v_pk_fma_f32 v[2:3], v[238:239], s[56:57], v[234:235]
    buffer_load_dwordx4 a[4:7], v222, s[24:27], s54 offen offset:1024 sc0 sc1
    v_pk_mul_f32 v[16:17], v[16:17], v[250:251] op_sel:[0,0] op_sel_hi:[1,0]
    v_pk_mul_f32 v[18:19], v[18:19], v[250:251] op_sel:[0,0] op_sel_hi:[1,0]
    v_exp_f32_e64 v232, v16 clamp
    v_exp_f32_e64 v233, v17 clamp
    v_exp_f32_e64 v234, v18 clamp
    v_exp_f32_e64 v235, v19 clamp
    v_max_f32 v236, v16, v228
    v_max_f32 v237, v17, v228
    v_max_f32 v238, v18, v228
    v_max_f32 v239, v19, v228
    v_pk_fma_f32 v[16:17], v[236:237], s[56:57], v[232:233]
    v_pk_fma_f32 v[18:19], v[238:239], s[56:57], v[234:235]
    buffer_load_dwordx4 a[8:11], v222, s[24:27], s54 offen offset:2048 sc0 sc1
    v_pk_mul_f32 v[32:33], v[32:33], v[250:251] op_sel:[0,0] op_sel_hi:[1,0]
    v_pk_mul_f32 v[34:35], v[34:35], v[250:251] op_sel:[0,0] op_sel_hi:[1,0]
    v_exp_f32_e64 v232, v32 clamp
    v_exp_f32_e64 v233, v33 clamp
    v_exp_f32_e64 v234, v34 clamp
    v_exp_f32_e64 v235, v35 clamp
    v_max_f32 v236, v32, v228
    v_max_f32 v237, v33, v228
    v_max_f32 v238, v34, v228
    v_max_f32 v239, v35, v228
    v_pk_fma_f32 v[32:33], v[236:237], s[56:57], v[232:233]
    v_pk_fma_f32 v[34:35], v[238:239], s[56:57], v[234:235]
    buffer_load_dwordx4 a[12:15], v222, s[24:27], s54 offen offset:3072 sc0 sc1
    v_pk_mul_f32 v[48:49], v[48:49], v[250:251] op_sel:[0,0] op_sel_hi:[1,0]
    v_pk_mul_f32 v[50:51], v[50:51], v[250:251] op_sel:[0,0] op_sel_hi:[1,0]
    v_exp_f32_e64 v232, v48 clamp
    v_exp_f32_e64 v233, v49 clamp
    v_exp_f32_e64 v234, v50 clamp
    v_exp_f32_e64 v235, v51 clamp
    v_max_f32 v236, v48, v228
    v_max_f32 v237, v49, v228
    v_max_f32 v238, v50, v228
    v_max_f32 v239, v51, v228
    v_pk_fma_f32 v[48:49], v[236:237], s[56:57], v[232:233]
    v_pk_fma_f32 v[50:51], v[238:239], s[56:57], v[234:235]
    s_add_u32 s54, s13, 0
    buffer_load_dwordx4 a[16:19], v222, s[24:27], s54 offen offset:0 sc0 sc1
    v_pk_mul_f32 v[64:65], v[64:65], v[250:251] op_sel:[0,0] op_sel_hi:[1,0]
    v_pk_mul_f32 v[66:67], v[66:67], v[250:251] op_sel:[0,0] op_sel_hi:[1,0]
    v_exp_f32_e64 v232, v64 clamp
    v_exp_f32_e64 v233, v65 clamp
    v_exp_f32_e64 v234, v66 clamp
    v_exp_f32_e64 v235, v67 clamp
    v_max_f32 v236, v64, v228
    v_max_f32 v237, v65, v228
    v_max_f32 v238, v66, v228
    v_max_f32 v239, v67, v228
    v_pk_fma_f32 v[64:65], v[236:237], s[56:57], v[232:233]
    v_pk_fma_f32 v[66:67], v[238:239], s[56:57], v[234:235]
    v_cvt_pk_bf16_f32 v104, v0, v1
    v_cvt_pk_bf16_f32 v105, v2, v3
    v_cvt_pk_bf16_f32 v106, v64, v65
    v_cvt_pk_bf16_f32 v107, v66, v67
    buffer_load_dwordx4 a[20:23], v222, s[24:27], s54 offen offset:1024 sc0 sc1
    v_cvt_pk_bf16_f32 v108, v16, v17
    v_cvt_pk_bf16_f32 v109, v18, v19
    v_cvt_pk_bf16_f32 v110, v64, v65
    v_cvt_pk_bf16_f32 v111, v66, v67
    v_cvt_pk_bf16_f32 v112, v32, v33
    v_cvt_pk_bf16_f32 v113, v34, v35
    v_cvt_pk_bf16_f32 v114, v64, v65
    v_cvt_pk_bf16_f32 v115, v66, v67
    buffer_load_dwordx4 a[24:27], v222, s[24:27], s54 offen offset:2048 sc0 sc1
    v_cvt_pk_bf16_f32 v116, v48, v49
    v_cvt_pk_bf16_f32 v117, v50, v51
    v_cvt_pk_bf16_f32 v118, v64, v65
    v_cvt_pk_bf16_f32 v119, v66, v67
    s_and_b32 s52, s48, 1
    s_lshl_b32 s49, s52, 1
    v_cmp_le_u32 s[32:33], s49, v225
    v_lshrrev_b32 v254, 2, v225
    v_cmp_eq_u32 s[16:17], s48, v254
    v_and_b32 v254, 3, v225
    s_add_u32 s49, s49, 2
    v_cmp_gt_u32 vcc, s49, v254
    v_cmp_eq_u32 s[20:21], s48, v254
    s_and_b64 s[10:11], s[16:17], vcc
    v_cmp_le_u32 s[74:75], s52, v224
    s_cmp_eq_u32 s52, 1
    s_cselect_b64 s[76:77], s[34:35], 0
    s_waitcnt vmcnt(7)
    s_barrier
    s_lshl2_add_u32 s49, s50, s81
    buffer_store_dword v248, v246, s[24:27], s49 offen sc0 sc1
    buffer_load_dwordx4 a[28:31], v222, s[24:27], s54 offen offset:3072 sc0 sc1
    v_pk_mul_f32 v[4:5], v[4:5], v[250:251] op_sel:[0,1] op_sel_hi:[1,1]
    v_pk_mul_f32 v[6:7], v[6:7], v[250:251] op_sel:[0,1] op_sel_hi:[1,1]
    v_exp_f32_e64 v232, v4 clamp
    v_exp_f32_e64 v233, v5 clamp
    v_exp_f32_e64 v234, v6 clamp
    v_exp_f32_e64 v235, v7 clamp
    v_max_f32 v236, v4, v228
    v_max_f32 v237, v5, v228
    v_max_f32 v238, v6, v228
    v_max_f32 v239, v7, v228
    v_pk_fma_f32 v[4:5], v[236:237], s[56:57], v[232:233]
    v_pk_fma_f32 v[6:7], v[238:239], s[56:57], v[234:235]
    s_add_u32 s54, s62, 0
    buffer_load_dwordx4 a[32:35], v222, s[24:27], s54 offen offset:0 sc0 sc1
    v_pk_mul_f32 v[20:21], v[20:21], v[250:251] op_sel:[0,1] op_sel_hi:[1,1]
    v_pk_mul_f32 v[22:23], v[22:23], v[250:251] op_sel:[0,1] op_sel_hi:[1,1]
    v_exp_f32_e64 v232, v20 clamp
    v_exp_f32_e64 v233, v21 clamp
    v_exp_f32_e64 v234, v22 clamp
    v_exp_f32_e64 v235, v23 clamp
    v_max_f32 v236, v20, v228
    v_max_f32 v237, v21, v228
    v_max_f32 v238, v22, v228
    v_max_f32 v239, v23, v228
    v_pk_fma_f32 v[20:21], v[236:237], s[56:57], v[232:233]
    v_pk_fma_f32 v[22:23], v[238:239], s[56:57], v[234:235]
    buffer_load_dwordx4 a[36:39], v222, s[24:27], s54 offen offset:1024 sc0 sc1
    v_pk_mul_f32 v[36:37], v[36:37], v[250:251] op_sel:[0,1] op_sel_hi:[1,1]
    v_pk_mul_f32 v[38:39], v[38:39], v[250:251] op_sel:[0,1] op_sel_hi:[1,1]
    v_exp_f32_e64 v232, v36 clamp
    v_exp_f32_e64 v233, v37 clamp
    v_exp_f32_e64 v234, v38 clamp
    v_exp_f32_e64 v235, v39 clamp
    v_max_f32 v236, v36, v228
    v_max_f32 v237, v37, v228
    v_max_f32 v238, v38, v228
    v_max_f32 v239, v39, v228
    v_pk_fma_f32 v[36:37], v[236:237], s[56:57], v[232:233]
    v_pk_fma_f32 v[38:39], v[238:239], s[56:57], v[234:235]
    buffer_load_dwordx4 a[40:43], v222, s[24:27], s54 offen offset:2048 sc0 sc1
    v_pk_mul_f32 v[52:53], v[52:53], v[250:251] op_sel:[0,1] op_sel_hi:[1,1]
    v_pk_mul_f32 v[54:55], v[54:55], v[250:251] op_sel:[0,1] op_sel_hi:[1,1]
    v_exp_f32_e64 v232, v52 clamp
    v_exp_f32_e64 v233, v53 clamp
    v_exp_f32_e64 v234, v54 clamp
    v_exp_f32_e64 v235, v55 clamp
    v_max_f32 v236, v52, v228
    v_max_f32 v237, v53, v228
    v_max_f32 v238, v54, v228
    v_max_f32 v239, v55, v228
    v_pk_fma_f32 v[52:53], v[236:237], s[56:57], v[232:233]
    v_pk_fma_f32 v[54:55], v[238:239], s[56:57], v[234:235]
    buffer_load_dwordx4 a[44:47], v222, s[24:27], s54 offen offset:3072 sc0 sc1
    v_pk_mul_f32 v[68:69], v[68:69], v[250:251] op_sel:[0,1] op_sel_hi:[1,1]
    v_pk_mul_f32 v[70:71], v[70:71], v[250:251] op_sel:[0,1] op_sel_hi:[1,1]
    v_exp_f32_e64 v232, v68 clamp
    v_exp_f32_e64 v233, v69 clamp
    v_exp_f32_e64 v234, v70 clamp
    v_exp_f32_e64 v235, v71 clamp
    v_max_f32 v236, v68, v228
    v_max_f32 v237, v69, v228
    v_max_f32 v238, v70, v228
    v_max_f32 v239, v71, v228
    v_pk_fma_f32 v[68:69], v[236:237], s[56:57], v[232:233]
    v_pk_fma_f32 v[70:71], v[238:239], s[56:57], v[234:235]
    v_cvt_pk_bf16_f32 v120, v4, v5
    v_cvt_pk_bf16_f32 v121, v6, v7
    v_cvt_pk_bf16_f32 v122, v68, v69
    v_cvt_pk_bf16_f32 v123, v70, v71
    s_add_u32 s54, s12, 2359296
    buffer_load_dwordx4 a[48:51], v222, s[24:27], s54 offen offset:0 sc0 sc1
    v_cvt_pk_bf16_f32 v124, v20, v21
    v_cvt_pk_bf16_f32 v125, v22, v23
    v_cvt_pk_bf16_f32 v126, v68, v69
    v_cvt_pk_bf16_f32 v127, v70, v71
    v_cvt_pk_bf16_f32 v128, v36, v37
    v_cvt_pk_bf16_f32 v129, v38, v39
    v_cvt_pk_bf16_f32 v130, v68, v69
    v_cvt_pk_bf16_f32 v131, v70, v71
    buffer_load_dwordx4 a[52:55], v222, s[24:27], s54 offen offset:1024 sc0 sc1
    v_cvt_pk_bf16_f32 v132, v52, v53
    v_cvt_pk_bf16_f32 v133, v54, v55
    v_cvt_pk_bf16_f32 v134, v68, v69
    v_cvt_pk_bf16_f32 v135, v70, v71
    buffer_load_dwordx4 a[56:59], v222, s[24:27], s54 offen offset:2048 sc0 sc1
    v_pk_mul_f32 v[8:9], v[8:9], v[252:253] op_sel:[0,0] op_sel_hi:[1,0]
    v_pk_mul_f32 v[10:11], v[10:11], v[252:253] op_sel:[0,0] op_sel_hi:[1,0]
    v_exp_f32_e64 v232, v8 clamp
    v_exp_f32_e64 v233, v9 clamp
    v_exp_f32_e64 v234, v10 clamp
    v_exp_f32_e64 v235, v11 clamp
    v_max_f32 v236, v8, v228
    v_max_f32 v237, v9, v228
    v_max_f32 v238, v10, v228
    v_max_f32 v239, v11, v228
    v_pk_fma_f32 v[8:9], v[236:237], s[56:57], v[232:233]
    v_pk_fma_f32 v[10:11], v[238:239], s[56:57], v[234:235]
    buffer_load_dwordx4 a[60:63], v222, s[24:27], s54 offen offset:3072 sc0 sc1
    v_pk_mul_f32 v[24:25], v[24:25], v[252:253] op_sel:[0,0] op_sel_hi:[1,0]
    v_pk_mul_f32 v[26:27], v[26:27], v[252:253] op_sel:[0,0] op_sel_hi:[1,0]
    v_exp_f32_e64 v232, v24 clamp
    v_exp_f32_e64 v233, v25 clamp
    v_exp_f32_e64 v234, v26 clamp
    v_exp_f32_e64 v235, v27 clamp
    v_max_f32 v236, v24, v228
    v_max_f32 v237, v25, v228
    v_max_f32 v238, v26, v228
    v_max_f32 v239, v27, v228
    v_pk_fma_f32 v[24:25], v[236:237], s[56:57], v[232:233]
    v_pk_fma_f32 v[26:27], v[238:239], s[56:57], v[234:235]
    s_add_u32 s54, s13, 2359296
    buffer_load_dwordx4 a[64:67], v222, s[24:27], s54 offen offset:0 sc0 sc1
    v_pk_mul_f32 v[40:41], v[40:41], v[252:253] op_sel:[0,0] op_sel_hi:[1,0]
    v_pk_mul_f32 v[42:43], v[42:43], v[252:253] op_sel:[0,0] op_sel_hi:[1,0]
    v_exp_f32_e64 v232, v40 clamp
    v_exp_f32_e64 v233, v41 clamp
    v_exp_f32_e64 v234, v42 clamp
    v_exp_f32_e64 v235, v43 clamp
    v_max_f32 v236, v40, v228
    v_max_f32 v237, v41, v228
    v_max_f32 v238, v42, v228
    v_max_f32 v239, v43, v228
    v_pk_fma_f32 v[40:41], v[236:237], s[56:57], v[232:233]
    v_pk_fma_f32 v[42:43], v[238:239], s[56:57], v[234:235]
    buffer_load_dwordx4 a[68:71], v222, s[24:27], s54 offen offset:1024 sc0 sc1
    v_pk_mul_f32 v[56:57], v[56:57], v[252:253] op_sel:[0,0] op_sel_hi:[1,0]
    v_pk_mul_f32 v[58:59], v[58:59], v[252:253] op_sel:[0,0] op_sel_hi:[1,0]
    v_exp_f32_e64 v232, v56 clamp
    v_exp_f32_e64 v233, v57 clamp
    v_exp_f32_e64 v234, v58 clamp
    v_exp_f32_e64 v235, v59 clamp
    v_max_f32 v236, v56, v228
    v_max_f32 v237, v57, v228
    v_max_f32 v238, v58, v228
    v_max_f32 v239, v59, v228
    v_pk_fma_f32 v[56:57], v[236:237], s[56:57], v[232:233]
    v_pk_fma_f32 v[58:59], v[238:239], s[56:57], v[234:235]
    buffer_load_dwordx4 a[72:75], v222, s[24:27], s54 offen offset:2048 sc0 sc1
    v_pk_mul_f32 v[72:73], v[72:73], v[252:253] op_sel:[0,0] op_sel_hi:[1,0]
    v_pk_mul_f32 v[74:75], v[74:75], v[252:253] op_sel:[0,0] op_sel_hi:[1,0]
    v_exp_f32_e64 v232, v72 clamp
    v_exp_f32_e64 v233, v73 clamp
    v_exp_f32_e64 v234, v74 clamp
    v_exp_f32_e64 v235, v75 clamp
    v_max_f32 v236, v72, v228
    v_max_f32 v237, v73, v228
    v_max_f32 v238, v74, v228
    v_max_f32 v239, v75, v228
    v_pk_fma_f32 v[72:73], v[236:237], s[56:57], v[232:233]
    v_pk_fma_f32 v[74:75], v[238:239], s[56:57], v[234:235]
    v_cvt_pk_bf16_f32 v136, v8, v9
    v_cvt_pk_bf16_f32 v137, v10, v11
    v_cvt_pk_bf16_f32 v138, v72, v73
    v_cvt_pk_bf16_f32 v139, v74, v75
    buffer_load_dwordx4 a[76:79], v222, s[24:27], s54 offen offset:3072 sc0 sc1
    v_cvt_pk_bf16_f32 v140, v24, v25
    v_cvt_pk_bf16_f32 v141, v26, v27
    v_cvt_pk_bf16_f32 v142, v72, v73
    v_cvt_pk_bf16_f32 v143, v74, v75
    v_cvt_pk_bf16_f32 v144, v40, v41
    v_cvt_pk_bf16_f32 v145, v42, v43
    v_cvt_pk_bf16_f32 v146, v72, v73
    v_cvt_pk_bf16_f32 v147, v74, v75
    s_add_u32 m0, s66, 0
    s_add_u32 s55, s3, 0
    buffer_load_dwordx4 v220, s[40:43], s55 offen lds
    v_cvt_pk_bf16_f32 v148, v56, v57
    v_cvt_pk_bf16_f32 v149, v58, v59
    v_cvt_pk_bf16_f32 v150, v72, v73
    v_cvt_pk_bf16_f32 v151, v74, v75
    s_mov_b32 s49, s81
    buffer_load_dword v249, v247, s[24:27], s49 offen sc0 sc1
    s_waitcnt vmcnt(0)
    v_cmp_eq_u32 vcc, s79, v249
    s_andn2_b32 s61, 0xff, vcc_lo
    s_cbranch_scc1 Lslow_38
Lback_39:
    s_add_u32 s58, s6, 0
    buffer_load_dwordx4 v[80:83], v242, s[24:27], s58 offen offset:0 sc0 sc1
    buffer_load_dwordx4 v[84:87], v242, s[24:27], s58 offen offset:1024 sc0 sc1
    buffer_load_dwordx4 v[88:91], v242, s[24:27], s58 offen offset:2048 sc0 sc1
    s_add_u32 s58, s6, 12288
    buffer_load_dwordx4 v[92:95], v242, s[24:27], s58 offen offset:0 sc0 sc1
    buffer_load_dwordx4 v[96:99], v242, s[24:27], s58 offen offset:1024 sc0 sc1
    buffer_load_dwordx4 v[100:103], v242, s[24:27], s58 offen offset:2048 sc0 sc1
    s_add_u32 s58, s6, 24576
    buffer_load_dwordx4 v[168:171], v242, s[24:27], s58 offen offset:0 sc0 sc1
    buffer_load_dwordx4 v[172:175], v242, s[24:27], s58 offen offset:1024 sc0 sc1
    buffer_load_dwordx4 v[176:179], v242, s[24:27], s58 offen offset:2048 sc0 sc1
    s_add_u32 s58, s6, 36864
    buffer_load_dwordx4 v[180:183], v242, s[24:27], s58 offen offset:0 sc0 sc1
    buffer_load_dwordx4 v[184:187], v242, s[24:27], s58 offen offset:1024 sc0 sc1
    buffer_load_dwordx4 v[188:191], v242, s[24:27], s58 offen offset:2048 sc0 sc1
    s_add_u32 s58, s6, 49152
    buffer_load_dwordx4 v[192:195], v242, s[24:27], s58 offen offset:0 sc0 sc1
    buffer_load_dwordx4 v[196:199], v242, s[24:27], s58 offen offset:1024 sc0 sc1
    buffer_load_dwordx4 v[200:203], v242, s[24:27], s58 offen offset:2048 sc0 sc1
    s_add_u32 s58, s6, 61440
    buffer_load_dwordx4 v[204:207], v242, s[24:27], s58 offen offset:0 sc0 sc1
    buffer_load_dwordx4 v[208:211], v242, s[24:27], s58 offen offset:1024 sc0 sc1
    buffer_load_dwordx4 v[212:215], v242, s[24:27], s58 offen offset:2048 sc0 sc1
    s_add_u32 s58, s6, 73728
    buffer_load_dwordx4 v[0:3], v242, s[24:27], s58 offen offset:0 sc0 sc1
    buffer_load_dwordx4 v[4:7], v242, s[24:27], s58 offen offset:1024 sc0 sc1
    buffer_load_dwordx4 v[8:11], v242, s[24:27], s58 offen offset:2048 sc0 sc1
    s_add_u32 s58, s6, 86016
    buffer_load_dwordx4 v[16:19], v242, s[24:27], s58 offen offset:0 sc0 sc1
    buffer_load_dwordx4 v[20:23], v242, s[24:27], s58 offen offset:1024 sc0 sc1
    buffer_load_dwordx4 v[24:27], v242, s[24:27], s58 offen offset:2048 sc0 sc1
    buffer_load_dwordx4 v221, s[40:43], s55 offen offset:1024 lds
    v_pk_mul_f32 v[12:13], v[12:13], v[252:253] op_sel:[0,1] op_sel_hi:[1,1]
    v_pk_mul_f32 v[14:15], v[14:15], v[252:253] op_sel:[0,1] op_sel_hi:[1,1]
    v_exp_f32_e64 v232, v12 clamp
    v_exp_f32_e64 v233, v13 clamp
    v_exp_f32_e64 v234, v14 clamp
    v_exp_f32_e64 v235, v15 clamp
    v_max_f32 v236, v12, v228
    v_max_f32 v237, v13, v228
    v_max_f32 v238, v14, v228
    v_max_f32 v239, v15, v228
    v_pk_fma_f32 v[12:13], v[236:237], s[56:57], v[232:233]
    v_pk_fma_f32 v[14:15], v[238:239], s[56:57], v[234:235]
    s_add_u32 m0, s66, 8192
    s_add_u32 s55, s14, 663552
    buffer_load_dwordx4 v220, s[40:43], s55 offen lds
    v_pk_mul_f32 v[28:29], v[28:29], v[252:253] op_sel:[0,1] op_sel_hi:[1,1]
    v_pk_mul_f32 v[30:31], v[30:31], v[252:253] op_sel:[0,1] op_sel_hi:[1,1]
    v_exp_f32_e64 v232, v28 clamp
    v_exp_f32_e64 v233, v29 clamp
    v_exp_f32_e64 v234, v30 clamp
    v_exp_f32_e64 v235, v31 clamp
    v_max_f32 v236, v28, v228
    v_max_f32 v237, v29, v228
    v_max_f32 v238, v30, v228
    v_max_f32 v239, v31, v228
    v_pk_fma_f32 v[28:29], v[236:237], s[56:57], v[232:233]
    v_pk_fma_f32 v[30:31], v[238:239], s[56:57], v[234:235]
    buffer_load_dwordx4 v221, s[40:43], s55 offen offset:1024 lds
    v_pk_mul_f32 v[44:45], v[44:45], v[252:253] op_sel:[0,1] op_sel_hi:[1,1]
    v_pk_mul_f32 v[46:47], v[46:47], v[252:253] op_sel:[0,1] op_sel_hi:[1,1]
    v_exp_f32_e64 v232, v44 clamp
    v_exp_f32_e64 v233, v45 clamp
    v_exp_f32_e64 v234, v46 clamp
    v_exp_f32_e64 v235, v47 clamp
    v_max_f32 v236, v44, v228
    v_max_f32 v237, v45, v228
    v_max_f32 v238, v46, v228
    v_max_f32 v239, v47, v228
    v_pk_fma_f32 v[44:45], v[236:237], s[56:57], v[232:233]
    v_pk_fma_f32 v[46:47], v[238:239], s[56:57], v[234:235]
    s_add_u32 m0, s66, 16384
    s_add_u32 s55, s3, 128
    buffer_load_dwordx4 v220, s[40:43], s55 offen lds
    v_pk_mul_f32 v[60:61], v[60:61], v[252:253] op_sel:[0,1] op_sel_hi:[1,1]
    v_pk_mul_f32 v[62:63], v[62:63], v[252:253] op_sel:[0,1] op_sel_hi:[1,1]
    v_exp_f32_e64 v232, v60 clamp
    v_exp_f32_e64 v233, v61 clamp
    v_exp_f32_e64 v234, v62 clamp
    v_exp_f32_e64 v235, v63 clamp
    v_max_f32 v236, v60, v228
    v_max_f32 v237, v61, v228
    v_max_f32 v238, v62, v228
    v_max_f32 v239, v63, v228
    v_pk_fma_f32 v[60:61], v[236:237], s[56:57], v[232:233]
    v_pk_fma_f32 v[62:63], v[238:239], s[56:57], v[234:235]
    buffer_load_dwordx4 v221, s[40:43], s55 offen offset:1024 lds
    v_pk_mul_f32 v[76:77], v[76:77], v[252:253] op_sel:[0,1] op_sel_hi:[1,1]
    v_pk_mul_f32 v[78:79], v[78:79], v[252:253] op_sel:[0,1] op_sel_hi:[1,1]
    v_exp_f32_e64 v232, v76 clamp
    v_exp_f32_e64 v233, v77 clamp
    v_exp_f32_e64 v234, v78 clamp
    v_exp_f32_e64 v235, v79 clamp
    v_max_f32 v236, v76, v228
    v_max_f32 v237, v77, v228
    v_max_f32 v238, v78, v228
    v_max_f32 v239, v79, v228
    v_pk_fma_f32 v[76:77], v[236:237], s[56:57], v[232:233]
    v_pk_fma_f32 v[78:79], v[238:239], s[56:57], v[234:235]
    v_cvt_pk_bf16_f32 v152, v12, v13
    v_cvt_pk_bf16_f32 v153, v14, v15
    v_cvt_pk_bf16_f32 v154, v76, v77
    v_cvt_pk_bf16_f32 v155, v78, v79
    s_add_u32 m0, s66, 24576
    s_add_u32 s55, s14, 663680
    buffer_load_dwordx4 v220, s[40:43], s55 offen lds
    v_cvt_pk_bf16_f32 v156, v28, v29
    v_cvt_pk_bf16_f32 v157, v30, v31
    v_cvt_pk_bf16_f32 v158, v76, v77
    v_cvt_pk_bf16_f32 v159, v78, v79
    v_cvt_pk_bf16_f32 v160, v44, v45
    v_cvt_pk_bf16_f32 v161, v46, v47
    v_cvt_pk_bf16_f32 v162, v76, v77
    v_cvt_pk_bf16_f32 v163, v78, v79
    buffer_load_dwordx4 v221, s[40:43], s55 offen offset:1024 lds
    v_cvt_pk_bf16_f32 v164, v60, v61
    v_cvt_pk_bf16_f32 v165, v62, v63
    v_cvt_pk_bf16_f32 v166, v76, v77
    v_cvt_pk_bf16_f32 v167, v78, v79
    s_add_u32 m0, s66, 32768
    s_add_u32 s55, s15, 663808
    buffer_load_dwordx4 v220, s[40:43], s55 offen lds
    buffer_load_dwordx4 v221, s[40:43], s55 offen offset:1024 lds
    s_add_u32 m0, s66, 40960
    s_add_u32 s55, s3, 663808
    buffer_load_dwordx4 v220, s[40:43], s55 offen lds
    buffer_load_dwordx4 v221, s[40:43], s55 offen offset:1024 lds
    s_add_u32 m0, s66, 49152
    s_add_u32 s55, s15, 663552
    buffer_load_dwordx4 v220, s[40:43], s55 offen lds
    buffer_load_dwordx4 v221, s[40:43], s55 offen offset:1024 lds
    s_waitcnt vmcnt(31)
    v_pk_add_f32 v[80:81], v[80:81], v[92:93]
    v_pk_add_f32 v[82:83], v[82:83], v[94:95]
    v_pk_add_f32 v[84:85], v[84:85], v[96:97]
    v_pk_add_f32 v[86:87], v[86:87], v[98:99]
    v_pk_add_f32 v[88:89], v[88:89], v[100:101]
    v_pk_add_f32 v[90:91], v[90:91], v[102:103]
    s_waitcnt vmcnt(28)
    v_pk_add_f32 v[80:81], v[80:81], v[168:169]
    v_pk_add_f32 v[82:83], v[82:83], v[170:171]
    v_pk_add_f32 v[84:85], v[84:85], v[172:173]
    v_pk_add_f32 v[86:87], v[86:87], v[174:175]
    v_pk_add_f32 v[88:89], v[88:89], v[176:177]
    v_pk_add_f32 v[90:91], v[90:91], v[178:179]
    s_waitcnt vmcnt(25)
    v_pk_add_f32 v[80:81], v[80:81], v[180:181]
    v_pk_add_f32 v[82:83], v[82:83], v[182:183]
    v_pk_add_f32 v[84:85], v[84:85], v[184:185]
    v_pk_add_f32 v[86:87], v[86:87], v[186:187]
    v_pk_add_f32 v[88:89], v[88:89], v[188:189]
    v_pk_add_f32 v[90:91], v[90:91], v[190:191]
    s_waitcnt vmcnt(22)
    v_pk_add_f32 v[80:81], v[80:81], v[192:193]
    v_pk_add_f32 v[82:83], v[82:83], v[194:195]
    v_pk_add_f32 v[84:85], v[84:85], v[196:197]
    v_pk_add_f32 v[86:87], v[86:87], v[198:199]
    v_pk_add_f32 v[88:89], v[88:89], v[200:201]
    v_pk_add_f32 v[90:91], v[90:91], v[202:203]
    s_waitcnt vmcnt(19)
    v_pk_add_f32 v[80:81], v[80:81], v[204:205]
    v_pk_add_f32 v[82:83], v[82:83], v[206:207]
    v_pk_add_f32 v[84:85], v[84:85], v[208:209]
    v_pk_add_f32 v[86:87], v[86:87], v[210:211]
    v_pk_add_f32 v[88:89], v[88:89], v[212:213]
    v_pk_add_f32 v[90:91], v[90:91], v[214:215]
    s_waitcnt vmcnt(16)
    v_pk_add_f32 v[80:81], v[80:81], v[0:1]
    v_pk_add_f32 v[82:83], v[82:83], v[2:3]
    v_pk_add_f32 v[84:85], v[84:85], v[4:5]
    v_pk_add_f32 v[86:87], v[86:87], v[6:7]
    v_pk_add_f32 v[88:89], v[88:89], v[8:9]
    v_pk_add_f32 v[90:91], v[90:91], v[10:11]
    s_waitcnt vmcnt(13)
    v_pk_add_f32 v[0:1], v[80:81], v[16:17]
    v_pk_add_f32 v[2:3], v[82:83], v[18:19]
    v_pk_add_f32 v[4:5], v[84:85], v[20:21]
    v_pk_add_f32 v[6:7], v[86:87], v[22:23]
    v_pk_add_f32 v[8:9], v[88:89], v[24:25]
    v_pk_add_f32 v[10:11], v[90:91], v[26:27]
    v_cvt_pk_bf16_f32 v12, v0, v1
    v_cvt_pk_bf16_f32 v13, v2, v3
    v_cvt_pk_bf16_f32 v14, v4, v5
    v_cvt_pk_bf16_f32 v15, v6, v7
    v_cvt_pk_bf16_f32 v16, v8, v9
    v_cvt_pk_bf16_f32 v17, v10, v11
    v_mov_b32 v18, v16
    v_mov_b32 v19, v17
    v_mov_b32 v20, v16
    v_mov_b32 v21, v17
    s_bitcmp1_b32 s48, 0
    s_cselect_b64 vcc, -1, 0
    v_permlane16_swap_b32 v18, v20
    v_permlane16_swap_b32 v19, v21
    v_mov_b32_dpp v22, v14 row_ror:4 row_mask:0xf bank_mask:0xf
    v_mov_b32_dpp v23, v15 row_ror:4 row_mask:0xf bank_mask:0xf
    v_cndmask_b32 v18, v20, v18, vcc
    v_cndmask_b32 v19, v21, v19, vcc
    v_cndmask_b32 v22, v14, v22, s[16:17]
    v_cndmask_b32 v23, v15, v23, s[16:17]
    v_mov_b32_dpp v20, v18 row_ror:4 row_mask:0xf bank_mask:0xf
    v_mov_b32_dpp v21, v19 row_ror:4 row_mask:0xf bank_mask:0xf
    v_cndmask_b32 v20, v18, v20, s[16:17]
    v_cndmask_b32 v21, v19, v21, s[16:17]
    s_and_b64 vcc, s[32:33], s[74:75]
    v_cndmask_b32 v24, 0, v12, vcc
    s_and_b64 vcc, s[32:33], s[32:33]
    v_cndmask_b32 v25, 0, v13, vcc
    s_and_b64 vcc, s[32:33], s[34:35]
    v_cndmask_b32 v26, 0, v16, vcc
    s_and_b64 vcc, s[32:33], s[76:77]
    v_cndmask_b32 v27, 0, v17, vcc
    s_and_b64 vcc, s[10:11], s[74:75]
    v_cndmask_b32 v28, 0, v14, vcc
    s_and_b64 vcc, s[10:11], s[10:11]
    v_cndmask_b32 v29, 0, v15, vcc
    s_and_b64 vcc, s[10:11], s[34:35]
    v_cndmask_b32 v30, 0, v18, vcc
    s_and_b64 vcc, s[10:11], s[76:77]
    v_cndmask_b32 v31, 0, v19, vcc
    s_and_b64 vcc, s[20:21], s[74:75]
    v_cndmask_b32 v32, 0, v22, vcc
    s_and_b64 vcc, s[20:21], s[20:21]
    v_cndmask_b32 v33, 0, v23, vcc
    s_and_b64 vcc, s[20:21], s[34:35]
    v_cndmask_b32 v34, 0, v20, vcc
    s_and_b64 vcc, s[20:21], s[76:77]
    v_cndmask_b32 v35, 0, v21, vcc
    s_mul_i32 s52, s48, 3072
    v_add_u32 v242, 0x25000, v242
    v_add_u32 v243, s52, v242
    ds_write_b128 v243, v[24:27] offset:0
    ds_write_b128 v243, v[28:31] offset:1024
    ds_write_b128 v243, v[32:35] offset:2048
    s_waitcnt lgkmcnt(0)
    s_barrier
    ds_read_b128 v[168:171], v242 offset:0
    ds_read_b128 v[172:175], v242 offset:1024
    ds_read_b128 v[176:179], v242 offset:2048
    ds_read_b128 v[180:183], v242 offset:3072
    ds_read_b128 v[184:187], v242 offset:4096
    ds_read_b128 v[188:191], v242 offset:5120
    ds_read_b128 v[192:195], v242 offset:6144
    ds_read_b128 v[196:199], v242 offset:7168
    ds_read_b128 v[200:203], v242 offset:8192
    ds_read_b128 v[204:207], v242 offset:9216
    ds_read_b128 v[208:211], v242 offset:10240
    ds_read_b128 v[212:215], v242 offset:11264
    s_lshl_b32 s52, s51, 1
    s_add_u32 s52, s52, 144
    s_mul_i32 s58, s52, 131072
    s_add_u32 s58, s58, 2359296
    s_add_u32 s59, s58, 131072
    s_lshr_b32 s52, s51, 1
    s_add_u32 s52, s52, 160
    s_mul_i32 s57, s52, 131072
    s_and_b32 s52, s51, 1
    s_lshl_b32 s52, s52, 3
    s_add_u32 s57, s57, s52
    s_add_u32 s57, s57, 2359296
    s_mov_b32 s56, 0x3fb8aa3b
    v_cmp_eq_u32 s[32:33], 1, v224
    v_cmp_eq_u32 s[34:35], 2, v224
    v_cmp_eq_u32 s[10:11], 3, v224
    s_waitcnt lgkmcnt(0)
    v_mfma_f32_16x16x32_bf16 v[0:3], v[168:171], v[104:107], 0
    v_mfma_f32_16x16x32_bf16 v[16:19], v[172:175], v[104:107], 0
    v_mfma_f32_16x16x32_bf16 v[20:23], v[176:179], v[104:107], 0
    v_mfma_f32_16x16x32_bf16 v[4:7], v[180:183], v[108:111], 0
    v_mfma_f32_16x16x32_bf16 v[16:19], v[184:187], v[108:111], v[16:19]
    v_mfma_f32_16x16x32_bf16 v[20:23], v[188:191], v[108:111], v[20:23]
    v_mfma_f32_16x16x32_bf16 v[8:11], v[192:195], v[112:115], 0
    v_mfma_f32_16x16x32_bf16 v[16:19], v[196:199], v[112:115], v[16:19]
    v_mfma_f32_16x16x32_bf16 v[20:23], v[200:203], v[112:115], v[20:23]
    v_mfma_f32_16x16x32_bf16 v[12:15], v[204:207], v[116:119], 0
    v_mfma_f32_16x16x32_bf16 v[16:19], v[208:211], v[116:119], v[16:19]
    v_mfma_f32_16x16x32_bf16 v[20:23], v[212:215], v[116:119], v[20:23]
    v_mfma_f32_16x16x32_bf16 v[24:27], v[168:171], v[120:123], 0
    v_mfma_f32_16x16x32_bf16 v[40:43], v[172:175], v[120:123], 0
    v_mfma_f32_16x16x32_bf16 v[44:47], v[176:179], v[120:123], 0
    v_mfma_f32_16x16x32_bf16 v[28:31], v[180:183], v[124:127], 0
    v_mfma_f32_16x16x32_bf16 v[40:43], v[184:187], v[124:127], v[40:43]
    v_mfma_f32_16x16x32_bf16 v[44:47], v[188:191], v[124:127], v[44:47]
    v_mfma_f32_16x16x32_bf16 v[32:35], v[192:195], v[128:131], 0
    v_mfma_f32_16x16x32_bf16 v[40:43], v[196:199], v[128:131], v[40:43]
    v_mfma_f32_16x16x32_bf16 v[44:47], v[200:203], v[128:131], v[44:47]
    v_mfma_f32_16x16x32_bf16 v[36:39], v[204:207], v[132:135], 0
    v_mfma_f32_16x16x32_bf16 v[40:43], v[208:211], v[132:135], v[40:43]
    v_mfma_f32_16x16x32_bf16 v[44:47], v[212:215], v[132:135], v[44:47]
    v_mfma_f32_16x16x32_bf16 v[48:51], v[168:171], v[136:139], 0
    v_mfma_f32_16x16x32_bf16 v[64:67], v[172:175], v[136:139], 0
    v_mfma_f32_16x16x32_bf16 v[68:71], v[176:179], v[136:139], 0
    v_mfma_f32_16x16x32_bf16 v[52:55], v[180:183], v[140:143], 0
    v_mfma_f32_16x16x32_bf16 v[64:67], v[184:187], v[140:143], v[64:67]
    v_mfma_f32_16x16x32_bf16 v[68:71], v[188:191], v[140:143], v[68:71]
    v_mfma_f32_16x16x32_bf16 v[56:59], v[192:195], v[144:147], 0
    v_mfma_f32_16x16x32_bf16 v[64:67], v[196:199], v[144:147], v[64:67]
    v_mfma_f32_16x16x32_bf16 v[68:71], v[200:203], v[144:147], v[68:71]
    v_mfma_f32_16x16x32_bf16 v[60:63], v[204:207], v[148:151], 0
    v_mfma_f32_16x16x32_bf16 v[64:67], v[208:211], v[148:151], v[64:67]
    v_mfma_f32_16x16x32_bf16 v[68:71], v[212:215], v[148:151], v[68:71]
    v_mfma_f32_16x16x32_bf16 v[72:75], v[168:171], v[152:155], 0
    v_mfma_f32_16x16x32_bf16 v[88:91], v[172:175], v[152:155], 0
    v_mfma_f32_16x16x32_bf16 v[92:95], v[176:179], v[152:155], 0
    v_mfma_f32_16x16x32_bf16 v[76:79], v[180:183], v[156:159], 0
    v_mfma_f32_16x16x32_bf16 v[88:91], v[184:187], v[156:159], v[88:91]
    v_mfma_f32_16x16x32_bf16 v[92:95], v[188:191], v[156:159], v[92:95]
    v_mfma_f32_16x16x32_bf16 v[80:83], v[192:195], v[160:163], 0
    v_mfma_f32_16x16x32_bf16 v[88:91], v[196:199], v[160:163], v[88:91]
    v_mfma_f32_16x16x32_bf16 v[92:95], v[200:203], v[160:163], v[92:95]
    v_mfma_f32_16x16x32_bf16 v[84:87], v[204:207], v[164:167], 0
    v_mfma_f32_16x16x32_bf16 v[88:91], v[208:211], v[164:167], v[88:91]
    v_mfma_f32_16x16x32_bf16 v[92:95], v[212:215], v[164:167], v[92:95]
    s_nop 7
    v_fma_f32 v20, v20, s56, v228
    v_fma_f32 v21, v21, s56, v228
    v_fma_f32 v22, v22, s56, v228
    v_fma_f32 v23, v23, s56, v228
    v_rcp_f32 v20, v20
    v_rcp_f32 v21, v21
    v_rcp_f32 v22, v22
    v_rcp_f32 v23, v23
    s_nop 0
    v_cndmask_b32 v240, v20, v21, s[32:33]
    v_cndmask_b32 v240, v240, v22, s[34:35]
    v_cndmask_b32 v240, v240, v23, s[10:11]
    v_pk_mul_f32 v[0:1], v[0:1], v[20:21] op_sel:[0,0] op_sel_hi:[1,0]
    v_pk_mul_f32 v[2:3], v[2:3], v[20:21] op_sel:[0,0] op_sel_hi:[1,0]
    v_pk_mul_f32 v[4:5], v[4:5], v[20:21] op_sel:[0,1] op_sel_hi:[1,1]
    v_pk_mul_f32 v[6:7], v[6:7], v[20:21] op_sel:[0,1] op_sel_hi:[1,1]
    v_pk_mul_f32 v[8:9], v[8:9], v[22:23] op_sel:[0,0] op_sel_hi:[1,0]
    v_pk_mul_f32 v[10:11], v[10:11], v[22:23] op_sel:[0,0] op_sel_hi:[1,0]
    v_pk_mul_f32 v[12:13], v[12:13], v[22:23] op_sel:[0,1] op_sel_hi:[1,1]
    v_pk_mul_f32 v[14:15], v[14:15], v[22:23] op_sel:[0,1] op_sel_hi:[1,1]
    v_pk_mul_f32 v[16:17], v[16:17], v[240:241] op_sel_hi:[1,0]
    v_pk_mul_f32 v[18:19], v[18:19], v[240:241] op_sel_hi:[1,0]
    v_cvt_pk_bf16_f32 v0, v0, v1
    v_cvt_pk_bf16_f32 v1, v2, v3
    v_cvt_pk_bf16_f32 v2, v4, v5
    v_cvt_pk_bf16_f32 v3, v6, v7
    v_cvt_pk_bf16_f32 v4, v8, v9
    v_cvt_pk_bf16_f32 v5, v10, v11
    v_cvt_pk_bf16_f32 v6, v12, v13
    v_cvt_pk_bf16_f32 v7, v14, v15
    v_cvt_pk_bf16_f32 v8, v16, v17
    v_cvt_pk_bf16_f32 v9, v18, v19
    buffer_store_dwordx4 v[0:3], v245, s[24:27], s58 offen offset:0 sc0 sc1
    buffer_store_dwordx4 v[4:7], v245, s[24:27], s59 offen offset:0 sc0 sc1
    buffer_store_dwordx2 v[8:9], v245, s[24:27], s57 offen offset:0 sc0 sc1
    v_fma_f32 v44, v44, s56, v228
    v_fma_f32 v45, v45, s56, v228
    v_fma_f32 v46, v46, s56, v228
    v_fma_f32 v47, v47, s56, v228
    v_rcp_f32 v44, v44
    v_rcp_f32 v45, v45
    v_rcp_f32 v46, v46
    v_rcp_f32 v47, v47
    s_nop 0
    v_cndmask_b32 v240, v44, v45, s[32:33]
    v_cndmask_b32 v240, v240, v46, s[34:35]
    v_cndmask_b32 v240, v240, v47, s[10:11]
    v_pk_mul_f32 v[24:25], v[24:25], v[44:45] op_sel:[0,0] op_sel_hi:[1,0]
    v_pk_mul_f32 v[26:27], v[26:27], v[44:45] op_sel:[0,0] op_sel_hi:[1,0]
    v_pk_mul_f32 v[28:29], v[28:29], v[44:45] op_sel:[0,1] op_sel_hi:[1,1]
    v_pk_mul_f32 v[30:31], v[30:31], v[44:45] op_sel:[0,1] op_sel_hi:[1,1]
    v_pk_mul_f32 v[32:33], v[32:33], v[46:47] op_sel:[0,0] op_sel_hi:[1,0]
    v_pk_mul_f32 v[34:35], v[34:35], v[46:47] op_sel:[0,0] op_sel_hi:[1,0]
    v_pk_mul_f32 v[36:37], v[36:37], v[46:47] op_sel:[0,1] op_sel_hi:[1,1]
    v_pk_mul_f32 v[38:39], v[38:39], v[46:47] op_sel:[0,1] op_sel_hi:[1,1]
    v_pk_mul_f32 v[40:41], v[40:41], v[240:241] op_sel_hi:[1,0]
    v_pk_mul_f32 v[42:43], v[42:43], v[240:241] op_sel_hi:[1,0]
    v_cvt_pk_bf16_f32 v24, v24, v25
    v_cvt_pk_bf16_f32 v25, v26, v27
    v_cvt_pk_bf16_f32 v26, v28, v29
    v_cvt_pk_bf16_f32 v27, v30, v31
    v_cvt_pk_bf16_f32 v28, v32, v33
    v_cvt_pk_bf16_f32 v29, v34, v35
    v_cvt_pk_bf16_f32 v30, v36, v37
    v_cvt_pk_bf16_f32 v31, v38, v39
    v_cvt_pk_bf16_f32 v32, v40, v41
    v_cvt_pk_bf16_f32 v33, v42, v43
    buffer_store_dwordx4 v[24:27], v245, s[24:27], s58 offen offset:1024 sc0 sc1
    buffer_store_dwordx4 v[28:31], v245, s[24:27], s59 offen offset:1024 sc0 sc1
    buffer_store_dwordx2 v[32:33], v245, s[24:27], s57 offen offset:1024 sc0 sc1
    v_fma_f32 v68, v68, s56, v228
    v_fma_f32 v69, v69, s56, v228
    v_fma_f32 v70, v70, s56, v228
    v_fma_f32 v71, v71, s56, v228
    v_rcp_f32 v68, v68
    v_rcp_f32 v69, v69
    v_rcp_f32 v70, v70
    v_rcp_f32 v71, v71
    s_nop 0
    v_cndmask_b32 v240, v68, v69, s[32:33]
    v_cndmask_b32 v240, v240, v70, s[34:35]
    v_cndmask_b32 v240, v240, v71, s[10:11]
    v_pk_mul_f32 v[48:49], v[48:49], v[68:69] op_sel:[0,0] op_sel_hi:[1,0]
    v_pk_mul_f32 v[50:51], v[50:51], v[68:69] op_sel:[0,0] op_sel_hi:[1,0]
    v_pk_mul_f32 v[52:53], v[52:53], v[68:69] op_sel:[0,1] op_sel_hi:[1,1]
    v_pk_mul_f32 v[54:55], v[54:55], v[68:69] op_sel:[0,1] op_sel_hi:[1,1]
    v_pk_mul_f32 v[56:57], v[56:57], v[70:71] op_sel:[0,0] op_sel_hi:[1,0]
    v_pk_mul_f32 v[58:59], v[58:59], v[70:71] op_sel:[0,0] op_sel_hi:[1,0]
    v_pk_mul_f32 v[60:61], v[60:61], v[70:71] op_sel:[0,1] op_sel_hi:[1,1]
    v_pk_mul_f32 v[62:63], v[62:63], v[70:71] op_sel:[0,1] op_sel_hi:[1,1]
    v_pk_mul_f32 v[64:65], v[64:65], v[240:241] op_sel_hi:[1,0]
    v_pk_mul_f32 v[66:67], v[66:67], v[240:241] op_sel_hi:[1,0]
    v_cvt_pk_bf16_f32 v48, v48, v49
    v_cvt_pk_bf16_f32 v49, v50, v51
    v_cvt_pk_bf16_f32 v50, v52, v53
    v_cvt_pk_bf16_f32 v51, v54, v55
    v_cvt_pk_bf16_f32 v52, v56, v57
    v_cvt_pk_bf16_f32 v53, v58, v59
    v_cvt_pk_bf16_f32 v54, v60, v61
    v_cvt_pk_bf16_f32 v55, v62, v63
    v_cvt_pk_bf16_f32 v56, v64, v65
    v_cvt_pk_bf16_f32 v57, v66, v67
    buffer_store_dwordx4 v[48:51], v245, s[24:27], s58 offen offset:2048 sc0 sc1
    buffer_store_dwordx4 v[52:55], v245, s[24:27], s59 offen offset:2048 sc0 sc1
    buffer_store_dwordx2 v[56:57], v245, s[24:27], s57 offen offset:2048 sc0 sc1
    v_fma_f32 v92, v92, s56, v228
    v_fma_f32 v93, v93, s56, v228
    v_fma_f32 v94, v94, s56, v228
    v_fma_f32 v95, v95, s56, v228
    v_rcp_f32 v92, v92
    v_rcp_f32 v93, v93
    v_rcp_f32 v94, v94
    v_rcp_f32 v95, v95
    s_nop 0
    v_cndmask_b32 v240, v92, v93, s[32:33]
    v_cndmask_b32 v240, v240, v94, s[34:35]
    v_cndmask_b32 v240, v240, v95, s[10:11]
    v_pk_mul_f32 v[72:73], v[72:73], v[92:93] op_sel:[0,0] op_sel_hi:[1,0]
    v_pk_mul_f32 v[74:75], v[74:75], v[92:93] op_sel:[0,0] op_sel_hi:[1,0]
    v_pk_mul_f32 v[76:77], v[76:77], v[92:93] op_sel:[0,1] op_sel_hi:[1,1]
    v_pk_mul_f32 v[78:79], v[78:79], v[92:93] op_sel:[0,1] op_sel_hi:[1,1]
    v_pk_mul_f32 v[80:81], v[80:81], v[94:95] op_sel:[0,0] op_sel_hi:[1,0]
    v_pk_mul_f32 v[82:83], v[82:83], v[94:95] op_sel:[0,0] op_sel_hi:[1,0]
    v_pk_mul_f32 v[84:85], v[84:85], v[94:95] op_sel:[0,1] op_sel_hi:[1,1]
    v_pk_mul_f32 v[86:87], v[86:87], v[94:95] op_sel:[0,1] op_sel_hi:[1,1]
    v_pk_mul_f32 v[88:89], v[88:89], v[240:241] op_sel_hi:[1,0]
    v_pk_mul_f32 v[90:91], v[90:91], v[240:241] op_sel_hi:[1,0]
    v_cvt_pk_bf16_f32 v72, v72, v73
    v_cvt_pk_bf16_f32 v73, v74, v75
    v_cvt_pk_bf16_f32 v74, v76, v77
    v_cvt_pk_bf16_f32 v75, v78, v79
    v_cvt_pk_bf16_f32 v76, v80, v81
    v_cvt_pk_bf16_f32 v77, v82, v83
    v_cvt_pk_bf16_f32 v78, v84, v85
    v_cvt_pk_bf16_f32 v79, v86, v87
    v_cvt_pk_bf16_f32 v80, v88, v89
    v_cvt_pk_bf16_f32 v81, v90, v91
    buffer_store_dwordx4 v[72:75], v245, s[24:27], s58 offen offset:3072 sc0 sc1
    buffer_store_dwordx4 v[76:79], v245, s[24:27], s59 offen offset:3072 sc0 sc1
    buffer_store_dwordx2 v[80:81], v245, s[24:27], s57 offen offset:3072 sc0 sc1
    v_mov_b32 v174, v244
    v_mov_b32 v175, v245
    v_mov_b32 v216, v246
    v_mov_b32 v217, v247
    v_mov_b32 v218, v248
    s_and_b32 s49, s48, 1
    s_lshl_b32 s49, s49, 4
    v_lshrrev_b32 v176, 3, v174
    v_add3_u32 v176, s49, v176, 0
    v_lshrrev_b32 v177, 4, v176
    v_mul_u32_u24 v177, 72, v177
    v_bfe_u32 v178, v176, 2, 2
    v_lshl_add_u32 v177, v178, 4, v177
    v_lshrrev_b32 v178, 1, v178
    v_lshl_add_u32 v177, v178, 2, v177
    v_and_b32 v178, 3, v176
    v_add3_u32 v177, v177, v178, 16
    v_sub_u32 v177, v177, v176
    v_mul_u32_u24 v177, 1152, v177
    v_add_u32 v197, v220, v177
    s_and_b32 s49, s48, 1
    s_lshl_b32 s49, s49, 4
    v_lshrrev_b32 v176, 3, v174
    v_add3_u32 v176, s49, v176, 8
    v_lshrrev_b32 v177, 4, v176
    v_mul_u32_u24 v177, 72, v177
    v_bfe_u32 v178, v176, 2, 2
    v_lshl_add_u32 v177, v178, 4, v177
    v_lshrrev_b32 v178, 1, v178
    v_lshl_add_u32 v177, v178, 2, v177
    v_and_b32 v178, 3, v176
    v_add3_u32 v177, v177, v178, 16
    v_sub_u32 v177, v177, v176
    v_mul_u32_u24 v177, 1152, v177
    v_add_u32 v198, v221, v177
    v_lshrrev_b32 v176, 4, v174
    v_bfe_u32 v177, v174, 2, 3
    v_and_b32 v178, 3, v174
    v_lshrrev_b32 v176, 1, v176
    v_lshlrev_b32 v176, 10, v176
    v_lshl_add_u32 v176, v177, 7, v176
    v_lshl_add_u32 v176, v178, 3, v176
    v_lshrrev_b32 v177, 1, v177
    v_xor_b32 v178, 0, v177
    v_lshl_add_u32 v160, v178, 5, v176
    v_add_u32 v164, 0x10000, v160
    v_add_u32 v168, 0x20000, v160
    v_xor_b32 v178, 1, v177
    v_lshl_add_u32 v161, v178, 5, v176
    v_add_u32 v165, 0x10000, v161
    v_add_u32 v169, 0x20000, v161
    v_xor_b32 v178, 2, v177
    v_lshl_add_u32 v162, v178, 5, v176
    v_add_u32 v166, 0x10000, v162
    v_add_u32 v170, 0x20000, v162
    v_xor_b32 v178, 3, v177
    v_lshl_add_u32 v163, v178, 5, v176
    v_add_u32 v167, 0x10000, v163
    v_add_u32 v171, 0x20000, v163
    s_mul_i32 s56, s70, 4128
    s_lshl_b32 s81, s51, 7
    s_add_u32 s81, s81, s80
    s_mov_b32 s52, s50
    s_mov_b32 s50, s51
    s_mov_b32 s51, s52
    s_cmp_lt_u32 s51, 6
    s_cbranch_scc1 Lp2a_41
    s_waitcnt vmcnt(0)
    s_barrier
    s_add_u32 s49, s81, 24576
    buffer_store_dword v218, v216, s[24:27], s49 offen sc0 sc1
    s_branch L_final
Lp2a_41:
    s_barrier
    v_xor_b32 v164, s56, v164
    ds_read_b64_tr_b16 v[128:129], v164 offset:16384
    ds_read_b64_tr_b16 v[130:131], v164 offset:18432
    ds_read_b64_tr_b16 v[132:133], v164 offset:24576
    ds_read_b64_tr_b16 v[134:135], v164 offset:26624
    v_xor_b32 v165, s56, v165
    ds_read_b64_tr_b16 v[136:137], v165 offset:16384
    ds_read_b64_tr_b16 v[138:139], v165 offset:18432
    ds_read_b64_tr_b16 v[140:141], v165 offset:24576
    ds_read_b64_tr_b16 v[142:143], v165 offset:26624
    s_waitcnt lgkmcnt(4)
    v_mfma_f32_16x16x32_bf16 v[0:3], v[128:131], a[0:3], 0
    s_add_u32 s54, s62, 2359296
    v_xor_b32 v166, s56, v166
    v_mfma_f32_16x16x32_bf16 v[0:3], v[132:135], a[16:19], v[0:3]
    ds_read_b64_tr_b16 v[144:145], v166 offset:16384
    v_mfma_f32_16x16x32_bf16 v[4:7], v[128:131], a[4:7], 0
    ds_read_b64_tr_b16 v[146:147], v166 offset:18432
    v_mfma_f32_16x16x32_bf16 v[4:7], v[132:135], a[20:23], v[4:7]
    buffer_load_dwordx4 a[80:83], v222, s[24:27], s54 offen offset:0 sc0 sc1
    v_mfma_f32_16x16x32_bf16 v[8:11], v[128:131], a[8:11], 0
    ds_read_b64_tr_b16 v[148:149], v166 offset:24576
    v_mfma_f32_16x16x32_bf16 v[8:11], v[132:135], a[24:27], v[8:11]
    buffer_load_dwordx4 a[84:87], v222, s[24:27], s54 offen offset:1024 sc0 sc1
    v_mfma_f32_16x16x32_bf16 v[12:15], v[128:131], a[12:15], 0
    ds_read_b64_tr_b16 v[150:151], v166 offset:26624
    v_mfma_f32_16x16x32_bf16 v[12:15], v[132:135], a[28:31], v[12:15]
    s_waitcnt lgkmcnt(4)
    v_mfma_f32_16x16x32_bf16 a[160:163], v[136:139], a[0:3], 0
    v_xor_b32 v167, s56, v167
    v_mfma_f32_16x16x32_bf16 a[160:163], v[140:143], a[16:19], a[160:163]
    ds_read_b64_tr_b16 v[152:153], v167 offset:16384
    v_mfma_f32_16x16x32_bf16 a[164:167], v[136:139], a[4:7], 0
    ds_read_b64_tr_b16 v[154:155], v167 offset:18432
    v_mfma_f32_16x16x32_bf16 a[164:167], v[140:143], a[20:23], a[164:167]
    buffer_load_dwordx4 a[88:91], v222, s[24:27], s54 offen offset:2048 sc0 sc1
    v_mfma_f32_16x16x32_bf16 a[168:171], v[136:139], a[8:11], 0
    ds_read_b64_tr_b16 v[156:157], v167 offset:24576
    v_mfma_f32_16x16x32_bf16 a[168:171], v[140:143], a[24:27], a[168:171]
    buffer_load_dwordx4 a[92:95], v222, s[24:27], s54 offen offset:3072 sc0 sc1
    v_mfma_f32_16x16x32_bf16 a[172:175], v[136:139], a[12:15], 0
    s_add_u32 m0, s66, 57344
    ds_read_b64_tr_b16 v[158:159], v167 offset:26624
    s_add_u32 s55, s3, 663552
    v_mfma_f32_16x16x32_bf16 a[172:175], v[140:143], a[28:31], a[172:175]
    s_waitcnt lgkmcnt(4)
    v_mfma_f32_16x16x32_bf16 v[16:19], v[144:147], a[0:3], 0
    ds_read_b64_tr_b16 v[128:129], v164 offset:32768
    v_mfma_f32_16x16x32_bf16 v[16:19], v[148:151], a[16:19], v[16:19]
    buffer_load_dwordx4 v220, s[40:43], s55 offen lds
    v_mfma_f32_16x16x32_bf16 v[20:23], v[144:147], a[4:7], 0
    ds_read_b64_tr_b16 v[130:131], v164 offset:34816
    v_mfma_f32_16x16x32_bf16 v[20:23], v[148:151], a[20:23], v[20:23]
    v_mfma_f32_16x16x32_bf16 v[24:27], v[144:147], a[8:11], 0
    ds_read_b64_tr_b16 v[132:133], v164 offset:40960
    v_mfma_f32_16x16x32_bf16 v[24:27], v[148:151], a[24:27], v[24:27]
    buffer_load_dwordx4 v221, s[40:43], s55 offen offset:1024 lds
    v_mfma_f32_16x16x32_bf16 v[28:31], v[144:147], a[12:15], 0
    s_add_u32 m0, s66, 65536
    ds_read_b64_tr_b16 v[134:135], v164 offset:43008
    s_add_u32 s55, s15, 663680
    v_mfma_f32_16x16x32_bf16 v[28:31], v[148:151], a[28:31], v[28:31]
    s_waitcnt lgkmcnt(4)
    v_mfma_f32_16x16x32_bf16 a[176:179], v[152:155], a[0:3], 0
    ds_read_b64_tr_b16 v[136:137], v165 offset:32768
    v_mfma_f32_16x16x32_bf16 a[176:179], v[156:159], a[16:19], a[176:179]
    v_mfma_f32_16x16x32_bf16 a[180:183], v[152:155], a[4:7], 0
    ds_read_b64_tr_b16 v[138:139], v165 offset:34816
    v_mfma_f32_16x16x32_bf16 a[180:183], v[156:159], a[20:23], a[180:183]
    v_mfma_f32_16x16x32_bf16 a[184:187], v[152:155], a[8:11], 0
    s_barrier
    v_mfma_f32_16x16x32_bf16 a[184:187], v[156:159], a[24:27], a[184:187]
    ds_read_b64_tr_b16 v[140:141], v165 offset:40960
    v_mfma_f32_16x16x32_bf16 a[188:191], v[152:155], a[12:15], 0
    ds_read_b64_tr_b16 v[142:143], v165 offset:43008
    v_mfma_f32_16x16x32_bf16 a[188:191], v[156:159], a[28:31], a[188:191]
    s_waitcnt lgkmcnt(4)
    buffer_load_dwordx4 v220, s[40:43], s55 offen lds
    v_mfma_f32_16x16x32_bf16 v[32:35], v[128:131], a[0:3], 0
    ds_read_b64_tr_b16 v[144:145], v166 offset:32768
    v_mfma_f32_16x16x32_bf16 v[32:35], v[132:135], a[16:19], v[32:35]
    buffer_load_dwordx4 v221, s[40:43], s55 offen offset:1024 lds
    v_mfma_f32_16x16x32_bf16 v[36:39], v[128:131], a[4:7], 0
    s_add_u32 m0, s66, 73728
    ds_read_b64_tr_b16 v[146:147], v166 offset:34816
    s_add_u32 s55, s3, 663680
    v_mfma_f32_16x16x32_bf16 v[36:39], v[132:135], a[20:23], v[36:39]
    v_mfma_f32_16x16x32_bf16 v[40:43], v[128:131], a[8:11], 0
    ds_read_b64_tr_b16 v[148:149], v166 offset:40960
    v_mfma_f32_16x16x32_bf16 v[40:43], v[132:135], a[24:27], v[40:43]
    buffer_load_dwordx4 v220, s[40:43], s55 offen lds
    v_mfma_f32_16x16x32_bf16 v[44:47], v[128:131], a[12:15], 0
    ds_read_b64_tr_b16 v[150:151], v166 offset:43008
    v_mfma_f32_16x16x32_bf16 v[44:47], v[132:135], a[28:31], v[44:47]
    s_waitcnt lgkmcnt(4)
    v_mfma_f32_16x16x32_bf16 a[192:195], v[136:139], a[0:3], 0
    ds_read_b64_tr_b16 v[152:153], v167 offset:32768
    v_mfma_f32_16x16x32_bf16 a[192:195], v[140:143], a[16:19], a[192:195]
    buffer_load_dwordx4 v221, s[40:43], s55 offen offset:1024 lds
    v_mfma_f32_16x16x32_bf16 a[196:199], v[136:139], a[4:7], 0
    s_add_u32 s54, s12, 4718592
    ds_read_b64_tr_b16 v[154:155], v167 offset:34816
    v_mfma_f32_16x16x32_bf16 a[196:199], v[140:143], a[20:23], a[196:199]
    v_mfma_f32_16x16x32_bf16 a[200:203], v[136:139], a[8:11], 0
    ds_read_b64_tr_b16 v[156:157], v167 offset:40960
    v_mfma_f32_16x16x32_bf16 a[200:203], v[140:143], a[24:27], a[200:203]
    buffer_load_dwordx4 a[96:99], v222, s[24:27], s54 offen offset:0 sc0 sc1
    v_mfma_f32_16x16x32_bf16 a[204:207], v[136:139], a[12:15], 0
    ds_read_b64_tr_b16 v[158:159], v167 offset:43008
    v_mfma_f32_16x16x32_bf16 a[204:207], v[140:143], a[28:31], a[204:207]
    s_waitcnt lgkmcnt(4)
    v_mfma_f32_16x16x32_bf16 v[48:51], v[144:147], a[0:3], 0
    ds_read_b64_tr_b16 v[128:129], v164 offset:49152
    v_mfma_f32_16x16x32_bf16 v[48:51], v[148:151], a[16:19], v[48:51]
    buffer_load_dwordx4 a[100:103], v222, s[24:27], s54 offen offset:1024 sc0 sc1
    v_mfma_f32_16x16x32_bf16 v[52:55], v[144:147], a[4:7], 0
    ds_read_b64_tr_b16 v[130:131], v164 offset:51200
    v_mfma_f32_16x16x32_bf16 v[52:55], v[148:151], a[20:23], v[52:55]
    v_mfma_f32_16x16x32_bf16 v[56:59], v[144:147], a[8:11], 0
    ds_read_b64_tr_b16 v[132:133], v164 offset:57344
    v_mfma_f32_16x16x32_bf16 v[56:59], v[148:151], a[24:27], v[56:59]
    v_mfma_f32_16x16x32_bf16 v[60:63], v[144:147], a[12:15], 0
    ds_read_b64_tr_b16 v[134:135], v164 offset:59392
    v_mfma_f32_16x16x32_bf16 v[60:63], v[148:151], a[28:31], v[60:63]
    s_waitcnt lgkmcnt(4)
    v_mfma_f32_16x16x32_bf16 a[208:211], v[152:155], a[0:3], 0
    ds_read_b64_tr_b16 v[136:137], v165 offset:49152
    v_mfma_f32_16x16x32_bf16 a[208:211], v[156:159], a[16:19], a[208:211]
    buffer_load_dwordx4 a[104:107], v222, s[24:27], s54 offen offset:2048 sc0 sc1
    v_mfma_f32_16x16x32_bf16 a[212:215], v[152:155], a[4:7], 0
    ds_read_b64_tr_b16 v[138:139], v165 offset:51200
    v_mfma_f32_16x16x32_bf16 a[212:215], v[156:159], a[20:23], a[212:215]
    v_mfma_f32_16x16x32_bf16 a[216:219], v[152:155], a[8:11], 0
    ds_read_b64_tr_b16 v[140:141], v165 offset:57344
    v_mfma_f32_16x16x32_bf16 a[216:219], v[156:159], a[24:27], a[216:219]
    buffer_load_dwordx4 a[108:111], v222, s[24:27], s54 offen offset:3072 sc0 sc1
    v_mfma_f32_16x16x32_bf16 a[220:223], v[152:155], a[12:15], 0
    s_add_u32 m0, s66, 147456
    ds_read_b64_tr_b16 v[142:143], v165 offset:59392
    s_add_u32 s55, s14, 1327360
    v_mfma_f32_16x16x32_bf16 a[220:223], v[156:159], a[28:31], a[220:223]
    s_waitcnt lgkmcnt(4)
    v_mfma_f32_16x16x32_bf16 v[224:227], v[128:131], a[0:3], 0
    ds_read_b64_tr_b16 v[144:145], v166 offset:49152
    v_mfma_f32_16x16x32_bf16 v[224:227], v[132:135], a[16:19], v[224:227]
    buffer_load_dwordx4 v220, s[40:43], s55 offen lds
    v_mfma_f32_16x16x32_bf16 v[228:231], v[128:131], a[4:7], 0
    ds_read_b64_tr_b16 v[146:147], v166 offset:51200
    v_mfma_f32_16x16x32_bf16 v[228:231], v[132:135], a[20:23], v[228:231]
    v_mfma_f32_16x16x32_bf16 v[232:235], v[128:131], a[8:11], 0
    ds_read_b64_tr_b16 v[148:149], v166 offset:57344
    v_mfma_f32_16x16x32_bf16 v[232:235], v[132:135], a[24:27], v[232:235]
    buffer_load_dwordx4 v221, s[40:43], s55 offen offset:1024 lds
    v_mfma_f32_16x16x32_bf16 v[236:239], v[128:131], a[12:15], 0
    s_add_u32 s54, s13, 4718592
    ds_read_b64_tr_b16 v[150:151], v166 offset:59392
    v_mfma_f32_16x16x32_bf16 v[236:239], v[132:135], a[28:31], v[236:239]
    s_waitcnt lgkmcnt(4)
    v_mfma_f32_16x16x32_bf16 a[224:227], v[136:139], a[0:3], 0
    ds_read_b64_tr_b16 v[152:153], v167 offset:49152
    v_mfma_f32_16x16x32_bf16 a[224:227], v[140:143], a[16:19], a[224:227]
    buffer_load_dwordx4 a[112:115], v222, s[24:27], s54 offen offset:0 sc0 sc1
    v_mfma_f32_16x16x32_bf16 a[228:231], v[136:139], a[4:7], 0
    ds_read_b64_tr_b16 v[154:155], v167 offset:51200
    v_mfma_f32_16x16x32_bf16 a[228:231], v[140:143], a[20:23], a[228:231]
    v_mfma_f32_16x16x32_bf16 a[232:235], v[136:139], a[8:11], 0
    s_waitcnt vmcnt(17)
    s_barrier
    s_add_u32 s49, s81, 24576
    v_mfma_f32_16x16x32_bf16 a[232:235], v[140:143], a[24:27], a[232:235]
    ds_read_b64_tr_b16 v[156:157], v167 offset:57344
    v_mfma_f32_16x16x32_bf16 a[236:239], v[136:139], a[12:15], 0
    ds_read_b64_tr_b16 v[158:159], v167 offset:59392
    v_mfma_f32_16x16x32_bf16 a[236:239], v[140:143], a[28:31], a[236:239]
    s_waitcnt lgkmcnt(4)
    buffer_load_dwordx4 a[116:119], v222, s[24:27], s54 offen offset:1024 sc0 sc1
    v_mfma_f32_16x16x32_bf16 v[240:243], v[144:147], a[0:3], 0
    v_xor_b32 v168, s56, v168
    v_mfma_f32_16x16x32_bf16 v[240:243], v[148:151], a[16:19], v[240:243]
    ds_read_b64_tr_b16 v[128:129], v168 offset:0
    v_mfma_f32_16x16x32_bf16 v[244:247], v[144:147], a[4:7], 0
    ds_read_b64_tr_b16 v[130:131], v168 offset:2048
    v_mfma_f32_16x16x32_bf16 v[244:247], v[148:151], a[20:23], v[244:247]
    buffer_store_dword v218, v216, s[24:27], s49 offen sc0 sc1
    v_mfma_f32_16x16x32_bf16 v[248:251], v[144:147], a[8:11], 0
    ds_read_b64_tr_b16 v[132:133], v168 offset:8192
    v_mfma_f32_16x16x32_bf16 v[248:251], v[148:151], a[24:27], v[248:251]
    buffer_load_dwordx4 a[120:123], v222, s[24:27], s54 offen offset:2048 sc0 sc1
    v_mfma_f32_16x16x32_bf16 v[252:255], v[144:147], a[12:15], 0
    ds_read_b64_tr_b16 v[134:135], v168 offset:10240
    v_mfma_f32_16x16x32_bf16 v[252:255], v[148:151], a[28:31], v[252:255]
    s_waitcnt lgkmcnt(4)
    v_mfma_f32_16x16x32_bf16 a[240:243], v[152:155], a[0:3], 0
    v_xor_b32 v169, s56, v169
    v_mfma_f32_16x16x32_bf16 a[240:243], v[156:159], a[16:19], a[240:243]
    ds_read_b64_tr_b16 v[136:137], v169 offset:0
    v_mfma_f32_16x16x32_bf16 a[244:247], v[152:155], a[4:7], 0
    ds_read_b64_tr_b16 v[138:139], v169 offset:2048
    v_mfma_f32_16x16x32_bf16 a[244:247], v[156:159], a[20:23], a[244:247]
    buffer_load_dwordx4 a[124:127], v222, s[24:27], s54 offen offset:3072 sc0 sc1
    v_mfma_f32_16x16x32_bf16 a[248:251], v[152:155], a[8:11], 0
    s_add_u32 m0, s66, 155648
    ds_read_b64_tr_b16 v[140:141], v169 offset:8192
    s_add_u32 s55, s15, 1327360
    v_mfma_f32_16x16x32_bf16 a[248:251], v[156:159], a[24:27], a[248:251]
    buffer_load_dwordx4 v220, s[40:43], s55 offen lds
    v_mfma_f32_16x16x32_bf16 a[252:255], v[152:155], a[12:15], 0
    ds_read_b64_tr_b16 v[142:143], v169 offset:10240
    v_mfma_f32_16x16x32_bf16 a[252:255], v[156:159], a[28:31], a[252:255]
    s_waitcnt lgkmcnt(4)
    v_mfma_f32_16x16x32_bf16 v[0:3], v[128:131], a[32:35], v[0:3]
    v_xor_b32 v170, s56, v170
    v_mfma_f32_16x16x32_bf16 v[0:3], v[132:135], a[48:51], v[0:3]
    ds_read_b64_tr_b16 v[144:145], v170 offset:0
    v_mfma_f32_16x16x32_bf16 v[4:7], v[128:131], a[36:39], v[4:7]
    ds_read_b64_tr_b16 v[146:147], v170 offset:2048
    v_mfma_f32_16x16x32_bf16 v[4:7], v[132:135], a[52:55], v[4:7]
    buffer_load_dwordx4 v221, s[40:43], s55 offen offset:1024 lds
    v_mfma_f32_16x16x32_bf16 v[8:11], v[128:131], a[40:43], v[8:11]
    s_add_u32 m0, s66, 81920
    ds_read_b64_tr_b16 v[148:149], v170 offset:8192
    s_add_u32 s55, s14, 1327104
    v_mfma_f32_16x16x32_bf16 v[8:11], v[132:135], a[56:59], v[8:11]
    buffer_load_dwordx4 v220, s[40:43], s55 offen lds
    v_mfma_f32_16x16x32_bf16 v[12:15], v[128:131], a[44:47], v[12:15]
    ds_read_b64_tr_b16 v[150:151], v170 offset:10240
    v_mfma_f32_16x16x32_bf16 v[12:15], v[132:135], a[60:63], v[12:15]
    s_waitcnt lgkmcnt(4)
    v_mfma_f32_16x16x32_bf16 a[160:163], v[136:139], a[32:35], a[160:163]
    v_xor_b32 v171, s56, v171
    v_mfma_f32_16x16x32_bf16 a[160:163], v[140:143], a[48:51], a[160:163]
    ds_read_b64_tr_b16 v[152:153], v171 offset:0
    v_mfma_f32_16x16x32_bf16 a[164:167], v[136:139], a[36:39], a[164:167]
    ds_read_b64_tr_b16 v[154:155], v171 offset:2048
    v_mfma_f32_16x16x32_bf16 a[164:167], v[140:143], a[52:55], a[164:167]
    v_mfma_f32_16x16x32_bf16 a[168:171], v[136:139], a[40:43], a[168:171]
    ds_read_b64_tr_b16 v[156:157], v171 offset:8192
    v_mfma_f32_16x16x32_bf16 a[168:171], v[140:143], a[56:59], a[168:171]
    buffer_load_dwordx4 v221, s[40:43], s55 offen offset:1024 lds
    v_mfma_f32_16x16x32_bf16 a[172:175], v[136:139], a[44:47], a[172:175]
    s_add_u32 m0, s66, 90112
    ds_read_b64_tr_b16 v[158:159], v171 offset:10240
    s_add_u32 s55, s15, 1327104
    v_mfma_f32_16x16x32_bf16 a[172:175], v[140:143], a[60:63], a[172:175]
    s_waitcnt lgkmcnt(4)
    v_mfma_f32_16x16x32_bf16 v[16:19], v[144:147], a[32:35], v[16:19]
    v_xor_b32 v160, s56, v160
    v_mfma_f32_16x16x32_bf16 v[16:19], v[148:151], a[48:51], v[16:19]
    ds_read_b64_tr_b16 v[128:129], v160 offset:0
    v_mfma_f32_16x16x32_bf16 v[20:23], v[144:147], a[36:39], v[20:23]
    ds_read_b64_tr_b16 v[130:131], v160 offset:2048
    v_mfma_f32_16x16x32_bf16 v[20:23], v[148:151], a[52:55], v[20:23]
    buffer_load_dwordx4 v220, s[40:43], s55 offen lds
    v_mfma_f32_16x16x32_bf16 v[24:27], v[144:147], a[40:43], v[24:27]
    ds_read_b64_tr_b16 v[132:133], v160 offset:8192
    v_mfma_f32_16x16x32_bf16 v[24:27], v[148:151], a[56:59], v[24:27]
    buffer_load_dwordx4 v221, s[40:43], s55 offen offset:1024 lds
    v_mfma_f32_16x16x32_bf16 v[28:31], v[144:147], a[44:47], v[28:31]
    s_add_u32 m0, s66, 98304
    ds_read_b64_tr_b16 v[134:135], v160 offset:10240
    s_add_u32 s55, s14, 1327232
    v_mfma_f32_16x16x32_bf16 v[28:31], v[148:151], a[60:63], v[28:31]
    s_waitcnt lgkmcnt(4)
    v_mfma_f32_16x16x32_bf16 a[176:179], v[152:155], a[32:35], a[176:179]
    v_xor_b32 v161, s56, v161
    v_mfma_f32_16x16x32_bf16 a[176:179], v[156:159], a[48:51], a[176:179]
    ds_read_b64_tr_b16 v[136:137], v161 offset:0
    v_mfma_f32_16x16x32_bf16 a[180:183], v[152:155], a[36:39], a[180:183]
    ds_read_b64_tr_b16 v[138:139], v161 offset:2048
    v_mfma_f32_16x16x32_bf16 a[180:183], v[156:159], a[52:55], a[180:183]
    buffer_load_dwordx4 v220, s[40:43], s55 offen lds
    v_mfma_f32_16x16x32_bf16 a[184:187], v[152:155], a[40:43], a[184:187]
    s_barrier
    v_mfma_f32_16x16x32_bf16 a[184:187], v[156:159], a[56:59], a[184:187]
    ds_read_b64_tr_b16 v[140:141], v161 offset:8192
    v_mfma_f32_16x16x32_bf16 a[188:191], v[152:155], a[44:47], a[188:191]
    ds_read_b64_tr_b16 v[142:143], v161 offset:10240
    v_mfma_f32_16x16x32_bf16 a[188:191], v[156:159], a[60:63], a[188:191]
    s_waitcnt lgkmcnt(4)
    buffer_load_dwordx4 v221, s[40:43], s55 offen offset:1024 lds
    v_mfma_f32_16x16x32_bf16 v[32:35], v[128:131], a[32:35], v[32:35]
    s_add_u32 m0, s66, 106496
    v_xor_b32 v162, s56, v162
    s_add_u32 s55, s15, 1327232
    v_mfma_f32_16x16x32_bf16 v[32:35], v[132:135], a[48:51], v[32:35]
    ds_read_b64_tr_b16 v[144:145], v162 offset:0
    v_mfma_f32_16x16x32_bf16 v[36:39], v[128:131], a[36:39], v[36:39]
    ds_read_b64_tr_b16 v[146:147], v162 offset:2048
    v_mfma_f32_16x16x32_bf16 v[36:39], v[132:135], a[52:55], v[36:39]
    buffer_load_dwordx4 v220, s[40:43], s55 offen lds
    v_mfma_f32_16x16x32_bf16 v[40:43], v[128:131], a[40:43], v[40:43]
    ds_read_b64_tr_b16 v[148:149], v162 offset:8192
    v_mfma_f32_16x16x32_bf16 v[40:43], v[132:135], a[56:59], v[40:43]
    v_mfma_f32_16x16x32_bf16 v[44:47], v[128:131], a[44:47], v[44:47]
    ds_read_b64_tr_b16 v[150:151], v162 offset:10240
    v_mfma_f32_16x16x32_bf16 v[44:47], v[132:135], a[60:63], v[44:47]
    s_waitcnt lgkmcnt(4)
    v_mfma_f32_16x16x32_bf16 a[192:195], v[136:139], a[32:35], a[192:195]
    v_xor_b32 v163, s56, v163
    v_mfma_f32_16x16x32_bf16 a[192:195], v[140:143], a[48:51], a[192:195]
    ds_read_b64_tr_b16 v[152:153], v163 offset:0
    v_mfma_f32_16x16x32_bf16 a[196:199], v[136:139], a[36:39], a[196:199]
    ds_read_b64_tr_b16 v[154:155], v163 offset:2048
    v_mfma_f32_16x16x32_bf16 a[196:199], v[140:143], a[52:55], a[196:199]
    buffer_load_dwordx4 v221, s[40:43], s55 offen offset:1024 lds
    v_mfma_f32_16x16x32_bf16 a[200:203], v[136:139], a[40:43], a[200:203]
    s_add_u32 s54, s62, 4718592
    ds_read_b64_tr_b16 v[156:157], v163 offset:8192
    v_mfma_f32_16x16x32_bf16 a[200:203], v[140:143], a[56:59], a[200:203]
    buffer_load_dwordx4 a[128:131], v222, s[24:27], s54 offen offset:0 sc0 sc1
    v_mfma_f32_16x16x32_bf16 a[204:207], v[136:139], a[44:47], a[204:207]
    ds_read_b64_tr_b16 v[158:159], v163 offset:10240
    v_mfma_f32_16x16x32_bf16 a[204:207], v[140:143], a[60:63], a[204:207]
    s_waitcnt lgkmcnt(4)
    v_mfma_f32_16x16x32_bf16 v[48:51], v[144:147], a[32:35], v[48:51]
    ds_read_b64_tr_b16 v[128:129], v160 offset:16384
    v_mfma_f32_16x16x32_bf16 v[48:51], v[148:151], a[48:51], v[48:51]
    buffer_load_dwordx4 a[132:135], v222, s[24:27], s54 offen offset:1024 sc0 sc1
    v_mfma_f32_16x16x32_bf16 v[52:55], v[144:147], a[36:39], v[52:55]
    ds_read_b64_tr_b16 v[130:131], v160 offset:18432
    v_mfma_f32_16x16x32_bf16 v[52:55], v[148:151], a[52:55], v[52:55]
    v_mfma_f32_16x16x32_bf16 v[56:59], v[144:147], a[40:43], v[56:59]
    ds_read_b64_tr_b16 v[132:133], v160 offset:24576
    v_mfma_f32_16x16x32_bf16 v[56:59], v[148:151], a[56:59], v[56:59]
    buffer_load_dwordx4 a[136:139], v222, s[24:27], s54 offen offset:2048 sc0 sc1
    v_mfma_f32_16x16x32_bf16 v[60:63], v[144:147], a[44:47], v[60:63]
    ds_read_b64_tr_b16 v[134:135], v160 offset:26624
    v_mfma_f32_16x16x32_bf16 v[60:63], v[148:151], a[60:63], v[60:63]
    s_waitcnt lgkmcnt(4)
    v_mfma_f32_16x16x32_bf16 a[208:211], v[152:155], a[32:35], a[208:211]
    ds_read_b64_tr_b16 v[136:137], v161 offset:16384
    v_mfma_f32_16x16x32_bf16 a[208:211], v[156:159], a[48:51], a[208:211]
    buffer_load_dwordx4 a[140:143], v222, s[24:27], s54 offen offset:3072 sc0 sc1
    v_mfma_f32_16x16x32_bf16 a[212:215], v[152:155], a[36:39], a[212:215]
    s_add_u32 m0, s66, 114688
    ds_read_b64_tr_b16 v[138:139], v161 offset:18432
    s_add_u32 s55, s3, 1327104
    v_mfma_f32_16x16x32_bf16 a[212:215], v[156:159], a[52:55], a[212:215]
    v_mfma_f32_16x16x32_bf16 a[216:219], v[152:155], a[40:43], a[216:219]
    ds_read_b64_tr_b16 v[140:141], v161 offset:24576
    v_mfma_f32_16x16x32_bf16 a[216:219], v[156:159], a[56:59], a[216:219]
    buffer_load_dwordx4 v220, s[40:43], s55 offen lds
    v_mfma_f32_16x16x32_bf16 a[220:223], v[152:155], a[44:47], a[220:223]
    ds_read_b64_tr_b16 v[142:143], v161 offset:26624
    v_mfma_f32_16x16x32_bf16 a[220:223], v[156:159], a[60:63], a[220:223]
    s_waitcnt lgkmcnt(4)
    v_mfma_f32_16x16x32_bf16 v[224:227], v[128:131], a[32:35], v[224:227]
    ds_read_b64_tr_b16 v[144:145], v162 offset:16384
    v_mfma_f32_16x16x32_bf16 v[224:227], v[132:135], a[48:51], v[224:227]
    v_mfma_f32_16x16x32_bf16 v[228:231], v[128:131], a[36:39], v[228:231]
    ds_read_b64_tr_b16 v[146:147], v162 offset:18432
    v_mfma_f32_16x16x32_bf16 v[228:231], v[132:135], a[52:55], v[228:231]
    v_mfma_f32_16x16x32_bf16 v[232:235], v[128:131], a[40:43], v[232:235]
    ds_read_b64_tr_b16 v[148:149], v162 offset:24576
    v_mfma_f32_16x16x32_bf16 v[232:235], v[132:135], a[56:59], v[232:235]
    buffer_load_dwordx4 v221, s[40:43], s55 offen offset:1024 lds
    v_mfma_f32_16x16x32_bf16 v[236:239], v[128:131], a[44:47], v[236:239]
    s_add_u32 s54, s12, 7077888
    ds_read_b64_tr_b16 v[150:151], v162 offset:26624
    v_mfma_f32_16x16x32_bf16 v[236:239], v[132:135], a[60:63], v[236:239]
    s_waitcnt lgkmcnt(4)
    v_mfma_f32_16x16x32_bf16 a[224:227], v[136:139], a[32:35], a[224:227]
    ds_read_b64_tr_b16 v[152:153], v163 offset:16384
    v_mfma_f32_16x16x32_bf16 a[224:227], v[140:143], a[48:51], a[224:227]
    buffer_load_dwordx4 a[144:147], v222, s[24:27], s54 offen offset:0 sc0 sc1
    v_mfma_f32_16x16x32_bf16 a[228:231], v[136:139], a[36:39], a[228:231]
    ds_read_b64_tr_b16 v[154:155], v163 offset:18432
    v_mfma_f32_16x16x32_bf16 a[228:231], v[140:143], a[52:55], a[228:231]
    v_mfma_f32_16x16x32_bf16 a[232:235], v[136:139], a[40:43], a[232:235]
    s_waitcnt vmcnt(32)
    s_barrier
    s_add_u32 s49, s72, 24576
    v_mfma_f32_16x16x32_bf16 a[232:235], v[140:143], a[56:59], a[232:235]
    ds_read_b64_tr_b16 v[156:157], v163 offset:24576
    v_mfma_f32_16x16x32_bf16 a[236:239], v[136:139], a[44:47], a[236:239]
    ds_read_b64_tr_b16 v[158:159], v163 offset:26624
    v_mfma_f32_16x16x32_bf16 a[236:239], v[140:143], a[60:63], a[236:239]
    s_waitcnt lgkmcnt(4)
    buffer_load_dwordx4 a[148:151], v222, s[24:27], s54 offen offset:1024 sc0 sc1
    v_mfma_f32_16x16x32_bf16 v[240:243], v[144:147], a[32:35], v[240:243]
    ds_read_b64_tr_b16 v[128:129], v160 offset:32768
    v_mfma_f32_16x16x32_bf16 v[240:243], v[148:151], a[48:51], v[240:243]
    buffer_load_dwordx4 a[152:155], v222, s[24:27], s54 offen offset:2048 sc0 sc1
    v_mfma_f32_16x16x32_bf16 v[244:247], v[144:147], a[36:39], v[244:247]
    ds_read_b64_tr_b16 v[130:131], v160 offset:34816
    v_mfma_f32_16x16x32_bf16 v[244:247], v[148:151], a[52:55], v[244:247]
    buffer_load_dword v219, v223, s[24:27], s49 offen sc0 sc1
    v_mfma_f32_16x16x32_bf16 v[248:251], v[144:147], a[40:43], v[248:251]
    ds_read_b64_tr_b16 v[132:133], v160 offset:40960
    v_mfma_f32_16x16x32_bf16 v[248:251], v[148:151], a[56:59], v[248:251]
    buffer_load_dwordx4 a[156:159], v222, s[24:27], s54 offen offset:3072 sc0 sc1
    v_mfma_f32_16x16x32_bf16 v[252:255], v[144:147], a[44:47], v[252:255]
    s_add_u32 m0, s66, 122880
    ds_read_b64_tr_b16 v[134:135], v160 offset:43008
    s_add_u32 s55, s14, 1990656
    v_mfma_f32_16x16x32_bf16 v[252:255], v[148:151], a[60:63], v[252:255]
    s_waitcnt lgkmcnt(4)
    v_mfma_f32_16x16x32_bf16 a[240:243], v[152:155], a[32:35], a[240:243]
    ds_read_b64_tr_b16 v[136:137], v161 offset:32768
    v_mfma_f32_16x16x32_bf16 a[240:243], v[156:159], a[48:51], a[240:243]
    v_mfma_f32_16x16x32_bf16 a[244:247], v[152:155], a[36:39], a[244:247]
    ds_read_b64_tr_b16 v[138:139], v161 offset:34816
    v_mfma_f32_16x16x32_bf16 a[244:247], v[156:159], a[52:55], a[244:247]
    v_mfma_f32_16x16x32_bf16 a[248:251], v[152:155], a[40:43], a[248:251]
    ds_read_b64_tr_b16 v[140:141], v161 offset:40960
    v_mfma_f32_16x16x32_bf16 a[248:251], v[156:159], a[56:59], a[248:251]
    buffer_load_dwordx4 v220, s[40:43], s55 offen lds
    v_mfma_f32_16x16x32_bf16 a[252:255], v[152:155], a[44:47], a[252:255]
    ds_read_b64_tr_b16 v[142:143], v161 offset:43008
    v_mfma_f32_16x16x32_bf16 a[252:255], v[156:159], a[60:63], a[252:255]
    s_waitcnt lgkmcnt(4)
    v_mfma_f32_16x16x32_bf16 v[0:3], v[128:131], a[64:67], v[0:3]
    ds_read_b64_tr_b16 v[144:145], v162 offset:32768
    v_mfma_f32_16x16x32_bf16 v[0:3], v[132:135], a[80:83], v[0:3]
    buffer_load_dwordx4 v221, s[40:43], s55 offen offset:1024 lds
    v_mfma_f32_16x16x32_bf16 v[4:7], v[128:131], a[68:71], v[4:7]
    s_add_u32 m0, s66, 131072
    ds_read_b64_tr_b16 v[146:147], v162 offset:34816
    s_add_u32 s55, s3, 1327232
    v_mfma_f32_16x16x32_bf16 v[4:7], v[132:135], a[84:87], v[4:7]
    v_mfma_f32_16x16x32_bf16 v[8:11], v[128:131], a[72:75], v[8:11]
    ds_read_b64_tr_b16 v[148:149], v162 offset:40960
    v_mfma_f32_16x16x32_bf16 v[8:11], v[132:135], a[88:91], v[8:11]
    buffer_load_dwordx4 v220, s[40:43], s55 offen lds
    v_mfma_f32_16x16x32_bf16 v[12:15], v[128:131], a[76:79], v[12:15]
    ds_read_b64_tr_b16 v[150:151], v162 offset:43008
    v_mfma_f32_16x16x32_bf16 v[12:15], v[132:135], a[92:95], v[12:15]
    s_waitcnt lgkmcnt(4)
    v_mfma_f32_16x16x32_bf16 a[160:163], v[136:139], a[64:67], a[160:163]
    ds_read_b64_tr_b16 v[152:153], v163 offset:32768
    v_mfma_f32_16x16x32_bf16 a[160:163], v[140:143], a[80:83], a[160:163]
    buffer_load_dwordx4 v221, s[40:43], s55 offen offset:1024 lds
    v_mfma_f32_16x16x32_bf16 a[164:167], v[136:139], a[68:71], a[164:167]
    s_add_u32 m0, s66, 139264
    ds_read_b64_tr_b16 v[154:155], v163 offset:34816
    s_add_u32 s55, s14, 1990784
    v_mfma_f32_16x16x32_bf16 a[164:167], v[140:143], a[84:87], a[164:167]
    v_mfma_f32_16x16x32_bf16 a[168:171], v[136:139], a[72:75], a[168:171]
    ds_read_b64_tr_b16 v[156:157], v163 offset:40960
    v_mfma_f32_16x16x32_bf16 a[168:171], v[140:143], a[88:91], a[168:171]
    buffer_load_dwordx4 v220, s[40:43], s55 offen lds
    v_mfma_f32_16x16x32_bf16 a[172:175], v[136:139], a[76:79], a[172:175]
    ds_read_b64_tr_b16 v[158:159], v163 offset:43008
    v_mfma_f32_16x16x32_bf16 a[172:175], v[140:143], a[92:95], a[172:175]
    s_waitcnt lgkmcnt(4)
    v_mfma_f32_16x16x32_bf16 v[16:19], v[144:147], a[64:67], v[16:19]
    ds_read_b64_tr_b16 v[128:129], v160 offset:49152
    v_mfma_f32_16x16x32_bf16 v[16:19], v[148:151], a[80:83], v[16:19]
    buffer_load_dwordx4 v221, s[40:43], s55 offen offset:1024 lds
    v_mfma_f32_16x16x32_bf16 v[20:23], v[144:147], a[68:71], v[20:23]
    s_add_u32 s54, s13, 7077888
    ds_read_b64_tr_b16 v[130:131], v160 offset:51200
    v_mfma_f32_16x16x32_bf16 v[20:23], v[148:151], a[84:87], v[20:23]
    v_mfma_f32_16x16x32_bf16 v[24:27], v[144:147], a[72:75], v[24:27]
    ds_read_b64_tr_b16 v[132:133], v160 offset:57344
    v_mfma_f32_16x16x32_bf16 v[24:27], v[148:151], a[88:91], v[24:27]
    v_mfma_f32_16x16x32_bf16 v[28:31], v[144:147], a[76:79], v[28:31]
    ds_read_b64_tr_b16 v[134:135], v160 offset:59392
    v_mfma_f32_16x16x32_bf16 v[28:31], v[148:151], a[92:95], v[28:31]
    s_waitcnt lgkmcnt(4)
    v_mfma_f32_16x16x32_bf16 a[176:179], v[152:155], a[64:67], a[176:179]
    ds_read_b64_tr_b16 v[136:137], v161 offset:49152
    v_mfma_f32_16x16x32_bf16 a[176:179], v[156:159], a[80:83], a[176:179]
    buffer_load_dwordx4 a[0:3], v222, s[24:27], s54 offen offset:0 sc0 sc1
    v_mfma_f32_16x16x32_bf16 a[180:183], v[152:155], a[68:71], a[180:183]
    ds_read_b64_tr_b16 v[138:139], v161 offset:51200
    v_mfma_f32_16x16x32_bf16 a[180:183], v[156:159], a[84:87], a[180:183]
    v_mfma_f32_16x16x32_bf16 a[184:187], v[152:155], a[72:75], a[184:187]
    s_waitcnt vmcnt(39)
    s_barrier
    v_mfma_f32_16x16x32_bf16 a[184:187], v[156:159], a[88:91], a[184:187]
    ds_read_b64_tr_b16 v[140:141], v161 offset:57344
    v_mfma_f32_16x16x32_bf16 a[188:191], v[152:155], a[76:79], a[188:191]
    ds_read_b64_tr_b16 v[142:143], v161 offset:59392
    v_mfma_f32_16x16x32_bf16 a[188:191], v[156:159], a[92:95], a[188:191]
    s_waitcnt lgkmcnt(4)
    buffer_load_dwordx4 a[4:7], v222, s[24:27], s54 offen offset:1024 sc0 sc1
    v_mfma_f32_16x16x32_bf16 v[32:35], v[128:131], a[64:67], v[32:35]
    ds_read_b64_tr_b16 v[144:145], v162 offset:49152
    v_mfma_f32_16x16x32_bf16 v[32:35], v[132:135], a[80:83], v[32:35]
    buffer_load_dwordx4 a[8:11], v222, s[24:27], s54 offen offset:2048 sc0 sc1
    v_mfma_f32_16x16x32_bf16 v[36:39], v[128:131], a[68:71], v[36:39]
    ds_read_b64_tr_b16 v[146:147], v162 offset:51200
    v_mfma_f32_16x16x32_bf16 v[36:39], v[132:135], a[84:87], v[36:39]
    v_mfma_f32_16x16x32_bf16 v[40:43], v[128:131], a[72:75], v[40:43]
    ds_read_b64_tr_b16 v[148:149], v162 offset:57344
    v_mfma_f32_16x16x32_bf16 v[40:43], v[132:135], a[88:91], v[40:43]
    buffer_load_dwordx4 a[12:15], v222, s[24:27], s54 offen offset:3072 sc0 sc1
    v_mfma_f32_16x16x32_bf16 v[44:47], v[128:131], a[76:79], v[44:47]
    s_add_u32 m0, s66, 0
    ds_read_b64_tr_b16 v[150:151], v162 offset:59392
    s_add_u32 s55, s15, 1990656
    v_mfma_f32_16x16x32_bf16 v[44:47], v[132:135], a[92:95], v[44:47]
    s_waitcnt lgkmcnt(4)
    v_mfma_f32_16x16x32_bf16 a[192:195], v[136:139], a[64:67], a[192:195]
    ds_read_b64_tr_b16 v[152:153], v163 offset:49152
    v_mfma_f32_16x16x32_bf16 a[192:195], v[140:143], a[80:83], a[192:195]
    buffer_load_dwordx4 v220, s[40:43], s55 offen lds
    v_mfma_f32_16x16x32_bf16 a[196:199], v[136:139], a[68:71], a[196:199]
    ds_read_b64_tr_b16 v[154:155], v163 offset:51200
    v_mfma_f32_16x16x32_bf16 a[196:199], v[140:143], a[84:87], a[196:199]
    v_mfma_f32_16x16x32_bf16 a[200:203], v[136:139], a[72:75], a[200:203]
    ds_read_b64_tr_b16 v[156:157], v163 offset:57344
    v_mfma_f32_16x16x32_bf16 a[200:203], v[140:143], a[88:91], a[200:203]
    buffer_load_dwordx4 v221, s[40:43], s55 offen offset:1024 lds
    v_mfma_f32_16x16x32_bf16 a[204:207], v[136:139], a[76:79], a[204:207]
    s_add_u32 s54, s62, 7077888
    ds_read_b64_tr_b16 v[158:159], v163 offset:59392
    v_mfma_f32_16x16x32_bf16 a[204:207], v[140:143], a[92:95], a[204:207]
    s_waitcnt lgkmcnt(4)
    v_mfma_f32_16x16x32_bf16 v[48:51], v[144:147], a[64:67], v[48:51]
    ds_read_b64_tr_b16 v[128:129], v164 offset:0
    v_mfma_f32_16x16x32_bf16 v[48:51], v[148:151], a[80:83], v[48:51]
    v_mfma_f32_16x16x32_bf16 v[52:55], v[144:147], a[68:71], v[52:55]
    ds_read_b64_tr_b16 v[130:131], v164 offset:2048
    v_mfma_f32_16x16x32_bf16 v[52:55], v[148:151], a[84:87], v[52:55]
    v_mfma_f32_16x16x32_bf16 v[56:59], v[144:147], a[72:75], v[56:59]
    ds_read_b64_tr_b16 v[132:133], v164 offset:8192
    v_mfma_f32_16x16x32_bf16 v[56:59], v[148:151], a[88:91], v[56:59]
    buffer_load_dwordx4 a[16:19], v222, s[24:27], s54 offen offset:0 sc0 sc1
    v_mfma_f32_16x16x32_bf16 v[60:63], v[144:147], a[76:79], v[60:63]
    ds_read_b64_tr_b16 v[134:135], v164 offset:10240
    v_mfma_f32_16x16x32_bf16 v[60:63], v[148:151], a[92:95], v[60:63]
    s_waitcnt lgkmcnt(4)
    v_mfma_f32_16x16x32_bf16 a[208:211], v[152:155], a[64:67], a[208:211]
    ds_read_b64_tr_b16 v[136:137], v165 offset:0
    v_mfma_f32_16x16x32_bf16 a[208:211], v[156:159], a[80:83], a[208:211]
    buffer_load_dwordx4 a[20:23], v222, s[24:27], s54 offen offset:1024 sc0 sc1
    v_mfma_f32_16x16x32_bf16 a[212:215], v[152:155], a[68:71], a[212:215]
    ds_read_b64_tr_b16 v[138:139], v165 offset:2048
    v_mfma_f32_16x16x32_bf16 a[212:215], v[156:159], a[84:87], a[212:215]
    v_mfma_f32_16x16x32_bf16 a[216:219], v[152:155], a[72:75], a[216:219]
    ds_read_b64_tr_b16 v[140:141], v165 offset:8192
    v_mfma_f32_16x16x32_bf16 a[216:219], v[156:159], a[88:91], a[216:219]
    buffer_load_dwordx4 a[24:27], v222, s[24:27], s54 offen offset:2048 sc0 sc1
    v_mfma_f32_16x16x32_bf16 a[220:223], v[152:155], a[76:79], a[220:223]
    ds_read_b64_tr_b16 v[142:143], v165 offset:10240
    v_mfma_f32_16x16x32_bf16 a[220:223], v[156:159], a[92:95], a[220:223]
    s_waitcnt lgkmcnt(4)
    v_mfma_f32_16x16x32_bf16 v[224:227], v[128:131], a[64:67], v[224:227]
    ds_read_b64_tr_b16 v[144:145], v166 offset:0
    v_mfma_f32_16x16x32_bf16 v[224:227], v[132:135], a[80:83], v[224:227]
    buffer_load_dwordx4 a[28:31], v222, s[24:27], s54 offen offset:3072 sc0 sc1
    v_mfma_f32_16x16x32_bf16 v[228:231], v[128:131], a[68:71], v[228:231]
    s_add_u32 m0, s66, 8192
    ds_read_b64_tr_b16 v[146:147], v166 offset:2048
    s_add_u32 s55, s3, 1990656
    v_mfma_f32_16x16x32_bf16 v[228:231], v[132:135], a[84:87], v[228:231]
    v_mfma_f32_16x16x32_bf16 v[232:235], v[128:131], a[72:75], v[232:235]
    ds_read_b64_tr_b16 v[148:149], v166 offset:8192
    v_mfma_f32_16x16x32_bf16 v[232:235], v[132:135], a[88:91], v[232:235]
    buffer_load_dwordx4 v220, s[40:43], s55 offen lds
    v_mfma_f32_16x16x32_bf16 v[236:239], v[128:131], a[76:79], v[236:239]
    ds_read_b64_tr_b16 v[150:151], v166 offset:10240
    v_mfma_f32_16x16x32_bf16 v[236:239], v[132:135], a[92:95], v[236:239]
    s_waitcnt lgkmcnt(4)
    v_mfma_f32_16x16x32_bf16 a[224:227], v[136:139], a[64:67], a[224:227]
    ds_read_b64_tr_b16 v[152:153], v167 offset:0
    v_mfma_f32_16x16x32_bf16 a[224:227], v[140:143], a[80:83], a[224:227]
    v_mfma_f32_16x16x32_bf16 a[228:231], v[136:139], a[68:71], a[228:231]
    ds_read_b64_tr_b16 v[154:155], v167 offset:2048
    v_mfma_f32_16x16x32_bf16 a[228:231], v[140:143], a[84:87], a[228:231]
    v_mfma_f32_16x16x32_bf16 a[232:235], v[136:139], a[72:75], a[232:235]
    s_waitcnt vmcnt(32)
    s_barrier
    v_mfma_f32_16x16x32_bf16 a[232:235], v[140:143], a[88:91], a[232:235]
    ds_read_b64_tr_b16 v[156:157], v167 offset:8192
    v_mfma_f32_16x16x32_bf16 a[236:239], v[136:139], a[76:79], a[236:239]
    ds_read_b64_tr_b16 v[158:159], v167 offset:10240
    v_mfma_f32_16x16x32_bf16 a[236:239], v[140:143], a[92:95], a[236:239]
    s_waitcnt lgkmcnt(4)
    buffer_load_dwordx4 v221, s[40:43], s55 offen offset:1024 lds
    v_mfma_f32_16x16x32_bf16 v[240:243], v[144:147], a[64:67], v[240:243]
    s_add_u32 m0, s66, 16384
    ds_read_b64_tr_b16 v[128:129], v168 offset:16384
    s_add_u32 s55, s15, 1990784
    v_mfma_f32_16x16x32_bf16 v[240:243], v[148:151], a[80:83], v[240:243]
    buffer_load_dwordx4 v220, s[40:43], s55 offen lds
    v_mfma_f32_16x16x32_bf16 v[244:247], v[144:147], a[68:71], v[244:247]
    ds_read_b64_tr_b16 v[130:131], v168 offset:18432
    v_mfma_f32_16x16x32_bf16 v[244:247], v[148:151], a[84:87], v[244:247]
    s_waitcnt vmcnt(20)
    v_cmp_eq_u32 vcc, s79, v219
    v_mfma_f32_16x16x32_bf16 v[248:251], v[144:147], a[72:75], v[248:251]
    ds_read_b64_tr_b16 v[132:133], v168 offset:24576
    v_mfma_f32_16x16x32_bf16 v[248:251], v[148:151], a[88:91], v[248:251]
    buffer_load_dwordx4 v221, s[40:43], s55 offen offset:1024 lds
    v_mfma_f32_16x16x32_bf16 v[252:255], v[144:147], a[76:79], v[252:255]
    s_add_u32 m0, s66, 24576
    ds_read_b64_tr_b16 v[134:135], v168 offset:26624
    s_add_u32 s55, s3, 1990784
    v_mfma_f32_16x16x32_bf16 v[252:255], v[148:151], a[92:95], v[252:255]
    s_waitcnt lgkmcnt(4)
    s_andn2_b32 s61, 0x01010101, vcc_lo
    s_cbranch_scc1 Lslow_42
Lback_43:
    v_mfma_f32_16x16x32_bf16 a[240:243], v[152:155], a[64:67], a[240:243]
    ds_read_b64_tr_b16 v[136:137], v169 offset:16384
    v_mfma_f32_16x16x32_bf16 a[240:243], v[156:159], a[80:83], a[240:243]
    buffer_load_dwordx4 v220, s[40:43], s55 offen lds
    v_mfma_f32_16x16x32_bf16 a[244:247], v[152:155], a[68:71], a[244:247]
    ds_read_b64_tr_b16 v[138:139], v169 offset:18432
    v_mfma_f32_16x16x32_bf16 a[244:247], v[156:159], a[84:87], a[244:247]
    v_mfma_f32_16x16x32_bf16 a[248:251], v[152:155], a[72:75], a[248:251]
    ds_read_b64_tr_b16 v[140:141], v169 offset:24576
    v_mfma_f32_16x16x32_bf16 a[248:251], v[156:159], a[88:91], a[248:251]
    buffer_load_dwordx4 v221, s[40:43], s55 offen offset:1024 lds
    v_mfma_f32_16x16x32_bf16 a[252:255], v[152:155], a[76:79], a[252:255]
    s_add_u32 s54, s7, 131072
    ds_read_b64_tr_b16 v[142:143], v169 offset:26624
    v_mfma_f32_16x16x32_bf16 a[252:255], v[156:159], a[92:95], a[252:255]
    s_waitcnt lgkmcnt(4)
    v_mfma_f32_16x16x32_bf16 v[0:3], v[128:131], a[96:99], v[0:3]
    ds_read_b64_tr_b16 v[144:145], v170 offset:16384
    v_mfma_f32_16x16x32_bf16 v[0:3], v[132:135], a[112:115], v[0:3]
    buffer_load_dwordx4 a[32:35], v222, s[24:27], s54 offen offset:0 sc0 sc1
    v_mfma_f32_16x16x32_bf16 v[4:7], v[128:131], a[100:103], v[4:7]
    ds_read_b64_tr_b16 v[146:147], v170 offset:18432
    v_mfma_f32_16x16x32_bf16 v[4:7], v[132:135], a[116:119], v[4:7]
    v_mfma_f32_16x16x32_bf16 v[8:11], v[128:131], a[104:107], v[8:11]
    ds_read_b64_tr_b16 v[148:149], v170 offset:24576
    v_mfma_f32_16x16x32_bf16 v[8:11], v[132:135], a[120:123], v[8:11]
    v_mfma_f32_16x16x32_bf16 v[12:15], v[128:131], a[108:111], v[12:15]
    ds_read_b64_tr_b16 v[150:151], v170 offset:26624
    v_mfma_f32_16x16x32_bf16 v[12:15], v[132:135], a[124:127], v[12:15]
    s_waitcnt lgkmcnt(4)
    v_mfma_f32_16x16x32_bf16 a[160:163], v[136:139], a[96:99], a[160:163]
    ds_read_b64_tr_b16 v[152:153], v171 offset:16384
    v_mfma_f32_16x16x32_bf16 a[160:163], v[140:143], a[112:115], a[160:163]
    buffer_load_dwordx4 a[36:39], v222, s[24:27], s54 offen offset:1024 sc0 sc1
    v_mfma_f32_16x16x32_bf16 a[164:167], v[136:139], a[100:103], a[164:167]
    ds_read_b64_tr_b16 v[154:155], v171 offset:18432
    v_mfma_f32_16x16x32_bf16 a[164:167], v[140:143], a[116:119], a[164:167]
    v_mfma_f32_16x16x32_bf16 a[168:171], v[136:139], a[104:107], a[168:171]
    ds_read_b64_tr_b16 v[156:157], v171 offset:24576
    v_mfma_f32_16x16x32_bf16 a[168:171], v[140:143], a[120:123], a[168:171]
    buffer_load_dwordx4 a[40:43], v222, s[24:27], s54 offen offset:2048 sc0 sc1
    v_mfma_f32_16x16x32_bf16 a[172:175], v[136:139], a[108:111], a[172:175]
    ds_read_b64_tr_b16 v[158:159], v171 offset:26624
    v_mfma_f32_16x16x32_bf16 a[172:175], v[140:143], a[124:127], a[172:175]
    s_waitcnt lgkmcnt(4)
    v_mfma_f32_16x16x32_bf16 v[16:19], v[144:147], a[96:99], v[16:19]
    ds_read_b64_tr_b16 v[128:129], v164 offset:16384
    v_mfma_f32_16x16x32_bf16 v[16:19], v[148:151], a[112:115], v[16:19]
    buffer_load_dwordx4 a[44:47], v222, s[24:27], s54 offen offset:3072 sc0 sc1
    v_mfma_f32_16x16x32_bf16 v[20:23], v[144:147], a[100:103], v[20:23]
    s_add_u32 m0, s66, 32768
    ds_read_b64_tr_b16 v[130:131], v164 offset:18432
    s_add_u32 s55, s65, 41472
    v_mfma_f32_16x16x32_bf16 v[20:23], v[148:151], a[116:119], v[20:23]
    v_mfma_f32_16x16x32_bf16 v[24:27], v[144:147], a[104:107], v[24:27]
    ds_read_b64_tr_b16 v[132:133], v164 offset:24576
    v_mfma_f32_16x16x32_bf16 v[24:27], v[148:151], a[120:123], v[24:27]
    buffer_load_dwordx4 v220, s[44:47], s55 offen lds
    v_mfma_f32_16x16x32_bf16 v[28:31], v[144:147], a[108:111], v[28:31]
    ds_read_b64_tr_b16 v[134:135], v164 offset:26624
    v_mfma_f32_16x16x32_bf16 v[28:31], v[148:151], a[124:127], v[28:31]
    s_waitcnt lgkmcnt(4)
    v_mfma_f32_16x16x32_bf16 a[176:179], v[152:155], a[96:99], a[176:179]
    ds_read_b64_tr_b16 v[136:137], v165 offset:16384
    v_mfma_f32_16x16x32_bf16 a[176:179], v[156:159], a[112:115], a[176:179]
    buffer_load_dwordx4 v221, s[44:47], s55 offen offset:1024 lds
    v_mfma_f32_16x16x32_bf16 a[180:183], v[152:155], a[100:103], a[180:183]
    s_add_u32 s54, s7, 393216
    ds_read_b64_tr_b16 v[138:139], v165 offset:18432
    v_mfma_f32_16x16x32_bf16 a[180:183], v[156:159], a[116:119], a[180:183]
    v_mfma_f32_16x16x32_bf16 a[184:187], v[152:155], a[104:107], a[184:187]
    s_barrier
    v_mfma_f32_16x16x32_bf16 a[184:187], v[156:159], a[120:123], a[184:187]
    ds_read_b64_tr_b16 v[140:141], v165 offset:24576
    v_mfma_f32_16x16x32_bf16 a[188:191], v[152:155], a[108:111], a[188:191]
    ds_read_b64_tr_b16 v[142:143], v165 offset:26624
    v_mfma_f32_16x16x32_bf16 a[188:191], v[156:159], a[124:127], a[188:191]
    s_waitcnt lgkmcnt(4)
    buffer_load_dwordx4 a[48:51], v222, s[24:27], s54 offen offset:0 sc0 sc1
    v_mfma_f32_16x16x32_bf16 v[32:35], v[128:131], a[96:99], v[32:35]
    ds_read_b64_tr_b16 v[144:145], v166 offset:16384
    v_mfma_f32_16x16x32_bf16 v[32:35], v[132:135], a[112:115], v[32:35]
    v_mfma_f32_16x16x32_bf16 v[36:39], v[128:131], a[100:103], v[36:39]
    ds_read_b64_tr_b16 v[146:147], v166 offset:18432
    v_mfma_f32_16x16x32_bf16 v[36:39], v[132:135], a[116:119], v[36:39]
    v_mfma_f32_16x16x32_bf16 v[40:43], v[128:131], a[104:107], v[40:43]
    ds_read_b64_tr_b16 v[148:149], v166 offset:24576
    v_mfma_f32_16x16x32_bf16 v[40:43], v[132:135], a[120:123], v[40:43]
    buffer_load_dwordx4 a[52:55], v222, s[24:27], s54 offen offset:1024 sc0 sc1
    v_mfma_f32_16x16x32_bf16 v[44:47], v[128:131], a[108:111], v[44:47]
    ds_read_b64_tr_b16 v[150:151], v166 offset:26624
    v_mfma_f32_16x16x32_bf16 v[44:47], v[132:135], a[124:127], v[44:47]
    s_waitcnt lgkmcnt(4)
    v_mfma_f32_16x16x32_bf16 a[192:195], v[136:139], a[96:99], a[192:195]
    ds_read_b64_tr_b16 v[152:153], v167 offset:16384
    v_mfma_f32_16x16x32_bf16 a[192:195], v[140:143], a[112:115], a[192:195]
    buffer_load_dwordx4 a[56:59], v222, s[24:27], s54 offen offset:2048 sc0 sc1
    v_mfma_f32_16x16x32_bf16 a[196:199], v[136:139], a[100:103], a[196:199]
    ds_read_b64_tr_b16 v[154:155], v167 offset:18432
    v_mfma_f32_16x16x32_bf16 a[196:199], v[140:143], a[116:119], a[196:199]
    v_mfma_f32_16x16x32_bf16 a[200:203], v[136:139], a[104:107], a[200:203]
    ds_read_b64_tr_b16 v[156:157], v167 offset:24576
    v_mfma_f32_16x16x32_bf16 a[200:203], v[140:143], a[120:123], a[200:203]
    buffer_load_dwordx4 a[60:63], v222, s[24:27], s54 offen offset:3072 sc0 sc1
    v_mfma_f32_16x16x32_bf16 a[204:207], v[136:139], a[108:111], a[204:207]
    s_add_u32 m0, s66, 40960
    ds_read_b64_tr_b16 v[158:159], v167 offset:26624
    s_add_u32 s55, s65, 124416
    v_mfma_f32_16x16x32_bf16 a[204:207], v[140:143], a[124:127], a[204:207]
    s_waitcnt lgkmcnt(4)
    v_mfma_f32_16x16x32_bf16 v[48:51], v[144:147], a[96:99], v[48:51]
    ds_read_b64_tr_b16 v[128:129], v164 offset:32768
    v_mfma_f32_16x16x32_bf16 v[48:51], v[148:151], a[112:115], v[48:51]
    buffer_load_dwordx4 v220, s[44:47], s55 offen lds
    v_mfma_f32_16x16x32_bf16 v[52:55], v[144:147], a[100:103], v[52:55]
    ds_read_b64_tr_b16 v[130:131], v164 offset:34816
    v_mfma_f32_16x16x32_bf16 v[52:55], v[148:151], a[116:119], v[52:55]
    v_mfma_f32_16x16x32_bf16 v[56:59], v[144:147], a[104:107], v[56:59]
    ds_read_b64_tr_b16 v[132:133], v164 offset:40960
    v_mfma_f32_16x16x32_bf16 v[56:59], v[148:151], a[120:123], v[56:59]
    buffer_load_dwordx4 v221, s[44:47], s55 offen offset:1024 lds
    v_mfma_f32_16x16x32_bf16 v[60:63], v[144:147], a[108:111], v[60:63]
    s_add_u32 m0, s66, 49152
    ds_read_b64_tr_b16 v[134:135], v164 offset:43008
    s_add_u32 s55, s65, 41600
    v_mfma_f32_16x16x32_bf16 v[60:63], v[148:151], a[124:127], v[60:63]
    s_waitcnt lgkmcnt(4)
    v_mfma_f32_16x16x32_bf16 a[208:211], v[152:155], a[96:99], a[208:211]
    ds_read_b64_tr_b16 v[136:137], v165 offset:32768
    v_mfma_f32_16x16x32_bf16 a[208:211], v[156:159], a[112:115], a[208:211]
    v_mfma_f32_16x16x32_bf16 a[212:215], v[152:155], a[100:103], a[212:215]
    ds_read_b64_tr_b16 v[138:139], v165 offset:34816
    v_mfma_f32_16x16x32_bf16 a[212:215], v[156:159], a[116:119], a[212:215]
    v_mfma_f32_16x16x32_bf16 a[216:219], v[152:155], a[104:107], a[216:219]
    ds_read_b64_tr_b16 v[140:141], v165 offset:40960
    v_mfma_f32_16x16x32_bf16 a[216:219], v[156:159], a[120:123], a[216:219]
    buffer_load_dwordx4 v220, s[44:47], s55 offen lds
    v_mfma_f32_16x16x32_bf16 a[220:223], v[152:155], a[108:111], a[220:223]
    ds_read_b64_tr_b16 v[142:143], v165 offset:43008
    v_mfma_f32_16x16x32_bf16 a[220:223], v[156:159], a[124:127], a[220:223]
    s_waitcnt lgkmcnt(4)
    v_mfma_f32_16x16x32_bf16 v[224:227], v[128:131], a[96:99], v[224:227]
    s_mul_i32 s75, s67, 36
    ds_read_b64_tr_b16 v[144:145], v166 offset:32768
    s_mul_i32 s52, s68, 12
    v_mfma_f32_16x16x32_bf16 v[224:227], v[132:135], a[112:115], v[224:227]
    buffer_load_dwordx4 v221, s[44:47], s55 offen offset:1024 lds
    v_mfma_f32_16x16x32_bf16 v[228:231], v[128:131], a[100:103], v[228:231]
    s_add_u32 m0, s66, 57344
    ds_read_b64_tr_b16 v[146:147], v166 offset:34816
    s_add_u32 s55, s65, 124544
    v_mfma_f32_16x16x32_bf16 v[228:231], v[132:135], a[116:119], v[228:231]
    s_lshr_b32 s60, s48, 1
    s_add_u32 s52, s52, s60
    s_add_u32 s75, s75, s52
    v_mfma_f32_16x16x32_bf16 v[232:235], v[128:131], a[104:107], v[232:235]
    s_lshl_b32 s75, s75, 16
    ds_read_b64_tr_b16 v[148:149], v166 offset:40960
    s_add_u32 s75, s75, 25427968
    v_mfma_f32_16x16x32_bf16 v[232:235], v[132:135], a[120:123], v[232:235]
    buffer_load_dwordx4 v220, s[44:47], s55 offen lds
    v_mfma_f32_16x16x32_bf16 v[236:239], v[128:131], a[108:111], v[236:239]
    s_add_u32 s4, s75, 524288
    ds_read_b64_tr_b16 v[150:151], v166 offset:43008
    s_add_u32 s5, s75, 655360
    v_mfma_f32_16x16x32_bf16 v[236:239], v[132:135], a[124:127], v[236:239]
    s_waitcnt lgkmcnt(4)
    s_add_u32 s6, s75, 0
    s_add_u32 s10, s75, 131072
    v_mfma_f32_16x16x32_bf16 a[224:227], v[136:139], a[96:99], a[224:227]
    s_add_u32 s11, s75, 262144
    ds_read_b64_tr_b16 v[152:153], v167 offset:32768
    s_add_u32 s20, s75, 393216
    v_mfma_f32_16x16x32_bf16 a[224:227], v[140:143], a[112:115], a[224:227]
    buffer_load_dwordx4 v221, s[44:47], s55 offen offset:1024 lds
    v_mfma_f32_16x16x32_bf16 a[228:231], v[136:139], a[100:103], a[228:231]
    s_add_u32 s54, s7, 655360
    ds_read_b64_tr_b16 v[154:155], v167 offset:34816
    s_mul_i32 s60, s67, 2359296
    v_mfma_f32_16x16x32_bf16 a[228:231], v[140:143], a[116:119], a[228:231]
    s_sub_u32 s73, s4, s60
    s_sub_u32 s75, s73, 25427968
    s_lshr_b32 s75, s75, 11
    v_mfma_f32_16x16x32_bf16 a[232:235], v[136:139], a[104:107], a[232:235]
    s_waitcnt vmcnt(36)
    s_barrier
    v_lshlrev_b32 v194, 4, v174
    v_mfma_f32_16x16x32_bf16 a[232:235], v[140:143], a[120:123], a[232:235]
    ds_read_b64_tr_b16 v[156:157], v167 offset:40960
    v_sub_u32 v192, v222, v194
    v_mfma_f32_16x16x32_bf16 a[236:239], v[136:139], a[108:111], a[236:239]
    ds_read_b64_tr_b16 v[158:159], v167 offset:43008
    v_lshrrev_b32 v193, 6, v192
    v_mfma_f32_16x16x32_bf16 a[236:239], v[140:143], a[124:127], a[236:239]
    s_waitcnt lgkmcnt(4)
    buffer_load_dwordx4 a[64:67], v222, s[24:27], s54 offen offset:0 sc0 sc1
    v_mfma_f32_16x16x32_bf16 v[240:243], v[144:147], a[96:99], v[240:243]
    ds_read_b64_tr_b16 v[128:129], v164 offset:49152
    v_lshrrev_b32 v192, 1, v192
    v_mfma_f32_16x16x32_bf16 v[240:243], v[148:151], a[112:115], v[240:243]
    buffer_load_dwordx4 a[68:71], v222, s[24:27], s54 offen offset:1024 sc0 sc1
    v_mfma_f32_16x16x32_bf16 v[244:247], v[144:147], a[100:103], v[244:247]
    ds_read_b64_tr_b16 v[130:131], v164 offset:51200
    v_add_u32 v192, v192, v194
    v_mfma_f32_16x16x32_bf16 v[244:247], v[148:151], a[116:119], v[244:247]
    s_lshl_b32 s52, s48, 10
    v_add_u32 v195, s52, v194
    v_xor_b32 v196, 0x800, v195
    v_mfma_f32_16x16x32_bf16 v[248:251], v[144:147], a[104:107], v[248:251]
    ds_read_b64_tr_b16 v[132:133], v164 offset:57344
    v_and_b32 v194, 15, v174
    v_mfma_f32_16x16x32_bf16 v[248:251], v[148:151], a[120:123], v[248:251]
    v_add_u32 v193, v193, v194
    v_mul_u32_u24 v193, 1152, v193
    v_mfma_f32_16x16x32_bf16 v[252:255], v[144:147], a[108:111], v[252:255]
    ds_read_b64_tr_b16 v[134:135], v164 offset:59392
    v_lshrrev_b32 v194, 4, v174
    v_mfma_f32_16x16x32_bf16 v[252:255], v[148:151], a[124:127], v[252:255]
    s_waitcnt lgkmcnt(4)
    v_lshl_add_u32 v193, v194, 3, v193
    s_mov_b32 s76, 0x3f80
    v_mfma_f32_16x16x32_bf16 a[240:243], v[152:155], a[96:99], a[240:243]
    s_mov_b32 s77, 0x3f800000
    ds_read_b64_tr_b16 v[136:137], v165 offset:49152
    s_mov_b32 s28, s18
    v_mfma_f32_16x16x32_bf16 a[240:243], v[156:159], a[112:115], a[240:243]
    buffer_load_dwordx4 a[72:75], v222, s[24:27], s54 offen offset:2048 sc0 sc1
    v_mfma_f32_16x16x32_bf16 a[244:247], v[152:155], a[100:103], a[244:247]
    s_and_b32 s29, s19, 0xffff
    ds_read_b64_tr_b16 v[138:139], v165 offset:51200
    s_mov_b32 s30, 0x240000
    v_mfma_f32_16x16x32_bf16 a[244:247], v[156:159], a[116:119], a[244:247]
    s_mov_b32 s31, 0x20000
    v_mfma_f32_16x16x32_bf16 a[248:251], v[152:155], a[104:107], a[248:251]
    ds_read_b64_tr_b16 v[140:141], v165 offset:57344
    v_mfma_f32_16x16x32_bf16 a[248:251], v[156:159], a[120:123], a[248:251]
    buffer_load_dwordx4 a[76:79], v222, s[24:27], s54 offen offset:3072 sc0 sc1
    v_mfma_f32_16x16x32_bf16 a[252:255], v[152:155], a[108:111], a[252:255]
    s_add_u32 m0, s66, 65536
    ds_read_b64_tr_b16 v[142:143], v165 offset:59392
    s_add_u32 s55, s65, 207488
    v_mfma_f32_16x16x32_bf16 a[252:255], v[156:159], a[124:127], a[252:255]
    s_waitcnt lgkmcnt(4)
    v_mfma_f32_16x16x32_bf16 v[32:35], v[128:131], a[128:131], v[32:35]
    ds_read_b64_tr_b16 v[144:145], v166 offset:49152
    v_mfma_f32_16x16x32_bf16 v[32:35], v[132:135], a[144:147], v[32:35]
    buffer_load_dwordx4 v220, s[44:47], s55 offen lds
    v_mfma_f32_16x16x32_bf16 v[36:39], v[128:131], a[132:135], v[36:39]
    ds_read_b64_tr_b16 v[146:147], v166 offset:51200
    v_mfma_f32_16x16x32_bf16 v[36:39], v[132:135], a[148:151], v[36:39]
    v_mfma_f32_16x16x32_bf16 v[40:43], v[128:131], a[136:139], v[40:43]
    ds_read_b64_tr_b16 v[148:149], v166 offset:57344
    v_mfma_f32_16x16x32_bf16 v[40:43], v[132:135], a[152:155], v[40:43]
    buffer_load_dwordx4 v221, s[44:47], s55 offen offset:1024 lds
    v_mfma_f32_16x16x32_bf16 v[44:47], v[128:131], a[140:143], v[44:47]
    s_add_u32 s54, s7, 917504
    ds_read_b64_tr_b16 v[150:151], v166 offset:59392
    v_mfma_f32_16x16x32_bf16 v[44:47], v[132:135], a[156:159], v[44:47]
    s_waitcnt lgkmcnt(4)
    v_mfma_f32_16x16x32_bf16 a[192:195], v[136:139], a[128:131], a[192:195]
    ds_read_b64_tr_b16 v[152:153], v167 offset:49152
    v_mfma_f32_16x16x32_bf16 a[192:195], v[140:143], a[144:147], a[192:195]
    buffer_load_dwordx4 a[80:83], v222, s[24:27], s54 offen offset:0 sc0 sc1
    v_mfma_f32_16x16x32_bf16 a[196:199], v[136:139], a[132:135], a[196:199]
    ds_read_b64_tr_b16 v[154:155], v167 offset:51200
    v_mfma_f32_16x16x32_bf16 a[196:199], v[140:143], a[148:151], a[196:199]
    v_mfma_f32_16x16x32_bf16 a[200:203], v[136:139], a[136:139], a[200:203]
    s_waitcnt vmcnt(39)
    s_barrier
    v_mfma_f32_16x16x32_bf16 a[200:203], v[140:143], a[152:155], a[200:203]
    ds_read_b64_tr_b16 v[156:157], v167 offset:57344
    v_mfma_f32_16x16x32_bf16 a[204:207], v[136:139], a[140:143], a[204:207]
    ds_read_b64_tr_b16 v[158:159], v167 offset:59392
    v_mfma_f32_16x16x32_bf16 a[204:207], v[140:143], a[156:159], a[204:207]
    s_waitcnt lgkmcnt(4)
    buffer_load_dwordx4 a[84:87], v222, s[24:27], s54 offen offset:1024 sc0 sc1
    v_mfma_f32_16x16x32_bf16 v[48:51], v[144:147], a[128:131], v[48:51]
    s_add_u32 s52, s75, 0
    ds_read_b64_tr_b16 v[128:129], v168 offset:0
    v_mfma_f32_16x16x32_bf16 v[48:51], v[148:151], a[144:147], v[48:51]
    buffer_load_dwordx2 v[176:177], v193, s[36:39], s52 offen offset:0
    v_mfma_f32_16x16x32_bf16 v[52:55], v[144:147], a[132:135], v[52:55]
    ds_read_b64_tr_b16 v[130:131], v168 offset:2048
    v_mfma_f32_16x16x32_bf16 v[52:55], v[148:151], a[148:151], v[52:55]
    buffer_load_dwordx2 v[184:185], v193, s[36:39], s52 offen offset:64
    v_mfma_f32_16x16x32_bf16 v[56:59], v[144:147], a[136:139], v[56:59]
    ds_read_b64_tr_b16 v[132:133], v168 offset:8192
    v_mfma_f32_16x16x32_bf16 v[56:59], v[148:151], a[152:155], v[56:59]
    v_mfma_f32_16x16x32_bf16 v[60:63], v[144:147], a[140:143], v[60:63]
    ds_read_b64_tr_b16 v[134:135], v168 offset:10240
    v_mfma_f32_16x16x32_bf16 v[60:63], v[148:151], a[156:159], v[60:63]
    s_waitcnt lgkmcnt(4)
    v_mfma_f32_16x16x32_bf16 a[208:211], v[152:155], a[128:131], a[208:211]
    ds_read_b64_tr_b16 v[136:137], v169 offset:0
    v_mfma_f32_16x16x32_bf16 a[208:211], v[156:159], a[144:147], a[208:211]
    v_mfma_f32_16x16x32_bf16 a[212:215], v[152:155], a[132:135], a[212:215]
    ds_read_b64_tr_b16 v[138:139], v169 offset:2048
    v_mfma_f32_16x16x32_bf16 a[212:215], v[156:159], a[148:151], a[212:215]
    v_mfma_f32_16x16x32_bf16 a[216:219], v[152:155], a[136:139], a[216:219]
    ds_read_b64_tr_b16 v[140:141], v169 offset:8192
    v_mfma_f32_16x16x32_bf16 a[216:219], v[156:159], a[152:155], a[216:219]
    buffer_load_dwordx4 a[88:91], v222, s[24:27], s54 offen offset:2048 sc0 sc1
    v_mfma_f32_16x16x32_bf16 a[220:223], v[152:155], a[140:143], a[220:223]
    ds_read_b64_tr_b16 v[142:143], v169 offset:10240
    v_mfma_f32_16x16x32_bf16 a[220:223], v[156:159], a[156:159], a[220:223]
    s_waitcnt lgkmcnt(4)
    v_mfma_f32_16x16x32_bf16 v[224:227], v[128:131], a[128:131], v[224:227]
    ds_read_b64_tr_b16 v[144:145], v170 offset:0
    v_mfma_f32_16x16x32_bf16 v[224:227], v[132:135], a[144:147], v[224:227]
    buffer_load_dwordx4 a[92:95], v222, s[24:27], s54 offen offset:3072 sc0 sc1
    v_mfma_f32_16x16x32_bf16 v[228:231], v[128:131], a[132:135], v[228:231]
    s_add_u32 m0, s66, 73728
    ds_read_b64_tr_b16 v[146:147], v170 offset:2048
    s_add_u32 s55, s65, 290432
    v_mfma_f32_16x16x32_bf16 v[228:231], v[132:135], a[148:151], v[228:231]
    v_mfma_f32_16x16x32_bf16 v[232:235], v[128:131], a[136:139], v[232:235]
    ds_read_b64_tr_b16 v[148:149], v170 offset:8192
    v_mfma_f32_16x16x32_bf16 v[232:235], v[132:135], a[152:155], v[232:235]
    buffer_load_dwordx4 v220, s[44:47], s55 offen lds
    v_mfma_f32_16x16x32_bf16 v[236:239], v[128:131], a[140:143], v[236:239]
    ds_read_b64_tr_b16 v[150:151], v170 offset:10240
    v_mfma_f32_16x16x32_bf16 v[236:239], v[132:135], a[156:159], v[236:239]
    s_waitcnt lgkmcnt(4)
    v_mfma_f32_16x16x32_bf16 a[224:227], v[136:139], a[128:131], a[224:227]
    ds_read_b64_tr_b16 v[152:153], v171 offset:0
    v_mfma_f32_16x16x32_bf16 a[224:227], v[140:143], a[144:147], a[224:227]
    v_mfma_f32_16x16x32_bf16 a[228:231], v[136:139], a[132:135], a[228:231]
    ds_read_b64_tr_b16 v[154:155], v171 offset:2048
    v_mfma_f32_16x16x32_bf16 a[228:231], v[140:143], a[148:151], a[228:231]
    v_mfma_f32_16x16x32_bf16 a[232:235], v[136:139], a[136:139], a[232:235]
    s_waitcnt vmcnt(33)
    s_barrier
    v_mfma_f32_16x16x32_bf16 a[232:235], v[140:143], a[152:155], a[232:235]
    ds_read_b64_tr_b16 v[156:157], v171 offset:8192
    v_mfma_f32_16x16x32_bf16 a[236:239], v[136:139], a[140:143], a[236:239]
    ds_read_b64_tr_b16 v[158:159], v171 offset:10240
    v_mfma_f32_16x16x32_bf16 a[236:239], v[140:143], a[156:159], a[236:239]
    s_waitcnt lgkmcnt(4)
    buffer_load_dwordx4 v221, s[44:47], s55 offen offset:1024 lds
    v_mfma_f32_16x16x32_bf16 v[240:243], v[144:147], a[128:131], v[240:243]
    s_add_u32 s54, s64, 0
    ds_read_b64_tr_b16 v[128:129], v160 offset:0
    v_mfma_f32_16x16x32_bf16 v[240:243], v[148:151], a[144:147], v[240:243]
    buffer_load_dwordx4 a[96:99], v222, s[24:27], s54 offen offset:0 sc0 sc1
    v_mfma_f32_16x16x32_bf16 v[244:247], v[144:147], a[132:135], v[244:247]
    ds_read_b64_tr_b16 v[130:131], v160 offset:2048
    v_mfma_f32_16x16x32_bf16 v[244:247], v[148:151], a[148:151], v[244:247]
    v_mfma_f32_16x16x32_bf16 v[248:251], v[144:147], a[136:139], v[248:251]
    ds_read_b64_tr_b16 v[132:133], v160 offset:8192
    v_mfma_f32_16x16x32_bf16 v[248:251], v[148:151], a[152:155], v[248:251]
    buffer_load_dwordx4 a[100:103], v222, s[24:27], s54 offen offset:1024 sc0 sc1
    v_mfma_f32_16x16x32_bf16 v[252:255], v[144:147], a[140:143], v[252:255]
    ds_read_b64_tr_b16 v[134:135], v160 offset:10240
    v_mfma_f32_16x16x32_bf16 v[252:255], v[148:151], a[156:159], v[252:255]
    s_waitcnt lgkmcnt(4)
    v_mfma_f32_16x16x32_bf16 a[240:243], v[152:155], a[128:131], a[240:243]
    ds_read_b64_tr_b16 v[136:137], v161 offset:0
    v_mfma_f32_16x16x32_bf16 a[240:243], v[156:159], a[144:147], a[240:243]
    buffer_load_dwordx4 a[104:107], v222, s[24:27], s54 offen offset:2048 sc0 sc1
    v_mfma_f32_16x16x32_bf16 a[244:247], v[152:155], a[132:135], a[244:247]
    ds_read_b64_tr_b16 v[138:139], v161 offset:2048
    v_mfma_f32_16x16x32_bf16 a[244:247], v[156:159], a[148:151], a[244:247]
    v_mfma_f32_16x16x32_bf16 a[248:251], v[152:155], a[136:139], a[248:251]
    ds_read_b64_tr_b16 v[140:141], v161 offset:8192
    v_mfma_f32_16x16x32_bf16 a[248:251], v[156:159], a[152:155], a[248:251]
    buffer_load_dwordx4 a[108:111], v222, s[24:27], s54 offen offset:3072 sc0 sc1
    v_mfma_f32_16x16x32_bf16 a[252:255], v[152:155], a[140:143], a[252:255]
    s_add_u32 m0, s66, 147456
    ds_read_b64_tr_b16 v[142:143], v161 offset:10240
    s_add_u32 s55, s65, 128
    v_mfma_f32_16x16x32_bf16 a[252:255], v[156:159], a[156:159], a[252:255]
    s_waitcnt lgkmcnt(4)
    v_mfma_f32_16x16x32_bf16 v[32:35], v[128:131], a[0:3], v[32:35]
    s_add_u32 s52, s75, 18432
    ds_read_b64_tr_b16 v[144:145], v162 offset:0
    v_mfma_f32_16x16x32_bf16 v[32:35], v[132:135], a[16:19], v[32:35]
    buffer_load_dwordx4 v197, s[44:47], s55 offen lds
    v_mfma_f32_16x16x32_bf16 v[36:39], v[128:131], a[4:7], v[36:39]
    ds_read_b64_tr_b16 v[146:147], v162 offset:2048
    v_mfma_f32_16x16x32_bf16 v[36:39], v[132:135], a[20:23], v[36:39]
    buffer_load_dwordx2 v[178:179], v193, s[36:39], s52 offen offset:0
    v_mfma_f32_16x16x32_bf16 v[40:43], v[128:131], a[8:11], v[40:43]
    ds_read_b64_tr_b16 v[148:149], v162 offset:8192
    v_mfma_f32_16x16x32_bf16 v[40:43], v[132:135], a[24:27], v[40:43]
    buffer_load_dwordx2 v[186:187], v193, s[36:39], s52 offen offset:64
    v_mfma_f32_16x16x32_bf16 v[44:47], v[128:131], a[12:15], v[44:47]
    ds_read_b64_tr_b16 v[150:151], v162 offset:10240
    v_mfma_f32_16x16x32_bf16 v[44:47], v[132:135], a[28:31], v[44:47]
    s_waitcnt lgkmcnt(4)
    v_mfma_f32_16x16x32_bf16 a[192:195], v[136:139], a[0:3], a[192:195]
    ds_read_b64_tr_b16 v[152:153], v163 offset:0
    v_mfma_f32_16x16x32_bf16 a[192:195], v[140:143], a[16:19], a[192:195]
    v_mfma_f32_16x16x32_bf16 a[196:199], v[136:139], a[4:7], a[196:199]
    ds_read_b64_tr_b16 v[154:155], v163 offset:2048
    v_mfma_f32_16x16x32_bf16 a[196:199], v[140:143], a[20:23], a[196:199]
    v_mfma_f32_16x16x32_bf16 a[200:203], v[136:139], a[8:11], a[200:203]
    s_waitcnt vmcnt(37)
    s_barrier
    v_mfma_f32_16x16x32_bf16 a[200:203], v[140:143], a[24:27], a[200:203]
    ds_read_b64_tr_b16 v[156:157], v163 offset:8192
    v_mfma_f32_16x16x32_bf16 a[204:207], v[136:139], a[12:15], a[204:207]
    ds_read_b64_tr_b16 v[158:159], v163 offset:10240
    v_mfma_f32_16x16x32_bf16 a[204:207], v[140:143], a[28:31], a[204:207]
    s_waitcnt lgkmcnt(4)
    v_mfma_f32_16x16x32_bf16 v[48:51], v[144:147], a[0:3], v[48:51]
    ds_read_b64_tr_b16 v[128:129], v160 offset:16384
    v_mfma_f32_16x16x32_bf16 v[48:51], v[148:151], a[16:19], v[48:51]
    buffer_load_dwordx4 v198, s[44:47], s55 offen offset:1024 lds
    v_mfma_f32_16x16x32_bf16 v[52:55], v[144:147], a[4:7], v[52:55]
    s_add_u32 s54, s64, 131072
    ds_read_b64_tr_b16 v[130:131], v160 offset:18432
    v_mfma_f32_16x16x32_bf16 v[52:55], v[148:151], a[20:23], v[52:55]
    v_mfma_f32_16x16x32_bf16 v[56:59], v[144:147], a[8:11], v[56:59]
    ds_read_b64_tr_b16 v[132:133], v160 offset:24576
    v_mfma_f32_16x16x32_bf16 v[56:59], v[148:151], a[24:27], v[56:59]
    buffer_load_dwordx4 a[112:115], v222, s[24:27], s54 offen offset:0 sc0 sc1
    v_mfma_f32_16x16x32_bf16 v[60:63], v[144:147], a[12:15], v[60:63]
    ds_read_b64_tr_b16 v[134:135], v160 offset:26624
    v_mfma_f32_16x16x32_bf16 v[60:63], v[148:151], a[28:31], v[60:63]
    s_waitcnt lgkmcnt(4)
    v_mfma_f32_16x16x32_bf16 a[208:211], v[152:155], a[0:3], a[208:211]
    ds_read_b64_tr_b16 v[136:137], v161 offset:16384
    v_mfma_f32_16x16x32_bf16 a[208:211], v[156:159], a[16:19], a[208:211]
    buffer_load_dwordx4 a[116:119], v222, s[24:27], s54 offen offset:1024 sc0 sc1
    v_mfma_f32_16x16x32_bf16 a[212:215], v[152:155], a[4:7], a[212:215]
    ds_read_b64_tr_b16 v[138:139], v161 offset:18432
    v_mfma_f32_16x16x32_bf16 a[212:215], v[156:159], a[20:23], a[212:215]
    v_mfma_f32_16x16x32_bf16 a[216:219], v[152:155], a[8:11], a[216:219]
    ds_read_b64_tr_b16 v[140:141], v161 offset:24576
    v_mfma_f32_16x16x32_bf16 a[216:219], v[156:159], a[24:27], a[216:219]
    buffer_load_dwordx4 a[120:123], v222, s[24:27], s54 offen offset:2048 sc0 sc1
    v_mfma_f32_16x16x32_bf16 a[220:223], v[152:155], a[12:15], a[220:223]
    ds_read_b64_tr_b16 v[142:143], v161 offset:26624
    v_mfma_f32_16x16x32_bf16 a[220:223], v[156:159], a[28:31], a[220:223]
    s_waitcnt lgkmcnt(4)
    v_mfma_f32_16x16x32_bf16 v[224:227], v[128:131], a[0:3], v[224:227]
    ds_read_b64_tr_b16 v[144:145], v162 offset:16384
    v_mfma_f32_16x16x32_bf16 v[224:227], v[132:135], a[16:19], v[224:227]
    v_mfma_f32_16x16x32_bf16 v[228:231], v[128:131], a[4:7], v[228:231]
    ds_read_b64_tr_b16 v[146:147], v162 offset:18432
    v_mfma_f32_16x16x32_bf16 v[228:231], v[132:135], a[20:23], v[228:231]
    v_mfma_f32_16x16x32_bf16 v[232:235], v[128:131], a[8:11], v[232:235]
    ds_read_b64_tr_b16 v[148:149], v162 offset:24576
    v_mfma_f32_16x16x32_bf16 v[232:235], v[132:135], a[24:27], v[232:235]
    buffer_load_dwordx4 a[124:127], v222, s[24:27], s54 offen offset:3072 sc0 sc1
    v_mfma_f32_16x16x32_bf16 v[236:239], v[128:131], a[12:15], v[236:239]
    s_add_u32 m0, s66, 155648
    ds_read_b64_tr_b16 v[150:151], v162 offset:26624
    s_add_u32 s55, s65, 166016
    v_mfma_f32_16x16x32_bf16 v[236:239], v[132:135], a[28:31], v[236:239]
    s_waitcnt lgkmcnt(4)
    v_mfma_f32_16x16x32_bf16 a[224:227], v[136:139], a[0:3], a[224:227]
    ds_read_b64_tr_b16 v[152:153], v163 offset:16384
    v_mfma_f32_16x16x32_bf16 a[224:227], v[140:143], a[16:19], a[224:227]
    buffer_load_dwordx4 v197, s[44:47], s55 offen lds
    v_mfma_f32_16x16x32_bf16 a[228:231], v[136:139], a[4:7], a[228:231]
    ds_read_b64_tr_b16 v[154:155], v163 offset:18432
    v_mfma_f32_16x16x32_bf16 a[228:231], v[140:143], a[20:23], a[228:231]
    v_mfma_f32_16x16x32_bf16 a[232:235], v[136:139], a[8:11], a[232:235]
    s_waitcnt vmcnt(31)
    s_barrier
    v_mfma_f32_16x16x32_bf16 a[232:235], v[140:143], a[24:27], a[232:235]
    ds_read_b64_tr_b16 v[156:157], v163 offset:24576
    v_mfma_f32_16x16x32_bf16 a[236:239], v[136:139], a[12:15], a[236:239]
    ds_read_b64_tr_b16 v[158:159], v163 offset:26624
    v_mfma_f32_16x16x32_bf16 a[236:239], v[140:143], a[28:31], a[236:239]
    s_waitcnt lgkmcnt(4)
    buffer_load_dwordx4 v198, s[44:47], s55 offen offset:1024 lds
    v_mfma_f32_16x16x32_bf16 v[240:243], v[144:147], a[0:3], v[240:243]
    s_add_u32 m0, s66, 81920
    ds_read_b64_tr_b16 v[128:129], v160 offset:32768
    s_add_u32 s55, s65, 207360
    v_mfma_f32_16x16x32_bf16 v[240:243], v[148:151], a[16:19], v[240:243]
    buffer_load_dwordx4 v220, s[44:47], s55 offen lds
    v_mfma_f32_16x16x32_bf16 v[244:247], v[144:147], a[4:7], v[244:247]
    s_add_u32 s52, s75, 36864
    ds_read_b64_tr_b16 v[130:131], v160 offset:34816
    v_mfma_f32_16x16x32_bf16 v[244:247], v[148:151], a[20:23], v[244:247]
    buffer_load_dwordx2 v[180:181], v193, s[36:39], s52 offen offset:0
    v_mfma_f32_16x16x32_bf16 v[248:251], v[144:147], a[8:11], v[248:251]
    ds_read_b64_tr_b16 v[132:133], v160 offset:40960
    v_mfma_f32_16x16x32_bf16 v[248:251], v[148:151], a[24:27], v[248:251]
    buffer_load_dwordx2 v[188:189], v193, s[36:39], s52 offen offset:64
    v_mfma_f32_16x16x32_bf16 v[252:255], v[144:147], a[12:15], v[252:255]
    ds_read_b64_tr_b16 v[134:135], v160 offset:43008
    v_mfma_f32_16x16x32_bf16 v[252:255], v[148:151], a[28:31], v[252:255]
    s_waitcnt lgkmcnt(4)
    v_mfma_f32_16x16x32_bf16 a[240:243], v[152:155], a[0:3], a[240:243]
    ds_read_b64_tr_b16 v[136:137], v161 offset:32768
    v_mfma_f32_16x16x32_bf16 a[240:243], v[156:159], a[16:19], a[240:243]
    v_mfma_f32_16x16x32_bf16 a[244:247], v[152:155], a[4:7], a[244:247]
    ds_read_b64_tr_b16 v[138:139], v161 offset:34816
    v_mfma_f32_16x16x32_bf16 a[244:247], v[156:159], a[20:23], a[244:247]
    v_mfma_f32_16x16x32_bf16 a[248:251], v[152:155], a[8:11], a[248:251]
    ds_read_b64_tr_b16 v[140:141], v161 offset:40960
    v_mfma_f32_16x16x32_bf16 a[248:251], v[156:159], a[24:27], a[248:251]
    v_mfma_f32_16x16x32_bf16 a[252:255], v[152:155], a[12:15], a[252:255]
    ds_read_b64_tr_b16 v[142:143], v161 offset:43008
    v_mfma_f32_16x16x32_bf16 a[252:255], v[156:159], a[28:31], a[252:255]
    s_waitcnt lgkmcnt(4)
    v_mfma_f32_16x16x32_bf16 v[32:35], v[128:131], a[32:35], v[32:35]
    ds_read_b64_tr_b16 v[144:145], v162 offset:32768
    v_mfma_f32_16x16x32_bf16 v[32:35], v[132:135], a[48:51], v[32:35]
    buffer_load_dwordx4 v221, s[44:47], s55 offen offset:1024 lds
    v_mfma_f32_16x16x32_bf16 v[36:39], v[128:131], a[36:39], v[36:39]
    s_add_u32 m0, s66, 90112
    ds_read_b64_tr_b16 v[146:147], v162 offset:34816
    s_add_u32 s55, s65, 290304
    v_mfma_f32_16x16x32_bf16 v[36:39], v[132:135], a[52:55], v[36:39]
    v_mfma_f32_16x16x32_bf16 v[40:43], v[128:131], a[40:43], v[40:43]
    ds_read_b64_tr_b16 v[148:149], v162 offset:40960
    v_mfma_f32_16x16x32_bf16 v[40:43], v[132:135], a[56:59], v[40:43]
    buffer_load_dwordx4 v220, s[44:47], s55 offen lds
    v_mfma_f32_16x16x32_bf16 v[44:47], v[128:131], a[44:47], v[44:47]
    ds_read_b64_tr_b16 v[150:151], v162 offset:43008
    v_mfma_f32_16x16x32_bf16 v[44:47], v[132:135], a[60:63], v[44:47]
    s_waitcnt lgkmcnt(4)
    v_mfma_f32_16x16x32_bf16 a[192:195], v[136:139], a[32:35], a[192:195]
    ds_read_b64_tr_b16 v[152:153], v163 offset:32768
    v_mfma_f32_16x16x32_bf16 a[192:195], v[140:143], a[48:51], a[192:195]
    buffer_load_dwordx4 v221, s[44:47], s55 offen offset:1024 lds
    v_mfma_f32_16x16x32_bf16 a[196:199], v[136:139], a[36:39], a[196:199]
    s_add_u32 m0, s66, 98304
    ds_read_b64_tr_b16 v[154:155], v163 offset:34816
    s_add_u32 s55, s65, 0
    v_mfma_f32_16x16x32_bf16 a[196:199], v[140:143], a[52:55], a[196:199]
    v_mfma_f32_16x16x32_bf16 a[200:203], v[136:139], a[40:43], a[200:203]
    s_waitcnt vmcnt(34)
    s_barrier
    v_mfma_f32_16x16x32_bf16 a[200:203], v[140:143], a[56:59], a[200:203]
    ds_read_b64_tr_b16 v[156:157], v163 offset:40960
    v_mfma_f32_16x16x32_bf16 a[204:207], v[136:139], a[44:47], a[204:207]
    ds_read_b64_tr_b16 v[158:159], v163 offset:43008
    v_mfma_f32_16x16x32_bf16 a[204:207], v[140:143], a[60:63], a[204:207]
    s_waitcnt lgkmcnt(4)
    buffer_load_dwordx4 v197, s[44:47], s55 offen lds
    v_mfma_f32_16x16x32_bf16 v[48:51], v[144:147], a[32:35], v[48:51]
    ds_read_b64_tr_b16 v[128:129], v160 offset:49152
    v_mfma_f32_16x16x32_bf16 v[48:51], v[148:151], a[48:51], v[48:51]
    buffer_load_dwordx4 v198, s[44:47], s55 offen offset:1024 lds
    v_mfma_f32_16x16x32_bf16 v[52:55], v[144:147], a[36:39], v[52:55]
    s_add_u32 m0, s66, 106496
    ds_read_b64_tr_b16 v[130:131], v160 offset:51200
    s_add_u32 s55, s65, 165888
    v_mfma_f32_16x16x32_bf16 v[52:55], v[148:151], a[52:55], v[52:55]
    v_mfma_f32_16x16x32_bf16 v[56:59], v[144:147], a[40:43], v[56:59]
    ds_read_b64_tr_b16 v[132:133], v160 offset:57344
    v_mfma_f32_16x16x32_bf16 v[56:59], v[148:151], a[56:59], v[56:59]
    v_mfma_f32_16x16x32_bf16 v[60:63], v[144:147], a[44:47], v[60:63]
    ds_read_b64_tr_b16 v[134:135], v160 offset:59392
    v_mfma_f32_16x16x32_bf16 v[60:63], v[148:151], a[60:63], v[60:63]
    s_waitcnt lgkmcnt(4)
    v_mfma_f32_16x16x32_bf16 a[208:211], v[152:155], a[32:35], a[208:211]
    ds_read_b64_tr_b16 v[136:137], v161 offset:49152
    v_mfma_f32_16x16x32_bf16 a[208:211], v[156:159], a[48:51], a[208:211]
    buffer_load_dwordx4 v197, s[44:47], s55 offen lds
    v_mfma_f32_16x16x32_bf16 a[212:215], v[152:155], a[36:39], a[212:215]
    ds_read_b64_tr_b16 v[138:139], v161 offset:51200
    v_mfma_f32_16x16x32_bf16 a[212:215], v[156:159], a[52:55], a[212:215]
    v_mfma_f32_16x16x32_bf16 a[216:219], v[152:155], a[40:43], a[216:219]
    ds_read_b64_tr_b16 v[140:141], v161 offset:57344
    v_mfma_f32_16x16x32_bf16 a[216:219], v[156:159], a[56:59], a[216:219]
    buffer_load_dwordx4 v198, s[44:47], s55 offen offset:1024 lds
    v_mfma_f32_16x16x32_bf16 a[220:223], v[152:155], a[44:47], a[220:223]
    s_add_u32 m0, s66, 114688
    ds_read_b64_tr_b16 v[142:143], v161 offset:59392
    s_add_u32 s55, s3, 1327360
    v_mfma_f32_16x16x32_bf16 a[220:223], v[156:159], a[60:63], a[220:223]
    s_waitcnt lgkmcnt(4)
    v_mfma_f32_16x16x32_bf16 v[224:227], v[128:131], a[32:35], v[224:227]
    s_add_u32 s52, s75, 55296
    ds_read_b64_tr_b16 v[144:145], v162 offset:49152
    v_mfma_f32_16x16x32_bf16 v[224:227], v[132:135], a[48:51], v[224:227]
    buffer_load_dwordx4 v220, s[40:43], s55 offen lds
    v_mfma_f32_16x16x32_bf16 v[228:231], v[128:131], a[36:39], v[228:231]
    ds_read_b64_tr_b16 v[146:147], v162 offset:51200
    v_mfma_f32_16x16x32_bf16 v[228:231], v[132:135], a[52:55], v[228:231]
    buffer_load_dwordx2 v[182:183], v193, s[36:39], s52 offen offset:0
    v_mfma_f32_16x16x32_bf16 v[232:235], v[128:131], a[40:43], v[232:235]
    ds_read_b64_tr_b16 v[148:149], v162 offset:57344
    v_mfma_f32_16x16x32_bf16 v[232:235], v[132:135], a[56:59], v[232:235]
    buffer_load_dwordx2 v[190:191], v193, s[36:39], s52 offen offset:64
    v_mfma_f32_16x16x32_bf16 v[236:239], v[128:131], a[44:47], v[236:239]
    ds_read_b64_tr_b16 v[150:151], v162 offset:59392
    v_mfma_f32_16x16x32_bf16 v[236:239], v[132:135], a[60:63], v[236:239]
    s_waitcnt lgkmcnt(4)
    v_mfma_f32_16x16x32_bf16 a[224:227], v[136:139], a[32:35], a[224:227]
    ds_read_b64_tr_b16 v[152:153], v163 offset:49152
    v_mfma_f32_16x16x32_bf16 a[224:227], v[140:143], a[48:51], a[224:227]
    v_mfma_f32_16x16x32_bf16 a[228:231], v[136:139], a[36:39], a[228:231]
    ds_read_b64_tr_b16 v[154:155], v163 offset:51200
    v_mfma_f32_16x16x32_bf16 a[228:231], v[140:143], a[52:55], a[228:231]
    v_mfma_f32_16x16x32_bf16 a[232:235], v[136:139], a[40:43], a[232:235]
    s_waitcnt vmcnt(13)
    s_barrier
    v_mfma_f32_16x16x32_bf16 a[232:235], v[140:143], a[56:59], a[232:235]
    ds_read_b64_tr_b16 v[156:157], v163 offset:57344
    v_mfma_f32_16x16x32_bf16 a[236:239], v[136:139], a[44:47], a[236:239]
    ds_read_b64_tr_b16 v[158:159], v163 offset:59392
    v_mfma_f32_16x16x32_bf16 a[236:239], v[140:143], a[60:63], a[236:239]
    s_waitcnt lgkmcnt(4)
    buffer_load_dwordx4 v221, s[40:43], s55 offen offset:1024 lds
    v_mfma_f32_16x16x32_bf16 v[240:243], v[144:147], a[32:35], v[240:243]
    s_add_u32 m0, s66, 122880
    ds_read_b64_tr_b16 v[128:129], v165 offset:0
    s_add_u32 s55, s14, 1990912
    v_mfma_f32_16x16x32_bf16 v[240:243], v[148:151], a[48:51], v[240:243]
    v_mfma_f32_16x16x32_bf16 v[244:247], v[144:147], a[36:39], v[244:247]
    ds_read_b64_tr_b16 v[130:131], v165 offset:2048
    v_mfma_f32_16x16x32_bf16 v[244:247], v[148:151], a[52:55], v[244:247]
    v_mfma_f32_16x16x32_bf16 v[248:251], v[144:147], a[40:43], v[248:251]
    ds_read_b64_tr_b16 v[132:133], v165 offset:8192
    v_mfma_f32_16x16x32_bf16 v[248:251], v[148:151], a[56:59], v[248:251]
    buffer_load_dwordx4 v220, s[40:43], s55 offen lds
    v_mfma_f32_16x16x32_bf16 v[252:255], v[144:147], a[44:47], v[252:255]
    ds_read_b64_tr_b16 v[134:135], v165 offset:10240
    v_mfma_f32_16x16x32_bf16 v[252:255], v[148:151], a[60:63], v[252:255]
    s_waitcnt lgkmcnt(4)
    v_mfma_f32_16x16x32_bf16 a[240:243], v[152:155], a[32:35], a[240:243]
    ds_read_b64_tr_b16 v[136:137], v167 offset:0
    v_mfma_f32_16x16x32_bf16 a[240:243], v[156:159], a[48:51], a[240:243]
    buffer_load_dwordx4 v221, s[40:43], s55 offen offset:1024 lds
    v_mfma_f32_16x16x32_bf16 a[244:247], v[152:155], a[36:39], a[244:247]
    s_add_u32 m0, s66, 131072
    ds_read_b64_tr_b16 v[138:139], v167 offset:2048
    s_add_u32 s55, s15, 1990912
    v_mfma_f32_16x16x32_bf16 a[244:247], v[156:159], a[52:55], a[244:247]
    v_mfma_f32_16x16x32_bf16 a[248:251], v[152:155], a[40:43], a[248:251]
    ds_read_b64_tr_b16 v[140:141], v167 offset:8192
    v_mfma_f32_16x16x32_bf16 a[248:251], v[156:159], a[56:59], a[248:251]
    buffer_load_dwordx4 v220, s[40:43], s55 offen lds
    v_mfma_f32_16x16x32_bf16 a[252:255], v[152:155], a[44:47], a[252:255]
    ds_read_b64_tr_b16 v[142:143], v167 offset:10240
    v_mfma_f32_16x16x32_bf16 a[252:255], v[156:159], a[60:63], a[252:255]
    s_waitcnt lgkmcnt(4)
    v_mfma_f32_16x16x32_bf16 a[224:227], v[128:131], a[64:67], a[224:227]
    ds_read_b64_tr_b16 v[144:145], v169 offset:16384
    v_mfma_f32_16x16x32_bf16 a[224:227], v[132:135], a[80:83], a[224:227]
    buffer_load_dwordx4 v221, s[40:43], s55 offen offset:1024 lds
    v_mfma_f32_16x16x32_bf16 a[228:231], v[128:131], a[68:71], a[228:231]
    s_add_u32 m0, s66, 139264
    ds_read_b64_tr_b16 v[146:147], v169 offset:18432
    s_add_u32 s55, s3, 1990912
    v_mfma_f32_16x16x32_bf16 a[228:231], v[132:135], a[84:87], a[228:231]
    v_mfma_f32_16x16x32_bf16 a[232:235], v[128:131], a[72:75], a[232:235]
    ds_read_b64_tr_b16 v[148:149], v169 offset:24576
    v_mfma_f32_16x16x32_bf16 a[232:235], v[132:135], a[88:91], a[232:235]
    buffer_load_dwordx4 v220, s[40:43], s55 offen lds
    v_mfma_f32_16x16x32_bf16 a[236:239], v[128:131], a[76:79], a[236:239]
    ds_read_b64_tr_b16 v[150:151], v169 offset:26624
    v_mfma_f32_16x16x32_bf16 a[236:239], v[132:135], a[92:95], a[236:239]
    s_waitcnt lgkmcnt(4)
    v_mfma_f32_16x16x32_bf16 a[240:243], v[136:139], a[64:67], a[240:243]
    s_barrier
    v_mfma_f32_16x16x32_bf16 a[240:243], v[140:143], a[80:83], a[240:243]
    ds_read_b64_tr_b16 v[152:153], v171 offset:16384
    v_mfma_f32_16x16x32_bf16 a[244:247], v[136:139], a[68:71], a[244:247]
    ds_read_b64_tr_b16 v[154:155], v171 offset:18432
    v_mfma_f32_16x16x32_bf16 a[244:247], v[140:143], a[84:87], a[244:247]
    v_mfma_f32_16x16x32_bf16 a[248:251], v[136:139], a[72:75], a[248:251]
    ds_read_b64_tr_b16 v[156:157], v171 offset:24576
    v_mfma_f32_16x16x32_bf16 a[248:251], v[140:143], a[88:91], a[248:251]
    buffer_load_dwordx4 v221, s[40:43], s55 offen offset:1024 lds
    v_mfma_f32_16x16x32_bf16 a[252:255], v[136:139], a[76:79], a[252:255]
    s_add_u32 m0, s66, 0
    ds_read_b64_tr_b16 v[158:159], v171 offset:26624
    s_add_u32 s55, s65, 41728
    v_mfma_f32_16x16x32_bf16 a[252:255], v[140:143], a[92:95], a[252:255]
    s_waitcnt lgkmcnt(4)
    v_mfma_f32_16x16x32_bf16 a[224:227], v[144:147], a[96:99], a[224:227]
    ds_read_b64_tr_b16 v[128:129], v164 offset:0
    v_mfma_f32_16x16x32_bf16 a[224:227], v[148:151], a[112:115], a[224:227]
    buffer_load_dwordx4 v220, s[44:47], s55 offen lds
    v_mfma_f32_16x16x32_bf16 a[228:231], v[144:147], a[100:103], a[228:231]
    ds_read_b64_tr_b16 v[130:131], v164 offset:2048
    v_mfma_f32_16x16x32_bf16 a[228:231], v[148:151], a[116:119], a[228:231]
    v_mfma_f32_16x16x32_bf16 a[232:235], v[144:147], a[104:107], a[232:235]
    ds_read_b64_tr_b16 v[132:133], v164 offset:8192
    v_mfma_f32_16x16x32_bf16 a[232:235], v[148:151], a[120:123], a[232:235]
    buffer_load_dwordx4 v221, s[44:47], s55 offen offset:1024 lds
    v_mfma_f32_16x16x32_bf16 a[236:239], v[144:147], a[108:111], a[236:239]
    s_add_u32 m0, s66, 8192
    ds_read_b64_tr_b16 v[134:135], v164 offset:10240
    s_add_u32 s55, s65, 124672
    v_mfma_f32_16x16x32_bf16 a[236:239], v[148:151], a[124:127], a[236:239]
    s_waitcnt lgkmcnt(4)
    v_mfma_f32_16x16x32_bf16 a[240:243], v[152:155], a[96:99], a[240:243]
    ds_read_b64_tr_b16 v[136:137], v166 offset:0
    v_mfma_f32_16x16x32_bf16 a[240:243], v[156:159], a[112:115], a[240:243]
    buffer_load_dwordx4 v220, s[44:47], s55 offen lds
    v_mfma_f32_16x16x32_bf16 a[244:247], v[152:155], a[100:103], a[244:247]
    ds_read_b64_tr_b16 v[138:139], v166 offset:2048
    v_mfma_f32_16x16x32_bf16 a[244:247], v[156:159], a[116:119], a[244:247]
    v_mfma_f32_16x16x32_bf16 a[248:251], v[152:155], a[104:107], a[248:251]
    ds_read_b64_tr_b16 v[140:141], v166 offset:8192
    v_mfma_f32_16x16x32_bf16 a[248:251], v[156:159], a[120:123], a[248:251]
    buffer_load_dwordx4 v221, s[44:47], s55 offen offset:1024 lds
    v_mfma_f32_16x16x32_bf16 a[252:255], v[152:155], a[108:111], a[252:255]
    s_add_u32 m0, s66, 16384
    ds_read_b64_tr_b16 v[142:143], v166 offset:10240
    s_add_u32 s55, s65, 207616
    v_mfma_f32_16x16x32_bf16 a[252:255], v[156:159], a[124:127], a[252:255]
    s_waitcnt lgkmcnt(4)
    v_mfma_f32_16x16x32_bf16 v[224:227], v[128:131], a[64:67], v[224:227]
    ds_read_b64_tr_b16 v[144:145], v168 offset:16384
    v_mfma_f32_16x16x32_bf16 v[224:227], v[132:135], a[80:83], v[224:227]
    buffer_load_dwordx4 v220, s[44:47], s55 offen lds
    v_mfma_f32_16x16x32_bf16 v[228:231], v[128:131], a[68:71], v[228:231]
    ds_read_b64_tr_b16 v[146:147], v168 offset:18432
    v_mfma_f32_16x16x32_bf16 v[228:231], v[132:135], a[84:87], v[228:231]
    v_mfma_f32_16x16x32_bf16 v[232:235], v[128:131], a[72:75], v[232:235]
    ds_read_b64_tr_b16 v[148:149], v168 offset:24576
    v_mfma_f32_16x16x32_bf16 v[232:235], v[132:135], a[88:91], v[232:235]
    v_mfma_f32_16x16x32_bf16 v[236:239], v[128:131], a[76:79], v[236:239]
    ds_read_b64_tr_b16 v[150:151], v168 offset:26624
    v_mfma_f32_16x16x32_bf16 v[236:239], v[132:135], a[92:95], v[236:239]
    s_waitcnt lgkmcnt(4)
    v_mfma_f32_16x16x32_bf16 v[240:243], v[136:139], a[64:67], v[240:243]
    s_waitcnt vmcnt(19)
    s_barrier
    v_mfma_f32_16x16x32_bf16 v[240:243], v[140:143], a[80:83], v[240:243]
    ds_read_b64_tr_b16 v[152:153], v170 offset:16384
    v_mfma_f32_16x16x32_bf16 v[244:247], v[136:139], a[68:71], v[244:247]
    ds_read_b64_tr_b16 v[154:155], v170 offset:18432
    v_mfma_f32_16x16x32_bf16 v[244:247], v[140:143], a[84:87], v[244:247]
    buffer_load_dwordx4 v221, s[44:47], s55 offen offset:1024 lds
    v_mfma_f32_16x16x32_bf16 v[248:251], v[136:139], a[72:75], v[248:251]
    s_add_u32 m0, s66, 57344
    ds_read_b64_tr_b16 v[156:157], v170 offset:24576
    s_add_u32 s55, s65, 290560
    v_mfma_f32_16x16x32_bf16 v[248:251], v[140:143], a[88:91], v[248:251]
    buffer_load_dwordx4 v220, s[44:47], s55 offen lds
    v_mfma_f32_16x16x32_bf16 v[252:255], v[136:139], a[76:79], v[252:255]
    ds_read_b64_tr_b16 v[158:159], v170 offset:26624
    v_mfma_f32_16x16x32_bf16 v[252:255], v[140:143], a[92:95], v[252:255]
    s_waitcnt lgkmcnt(4)
    ds_write_b128 v195, a[224:227] offset:24576
    v_mfma_f32_16x16x32_bf16 v[224:227], v[144:147], a[96:99], v[224:227]
    ds_read_b64_tr_b16 v[128:129], v165 offset:16384
    v_mfma_f32_16x16x32_bf16 v[224:227], v[148:151], a[112:115], v[224:227]
    buffer_load_dwordx4 v221, s[44:47], s55 offen offset:1024 lds
    v_mfma_f32_16x16x32_bf16 v[228:231], v[144:147], a[100:103], v[228:231]
    ds_read_b64_tr_b16 v[130:131], v165 offset:18432
    v_mfma_f32_16x16x32_bf16 v[228:231], v[148:151], a[116:119], v[228:231]
    ds_write_b128 v195, a[228:231] offset:28672
    v_mfma_f32_16x16x32_bf16 v[232:235], v[144:147], a[104:107], v[232:235]
    ds_read_b64_tr_b16 v[132:133], v165 offset:24576
    v_mfma_f32_16x16x32_bf16 v[232:235], v[148:151], a[120:123], v[232:235]
    ds_write_b128 v195, a[232:235] offset:32768
    v_mfma_f32_16x16x32_bf16 v[236:239], v[144:147], a[108:111], v[236:239]
    ds_read_b64_tr_b16 v[134:135], v165 offset:26624
    v_mfma_f32_16x16x32_bf16 v[236:239], v[148:151], a[124:127], v[236:239]
    s_waitcnt lgkmcnt(7)
    ds_write_b128 v195, a[236:239] offset:36864
    v_mfma_f32_16x16x32_bf16 v[240:243], v[152:155], a[96:99], v[240:243]
    ds_read_b64_tr_b16 v[136:137], v167 offset:16384
    v_mfma_f32_16x16x32_bf16 v[240:243], v[156:159], a[112:115], v[240:243]
    ds_write_b128 v195, a[240:243] offset:40960
    v_mfma_f32_16x16x32_bf16 v[244:247], v[152:155], a[100:103], v[244:247]
    ds_read_b64_tr_b16 v[138:139], v167 offset:18432
    v_mfma_f32_16x16x32_bf16 v[244:247], v[156:159], a[116:119], v[244:247]
    ds_write_b128 v195, a[244:247] offset:45056
    v_mfma_f32_16x16x32_bf16 v[248:251], v[152:155], a[104:107], v[248:251]
    ds_write_b128 v195, a[248:251] offset:49152
    ds_write_b128 v195, a[252:255] offset:53248
    s_waitcnt lgkmcnt(0)
    s_waitcnt vmcnt(18)
    s_barrier
    s_add_u32 m0, s66, 65536
    v_mfma_f32_16x16x32_bf16 v[248:251], v[156:159], a[120:123], v[248:251]
    s_add_u32 s55, s65, 256
    ds_read_b64_tr_b16 v[140:141], v167 offset:24576
    v_mfma_f32_16x16x32_bf16 v[252:255], v[152:155], a[108:111], v[252:255]
    ds_read_b64_tr_b16 v[142:143], v167 offset:26624
    v_mfma_f32_16x16x32_bf16 v[252:255], v[156:159], a[124:127], v[252:255]
    buffer_load_dwordx4 v197, s[44:47], s55 offen lds
    v_mfma_f32_16x16x32_bf16 a[192:195], v[128:131], a[64:67], a[192:195]
    ds_read_b64_tr_b16 v[144:145], v165 offset:32768
    v_mfma_f32_16x16x32_bf16 a[192:195], v[132:135], a[80:83], a[192:195]
    buffer_load_dwordx4 v198, s[44:47], s55 offen offset:1024 lds
    v_mfma_f32_16x16x32_bf16 a[196:199], v[128:131], a[68:71], a[196:199]
    s_add_u32 m0, s66, 73728
    ds_read_b64_tr_b16 v[146:147], v165 offset:34816
    s_add_u32 s55, s65, 166144
    v_mfma_f32_16x16x32_bf16 a[196:199], v[132:135], a[84:87], a[196:199]
    ds_read_b128 v[64:67], v196 offset:24576
    v_mfma_f32_16x16x32_bf16 a[200:203], v[128:131], a[72:75], a[200:203]
    ds_read_b64_tr_b16 v[148:149], v165 offset:40960
    v_mfma_f32_16x16x32_bf16 a[200:203], v[132:135], a[88:91], a[200:203]
    buffer_load_dwordx4 v197, s[44:47], s55 offen lds
    v_mfma_f32_16x16x32_bf16 a[204:207], v[128:131], a[76:79], a[204:207]
    ds_read_b64_tr_b16 v[150:151], v165 offset:43008
    v_mfma_f32_16x16x32_bf16 a[204:207], v[132:135], a[92:95], a[204:207]
    s_waitcnt lgkmcnt(5)
    ds_read_b128 v[68:71], v196 offset:28672
    v_mfma_f32_16x16x32_bf16 a[208:211], v[136:139], a[64:67], a[208:211]
    ds_read_b64_tr_b16 v[152:153], v167 offset:32768
    v_mfma_f32_16x16x32_bf16 a[208:211], v[140:143], a[80:83], a[208:211]
    buffer_load_dwordx4 v198, s[44:47], s55 offen offset:1024 lds
    v_mfma_f32_16x16x32_bf16 a[212:215], v[136:139], a[68:71], a[212:215]
    ds_read_b64_tr_b16 v[154:155], v167 offset:34816
    v_mfma_f32_16x16x32_bf16 a[212:215], v[140:143], a[84:87], a[212:215]
    ds_read_b128 v[72:75], v196 offset:32768
    v_mfma_f32_16x16x32_bf16 a[216:219], v[136:139], a[72:75], a[216:219]
    ds_read_b64_tr_b16 v[156:157], v167 offset:40960
    v_mfma_f32_16x16x32_bf16 a[216:219], v[140:143], a[88:91], a[216:219]
    ds_read_b128 v[76:79], v196 offset:36864
    v_mfma_f32_16x16x32_bf16 a[220:223], v[136:139], a[76:79], a[220:223]
    ds_read_b64_tr_b16 v[158:159], v167 offset:43008
    v_mfma_f32_16x16x32_bf16 a[220:223], v[140:143], a[92:95], a[220:223]
    s_waitcnt lgkmcnt(7)
    ds_read_b128 v[80:83], v196 offset:40960
    ds_read_b128 v[84:87], v196 offset:45056
    ds_read_b128 v[88:91], v196 offset:49152
    ds_read_b128 v[92:95], v196 offset:53248
    s_waitcnt lgkmcnt(0)
    v_mfma_f32_16x16x32_bf16 a[192:195], v[144:147], a[96:99], a[192:195]
    ds_read_b64_tr_b16 v[128:129], v164 offset:16384
    v_add_f32 v224, v224, v64
    v_add_f32 v225, v225, v65
    v_mfma_f32_16x16x32_bf16 a[192:195], v[148:151], a[112:115], a[192:195]
    v_add_f32 v226, v226, v66
    v_add_f32 v227, v227, v67
    v_mfma_f32_16x16x32_bf16 a[196:199], v[144:147], a[100:103], a[196:199]
    ds_read_b64_tr_b16 v[130:131], v164 offset:18432
    v_add_f32 v228, v228, v68
    v_mfma_f32_16x16x32_bf16 a[196:199], v[148:151], a[116:119], a[196:199]
    v_add_f32 v229, v229, v69
    v_add_f32 v230, v230, v70
    v_mfma_f32_16x16x32_bf16 a[200:203], v[144:147], a[104:107], a[200:203]
    ds_read_b64_tr_b16 v[132:133], v164 offset:24576
    v_add_f32 v231, v231, v71
    v_cvt_pk_bf16_f32 v224, v224, v225
    v_mfma_f32_16x16x32_bf16 a[200:203], v[148:151], a[120:123], a[200:203]
    v_cvt_pk_bf16_f32 v225, v226, v227
    v_add_f32 v232, v232, v72
    v_mfma_f32_16x16x32_bf16 a[204:207], v[144:147], a[108:111], a[204:207]
    ds_read_b64_tr_b16 v[134:135], v164 offset:26624
    v_cvt_pk_bf16_f32 v226, v228, v229
    v_mfma_f32_16x16x32_bf16 a[204:207], v[148:151], a[124:127], a[204:207]
    v_cvt_pk_bf16_f32 v227, v230, v231
    v_add_f32 v233, v233, v73
    v_mfma_f32_16x16x32_bf16 a[208:211], v[152:155], a[96:99], a[208:211]
    ds_read_b64_tr_b16 v[136:137], v166 offset:16384
    v_add_f32 v234, v234, v74
    v_add_f32 v235, v235, v75
    v_mfma_f32_16x16x32_bf16 a[208:211], v[156:159], a[112:115], a[208:211]
    buffer_store_dwordx4 v[224:227], v192, s[24:27], s11 offen offset:0 sc0 sc1
    v_add_f32 v236, v236, v76
    v_mfma_f32_16x16x32_bf16 a[212:215], v[152:155], a[100:103], a[212:215]
    ds_read_b64_tr_b16 v[138:139], v166 offset:18432
    v_add_f32 v237, v237, v77
    v_mfma_f32_16x16x32_bf16 a[212:215], v[156:159], a[116:119], a[212:215]
    v_add_f32 v238, v238, v78
    v_add_f32 v239, v239, v79
    v_mfma_f32_16x16x32_bf16 a[216:219], v[152:155], a[104:107], a[216:219]
    ds_read_b64_tr_b16 v[140:141], v166 offset:24576
    v_cvt_pk_bf16_f32 v232, v232, v233
    v_cvt_pk_bf16_f32 v233, v234, v235
    v_mfma_f32_16x16x32_bf16 a[216:219], v[156:159], a[120:123], a[216:219]
    v_cvt_pk_bf16_f32 v234, v236, v237
    v_cvt_pk_bf16_f32 v235, v238, v239
    v_mfma_f32_16x16x32_bf16 a[220:223], v[152:155], a[108:111], a[220:223]
    ds_read_b64_tr_b16 v[142:143], v166 offset:26624
    v_add_f32 v240, v240, v80
    v_mfma_f32_16x16x32_bf16 a[220:223], v[156:159], a[124:127], a[220:223]
    s_waitcnt lgkmcnt(4)
    buffer_store_dwordx4 v[232:235], v192, s[24:27], s11 offen offset:1024 sc0 sc1
    v_add_f32 v241, v241, v81
    v_mfma_f32_16x16x32_bf16 v[32:35], v[128:131], a[64:67], v[32:35]
    ds_read_b64_tr_b16 v[144:145], v164 offset:32768
    v_add_f32 v242, v242, v82
    v_mfma_f32_16x16x32_bf16 v[32:35], v[132:135], a[80:83], v[32:35]
    v_add_f32 v243, v243, v83
    v_add_f32 v244, v244, v84
    v_mfma_f32_16x16x32_bf16 v[36:39], v[128:131], a[68:71], v[36:39]
    ds_read_b64_tr_b16 v[146:147], v164 offset:34816
    v_add_f32 v245, v245, v85
    v_mfma_f32_16x16x32_bf16 v[36:39], v[132:135], a[84:87], v[36:39]
    v_add_f32 v246, v246, v86
    v_add_f32 v247, v247, v87
    v_mfma_f32_16x16x32_bf16 v[40:43], v[128:131], a[72:75], v[40:43]
    ds_read_b64_tr_b16 v[148:149], v164 offset:40960
    v_cvt_pk_bf16_f32 v240, v240, v241
    v_mfma_f32_16x16x32_bf16 v[40:43], v[132:135], a[88:91], v[40:43]
    v_cvt_pk_bf16_f32 v241, v242, v243
    v_add_f32 v248, v248, v88
    v_mfma_f32_16x16x32_bf16 v[44:47], v[128:131], a[76:79], v[44:47]
    ds_read_b64_tr_b16 v[150:151], v164 offset:43008
    v_cvt_pk_bf16_f32 v242, v244, v245
    v_mfma_f32_16x16x32_bf16 v[44:47], v[132:135], a[92:95], v[44:47]
    s_waitcnt lgkmcnt(4)
    v_cvt_pk_bf16_f32 v243, v246, v247
    v_add_f32 v249, v249, v89
    v_mfma_f32_16x16x32_bf16 v[48:51], v[136:139], a[64:67], v[48:51]
    s_waitcnt vmcnt(18)
    s_barrier
    v_add_f32 v250, v250, v90
    v_mfma_f32_16x16x32_bf16 v[48:51], v[140:143], a[80:83], v[48:51]
    ds_read_b64_tr_b16 v[152:153], v166 offset:32768
    v_add_f32 v251, v251, v91
    v_mfma_f32_16x16x32_bf16 v[52:55], v[136:139], a[68:71], v[52:55]
    ds_read_b64_tr_b16 v[154:155], v166 offset:34816
    v_add_f32 v252, v252, v92
    v_mfma_f32_16x16x32_bf16 v[52:55], v[140:143], a[84:87], v[52:55]
    ds_write_b128 v195, a[192:195] offset:24576
    v_mfma_f32_16x16x32_bf16 v[56:59], v[136:139], a[72:75], v[56:59]
    ds_read_b64_tr_b16 v[156:157], v166 offset:40960
    v_add_f32 v253, v253, v93
    v_mfma_f32_16x16x32_bf16 v[56:59], v[140:143], a[88:91], v[56:59]
    ds_write_b128 v195, a[196:199] offset:28672
    v_mfma_f32_16x16x32_bf16 v[60:63], v[136:139], a[76:79], v[60:63]
    ds_read_b64_tr_b16 v[158:159], v166 offset:43008
    v_add_f32 v254, v254, v94
    v_mfma_f32_16x16x32_bf16 v[60:63], v[140:143], a[92:95], v[60:63]
    s_waitcnt lgkmcnt(6)
    ds_write_b128 v195, a[200:203] offset:32768
    v_mfma_f32_16x16x32_bf16 v[32:35], v[144:147], a[96:99], v[32:35]
    ds_read_b64_tr_b16 v[128:129], v165 offset:49152
    v_add_f32 v255, v255, v95
    v_cvt_pk_bf16_f32 v248, v248, v249
    v_mfma_f32_16x16x32_bf16 v[32:35], v[148:151], a[112:115], v[32:35]
    ds_write_b128 v195, a[204:207] offset:36864
    v_cvt_pk_bf16_f32 v249, v250, v251
    v_mfma_f32_16x16x32_bf16 v[36:39], v[144:147], a[100:103], v[36:39]
    ds_read_b64_tr_b16 v[130:131], v165 offset:51200
    v_cvt_pk_bf16_f32 v250, v252, v253
    v_mfma_f32_16x16x32_bf16 v[36:39], v[148:151], a[116:119], v[36:39]
    ds_write_b128 v195, a[208:211] offset:40960
    buffer_store_dwordx4 v[240:243], v192, s[24:27], s20 offen offset:0 sc0 sc1
    v_mfma_f32_16x16x32_bf16 v[40:43], v[144:147], a[104:107], v[40:43]
    ds_read_b64_tr_b16 v[132:133], v165 offset:57344
    v_cvt_pk_bf16_f32 v251, v254, v255
    v_mfma_f32_16x16x32_bf16 v[40:43], v[148:151], a[120:123], v[40:43]
    ds_write_b128 v195, a[212:215] offset:45056
    v_mfma_f32_16x16x32_bf16 v[44:47], v[144:147], a[108:111], v[44:47]
    ds_read_b64_tr_b16 v[134:135], v165 offset:59392
    v_mfma_f32_16x16x32_bf16 v[44:47], v[148:151], a[124:127], v[44:47]
    s_waitcnt lgkmcnt(8)
    ds_write_b128 v195, a[216:219] offset:49152
    buffer_store_dwordx4 v[248:251], v192, s[24:27], s20 offen offset:1024 sc0 sc1
    v_mfma_f32_16x16x32_bf16 v[48:51], v[152:155], a[96:99], v[48:51]
    ds_read_b64_tr_b16 v[136:137], v167 offset:49152
    v_mfma_f32_16x16x32_bf16 v[48:51], v[156:159], a[112:115], v[48:51]
    ds_write_b128 v195, a[220:223] offset:53248
    v_mfma_f32_16x16x32_bf16 v[52:55], v[152:155], a[100:103], v[52:55]
    ds_read_b64_tr_b16 v[138:139], v167 offset:51200
    v_mfma_f32_16x16x32_bf16 v[52:55], v[156:159], a[116:119], v[52:55]
    v_mfma_f32_16x16x32_bf16 v[56:59], v[152:155], a[104:107], v[56:59]
    s_waitcnt lgkmcnt(1)
    s_barrier
    v_mfma_f32_16x16x32_bf16 v[56:59], v[156:159], a[120:123], v[56:59]
    ds_read_b64_tr_b16 v[140:141], v167 offset:57344
    v_mfma_f32_16x16x32_bf16 v[60:63], v[152:155], a[108:111], v[60:63]
    ds_read_b64_tr_b16 v[142:143], v167 offset:59392
    v_mfma_f32_16x16x32_bf16 v[60:63], v[156:159], a[124:127], v[60:63]
    ds_read_b128 v[96:99], v196 offset:24576
    v_mfma_f32_16x16x32_bf16 a[160:163], v[128:131], a[128:131], a[160:163]
    s_waitcnt vmcnt(12)
    s_barrier
    v_mfma_f32_16x16x32_bf16 a[160:163], v[132:135], a[144:147], a[160:163]
    ds_read_b64_tr_b16 v[144:145], v169 offset:0
    v_mfma_f32_16x16x32_bf16 a[164:167], v[128:131], a[132:135], a[164:167]
    ds_read_b64_tr_b16 v[146:147], v169 offset:2048
    v_mfma_f32_16x16x32_bf16 a[164:167], v[132:135], a[148:151], a[164:167]
    ds_read_b128 v[100:103], v196 offset:28672
    v_mfma_f32_16x16x32_bf16 a[168:171], v[128:131], a[136:139], a[168:171]
    ds_read_b64_tr_b16 v[148:149], v169 offset:8192
    v_mfma_f32_16x16x32_bf16 a[168:171], v[132:135], a[152:155], a[168:171]
    ds_read_b128 v[104:107], v196 offset:32768
    v_mfma_f32_16x16x32_bf16 a[172:175], v[128:131], a[140:143], a[172:175]
    ds_read_b64_tr_b16 v[150:151], v169 offset:10240
    v_mfma_f32_16x16x32_bf16 a[172:175], v[132:135], a[156:159], a[172:175]
    s_waitcnt lgkmcnt(7)
    ds_read_b128 v[108:111], v196 offset:36864
    v_mfma_f32_16x16x32_bf16 a[176:179], v[136:139], a[128:131], a[176:179]
    ds_read_b64_tr_b16 v[152:153], v171 offset:0
    v_mfma_f32_16x16x32_bf16 a[176:179], v[140:143], a[144:147], a[176:179]
    ds_read_b128 v[112:115], v196 offset:40960
    v_mfma_f32_16x16x32_bf16 a[180:183], v[136:139], a[132:135], a[180:183]
    ds_read_b64_tr_b16 v[154:155], v171 offset:2048
    v_mfma_f32_16x16x32_bf16 a[180:183], v[140:143], a[148:151], a[180:183]
    ds_read_b128 v[116:119], v196 offset:45056
    v_mfma_f32_16x16x32_bf16 a[184:187], v[136:139], a[136:139], a[184:187]
    ds_read_b64_tr_b16 v[156:157], v171 offset:8192
    v_mfma_f32_16x16x32_bf16 a[184:187], v[140:143], a[152:155], a[184:187]
    ds_read_b128 v[120:123], v196 offset:49152
    v_mfma_f32_16x16x32_bf16 a[188:191], v[136:139], a[140:143], a[188:191]
    ds_read_b64_tr_b16 v[158:159], v171 offset:10240
    v_mfma_f32_16x16x32_bf16 a[188:191], v[140:143], a[156:159], a[188:191]
    s_waitcnt lgkmcnt(8)
    ds_read_b128 v[124:127], v196 offset:53248
    s_waitcnt lgkmcnt(0)
    v_mfma_f32_16x16x32_bf16 a[160:163], v[144:147], a[0:3], a[160:163]
    ds_read_b64_tr_b16 v[128:129], v161 offset:0
    v_add_f32 v32, v32, v96
    v_add_f32 v33, v33, v97
    v_mfma_f32_16x16x32_bf16 a[160:163], v[148:151], a[16:19], a[160:163]
    v_add_f32 v34, v34, v98
    v_add_f32 v35, v35, v99
    v_mfma_f32_16x16x32_bf16 a[164:167], v[144:147], a[4:7], a[164:167]
    ds_read_b64_tr_b16 v[130:131], v161 offset:2048
    v_add_f32 v36, v36, v100
    v_mfma_f32_16x16x32_bf16 a[164:167], v[148:151], a[20:23], a[164:167]
    v_add_f32 v37, v37, v101
    v_add_f32 v38, v38, v102
    v_mfma_f32_16x16x32_bf16 a[168:171], v[144:147], a[8:11], a[168:171]
    ds_read_b64_tr_b16 v[132:133], v161 offset:8192
    v_add_f32 v39, v39, v103
    v_cvt_pk_bf16_f32 v32, v32, v33
    v_mfma_f32_16x16x32_bf16 a[168:171], v[148:151], a[24:27], a[168:171]
    v_cvt_pk_bf16_f32 v33, v34, v35
    v_add_f32 v40, v40, v104
    v_mfma_f32_16x16x32_bf16 a[172:175], v[144:147], a[12:15], a[172:175]
    ds_read_b64_tr_b16 v[134:135], v161 offset:10240
    v_cvt_pk_bf16_f32 v34, v36, v37
    v_mfma_f32_16x16x32_bf16 a[172:175], v[148:151], a[28:31], a[172:175]
    v_cvt_pk_bf16_f32 v35, v38, v39
    v_add_f32 v41, v41, v105
    v_mfma_f32_16x16x32_bf16 a[176:179], v[152:155], a[0:3], a[176:179]
    ds_read_b64_tr_b16 v[136:137], v163 offset:0
    v_add_f32 v42, v42, v106
    v_add_f32 v43, v43, v107
    v_mfma_f32_16x16x32_bf16 a[176:179], v[156:159], a[16:19], a[176:179]
    buffer_store_dwordx4 v[32:35], v192, s[24:27], s6 offen offset:0 sc0 sc1
    v_add_f32 v44, v44, v108
    v_mfma_f32_16x16x32_bf16 a[180:183], v[152:155], a[4:7], a[180:183]
    ds_read_b64_tr_b16 v[138:139], v163 offset:2048
    v_add_f32 v45, v45, v109
    v_mfma_f32_16x16x32_bf16 a[180:183], v[156:159], a[20:23], a[180:183]
    v_add_f32 v46, v46, v110
    v_add_f32 v47, v47, v111
    v_mfma_f32_16x16x32_bf16 a[184:187], v[152:155], a[8:11], a[184:187]
    ds_read_b64_tr_b16 v[140:141], v163 offset:8192
    v_cvt_pk_bf16_f32 v40, v40, v41
    v_cvt_pk_bf16_f32 v41, v42, v43
    v_mfma_f32_16x16x32_bf16 a[184:187], v[156:159], a[24:27], a[184:187]
    v_cvt_pk_bf16_f32 v42, v44, v45
    v_cvt_pk_bf16_f32 v43, v46, v47
    v_mfma_f32_16x16x32_bf16 a[188:191], v[152:155], a[12:15], a[188:191]
    ds_read_b64_tr_b16 v[142:143], v163 offset:10240
    v_add_f32 v48, v48, v112
    v_mfma_f32_16x16x32_bf16 a[188:191], v[156:159], a[28:31], a[188:191]
    s_waitcnt lgkmcnt(4)
    buffer_store_dwordx4 v[40:43], v192, s[24:27], s6 offen offset:1024 sc0 sc1
    v_add_f32 v49, v49, v113
    v_mfma_f32_16x16x32_bf16 a[160:163], v[128:131], a[32:35], a[160:163]
    s_waitcnt vmcnt(6)
    s_barrier
    v_add_f32 v50, v50, v114
    v_mfma_f32_16x16x32_bf16 a[160:163], v[132:135], a[48:51], a[160:163]
    ds_read_b64_tr_b16 v[144:145], v161 offset:16384
    v_add_f32 v51, v51, v115
    v_mfma_f32_16x16x32_bf16 a[164:167], v[128:131], a[36:39], a[164:167]
    ds_read_b64_tr_b16 v[146:147], v161 offset:18432
    v_add_f32 v52, v52, v116
    v_mfma_f32_16x16x32_bf16 a[164:167], v[132:135], a[52:55], a[164:167]
    v_add_f32 v53, v53, v117
    v_add_f32 v54, v54, v118
    v_mfma_f32_16x16x32_bf16 a[168:171], v[128:131], a[40:43], a[168:171]
    ds_read_b64_tr_b16 v[148:149], v161 offset:57344
    v_add_f32 v55, v55, v119
    v_mfma_f32_16x16x32_bf16 a[168:171], v[132:135], a[56:59], a[168:171]
    v_cvt_pk_bf16_f32 v48, v48, v49
    v_add_f32 v56, v56, v120
    v_mfma_f32_16x16x32_bf16 a[172:175], v[128:131], a[44:47], a[172:175]
    ds_read_b64_tr_b16 v[150:151], v161 offset:59392
    v_cvt_pk_bf16_f32 v49, v50, v51
    v_mfma_f32_16x16x32_bf16 a[172:175], v[132:135], a[60:63], a[172:175]
    s_waitcnt lgkmcnt(4)
    v_cvt_pk_bf16_f32 v50, v52, v53
    v_cvt_pk_bf16_f32 v51, v54, v55
    v_mfma_f32_16x16x32_bf16 a[176:179], v[136:139], a[32:35], a[176:179]
    ds_read_b64_tr_b16 v[152:153], v163 offset:16384
    v_add_f32 v57, v57, v121
    v_mfma_f32_16x16x32_bf16 a[176:179], v[140:143], a[48:51], a[176:179]
    buffer_store_dwordx4 v[48:51], v192, s[24:27], s10 offen offset:0 sc0 sc1
    v_add_f32 v58, v58, v122
    v_mfma_f32_16x16x32_bf16 a[180:183], v[136:139], a[36:39], a[180:183]
    ds_read_b64_tr_b16 v[154:155], v163 offset:18432
    v_add_f32 v59, v59, v123
    v_mfma_f32_16x16x32_bf16 a[180:183], v[140:143], a[52:55], a[180:183]
    v_add_f32 v60, v60, v124
    v_add_f32 v61, v61, v125
    v_mfma_f32_16x16x32_bf16 a[184:187], v[136:139], a[40:43], a[184:187]
    ds_read_b64_tr_b16 v[156:157], v163 offset:57344
    v_add_f32 v62, v62, v126
    v_mfma_f32_16x16x32_bf16 a[184:187], v[140:143], a[56:59], a[184:187]
    v_add_f32 v63, v63, v127
    v_cvt_pk_bf16_f32 v56, v56, v57
    v_mfma_f32_16x16x32_bf16 a[188:191], v[136:139], a[44:47], a[188:191]
    ds_read_b64_tr_b16 v[158:159], v163 offset:59392
    v_cvt_pk_bf16_f32 v57, v58, v59
    v_mfma_f32_16x16x32_bf16 a[188:191], v[140:143], a[60:63], a[188:191]
    s_waitcnt lgkmcnt(4)
    v_cvt_pk_bf16_f32 v58, v60, v61
    v_cvt_pk_bf16_f32 v59, v62, v63
    v_mfma_f32_16x16x32_bf16 a[160:163], v[144:147], a[64:67], a[160:163]
    ds_read_b64_tr_b16 v[128:129], v165 offset:0
    v_mfma_f32_16x16x32_bf16 a[160:163], v[148:151], a[80:83], a[160:163]
    buffer_store_dwordx4 v[56:59], v192, s[24:27], s10 offen offset:1024 sc0 sc1
    v_mfma_f32_16x16x32_bf16 a[164:167], v[144:147], a[68:71], a[164:167]
    ds_read_b64_tr_b16 v[130:131], v165 offset:2048
    v_mfma_f32_16x16x32_bf16 a[164:167], v[148:151], a[84:87], a[164:167]
    v_mfma_f32_16x16x32_bf16 a[168:171], v[144:147], a[72:75], a[168:171]
    ds_read_b64_tr_b16 v[132:133], v165 offset:8192
    v_mfma_f32_16x16x32_bf16 a[168:171], v[148:151], a[88:91], a[168:171]
    v_mfma_f32_16x16x32_bf16 a[172:175], v[144:147], a[76:79], a[172:175]
    ds_read_b64_tr_b16 v[134:135], v165 offset:10240
    v_mfma_f32_16x16x32_bf16 a[172:175], v[148:151], a[92:95], a[172:175]
    s_waitcnt lgkmcnt(4)
    v_mfma_f32_16x16x32_bf16 a[176:179], v[152:155], a[64:67], a[176:179]
    ds_read_b64_tr_b16 v[136:137], v167 offset:0
    v_mfma_f32_16x16x32_bf16 a[176:179], v[156:159], a[80:83], a[176:179]
    v_mfma_f32_16x16x32_bf16 a[180:183], v[152:155], a[68:71], a[180:183]
    ds_read_b64_tr_b16 v[138:139], v167 offset:2048
    v_mfma_f32_16x16x32_bf16 a[180:183], v[156:159], a[84:87], a[180:183]
    v_mfma_f32_16x16x32_bf16 a[184:187], v[152:155], a[72:75], a[184:187]
    ds_read_b64_tr_b16 v[140:141], v167 offset:8192
    v_mfma_f32_16x16x32_bf16 a[184:187], v[156:159], a[88:91], a[184:187]
    v_mfma_f32_16x16x32_bf16 a[188:191], v[152:155], a[76:79], a[188:191]
    ds_read_b64_tr_b16 v[142:143], v167 offset:10240
    v_mfma_f32_16x16x32_bf16 a[188:191], v[156:159], a[92:95], a[188:191]
    s_waitcnt lgkmcnt(4)
    v_mfma_f32_16x16x32_bf16 a[160:163], v[128:131], a[96:99], a[160:163]
    ds_read_b64_tr_b16 v[144:145], v164 offset:49152
    v_mfma_f32_16x16x32_bf16 a[160:163], v[132:135], a[112:115], a[160:163]
    v_mfma_f32_16x16x32_bf16 a[164:167], v[128:131], a[100:103], a[164:167]
    ds_read_b64_tr_b16 v[146:147], v164 offset:51200
    v_mfma_f32_16x16x32_bf16 a[164:167], v[132:135], a[116:119], a[164:167]
    v_mfma_f32_16x16x32_bf16 a[168:171], v[128:131], a[104:107], a[168:171]
    ds_read_b64_tr_b16 v[148:149], v164 offset:57344
    v_mfma_f32_16x16x32_bf16 a[168:171], v[132:135], a[120:123], a[168:171]
    v_mfma_f32_16x16x32_bf16 a[172:175], v[128:131], a[108:111], a[172:175]
    ds_read_b64_tr_b16 v[150:151], v164 offset:59392
    v_mfma_f32_16x16x32_bf16 a[172:175], v[132:135], a[124:127], a[172:175]
    s_waitcnt lgkmcnt(4)
    v_mfma_f32_16x16x32_bf16 a[176:179], v[136:139], a[96:99], a[176:179]
    s_mov_b32 s49, s9
    ds_read_b64_tr_b16 v[152:153], v166 offset:49152
    v_mfma_f32_16x16x32_bf16 a[176:179], v[140:143], a[112:115], a[176:179]
    buffer_load_dword v219, v217, s[24:27], s49 offen sc0 sc1
    v_mfma_f32_16x16x32_bf16 a[180:183], v[136:139], a[100:103], a[180:183]
    ds_read_b64_tr_b16 v[154:155], v166 offset:51200
    v_mfma_f32_16x16x32_bf16 a[180:183], v[140:143], a[116:119], a[180:183]
    v_mfma_f32_16x16x32_bf16 a[184:187], v[136:139], a[104:107], a[184:187]
    ds_read_b64_tr_b16 v[156:157], v166 offset:57344
    v_mfma_f32_16x16x32_bf16 a[184:187], v[140:143], a[120:123], a[184:187]
    v_mfma_f32_16x16x32_bf16 a[188:191], v[136:139], a[108:111], a[188:191]
    ds_read_b64_tr_b16 v[158:159], v166 offset:59392
    v_mfma_f32_16x16x32_bf16 a[188:191], v[140:143], a[124:127], a[188:191]
    s_waitcnt lgkmcnt(4)
    v_mfma_f32_16x16x32_bf16 v[0:3], v[144:147], a[128:131], v[0:3]
    ds_read_b64_tr_b16 v[128:129], v168 offset:0
    v_mfma_f32_16x16x32_bf16 v[0:3], v[148:151], a[144:147], v[0:3]
    v_mfma_f32_16x16x32_bf16 v[4:7], v[144:147], a[132:135], v[4:7]
    ds_read_b64_tr_b16 v[130:131], v168 offset:2048
    v_mfma_f32_16x16x32_bf16 v[4:7], v[148:151], a[148:151], v[4:7]
    v_mfma_f32_16x16x32_bf16 v[8:11], v[144:147], a[136:139], v[8:11]
    ds_read_b64_tr_b16 v[132:133], v168 offset:8192
    v_mfma_f32_16x16x32_bf16 v[8:11], v[148:151], a[152:155], v[8:11]
    v_mfma_f32_16x16x32_bf16 v[12:15], v[144:147], a[140:143], v[12:15]
    ds_read_b64_tr_b16 v[134:135], v168 offset:10240
    v_mfma_f32_16x16x32_bf16 v[12:15], v[148:151], a[156:159], v[12:15]
    s_waitcnt lgkmcnt(4)
    v_mfma_f32_16x16x32_bf16 v[16:19], v[152:155], a[128:131], v[16:19]
    s_barrier
    v_mfma_f32_16x16x32_bf16 v[16:19], v[156:159], a[144:147], v[16:19]
    ds_read_b64_tr_b16 v[136:137], v170 offset:0
    v_mfma_f32_16x16x32_bf16 v[20:23], v[152:155], a[132:135], v[20:23]
    ds_read_b64_tr_b16 v[138:139], v170 offset:2048
    v_mfma_f32_16x16x32_bf16 v[20:23], v[156:159], a[148:151], v[20:23]
    ds_write_b128 v195, a[160:163] offset:24576
    v_mfma_f32_16x16x32_bf16 v[24:27], v[152:155], a[136:139], v[24:27]
    ds_read_b64_tr_b16 v[140:141], v170 offset:8192
    v_mfma_f32_16x16x32_bf16 v[24:27], v[156:159], a[152:155], v[24:27]
    ds_write_b128 v195, a[164:167] offset:28672
    v_mfma_f32_16x16x32_bf16 v[28:31], v[152:155], a[140:143], v[28:31]
    ds_read_b64_tr_b16 v[142:143], v170 offset:10240
    v_mfma_f32_16x16x32_bf16 v[28:31], v[156:159], a[156:159], v[28:31]
    s_waitcnt lgkmcnt(6)
    ds_write_b128 v195, a[168:171] offset:32768
    v_mfma_f32_16x16x32_bf16 v[0:3], v[128:131], a[0:3], v[0:3]
    ds_read_b64_tr_b16 v[144:145], v160 offset:0
    v_mfma_f32_16x16x32_bf16 v[0:3], v[132:135], a[16:19], v[0:3]
    ds_write_b128 v195, a[172:175] offset:36864
    v_mfma_f32_16x16x32_bf16 v[4:7], v[128:131], a[4:7], v[4:7]
    ds_read_b64_tr_b16 v[146:147], v160 offset:2048
    v_mfma_f32_16x16x32_bf16 v[4:7], v[132:135], a[20:23], v[4:7]
    ds_write_b128 v195, a[176:179] offset:40960
    v_mfma_f32_16x16x32_bf16 v[8:11], v[128:131], a[8:11], v[8:11]
    ds_read_b64_tr_b16 v[148:149], v160 offset:8192
    v_mfma_f32_16x16x32_bf16 v[8:11], v[132:135], a[24:27], v[8:11]
    ds_write_b128 v195, a[180:183] offset:45056
    v_mfma_f32_16x16x32_bf16 v[12:15], v[128:131], a[12:15], v[12:15]
    ds_read_b64_tr_b16 v[150:151], v160 offset:10240
    v_mfma_f32_16x16x32_bf16 v[12:15], v[132:135], a[28:31], v[12:15]
    s_waitcnt lgkmcnt(8)
    ds_write_b128 v195, a[184:187] offset:49152
    v_mfma_f32_16x16x32_bf16 v[16:19], v[136:139], a[0:3], v[16:19]
    s_waitcnt vmcnt(1)
    s_barrier
    v_mfma_f32_16x16x32_bf16 v[16:19], v[140:143], a[16:19], v[16:19]
    ds_read_b64_tr_b16 v[152:153], v162 offset:0
    v_mfma_f32_16x16x32_bf16 v[20:23], v[136:139], a[4:7], v[20:23]
    ds_read_b64_tr_b16 v[154:155], v162 offset:2048
    v_mfma_f32_16x16x32_bf16 v[20:23], v[140:143], a[20:23], v[20:23]
    ds_write_b128 v195, a[188:191] offset:53248
    v_mfma_f32_16x16x32_bf16 v[24:27], v[136:139], a[8:11], v[24:27]
    s_waitcnt lgkmcnt(0)
    s_barrier
    s_lshl2_add_u32 s49, s67, s9
    v_mfma_f32_16x16x32_bf16 v[24:27], v[140:143], a[24:27], v[24:27]
    s_add_u32 s49, s49, 32
    ds_read_b64_tr_b16 v[156:157], v162 offset:8192
    v_mfma_f32_16x16x32_bf16 v[28:31], v[136:139], a[12:15], v[28:31]
    ds_read_b64_tr_b16 v[158:159], v162 offset:10240
    v_mfma_f32_16x16x32_bf16 v[28:31], v[140:143], a[28:31], v[28:31]
    buffer_store_dword v218, v216, s[24:27], s49 offen sc0 sc1
    v_mfma_f32_16x16x32_bf16 v[0:3], v[144:147], a[32:35], v[0:3]
    ds_read_b64_tr_b16 v[128:129], v160 offset:16384
    v_mfma_f32_16x16x32_bf16 v[0:3], v[148:151], a[48:51], v[0:3]
    ds_read_b128 v[64:67], v196 offset:24576
    v_mfma_f32_16x16x32_bf16 v[4:7], v[144:147], a[36:39], v[4:7]
    ds_read_b64_tr_b16 v[130:131], v160 offset:18432
    v_mfma_f32_16x16x32_bf16 v[4:7], v[148:151], a[52:55], v[4:7]
    ds_read_b128 v[68:71], v196 offset:28672
    v_mfma_f32_16x16x32_bf16 v[8:11], v[144:147], a[40:43], v[8:11]
    ds_read_b64_tr_b16 v[132:133], v160 offset:57344
    v_mfma_f32_16x16x32_bf16 v[8:11], v[148:151], a[56:59], v[8:11]
    ds_read_b128 v[72:75], v196 offset:32768
    v_mfma_f32_16x16x32_bf16 v[12:15], v[144:147], a[44:47], v[12:15]
    ds_read_b64_tr_b16 v[134:135], v160 offset:59392
    v_mfma_f32_16x16x32_bf16 v[12:15], v[148:151], a[60:63], v[12:15]
    s_waitcnt lgkmcnt(7)
    ds_read_b128 v[76:79], v196 offset:36864
    v_mfma_f32_16x16x32_bf16 v[16:19], v[152:155], a[32:35], v[16:19]
    ds_read_b64_tr_b16 v[136:137], v162 offset:16384
    v_mfma_f32_16x16x32_bf16 v[16:19], v[156:159], a[48:51], v[16:19]
    ds_read_b128 v[80:83], v196 offset:40960
    v_mfma_f32_16x16x32_bf16 v[20:23], v[152:155], a[36:39], v[20:23]
    ds_read_b64_tr_b16 v[138:139], v162 offset:18432
    v_mfma_f32_16x16x32_bf16 v[20:23], v[156:159], a[52:55], v[20:23]
    ds_read_b128 v[84:87], v196 offset:45056
    v_mfma_f32_16x16x32_bf16 v[24:27], v[152:155], a[40:43], v[24:27]
    ds_read_b64_tr_b16 v[140:141], v162 offset:57344
    v_mfma_f32_16x16x32_bf16 v[24:27], v[156:159], a[56:59], v[24:27]
    ds_read_b128 v[88:91], v196 offset:49152
    v_mfma_f32_16x16x32_bf16 v[28:31], v[152:155], a[44:47], v[28:31]
    ds_read_b64_tr_b16 v[142:143], v162 offset:59392
    v_mfma_f32_16x16x32_bf16 v[28:31], v[156:159], a[60:63], v[28:31]
    s_waitcnt lgkmcnt(8)
    ds_read_b128 v[92:95], v196 offset:53248
    v_mfma_f32_16x16x32_bf16 v[0:3], v[128:131], a[64:67], v[0:3]
    ds_read_b64_tr_b16 v[144:145], v164 offset:0
    v_mfma_f32_16x16x32_bf16 v[0:3], v[132:135], a[80:83], v[0:3]
    s_waitcnt vmcnt(1)
    v_cmp_eq_u32 vcc, s79, v219
    v_mfma_f32_16x16x32_bf16 v[4:7], v[128:131], a[68:71], v[4:7]
    ds_read_b64_tr_b16 v[146:147], v164 offset:2048
    v_mfma_f32_16x16x32_bf16 v[4:7], v[132:135], a[84:87], v[4:7]
    s_andn2_b32 s61, 0xf, vcc_lo
    s_cbranch_scc1 Lslow_45
Lback_46:
    s_add_u32 s58, s73, 0
    v_mfma_f32_16x16x32_bf16 v[8:11], v[128:131], a[72:75], v[8:11]
    ds_read_b64_tr_b16 v[148:149], v164 offset:8192
    v_mfma_f32_16x16x32_bf16 v[8:11], v[132:135], a[88:91], v[8:11]
    buffer_load_dwordx4 v[96:99], v192, s[24:27], s58 offen offset:0 sc0 sc1
    v_mfma_f32_16x16x32_bf16 v[12:15], v[128:131], a[76:79], v[12:15]
    ds_read_b64_tr_b16 v[150:151], v164 offset:10240
    v_mfma_f32_16x16x32_bf16 v[12:15], v[132:135], a[92:95], v[12:15]
    s_waitcnt lgkmcnt(5)
    buffer_load_dwordx4 v[100:103], v192, s[24:27], s58 offen offset:1024 sc0 sc1
    v_mfma_f32_16x16x32_bf16 v[16:19], v[136:139], a[64:67], v[16:19]
    s_add_u32 s58, s58, 131072
    ds_read_b64_tr_b16 v[152:153], v166 offset:0
    v_mfma_f32_16x16x32_bf16 v[16:19], v[140:143], a[80:83], v[16:19]
    buffer_load_dwordx4 v[104:107], v192, s[24:27], s58 offen offset:0 sc0 sc1
    v_mfma_f32_16x16x32_bf16 v[20:23], v[136:139], a[68:71], v[20:23]
    ds_read_b64_tr_b16 v[154:155], v166 offset:2048
    v_mfma_f32_16x16x32_bf16 v[20:23], v[140:143], a[84:87], v[20:23]
    buffer_load_dwordx4 v[108:111], v192, s[24:27], s58 offen offset:1024 sc0 sc1
    v_mfma_f32_16x16x32_bf16 v[24:27], v[136:139], a[72:75], v[24:27]
    s_add_u32 s58, s73, 2359296
    ds_read_b64_tr_b16 v[156:157], v166 offset:8192
    v_mfma_f32_16x16x32_bf16 v[24:27], v[140:143], a[88:91], v[24:27]
    buffer_load_dwordx4 v[112:115], v192, s[24:27], s58 offen offset:0 sc0 sc1
    v_mfma_f32_16x16x32_bf16 v[28:31], v[136:139], a[76:79], v[28:31]
    ds_read_b64_tr_b16 v[158:159], v166 offset:10240
    v_mfma_f32_16x16x32_bf16 v[28:31], v[140:143], a[92:95], v[28:31]
    s_waitcnt lgkmcnt(4)
    buffer_load_dwordx4 v[116:119], v192, s[24:27], s58 offen offset:1024 sc0 sc1
    v_mfma_f32_16x16x32_bf16 v[0:3], v[144:147], a[96:99], v[0:3]
    s_add_u32 s58, s58, 131072
    v_mfma_f32_16x16x32_bf16 v[0:3], v[148:151], a[112:115], v[0:3]
    buffer_load_dwordx4 v[120:123], v192, s[24:27], s58 offen offset:0 sc0 sc1
    v_mfma_f32_16x16x32_bf16 v[4:7], v[144:147], a[100:103], v[4:7]
    buffer_load_dwordx4 v[124:127], v192, s[24:27], s58 offen offset:1024 sc0 sc1
    v_mfma_f32_16x16x32_bf16 v[4:7], v[148:151], a[116:119], v[4:7]
    s_add_u32 s58, s73, 4718592
    v_mfma_f32_16x16x32_bf16 v[8:11], v[144:147], a[104:107], v[8:11]
    buffer_load_dwordx4 v[32:35], v192, s[24:27], s58 offen offset:0 sc0 sc1
    v_mfma_f32_16x16x32_bf16 v[8:11], v[148:151], a[120:123], v[8:11]
    buffer_load_dwordx4 v[36:39], v192, s[24:27], s58 offen offset:1024 sc0 sc1
    v_mfma_f32_16x16x32_bf16 v[12:15], v[144:147], a[108:111], v[12:15]
    s_add_u32 s58, s58, 131072
    v_mfma_f32_16x16x32_bf16 v[12:15], v[148:151], a[124:127], v[12:15]
    s_waitcnt lgkmcnt(0)
    buffer_load_dwordx4 v[40:43], v192, s[24:27], s58 offen offset:0 sc0 sc1
    v_mfma_f32_16x16x32_bf16 v[16:19], v[152:155], a[96:99], v[16:19]
    buffer_load_dwordx4 v[44:47], v192, s[24:27], s58 offen offset:1024 sc0 sc1
    v_mfma_f32_16x16x32_bf16 v[16:19], v[156:159], a[112:115], v[16:19]
    s_add_u32 s58, s73, 7077888
    v_mfma_f32_16x16x32_bf16 v[20:23], v[152:155], a[100:103], v[20:23]
    buffer_load_dwordx4 v[48:51], v192, s[24:27], s58 offen offset:0 sc0 sc1
    v_mfma_f32_16x16x32_bf16 v[20:23], v[156:159], a[116:119], v[20:23]
    buffer_load_dwordx4 v[52:55], v192, s[24:27], s58 offen offset:1024 sc0 sc1
    v_mfma_f32_16x16x32_bf16 v[24:27], v[152:155], a[104:107], v[24:27]
    s_add_u32 s58, s58, 131072
    v_mfma_f32_16x16x32_bf16 v[24:27], v[156:159], a[120:123], v[24:27]
    buffer_load_dwordx4 v[56:59], v192, s[24:27], s58 offen offset:0 sc0 sc1
    v_mfma_f32_16x16x32_bf16 v[28:31], v[152:155], a[108:111], v[28:31]
    buffer_load_dwordx4 v[60:63], v192, s[24:27], s58 offen offset:1024 sc0 sc1
    v_mfma_f32_16x16x32_bf16 v[28:31], v[156:159], a[124:127], v[28:31]
    s_nop 7
Lfw_48:
    v_pk_add_f32 v[0:1], v[0:1], v[64:65]
    v_pk_add_f32 v[2:3], v[2:3], v[66:67]
    v_pk_add_f32 v[4:5], v[4:5], v[68:69]
    v_pk_add_f32 v[6:7], v[6:7], v[70:71]
    v_pk_add_f32 v[8:9], v[8:9], v[72:73]
    v_pk_add_f32 v[10:11], v[10:11], v[74:75]
    v_pk_add_f32 v[12:13], v[12:13], v[76:77]
    v_pk_add_f32 v[14:15], v[14:15], v[78:79]
    v_dot2_f32_bf16 v0, v176, s76, v0
    v_dot2_f32_bf16 v1, v176, s77, v1
    v_dot2_f32_bf16 v2, v177, s76, v2
    v_dot2_f32_bf16 v3, v177, s77, v3
    v_dot2_f32_bf16 v4, v178, s76, v4
    v_dot2_f32_bf16 v5, v178, s77, v5
    v_dot2_f32_bf16 v6, v179, s76, v6
    v_dot2_f32_bf16 v7, v179, s77, v7
    v_dot2_f32_bf16 v8, v180, s76, v8
    v_dot2_f32_bf16 v9, v180, s77, v9
    v_dot2_f32_bf16 v10, v181, s76, v10
    v_dot2_f32_bf16 v11, v181, s77, v11
    v_dot2_f32_bf16 v12, v182, s76, v12
    v_dot2_f32_bf16 v13, v182, s77, v13
    v_dot2_f32_bf16 v14, v183, s76, v14
    v_dot2_f32_bf16 v15, v183, s77, v15
    v_pk_add_f32 v[16:17], v[16:17], v[80:81]
    v_pk_add_f32 v[18:19], v[18:19], v[82:83]
    v_pk_add_f32 v[20:21], v[20:21], v[84:85]
    v_pk_add_f32 v[22:23], v[22:23], v[86:87]
    v_pk_add_f32 v[24:25], v[24:25], v[88:89]
    v_pk_add_f32 v[26:27], v[26:27], v[90:91]
    v_pk_add_f32 v[28:29], v[28:29], v[92:93]
    v_pk_add_f32 v[30:31], v[30:31], v[94:95]
    v_dot2_f32_bf16 v16, v184, s76, v16
    v_dot2_f32_bf16 v17, v184, s77, v17
    v_dot2_f32_bf16 v18, v185, s76, v18
    v_dot2_f32_bf16 v19, v185, s77, v19
    v_dot2_f32_bf16 v20, v186, s76, v20
    v_dot2_f32_bf16 v21, v186, s77, v21
    v_dot2_f32_bf16 v22, v187, s76, v22
    v_dot2_f32_bf16 v23, v187, s77, v23
    v_dot2_f32_bf16 v24, v188, s76, v24
    v_dot2_f32_bf16 v25, v188, s77, v25
    v_dot2_f32_bf16 v26, v189, s76, v26
    v_dot2_f32_bf16 v27, v189, s77, v27
    v_dot2_f32_bf16 v28, v190, s76, v28
    v_dot2_f32_bf16 v29, v190, s77, v29
    v_dot2_f32_bf16 v30, v191, s76, v30
    v_dot2_f32_bf16 v31, v191, s77, v31
    s_waitcnt vmcnt(12)
    v_dot2_f32_bf16 v0, v96, s76, v0
    v_dot2_f32_bf16 v1, v96, s77, v1
    v_dot2_f32_bf16 v2, v97, s76, v2
    v_dot2_f32_bf16 v3, v97, s77, v3
    v_dot2_f32_bf16 v4, v98, s76, v4
    v_dot2_f32_bf16 v5, v98, s77, v5
    v_dot2_f32_bf16 v6, v99, s76, v6
    v_dot2_f32_bf16 v7, v99, s77, v7
    v_dot2_f32_bf16 v8, v100, s76, v8
    v_dot2_f32_bf16 v9, v100, s77, v9
    v_dot2_f32_bf16 v10, v101, s76, v10
    v_dot2_f32_bf16 v11, v101, s77, v11
    v_dot2_f32_bf16 v12, v102, s76, v12
    v_dot2_f32_bf16 v13, v102, s77, v13
    v_dot2_f32_bf16 v14, v103, s76, v14
    v_dot2_f32_bf16 v15, v103, s77, v15
    v_dot2_f32_bf16 v16, v104, s76, v16
    v_dot2_f32_bf16 v17, v104, s77, v17
    v_dot2_f32_bf16 v18, v105, s76, v18
    v_dot2_f32_bf16 v19, v105, s77, v19
    v_dot2_f32_bf16 v20, v106, s76, v20
    v_dot2_f32_bf16 v21, v106, s77, v21
    v_dot2_f32_bf16 v22, v107, s76, v22
    v_dot2_f32_bf16 v23, v107, s77, v23
    v_dot2_f32_bf16 v24, v108, s76, v24
    v_dot2_f32_bf16 v25, v108, s77, v25
    v_dot2_f32_bf16 v26, v109, s76, v26
    v_dot2_f32_bf16 v27, v109, s77, v27
    v_dot2_f32_bf16 v28, v110, s76, v28
    v_dot2_f32_bf16 v29, v110, s77, v29
    v_dot2_f32_bf16 v30, v111, s76, v30
    v_dot2_f32_bf16 v31, v111, s77, v31
    s_waitcnt vmcnt(8)
    v_dot2_f32_bf16 v0, v112, s76, v0
    v_dot2_f32_bf16 v1, v112, s77, v1
    v_dot2_f32_bf16 v2, v113, s76, v2
    v_dot2_f32_bf16 v3, v113, s77, v3
    v_dot2_f32_bf16 v4, v114, s76, v4
    v_dot2_f32_bf16 v5, v114, s77, v5
    v_dot2_f32_bf16 v6, v115, s76, v6
    v_dot2_f32_bf16 v7, v115, s77, v7
    v_dot2_f32_bf16 v8, v116, s76, v8
    v_dot2_f32_bf16 v9, v116, s77, v9
    v_dot2_f32_bf16 v10, v117, s76, v10
    v_dot2_f32_bf16 v11, v117, s77, v11
    v_dot2_f32_bf16 v12, v118, s76, v12
    v_dot2_f32_bf16 v13, v118, s77, v13
    v_dot2_f32_bf16 v14, v119, s76, v14
    v_dot2_f32_bf16 v15, v119, s77, v15
    v_dot2_f32_bf16 v16, v120, s76, v16
    v_dot2_f32_bf16 v17, v120, s77, v17
    v_dot2_f32_bf16 v18, v121, s76, v18
    v_dot2_f32_bf16 v19, v121, s77, v19
    v_dot2_f32_bf16 v20, v122, s76, v20
    v_dot2_f32_bf16 v21, v122, s77, v21
    v_dot2_f32_bf16 v22, v123, s76, v22
    v_dot2_f32_bf16 v23, v123, s77, v23
    v_dot2_f32_bf16 v24, v124, s76, v24
    v_dot2_f32_bf16 v25, v124, s77, v25
    v_dot2_f32_bf16 v26, v125, s76, v26
    v_dot2_f32_bf16 v27, v125, s77, v27
    v_dot2_f32_bf16 v28, v126, s76, v28
    v_dot2_f32_bf16 v29, v126, s77, v29
    v_dot2_f32_bf16 v30, v127, s76, v30
    v_dot2_f32_bf16 v31, v127, s77, v31
    s_waitcnt vmcnt(4)
    v_dot2_f32_bf16 v0, v32, s76, v0
    v_dot2_f32_bf16 v1, v32, s77, v1
    v_dot2_f32_bf16 v2, v33, s76, v2
    v_dot2_f32_bf16 v3, v33, s77, v3
    v_dot2_f32_bf16 v4, v34, s76, v4
    v_dot2_f32_bf16 v5, v34, s77, v5
    v_dot2_f32_bf16 v6, v35, s76, v6
    v_dot2_f32_bf16 v7, v35, s77, v7
    v_dot2_f32_bf16 v8, v36, s76, v8
    v_dot2_f32_bf16 v9, v36, s77, v9
    v_dot2_f32_bf16 v10, v37, s76, v10
    v_dot2_f32_bf16 v11, v37, s77, v11
    v_dot2_f32_bf16 v12, v38, s76, v12
    v_dot2_f32_bf16 v13, v38, s77, v13
    v_dot2_f32_bf16 v14, v39, s76, v14
    v_dot2_f32_bf16 v15, v39, s77, v15
    v_dot2_f32_bf16 v16, v40, s76, v16
    v_dot2_f32_bf16 v17, v40, s77, v17
    v_dot2_f32_bf16 v18, v41, s76, v18
    v_dot2_f32_bf16 v19, v41, s77, v19
    v_dot2_f32_bf16 v20, v42, s76, v20
    v_dot2_f32_bf16 v21, v42, s77, v21
    v_dot2_f32_bf16 v22, v43, s76, v22
    v_dot2_f32_bf16 v23, v43, s77, v23
    v_dot2_f32_bf16 v24, v44, s76, v24
    v_dot2_f32_bf16 v25, v44, s77, v25
    v_dot2_f32_bf16 v26, v45, s76, v26
    v_dot2_f32_bf16 v27, v45, s77, v27
    v_dot2_f32_bf16 v28, v46, s76, v28
    v_dot2_f32_bf16 v29, v46, s77, v29
    v_dot2_f32_bf16 v30, v47, s76, v30
    v_dot2_f32_bf16 v31, v47, s77, v31
    s_waitcnt vmcnt(0)
    v_dot2_f32_bf16 v0, v48, s76, v0
    v_dot2_f32_bf16 v1, v48, s77, v1
    v_dot2_f32_bf16 v2, v49, s76, v2
    v_dot2_f32_bf16 v3, v49, s77, v3
    v_dot2_f32_bf16 v4, v50, s76, v4
    v_dot2_f32_bf16 v5, v50, s77, v5
    v_dot2_f32_bf16 v6, v51, s76, v6
    v_dot2_f32_bf16 v7, v51, s77, v7
    v_dot2_f32_bf16 v8, v52, s76, v8
    v_dot2_f32_bf16 v9, v52, s77, v9
    v_dot2_f32_bf16 v10, v53, s76, v10
    v_dot2_f32_bf16 v11, v53, s77, v11
    v_dot2_f32_bf16 v12, v54, s76, v12
    v_dot2_f32_bf16 v13, v54, s77, v13
    v_dot2_f32_bf16 v14, v55, s76, v14
    v_dot2_f32_bf16 v15, v55, s77, v15
    v_dot2_f32_bf16 v16, v56, s76, v16
    v_dot2_f32_bf16 v17, v56, s77, v17
    v_dot2_f32_bf16 v18, v57, s76, v18
    v_dot2_f32_bf16 v19, v57, s77, v19
    v_dot2_f32_bf16 v20, v58, s76, v20
    v_dot2_f32_bf16 v21, v58, s77, v21
    v_dot2_f32_bf16 v22, v59, s76, v22
    v_dot2_f32_bf16 v23, v59, s77, v23
    v_dot2_f32_bf16 v24, v60, s76, v24
    v_dot2_f32_bf16 v25, v60, s77, v25
    v_dot2_f32_bf16 v26, v61, s76, v26
    v_dot2_f32_bf16 v27, v61, s77, v27
    v_dot2_f32_bf16 v28, v62, s76, v28
    v_dot2_f32_bf16 v29, v62, s77, v29
    v_dot2_f32_bf16 v30, v63, s76, v30
    v_dot2_f32_bf16 v31, v63, s77, v31
    s_nop 2
    v_cvt_pk_bf16_f32 v0, v0, v1
    v_cvt_pk_bf16_f32 v1, v2, v3
    v_cvt_pk_bf16_f32 v2, v4, v5
    v_cvt_pk_bf16_f32 v3, v6, v7
    v_cvt_pk_bf16_f32 v4, v8, v9
    v_cvt_pk_bf16_f32 v5, v10, v11
    v_cvt_pk_bf16_f32 v6, v12, v13
    v_cvt_pk_bf16_f32 v7, v14, v15
    s_add_u32 s52, s75, 0
    buffer_store_dwordx2 v[0:1], v193, s[28:31], s52 offen offset:0
    s_add_u32 s52, s75, 18432
    buffer_store_dwordx2 v[2:3], v193, s[28:31], s52 offen offset:0
    s_add_u32 s52, s75, 36864
    buffer_store_dwordx2 v[4:5], v193, s[28:31], s52 offen offset:0
    s_add_u32 s52, s75, 55296
    buffer_store_dwordx2 v[6:7], v193, s[28:31], s52 offen offset:0
    v_cvt_pk_bf16_f32 v16, v16, v17
    v_cvt_pk_bf16_f32 v17, v18, v19
    v_cvt_pk_bf16_f32 v18, v20, v21
    v_cvt_pk_bf16_f32 v19, v22, v23
    v_cvt_pk_bf16_f32 v20, v24, v25
    v_cvt_pk_bf16_f32 v21, v26, v27
    v_cvt_pk_bf16_f32 v22, v28, v29
    v_cvt_pk_bf16_f32 v23, v30, v31
    s_add_u32 s52, s75, 0
    buffer_store_dwordx2 v[16:17], v193, s[28:31], s52 offen offset:64
    s_add_u32 s52, s75, 18432
    buffer_store_dwordx2 v[18:19], v193, s[28:31], s52 offen offset:64
    s_add_u32 s52, s75, 36864
    buffer_store_dwordx2 v[20:21], v193, s[28:31], s52 offen offset:64
    s_add_u32 s52, s75, 55296
    buffer_store_dwordx2 v[22:23], v193, s[28:31], s52 offen offset:64
    s_branch L_final
Lslow_2:
    s_mov_b32 s59, 40000
Lspin_4:
    s_sleep 1
    s_mov_b32 s49, s83
    buffer_load_dword v219, v217, s[24:27], s49 offen sc0 sc1
    s_waitcnt vmcnt(0)
    v_cmp_eq_u32 vcc, s79, v219
    s_andn2_b32 s61, 0xff, vcc_lo
    s_cbranch_scc0 Lback_3
    s_sub_u32 s59, s59, 1
    s_cmp_lg_u32 s59, 0
    s_cbranch_scc1 Lspin_4
    s_branch Lback_3
Lslow_5:
    s_mov_b32 s59, 40000
Lspin_7:
    s_sleep 1
    s_mov_b32 s49, 0
    buffer_load_dwordx4 v[200:203], v223, s[24:27], s49 offen offset:0 sc0 sc1
    buffer_load_dwordx4 v[204:207], v223, s[24:27], s49 offen offset:256 sc0 sc1
    buffer_load_dwordx4 v[208:211], v223, s[24:27], s49 offen offset:512 sc0 sc1
    buffer_load_dwordx4 v[212:215], v223, s[24:27], s49 offen offset:768 sc0 sc1
    s_waitcnt vmcnt(0)
    v_cmp_eq_u32 s[60:61], s79, v201
    v_cmp_eq_u32 vcc, s79, v203
    s_and_b64 s[60:61], s[60:61], vcc
    v_cmp_eq_u32 vcc, s79, v205
    s_and_b64 s[60:61], s[60:61], vcc
    v_cmp_eq_u32 vcc, s79, v207
    s_and_b64 s[60:61], s[60:61], vcc
    v_cmp_eq_u32 vcc, s79, v209
    s_and_b64 s[60:61], s[60:61], vcc
    v_cmp_eq_u32 vcc, s79, v211
    s_and_b64 s[60:61], s[60:61], vcc
    v_cmp_eq_u32 vcc, s79, v213
    s_and_b64 s[60:61], s[60:61], vcc
    v_cmp_eq_u32 vcc, s79, v215
    s_and_b64 s[60:61], s[60:61], vcc
    s_cmp_lg_u64 s[60:61], -1
    s_cbranch_scc0 Lback_6
    s_sub_u32 s59, s59, 1
    s_cmp_lg_u32 s59, 0
    s_cbranch_scc1 Lspin_7
    s_branch Lback_6
Lslow_8:
    s_mov_b32 s59, 40000
Lspin_10:
    s_sleep 1
    s_mov_b32 s49, s83
    buffer_load_dword v219, v217, s[24:27], s49 offen sc0 sc1
    s_waitcnt vmcnt(0)
    v_cmp_eq_u32 vcc, s79, v219
    s_andn2_b32 s61, 0xff00, vcc_lo
    s_cbranch_scc0 Lback_9
    s_sub_u32 s59, s59, 1
    s_cmp_lg_u32 s59, 0
    s_cbranch_scc1 Lspin_10
    s_branch Lback_9
Lslow_11:
    s_mov_b32 s59, 40000
Lspin_13:
    s_sleep 1
    s_add_u32 s49, s71, 40960
    buffer_load_dword v223, v217, s[24:27], s49 offen sc0 sc1
    s_waitcnt vmcnt(0)
    v_cmp_eq_u32 vcc, s79, v223
    s_andn2_b32 s61, 7, vcc_lo
    s_cbranch_scc0 Lback_12
    s_sub_u32 s59, s59, 1
    s_cmp_lg_u32 s59, 0
    s_cbranch_scc1 Lspin_13
    s_branch Lback_12
Lslow_14:
    s_mov_b32 s59, 40000
Lspin_16:
    s_sleep 1
    s_add_u32 s49, s71, 49152
    buffer_load_dword v219, v217, s[24:27], s49 offen sc0 sc1
    s_waitcnt vmcnt(0)
    v_cmp_eq_u32 vcc, s79, v219
    s_andn2_b32 s61, 7, vcc_lo
    s_cbranch_scc0 Lback_15
    s_sub_u32 s59, s59, 1
    s_cmp_lg_u32 s59, 0
    s_cbranch_scc1 Lspin_16
    s_branch Lback_15
Lslow_17:
    s_mov_b32 s59, 40000
Lspin_19:
    s_sleep 1
    s_add_u32 s49, s71, 57344
    buffer_load_dword v219, v217, s[24:27], s49 offen sc0 sc1
    s_waitcnt vmcnt(0)
    v_cmp_eq_u32 vcc, s79, v219
    s_andn2_b32 s61, 7, vcc_lo
    s_cbranch_scc0 Lback_18
    s_sub_u32 s59, s59, 1
    s_cmp_lg_u32 s59, 0
    s_cbranch_scc1 Lspin_19
    s_branch Lback_18
Lslow_20:
    s_mov_b32 s59, 40000
Lspin_22:
    s_sleep 1
    s_add_u32 s49, s71, 24576
    buffer_load_dword v223, v217, s[24:27], s49 offen sc0 sc1
    s_waitcnt vmcnt(0)
    v_cmp_eq_u32 vcc, s79, v223
    s_andn2_b32 s61, 1, vcc_lo
    s_cbranch_scc0 Lback_21
    s_sub_u32 s59, s59, 1
    s_cmp_lg_u32 s59, 0
    s_cbranch_scc1 Lspin_22
    s_branch Lback_21
Lslow_23:
    s_mov_b32 s59, 40000
Lspin_25:
    s_sleep 1
    s_add_u32 s49, s71, 65536
    buffer_load_dword v219, v217, s[24:27], s49 offen sc0 sc1
    s_waitcnt vmcnt(0)
    v_cmp_eq_u32 vcc, s79, v219
    s_andn2_b32 s61, 7, vcc_lo
    s_cbranch_scc0 Lback_24
    s_sub_u32 s59, s59, 1
    s_cmp_lg_u32 s59, 0
    s_cbranch_scc1 Lspin_25
    s_branch Lback_24
Lslow_29:
    s_mov_b32 s59, 40000
Lspin_31:
    s_sleep 1
    s_mov_b32 s49, s83
    buffer_load_dword v249, v247, s[24:27], s49 offen sc0 sc1
    s_waitcnt vmcnt(0)
    v_cmp_eq_u32 vcc, s79, v249
    s_andn2_b32 s61, 0xff, vcc_lo
    s_cbranch_scc0 Lback_30
    s_sub_u32 s59, s59, 1
    s_cmp_lg_u32 s59, 0
    s_cbranch_scc1 Lspin_31
    s_branch Lback_30
Lslow_32:
    s_mov_b32 s59, 40000
Lspin_34:
    s_sleep 1
    s_mov_b32 s49, 0
    buffer_load_dwordx4 a[52:55], v250, s[24:27], s49 offen offset:0 sc0 sc1
    buffer_load_dwordx4 a[56:59], v250, s[24:27], s49 offen offset:256 sc0 sc1
    buffer_load_dwordx4 a[60:63], v250, s[24:27], s49 offen offset:512 sc0 sc1
    buffer_load_dwordx4 a[64:67], v250, s[24:27], s49 offen offset:768 sc0 sc1
    s_waitcnt vmcnt(0)
    v_accvgpr_read_b32 v255, a53
    v_cmp_eq_u32 s[60:61], s79, v255
    v_accvgpr_read_b32 v255, a55
    v_cmp_eq_u32 vcc, s79, v255
    s_and_b64 s[60:61], s[60:61], vcc
    v_accvgpr_read_b32 v255, a57
    v_cmp_eq_u32 vcc, s79, v255
    s_and_b64 s[60:61], s[60:61], vcc
    v_accvgpr_read_b32 v255, a59
    v_cmp_eq_u32 vcc, s79, v255
    s_and_b64 s[60:61], s[60:61], vcc
    v_accvgpr_read_b32 v255, a61
    v_cmp_eq_u32 vcc, s79, v255
    s_and_b64 s[60:61], s[60:61], vcc
    v_accvgpr_read_b32 v255, a63
    v_cmp_eq_u32 vcc, s79, v255
    s_and_b64 s[60:61], s[60:61], vcc
    v_accvgpr_read_b32 v255, a65
    v_cmp_eq_u32 vcc, s79, v255
    s_and_b64 s[60:61], s[60:61], vcc
    v_accvgpr_read_b32 v255, a67
    v_cmp_eq_u32 vcc, s79, v255
    s_and_b64 s[60:61], s[60:61], vcc
    s_cmp_lg_u64 s[60:61], -1
    s_cbranch_scc0 Lback_33
    s_sub_u32 s59, s59, 1
    s_cmp_lg_u32 s59, 0
    s_cbranch_scc1 Lspin_34
    s_branch Lback_33
Lslow_35:
    s_mov_b32 s59, 40000
Lspin_37:
    s_sleep 1
    s_add_u32 s49, s72, 32768
    buffer_load_dword v231, v223, s[24:27], s49 offen sc0 sc1
    s_waitcnt vmcnt(0)
    v_cmp_eq_u32 vcc, s79, v231
    s_andn2_b32 s61, s71, vcc_lo
    s_cbranch_scc0 Lback_36
    s_sub_u32 s59, s59, 1
    s_cmp_lg_u32 s59, 0
    s_cbranch_scc1 Lspin_37
    s_branch Lback_36
Lslow_38:
    s_mov_b32 s59, 40000
Lspin_40:
    s_sleep 1
    s_mov_b32 s49, s81
    buffer_load_dword v249, v247, s[24:27], s49 offen sc0 sc1
    s_waitcnt vmcnt(0)
    v_cmp_eq_u32 vcc, s79, v249
    s_andn2_b32 s61, 0xff, vcc_lo
    s_cbranch_scc0 Lback_39
    s_sub_u32 s59, s59, 1
    s_cmp_lg_u32 s59, 0
    s_cbranch_scc1 Lspin_40
    s_branch Lback_39
Lslow_42:
    s_mov_b32 s59, 40000
Lspin_44:
    s_sleep 1
    s_add_u32 s49, s72, 24576
    buffer_load_dword v219, v223, s[24:27], s49 offen sc0 sc1
    s_waitcnt vmcnt(0)
    v_cmp_eq_u32 vcc, s79, v219
    s_andn2_b32 s61, 0x01010101, vcc_lo
    s_cbranch_scc0 Lback_43
    s_sub_u32 s59, s59, 1
    s_cmp_lg_u32 s59, 0
    s_cbranch_scc1 Lspin_44
    s_branch Lback_43
Lslow_45:
    s_mov_b32 s59, 40000
Lspin_47:
    s_sleep 1
    s_mov_b32 s49, s9
    buffer_load_dword v219, v217, s[24:27], s49 offen sc0 sc1
    s_waitcnt vmcnt(0)
    v_cmp_eq_u32 vcc, s79, v219
    s_andn2_b32 s61, 0xf, vcc_lo
    s_cbranch_scc0 Lback_46
    s_sub_u32 s59, s59, 1
    s_cmp_lg_u32 s59, 0
    s_cbranch_scc1 Lspin_47
    s_branch Lback_46
L_code_end:
    s_endpgm
.section .rodata,"a"
.p2align 6
.amdhsa_kernel parallel_sum__linear_attn_block__glu_gated_swiglu__prompt_kernel
  .amdhsa_next_free_vgpr 512
  .amdhsa_next_free_sgpr 102
  .amdhsa_accum_offset 256
  .amdhsa_group_segment_fixed_size 0
  .amdhsa_kernarg_size 80
  .amdhsa_user_sgpr_count 2
  .amdhsa_user_sgpr_kernarg_segment_ptr 1
  .amdhsa_system_sgpr_workgroup_id_x 1
.end_amdhsa_kernel
```
